```python
import torch

def _softmax(x, axis=-1):
    return torch.softmax(x, dim=axis)
def _gelu(x):
    return torch.nn.functional.gelu(x, approximate="tanh")
def _silu(x):
    return torch.nn.functional.silu(x)
def _sigmoid(x):
    return torch.sigmoid(x)
def _layernorm(x, axis=-1, eps=1e-5):
    m = x.mean(dim=axis, keepdim=True)
    v = x.var(dim=axis, keepdim=True, unbiased=False)
    return (x - m) / torch.sqrt(v + eps)
def _scatter_add(tgt, idx, src, axis=0):
    return tgt.clone().index_add_(axis, idx, src)
def _segment_sum(src, seg, n):
    out = torch.zeros((n,) + src.shape[1:], dtype=src.dtype)
    return out.index_add_(0, seg, src)
def _pad(x, pw):
    flat = tuple(v for pair in reversed(pw) for v in pair)
    return torch.nn.functional.pad(x, flat)

kernel_name = 'interleave_layers__sliding_block__glu_gated_geglu__prompt'

def setup_inputs():

    _w = (lambda a: (lambda t: t.to(torch.bfloat16) if t.is_floating_point() else t)(torch.as_tensor(a)))
    def _A_setup():
        B, S, D = 1, 2048, 640
        return {
            "x": _w((lambda *s: torch.randn(*s, dtype=torch.bfloat16) * 0.05)(B, S, D)),
            "wqkv": _w((lambda *s: torch.randn(*s, dtype=torch.bfloat16) * 0.05)(D, 3 * D)),
            "wo": _w((lambda *s: torch.randn(*s, dtype=torch.bfloat16) * 0.05)(D, D)),
        }
    _A_in = _A_setup()

    def _B_setup():
        B, S, Dm, Df = 1, 2048, 640, 1536
        return {
            "x": _w((lambda *s: torch.randn(*s, dtype=torch.bfloat16) * 0.05)(B, S, Dm)),
            "w_gate": _w((lambda *s: torch.randn(*s, dtype=torch.bfloat16) * 0.8)(Dm, Df) * (Dm ** -0.5)),
            "w_up": _w((lambda *s: torch.randn(*s, dtype=torch.bfloat16) * 0.8)(Dm, Df) * (Dm ** -0.5)),
            "w_down": _w((lambda *s: torch.randn(*s, dtype=torch.bfloat16) * 0.8)(Df, Dm) * (Df ** -0.5)),
        }
    _B_in = _B_setup()

    return {
        "A_x": _A_in["x"],
        "A_wqkv": _A_in["wqkv"],
        "A_wo": _A_in["wo"],
        "B_x": _B_in["x"],
        "B_w_gate": _B_in["w_gate"],
        "B_w_up": _B_in["w_up"],
        "B_w_down": _B_in["w_down"],
    }

def reference(A_x, A_wqkv, A_wo, B_x, B_w_gate, B_w_up, B_w_down):
    def _A_ref(x, wqkv, wo):
        B, S, D = x.shape
        H = 32; Dh = D // H; W = 256
        qkv = (lambda x, *d: x.permute(*d))((x @ wqkv).reshape(B, S, 3, H, Dh), 2, 0, 3, 1, 4)
        q, k, v = qkv[0], qkv[1], qkv[2]
        scores = torch.einsum("bhqd,bhkd->bhqk", q, k) * (Dh ** -0.5)
        idx = torch.arange(S)
        mask = (idx[:, None] - idx[None, :] >= 0) & (idx[:, None] - idx[None, :] < W)
        scores = torch.where(mask[None, None], scores, -1e9)
        p = _softmax(scores, axis=-1)
        o = torch.einsum("bhqk,bhkd->bhqd", p, v)
        return (lambda x, *d: x.permute(*d))(o, 0, 2, 1, 3).reshape(B, S, D) @ wo

    def _B_ref(x, w_gate, w_up, w_down):
        g = torch.einsum("bsd,df->bsf", x, w_gate)
        u = torch.einsum("bsd,df->bsf", x, w_up)
        h = _gelu(g) * u
        return torch.einsum("bsf,fd->bsd", h, w_down)

    x = A_x
    x = x + _A_ref(_layernorm(x, axis=-1), A_wqkv, A_wo)
    x = x + _B_ref(_layernorm(x, axis=-1), B_w_gate, B_w_up, B_w_down)
    x = x + _A_ref(_layernorm(x, axis=-1), A_wqkv, A_wo)
    x = x + _B_ref(_layernorm(x, axis=-1), B_w_gate, B_w_up, B_w_down)
    return x
```

```asm
; @launch grid=(256,1,1) block=(256,1,1) lds=163840
.amdgcn_target "amdgcn-amd-amdhsa--gfx950"
.text
.globl interleave_layers__sliding_block__glu_gated_geglu__prompt_kernel
.p2align 8
.type interleave_layers__sliding_block__glu_gated_geglu__prompt_kernel,@function
interleave_layers__sliding_block__glu_gated_geglu__prompt_kernel:
s_cmp_ge_u32 s2, 256
s_cbranch_scc1 M_end
s_load_dwordx16 s[64:79], s[0:1], 0
s_load_dwordx4 s[80:83], s[0:1], 64
s_getpc_b64 s[60:61]
A_pc:
v_and_b32 v40, 63, v0
v_lshlrev_b32 v1, 4, v40
v_lshlrev_b32 v44, 5, v0
s_lshr_b32 s52, s2, 3
s_mul_i32 s52, s52, (M_hot_end-C_pc+4095)/4096*128
s_add_u32 s52, s52, C_pc-A_pc
v_and_b32 v45, 0xffffff80, v44
v_min_u32 v45, C_pc-A_pc, v45
global_load_dword v235, v45, s[60:61]
v_lshrrev_b32 v46, 6, v0
s_nop 0
v_readfirstlane_b32 s18, v46
v_lshrrev_b32 v44, 1, v44
v_min_u32 v44, (M_hot_end-C_pc+4095)/4096*128-128, v44
v_add_u32 v44, s52, v44
v_min_u32 v44, M_hot_end-A_pc, v44
global_load_dword v235, v44, s[60:61]
s_and_b32 s16, s2, 7
s_lshl_b32 s16, s16, 1
s_lshr_b32 s17, s2, 7
s_add_u32 s16, s16, s17
s_bfe_u32 s17, s2, 0x40003
v_lshlrev_b32 v0, 7, v40
v_lshrrev_b32 v41, 4, v40
v_and_b32 v42, 15, v40
v_lshlrev_b32 v43, 4, v42
v_mov_b32 v44, 0x40000000
v_mov_b32 v12, 0
v_mov_b32 v14, 0
s_mul_i32 s84, s16, 40
s_lshl_b32 s85, s16, 4
s_add_u32 s85, s85, s17
v_mul_u32_u24 v45, 52, v42
v_lshrrev_b32 v45, 8, v45
v_mul_u32_u24 v45, 1200, v45
v_add_u32 v45, v45, v43
v_cmp_gt_u32 s[54:55], 15, v42
v_mul_u32_u24 v46, 3840, v41
v_add_u32 v45, v45, v46
v_cndmask_b32 v45, v44, v45, s[54:55]
v_lshrrev_b32 v47, 5, v40
v_mul_u32_u24 v47, 768, v47
v_add_u32 v47, v47, v1
v_and_b32 v48, 16, v40
v_lshl_add_u32 v48, v48, 26, v47
s_lshl_b32 s22, s16, 2
s_add_u32 s22, s22, s18
s_mul_i32 s92, s18, 8192
s_add_u32 s92, s92, 40960
s_lshl_b32 s60, s85, 2
s_add_u32 s60, s60, s18
s_mul_i32 s60, s60, 2560
s_lshl_b32 s52, s18, 2
s_add_u32 s53, s52, s84
s_mul_i32 s53, s53, 3840
s_mul_i32 s54, s17, 80
s_add_u32 s53, s53, s54
s_lshl_b32 s52, s18, 10
s_add_u32 m0, s52, 108544
s_cmp_eq_u32 s18, 3
s_cselect_b32 s52, s2, 1
s_cmp_eq_u32 s52, 0
s_cselect_b32 s98, -1, 0
s_cselect_b32 s99, 0xffff, 0
v_mul_u32_u24 v52, 4352, v40
s_cmp_lt_u32 s18, 2
s_cselect_b64 s[54:55], -1, 0
s_mov_b32 s52, 54525952
s_waitcnt lgkmcnt(0)
s_mov_b32 s56, s66
s_and_b32 s57, s67, 0xffff
s_mov_b32 s58, 2457600
s_mov_b32 s59, 0x20000
s_mov_b32 s4, s82
s_and_b32 s5, s83, 0xffff
s_mov_b32 s6, 268435456
s_mov_b32 s7, 0x20000
buffer_load_dwordx4 v45, s[56:59], s53 offen nt lds
s_add_u32 m0, m0, 4096
s_add_u32 s53, s53, 61440
buffer_load_dwordx4 v45, s[56:59], s53 offen nt lds
s_add_u32 m0, m0, 4096
s_add_u32 s53, s53, 61440
s_mov_b64 exec, s[54:55]
buffer_load_dwordx4 v45, s[56:59], s53 offen nt lds
s_mov_b64 exec, s[98:99]
s_mov_b32 s3, s98
buffer_store_dword v12, v52, s[4:7], s52 offen sc1
s_mov_b64 exec, -1
s_mov_b32 s8, s64
s_and_b32 s9, s65, 0xffff
s_mov_b32 s10, 2621440
s_mov_b32 s11, 0x20000
buffer_load_dwordx4 v[144:147], v47, s[8:11], s60 offen
buffer_load_dwordx4 v[148:151], v47, s[8:11], s60 offen offset:512
buffer_load_dwordx4 v[152:155], v48, s[8:11], s60 offen offset:1024
s_mov_b32 s12, s78
s_and_b32 s13, s79, 0xffff
s_mov_b32 s14, 2621440
s_mov_b32 s15, 0x20000
s_and_b32 s20, s17, 7
s_lshr_b32 s21, s17, 3
s_lshl_b32 s86, s16, 1
s_add_u32 s86, s86, s21
s_lshl_b32 s87, s86, 2
s_add_u32 s87, s87, s18
s_mul_i32 s46, s87, 20480
s_mul_i32 s52, s20, 160
s_add_u32 s46, s46, s52
v_mul_u32_u24 v53, 1280, v42
v_lshl_add_u32 v54, v41, 3, v53
v_lshl_add_u32 v53, v41, 4, v53
v_add_u32 v2, 0x10000, v1
v_add_u32 v3, 0x20000, v1
v_lshrrev_b32 v66, 5, v40
v_and_b32 v67, 31, v40
v_and_b32 v68, 1, v41
v_lshl_add_u32 v4, v41, 9, v43
v_lshl_add_u32 v5, v66, 9, v43
v_lshl_add_u32 v5, v68, 3, v5
v_add_u32 v5, 4096, v5
v_lshlrev_b32 v69, 2, v42
v_lshl_add_u32 v7, v66, 6, v69
v_lshl_add_u32 v6, v68, 10, v7
v_lshlrev_b32 v8, 4, v41
v_add_u32 v8, 161280, v8
v_lshlrev_b32 v67, 4, v67
v_lshl_add_u32 v11, v66, 3, v67
v_mov_b32 v13, 1
s_mov_b32 s44, 0
s_mov_b32 s45, -1
s_mul_i32 s52, s18, 3200
v_add_u32 v9, s52, v1
v_and_b32 v69, v66, v68
v_lshlrev_b32 v69, 6, v69
v_xor_b32 v39, v69, v4
v_and_b32 v70, 3, v40
v_and_b32 v71, 1, v70
v_lshrrev_b32 v72, 1, v70
v_lshrrev_b32 v73, 2, v42
v_lshl_add_u32 v74, v66, 2, v73
v_lshlrev_b32 v74, 4, v74
v_lshl_add_u32 v74, v72, 3, v74
v_mul_u32_u24 v75, 576, v71
v_xor_b32 v75, v75, v74
v_cmp_eq_u32 s[54:55], 1, v68
v_add_u32 v75, 1024, v75
v_add_u32 v76, 2688, v74
v_cndmask_b32 v75, v75, v76, s[54:55]
v_add_u32 v10, s52, v75
v_lshlrev_b32 v73, 8, v73
v_mov_b32 v77, 0x3f803f80
v_lshlrev_b32 v78, 2, v40
v_and_b32 v79, 1, v40
v_lshlrev_b32 v79, 3, v79
v_xor_b32 v79, s17, v79
v_mul_u32_u24 v79, 4352, v79
v_add_u32 v37, 54665216, v79
s_lshl_b32 s52, s16, 7
s_add_u32 s23, s52, 8192
s_lshl_b32 s53, s17, 2
s_add_u32 s49, s23, s53
s_mul_i32 s25, s85, 4352
s_add_u32 s25, s25, 55574528
s_mul_i32 s28, s17, 153600
s_add_u32 s28, s28, 1572864
s_mul_i32 s29, s17, 245760
s_add_u32 s29, s29, 4194304
s_mul_i32 s88, s16, 5
s_cmp_eq_u32 s18, 1
s_cselect_b32 s52, s25, s49
s_cselect_b32 exec_hi, 1, 0
s_mov_b32 exec_lo, 1
buffer_store_dword v12, v7, s[4:7], s52 offen sc1
s_mov_b64 exec, -1
s_cmp_eq_u32 s18, 0
s_cselect_b64 s[98:99], 0, -1
s_max_u32 s93, s18, 1
s_sub_u32 s93, s93, 1
v_lshrrev_b32 v50, 2, v40
v_mul_u32_u24 v50, 3072, v50
v_lshl_add_u32 v50, v70, 4, v50
v_cmp_gt_u32 s[54:55], 10, v42
v_mul_u32_u24 v51, 1280, v41
v_add_u32 v51, v51, v43
v_cndmask_b32 v51, v44, v51, s[54:55]
s_mul_i32 s65, s93, 12288
s_add_u32 s65, s65, 118784
s_mov_b32 s52, 2963300432
s_mov_b32 s53, 3098044504
s_cmp_eq_u32 s18, 1
s_cselect_b32 s52, 3902324848, s52
s_cselect_b32 s53, 4042278944, s53
s_cmp_eq_u32 s18, 2
s_cselect_b32 s52, 3637020792, s52
s_cselect_b32 s53, 3771764864, s53
s_cmp_eq_u32 s18, 3
s_cselect_b32 s52, 940582912, s52
s_cselect_b32 s53, 1075326984, s53
v_cmp_eq_u32 s[54:55], 1, v68
v_mov_b32 v125, s52
v_mov_b32 v126, s53
v_cndmask_b32 v125, v125, v126, s[54:55]
v_lshlrev_b32 v126, 3, v70
v_lshrrev_b32 v125, v126, v125
v_and_b32 v125, 0xff, v125
v_add_u32 v125, v125, v73
v_add_u32 v126, 108544, v125
v_lshl_add_u32 v125, v66, 11, v126
v_cndmask_b32 v127, v77, 0, s[44:45]
s_lshl_b32 s52, s18, 11
s_mul_i32 s53, s18, 40960
s_sub_u32 s53, s53, 10240
s_cmp_lt_u32 s18, 2
s_cselect_b32 s52, s52, s53
s_mov_b32 s53, 2048
s_cselect_b32 s53, 3584, s53
s_add_u32 s52, s52, s28
s_cmp_eq_u32 s18, 1
s_cselect_b32 s54, 1, 0
v_and_b32 v124, s54, v68
v_lshl_add_u32 v131, v68, 10, v43
v_lshrrev_b32 v130, 3, v42
v_and_b32 v130, v130, v124
v_lshl_add_u32 v131, v130, 30, v131
v_sub_u32 v124, 8, v124
v_add_u32 v128, s88, v66
v_lshrrev_b32 v129, 2, v128
v_mul_u32_u24 v129, s53, v129
v_and_b32 v130, 3, v128
v_lshl_add_u32 v129, v130, v124, v129
v_add3_u32 v120, v129, v131, s52
v_add_u32 v128, 2, v128
v_lshrrev_b32 v129, 2, v128
v_mul_u32_u24 v129, s53, v129
v_and_b32 v130, 3, v128
v_lshl_add_u32 v129, v130, v124, v129
v_add3_u32 v121, v129, v131, s52
v_add_u32 v128, 2, v128
v_lshrrev_b32 v129, 2, v128
v_mul_u32_u24 v129, s53, v129
v_and_b32 v130, 3, v128
v_lshl_add_u32 v129, v130, v124, v129
v_add3_u32 v122, v129, v131, s52
v_add_u32 v128, 2, v128
v_cndmask_b32 v122, v122, v44, s[44:45]
s_lshl_b32 s54, s17, 4
s_add_u32 s54, s54, s16
s_lshl_b32 s54, s54, 9
s_lshl_b32 s55, s18, 7
s_add_u32 s54, s54, s55
s_add_u32 s54, s54, 147456
v_add_u32 v123, s54, v78
v_cndmask_b32 v123, v123, v44, s[44:45]
v_mov_b32 v130, 0
v_mov_b32 v140, 0
v_mov_b32 v141, 0
s_lshr_b32 s54, s85, 1
s_lshl_b32 s54, s54, 10
s_and_b32 s55, s17, 1
s_lshl_b32 s55, s55, 2
s_add_u32 s55, s55, s18
s_lshl_b32 s55, s55, 3
s_add_u32 s54, s54, s55
s_add_u32 s54, s54, 475136
v_bfe_u32 v142, v40, 2, 3
v_lshlrev_b32 v142, 7, v142
v_lshl_add_u32 v142, v71, 6, v142
v_lshl_add_u32 v142, v66, 2, v142
v_lshl_add_u32 v142, v72, 30, v142
v_add_u32 v142, s54, v142
s_getreg_b32 s55, hwreg(HW_REG_XCC_ID, 0, 4)
s_mul_i32 s56, s55, s55
s_lshl_b32 s56, s56, 16
s_lshl_b32 s55, s55, 8
s_add_u32 s55, s55, s56
s_add_u32 s89, s55, 1
v_mov_b32 v136, 1
v_writelane_b32 v136, s89, 1
s_mul_i32 s55, s17, 4352
s_add_u32 s55, s55, 54595584
v_mov_b32 v137, s55
s_mul_i32 s55, s16, 4352
s_add_u32 s55, s55, 54525952
v_writelane_b32 v137, s55, 1
v_writelane_b32 v37, s55, 2
s_lshl_b32 s52, s20, 2
s_add_u32 s52, s52, s18
s_mul_i32 s30, s52, 25600
s_add_u32 s30, s30, 8388608
s_mul_i32 s31, s52, 61440
s_add_u32 s31, s31, 9306112
s_mul_i32 s52, s20, 0
s_add_u32 s30, s30, s52
s_add_u32 s31, s31, s52
s_and_b32 s47, s22, 7
s_and_b32 s48, s86, 3
s_mul_i32 s52, s22, 40960
s_add_u32 s32, s52, 0
s_mul_i32 s53, s17, 2560
s_add_u32 s38, s52, s53
s_add_u32 s38, s38, 21889024
s_lshl_b32 s52, s22, 11
s_add_u32 s33, s52, 475136
s_mul_i32 s52, s22, 102400
s_mul_i32 s53, s17, 6400
s_add_u32 s57, s52, s53
s_add_u32 s40, s57, 27131904
s_lshl_b32 s52, s86, 1
s_mul_i32 s53, s52, 40960
s_mul_i32 s54, s18, 10240
s_add_u32 s39, s53, s54
s_add_u32 s39, s39, 21889024
s_mul_i32 s53, s52, 102400
s_mul_i32 s54, s18, 25600
s_add_u32 s41, s53, s54
s_add_u32 s41, s41, 27131904
s_lshr_b32 s53, s87, 1
s_mul_i32 s53, s53, 40960
s_mul_i32 s54, s20, 5120
s_add_u32 s53, s53, s54
s_and_b32 s54, s18, 1
s_lshl_b32 s54, s54, 8
s_add_u32 s53, s53, s54
s_add_u32 s34, s53, 0
s_lshl_b32 s53, s87, 3
s_add_u32 s53, s53, s20
s_lshl_b32 s53, s53, 7
s_add_u32 s35, s53, 475136
s_add_u32 s36, s57, 40239104
s_mul_i32 s56, s85, 6400
s_add_u32 s56, s56, 1310720
s_sub_u32 s53, s36, 409600
s_sub_u32 s55, s25, 69632
s_cmp_ge_u32 s16, 1
s_cselect_b32 s37, s53, s56
s_cselect_b32 s55, s55, s25
s_cselect_b32 s42, 1, 0
s_cselect_b32 s26, 8, 0
v_writelane_b32 v37, s55, 3
s_sub_u32 s53, s36, 819200
s_sub_u32 s55, s25, 139264
s_cmp_ge_u32 s16, 2
s_cselect_b32 s79, s53, s56
s_cselect_b32 s55, s55, s25
s_cselect_b32 s43, 1, 0
s_cselect_b32 s26, 24, s26
v_writelane_b32 v37, s55, 4
s_mov_b32 s27, 0
s_mov_b32 s52, s93
v_lshl_add_u32 v165, v70, 1, v68
v_lshrrev_b32 v166, 2, v73
v_lshl_add_u32 v165, v165, 3, v166
v_mul_u32_u24 v166, 3072, v66
v_add3_u32 v165, v165, v166, s65
s_mul_i32 s53, s52, 81920
s_add_u32 s53, s53, s29
s_lshl_b32 s54, s17, 4
s_add_u32 s54, s54, s16
s_mul_i32 s54, s54, 768
s_lshl_b32 s55, s52, 8
s_add_u32 s54, s54, s55
s_add_u32 s54, s54, 278528
s_mul_i32 s60, s20, 102400
s_add_u32 s60, s60, 8388608
s_mul_i32 s61, s20, 245760
s_add_u32 s61, s61, 9306112
s_lshl_b32 s62, s21, 1
s_add_u32 s62, s62, s88
s_add_u32 s63, s88, 4
s_mul_i32 s64, s86, 6
s_mul_i32 s66, s52, 3
s_add_u32 s64, s64, s66
s_sub_u32 s64, s64, 3
s_add_u32 s66, s64, 2
s_add_u32 s67, s65, 6144
s_cmp_eq_u32 s52, 0
s_cselect_b32 s60, s60, s61
s_cselect_b32 s62, s62, s64
s_cselect_b32 s63, s63, s66
v_lshrrev_b32 v167, 1, v41
v_lshl_add_u32 v167, v167, 3, v68
v_lshl_add_u32 v167, v70, 1, v167
v_lshl_add_u32 v167, v167, 3, v73
v_add_u32 v167, s67, v167
v_min_u32 v168, 2, v41
v_lshl_add_u32 v169, v168, 11, v73
v_lshl_add_u32 v169, v70, 3, v169
v_add_u32 v169, s67, v169
v_lshl_add_u32 v171, v66, 10, v67
v_lshl_add_u32 v170, v41, 10, v43
v_add_u32 v221, s54, v78
s_add_u32 s57, s88, 0
s_lshr_b32 s58, s57, 2
s_lshl_b32 s58, s58, 12
s_and_b32 s57, s57, 3
s_lshl_b32 s57, s57, 8
s_add_u32 s57, s57, s58
s_add_u32 s57, s57, s53
v_add_u32 v212, s57, v170
s_add_u32 s57, s88, 1
s_lshr_b32 s58, s57, 2
s_lshl_b32 s58, s58, 12
s_and_b32 s57, s57, 3
s_lshl_b32 s57, s57, 8
s_add_u32 s57, s57, s58
s_add_u32 s57, s57, s53
v_add_u32 v213, s57, v170
s_add_u32 s57, s88, 2
s_lshr_b32 s58, s57, 2
s_lshl_b32 s58, s58, 12
s_and_b32 s57, s57, 3
s_lshl_b32 s57, s57, 8
s_add_u32 s57, s57, s58
s_add_u32 s57, s57, s53
v_add_u32 v214, s57, v170
s_add_u32 s57, s88, 3
s_lshr_b32 s58, s57, 2
s_lshl_b32 s58, s58, 12
s_and_b32 s57, s57, 3
s_lshl_b32 s57, s57, 8
s_add_u32 s57, s57, s58
s_add_u32 s57, s57, s53
v_add_u32 v215, s57, v170
s_add_u32 s57, s88, 4
s_lshr_b32 s58, s57, 2
s_lshl_b32 s58, s58, 12
s_and_b32 s57, s57, 3
s_lshl_b32 s57, s57, 8
s_add_u32 s57, s57, s58
s_add_u32 s57, s57, s53
v_add_u32 v216, s57, v170
s_add_u32 s57, s62, 0
s_lshr_b32 s58, s57, 2
s_mul_i32 s58, s58, 5120
s_and_b32 s57, s57, 3
s_lshl_b32 s57, s57, 8
s_add_u32 s57, s57, s58
s_add_u32 s57, s57, s60
v_add_u32 v217, s57, v170
v_mov_b32 v220, s57
s_add_u32 s57, s62, 1
s_lshr_b32 s58, s57, 2
s_mul_i32 s58, s58, 5120
s_and_b32 s57, s57, 3
s_lshl_b32 s57, s57, 8
s_add_u32 s57, s57, s58
s_add_u32 s57, s57, s60
v_add_u32 v218, s57, v170
v_cmp_eq_u32 s[58:59], 1, v168
v_mov_b32 v166, s57
s_nop 0
v_cndmask_b32 v220, v220, v166, s[58:59]
s_mov_b32 s57, s63
s_lshr_b32 s58, s57, 2
s_mul_i32 s58, s58, 5120
s_and_b32 s57, s57, 3
s_lshl_b32 s57, s57, 8
s_add_u32 s57, s57, s58
s_add_u32 s57, s57, s60
v_add_u32 v219, s57, v170
v_cmp_eq_u32 s[58:59], 2, v168
v_mov_b32 v166, s57
s_nop 0
v_cndmask_b32 v220, v220, v166, s[58:59]
v_add_u32 v220, v220, v43
v_add_u32 v220, 4096, v220
v_cndmask_b32 v212, v44, v212, s[98:99]
v_cndmask_b32 v213, v44, v213, s[98:99]
v_cndmask_b32 v214, v44, v214, s[98:99]
v_cndmask_b32 v215, v44, v215, s[98:99]
v_cndmask_b32 v216, v44, v216, s[98:99]
v_cndmask_b32 v217, v44, v217, s[98:99]
v_cndmask_b32 v218, v44, v218, s[98:99]
v_cndmask_b32 v219, v44, v219, s[98:99]
v_cndmask_b32 v220, v44, v220, s[98:99]
v_cndmask_b32 v221, v44, v221, s[98:99]
s_mul_i32 s60, s22, 40960
s_add_u32 s61, s60, 20480
s_mul_i32 s62, s18, 12288
s_add_u32 s62, s62, 106496
v_xor_b32 v131, v42, v41
v_mul_u32_u24 v129, 1280, v41
v_lshlrev_b32 v138, 4, v43
v_xor_b32 v139, 0, v131
v_lshl_add_u32 v139, v139, 4, v129
v_add_u32 v46, 0, v139
v_xor_b32 v139, 4, v131
v_lshl_add_u32 v139, v139, 4, v129
v_add_u32 v47, 5120, v139
v_xor_b32 v139, 8, v131
v_lshl_add_u32 v139, v139, 4, v129
v_add_u32 v48, 10240, v139
v_xor_b32 v139, 12, v131
v_lshl_add_u32 v139, v139, 4, v129
v_add_u32 v49, 15360, v139
v_xor_b32 v139, 0, v131
v_lshl_add_u32 v139, v139, 4, v138
v_add_u32 v192, s92, v139
v_add_u32 v196, s62, v139
v_xor_b32 v139, 4, v131
v_lshl_add_u32 v139, v139, 4, v138
v_add_u32 v193, s92, v139
v_add_u32 v197, s62, v139
v_xor_b32 v139, 8, v131
v_lshl_add_u32 v139, v139, 4, v138
v_add_u32 v194, s92, v139
v_add_u32 v198, s62, v139
v_xor_b32 v139, 12, v131
v_lshl_add_u32 v139, v139, 4, v138
v_add_u32 v195, s92, v139
v_add_u32 v199, s62, v139
s_mul_i32 s53, s21, 20
s_add_u32 s53, s53, s84
s_mul_i32 s54, s86, 48
s_mul_i32 s55, s93, 24
s_add_u32 s54, s54, s55
s_sub_u32 s54, s54, 24
s_add_u32 s55, s84, 16
s_add_u32 s67, s54, 16
s_cmp_eq_u32 s93, 0
s_cselect_b32 s53, s53, s54
s_cselect_b32 s67, s55, s67
s_cselect_b32 s64, 20, 4
s_cselect_b32 s56, s68, s76
s_cselect_b32 s57, s69, s77
s_mov_b32 s58, 1966080
s_cselect_b32 s58, 819200, s58
s_and_b32 s57, s57, 0xffff
s_mov_b32 s59, 0x20000
s_add_u32 m0, s65, 6144
s_mul_i32 s55, s20, 160
s_mul_i32 s53, s53, 1280
s_add_u32 s53, s53, s55
s_mul_i32 s67, s67, 1280
s_add_u32 s67, s67, s55
s_mul_i32 s64, s64, 1280
s_mov_b64 exec, s[98:99]
buffer_load_dwordx4 v51, s[56:59], s53 offen nt lds
s_add_u32 m0, m0, 1024
s_add_u32 s53, s53, 5120
buffer_load_dwordx4 v51, s[56:59], s53 offen nt lds
s_add_u32 m0, m0, 1024
s_add_u32 s53, s53, 5120
buffer_load_dwordx4 v51, s[56:59], s53 offen nt lds
s_add_u32 m0, m0, 1024
s_add_u32 s53, s53, 5120
buffer_load_dwordx4 v51, s[56:59], s53 offen nt lds
s_add_u32 m0, m0, 1024
s_add_u32 s53, s53, 5120
buffer_load_dwordx4 v51, s[56:59], s67 offen nt lds
s_add_u32 m0, m0, 1024
s_add_u32 s67, s67, s64
buffer_load_dwordx4 v51, s[56:59], s67 offen nt lds
s_add_u32 m0, m0, 1024
s_add_u32 s67, s67, s64
s_mov_b64 exec, -1
s_waitcnt vmcnt(10)
s_and_b32 exec_lo, s3, 1
s_mov_b32 exec_hi, 0
global_store_dword v12, v13, s[80:81] sc1
s_mov_b64 exec, -1
s_barrier
ds_read_b64_tr_b16 v[80:81], v125 offset:0
ds_read_b64_tr_b16 v[82:83], v125 offset:1024
ds_read_b64_tr_b16 v[84:85], v125 offset:4096
ds_read_b64_tr_b16 v[86:87], v125 offset:5120
ds_read_b64_tr_b16 v[88:89], v126 offset:8192
ds_read_b64_tr_b16 v[90:91], v126 offset:9216
s_waitcnt lgkmcnt(4)
buffer_store_dwordx4 v[80:83], v120, s[4:7], 0 offen sc1
s_waitcnt lgkmcnt(2)
buffer_store_dwordx4 v[84:87], v121, s[4:7], 0 offen sc1
s_waitcnt lgkmcnt(0)
buffer_store_dwordx4 v[88:91], v122, s[4:7], 0 offen sc1
v_dot2c_f32_bf16 v130, v80, v77
v_dot2c_f32_bf16 v130, v81, v77
v_dot2c_f32_bf16 v130, v82, v77
v_dot2c_f32_bf16 v130, v83, v77
v_dot2c_f32_bf16 v130, v84, v77
v_dot2c_f32_bf16 v130, v85, v77
v_dot2c_f32_bf16 v130, v86, v77
v_dot2c_f32_bf16 v130, v87, v77
v_dot2c_f32_bf16 v130, v88, v127
v_dot2c_f32_bf16 v130, v89, v127
v_dot2c_f32_bf16 v130, v90, v127
v_dot2c_f32_bf16 v130, v91, v127
s_nop 2
v_mov_b32 v131, v130
s_nop 1
v_permlane32_swap_b32 v130, v131
v_add_f32 v130, v130, v131
buffer_store_dword v130, v123, s[4:7], 0 offen sc1
s_waitcnt vmcnt(14)
v_dot2c_f32_bf16 v140, v144, v77
v_dot2c_f32_bf16 v141, v144, v144
v_dot2c_f32_bf16 v140, v145, v77
v_dot2c_f32_bf16 v141, v145, v145
v_dot2c_f32_bf16 v140, v146, v77
v_dot2c_f32_bf16 v141, v146, v146
v_dot2c_f32_bf16 v140, v147, v77
v_dot2c_f32_bf16 v141, v147, v147
s_waitcnt vmcnt(13)
v_dot2c_f32_bf16 v140, v148, v77
v_dot2c_f32_bf16 v141, v148, v148
v_dot2c_f32_bf16 v140, v149, v77
v_dot2c_f32_bf16 v141, v149, v149
v_dot2c_f32_bf16 v140, v150, v77
v_dot2c_f32_bf16 v141, v150, v150
v_dot2c_f32_bf16 v140, v151, v77
v_dot2c_f32_bf16 v141, v151, v151
s_waitcnt vmcnt(12)
v_dot2c_f32_bf16 v140, v152, v77
v_dot2c_f32_bf16 v141, v152, v152
v_dot2c_f32_bf16 v140, v153, v77
v_dot2c_f32_bf16 v141, v153, v153
v_dot2c_f32_bf16 v140, v154, v77
v_dot2c_f32_bf16 v141, v154, v154
v_dot2c_f32_bf16 v140, v155, v77
v_dot2c_f32_bf16 v141, v155, v155
v_cmp_eq_u32 s[54:55], 1, v71
s_nop 0
v_add_f32_dpp v140, v140, v140 quad_perm:[1,0,3,2] row_mask:0xf bank_mask:0xf
v_add_f32_dpp v141, v141, v141 quad_perm:[1,0,3,2] row_mask:0xf bank_mask:0xf
s_nop 0
v_add_f32_dpp v140, v140, v140 quad_perm:[2,3,0,1] row_mask:0xf bank_mask:0xf
v_add_f32_dpp v141, v141, v141 quad_perm:[2,3,0,1] row_mask:0xf bank_mask:0xf
v_cndmask_b32 v140, v140, v141, s[54:55]
buffer_store_dword v140, v142, s[4:7], 0 offen sc1
s_andn2_b64 exec, 1, s[98:99]
global_load_dword v15, v12, s[80:81] sc1
s_mov_b64 exec, -1
s_mul_i32 s66, s84, 3072
s_mul_i32 s54, s17, 192
s_add_u32 s66, s66, s54
s_lshl_b32 s54, s93, 6
s_add_u32 s66, s66, s54
s_add_u32 m0, s65, 0
s_mov_b32 s56, s72
s_and_b32 s57, s73, 0xffff
s_mov_b32 s58, 1966080
s_mov_b32 s59, 0x20000
s_mov_b32 s53, s66
s_mov_b64 exec, s[98:99]
buffer_load_dwordx4 v50, s[56:59], s53 offen nt lds
s_add_u32 m0, m0, 1024
s_add_u32 s53, s53, 49152
buffer_load_dwordx4 v50, s[56:59], s53 offen nt lds
s_add_u32 m0, m0, 1024
s_add_u32 s53, s53, 49152
s_mov_b32 exec_hi, 0
buffer_load_dwordx4 v50, s[56:59], s53 offen nt lds
s_add_u32 m0, m0, 1024
s_add_u32 s53, s53, 49152
s_mov_b32 s56, s74
s_and_b32 s57, s75, 0xffff
s_mov_b32 s58, 1966080
s_mov_b32 s59, 0x20000
s_mov_b32 s53, s66
s_mov_b64 exec, s[98:99]
buffer_load_dwordx4 v50, s[56:59], s53 offen nt lds
s_add_u32 m0, m0, 1024
s_add_u32 s53, s53, 49152
buffer_load_dwordx4 v50, s[56:59], s53 offen nt lds
s_add_u32 m0, m0, 1024
s_add_u32 s53, s53, 49152
s_mov_b32 exec_hi, 0
buffer_load_dwordx4 v50, s[56:59], s53 offen nt lds
s_add_u32 m0, m0, 1024
s_add_u32 s53, s53, 49152
s_mov_b64 exec, -1
s_waitcnt vmcnt(6)
v_cmp_eq_u32 s[54:55], 0, v15
s_nop 0
s_andn2_b32 s54, s54, s98
s_and_b32 s54, s54, 1
s_cbranch_scc1 A_spin
A_spun:
s_barrier
s_andn2_b64 exec, 3, s[98:99]
buffer_atomic_add v136, v137, s[4:7], 0 offen sc1
s_mov_b64 exec, -1
s_cmp_eq_u32 s18, 3
s_cselect_b32 s53, s16, 2
s_cmp_lt_u32 s53, 2
s_cbranch_scc1 A_inv
A_noinv:
s_getpc_b64 s[74:75]
C_pc:
s_lshr_b32 s52, s2, 3
s_lshl_b32 s52, s52, 2
s_add_u32 s52, s52, s18
s_mul_i32 s52, s52, 128
s_min_u32 s52, s52, M_hot_end-C_pc
s_add_u32 s74, s74, s52
s_addc_u32 s75, s75, 0
v_and_b32 v74, 0x70, v1
v_lshrrev_b32 v72, 3, v40
v_lshl_add_u32 v72, v72, 10, v74
s_lshl_b32 s77, s18, 7
s_lshl_b32 s76, s17, 13
s_add_u32 s76, s76, s77
s_add_u32 s76, s76, 147456
s_add_u32 s77, s77, 161280
v_bfrev_b32 v73, v41
v_lshrrev_b32 v73, 28, v73
v_add3_u32 v73, v73, v74, s77
v_mov_b32 v16, v53
v_mov_b32 v17, v54
s_add_u32 m0, s92, 0
s_nop 0
buffer_load_dwordx4 v46, s[8:11], s60 offen offset:0 lds
s_add_u32 m0, s92, 1024
s_nop 0
buffer_load_dwordx4 v47, s[8:11], s60 offen offset:0 lds
s_add_u32 m0, s92, 2048
s_nop 0
buffer_load_dwordx4 v48, s[8:11], s60 offen offset:0 lds
s_add_u32 m0, s92, 3072
s_nop 0
buffer_load_dwordx4 v49, s[8:11], s60 offen offset:0 lds
s_add_u32 m0, s92, 4096
s_nop 0
buffer_load_dwordx4 v46, s[8:11], s61 offen offset:0 lds
s_add_u32 m0, s92, 5120
s_nop 0
buffer_load_dwordx4 v47, s[8:11], s61 offen offset:0 lds
s_add_u32 m0, s92, 6144
s_nop 0
buffer_load_dwordx4 v48, s[8:11], s61 offen offset:0 lds
s_add_u32 m0, s92, 7168
s_nop 0
buffer_load_dwordx4 v49, s[8:11], s61 offen offset:0 lds
s_add_u32 m0, s92, 32512
s_nop 0
buffer_load_dwordx4 v46, s[8:11], s60 offen offset:256 lds
s_add_u32 m0, s92, 33536
s_nop 0
buffer_load_dwordx4 v47, s[8:11], s60 offen offset:256 lds
s_add_u32 m0, s92, 34560
s_nop 0
buffer_load_dwordx4 v48, s[8:11], s60 offen offset:256 lds
s_add_u32 m0, s92, 35584
s_nop 0
buffer_load_dwordx4 v49, s[8:11], s60 offen offset:256 lds
s_add_u32 m0, s92, 36608
s_nop 0
buffer_load_dwordx4 v46, s[8:11], s61 offen offset:256 lds
s_add_u32 m0, s92, 37632
s_nop 0
buffer_load_dwordx4 v47, s[8:11], s61 offen offset:256 lds
s_add_u32 m0, s92, 38656
s_nop 0
buffer_load_dwordx4 v48, s[8:11], s61 offen offset:256 lds
s_add_u32 m0, s92, 39680
s_nop 0
buffer_load_dwordx4 v49, s[8:11], s61 offen offset:256 lds
s_waitcnt vmcnt(17)
ds_read_b64_tr_b16 v[80:81], v165 offset:0
ds_read_b64_tr_b16 v[82:83], v165 offset:256
ds_read_b64_tr_b16 v[84:85], v165 offset:512
ds_read_b64_tr_b16 v[86:87], v165 offset:768
ds_read_b64_tr_b16 v[88:89], v165 offset:1024
ds_read_b64_tr_b16 v[90:91], v165 offset:1280
ds_read_b64_tr_b16 v[92:93], v165 offset:1536
ds_read_b64_tr_b16 v[94:95], v165 offset:1792
ds_read_b64_tr_b16 v[96:97], v165 offset:2048
ds_read_b64_tr_b16 v[98:99], v165 offset:2304
ds_read_b64_tr_b16 v[100:101], v167 offset:0
ds_read_b64_tr_b16 v[102:103], v167 offset:1024
ds_read_b64_tr_b16 v[200:201], v167 offset:2048
ds_read_b64_tr_b16 v[202:203], v167 offset:3072
ds_read_b64_tr_b16 v[204:205], v167 offset:4096
ds_read_b64_tr_b16 v[206:207], v167 offset:5120
ds_read_b64_tr_b16 v[240:241], v169 offset:128
ds_read_b64_tr_b16 v[242:243], v169 offset:1152
v_mov_b32 v244, 0
s_waitcnt lgkmcnt(15)
v_dot2c_f32_bf16 v244, v80, v77
v_dot2c_f32_bf16 v244, v81, v77
s_waitcnt lgkmcnt(15)
v_dot2c_f32_bf16 v244, v82, v77
v_dot2c_f32_bf16 v244, v83, v77
s_waitcnt lgkmcnt(15)
v_dot2c_f32_bf16 v244, v84, v77
v_dot2c_f32_bf16 v244, v85, v77
s_waitcnt lgkmcnt(14)
v_dot2c_f32_bf16 v244, v86, v77
v_dot2c_f32_bf16 v244, v87, v77
s_waitcnt lgkmcnt(13)
v_dot2c_f32_bf16 v244, v88, v77
v_dot2c_f32_bf16 v244, v89, v77
s_waitcnt lgkmcnt(12)
v_dot2c_f32_bf16 v244, v90, v77
v_dot2c_f32_bf16 v244, v91, v77
s_waitcnt lgkmcnt(11)
v_dot2c_f32_bf16 v244, v92, v77
v_dot2c_f32_bf16 v244, v93, v77
s_waitcnt lgkmcnt(10)
v_dot2c_f32_bf16 v244, v94, v77
v_dot2c_f32_bf16 v244, v95, v77
s_waitcnt lgkmcnt(9)
v_dot2c_f32_bf16 v244, v96, v77
v_dot2c_f32_bf16 v244, v97, v77
s_waitcnt lgkmcnt(8)
v_dot2c_f32_bf16 v244, v98, v77
v_dot2c_f32_bf16 v244, v99, v77
s_waitcnt lgkmcnt(0)
s_add_u32 m0, s62, 4294966784
s_nop 0
buffer_load_dwordx4 v46, s[8:11], s60 offen offset:512 lds
s_add_u32 m0, s62, 512
s_nop 0
buffer_load_dwordx4 v47, s[8:11], s60 offen offset:512 lds
s_add_u32 m0, s62, 1536
s_nop 0
buffer_load_dwordx4 v48, s[8:11], s60 offen offset:512 lds
s_add_u32 m0, s62, 2560
s_nop 0
buffer_load_dwordx4 v49, s[8:11], s60 offen offset:512 lds
s_add_u32 m0, s62, 3584
s_nop 0
buffer_load_dwordx4 v46, s[8:11], s61 offen offset:512 lds
s_add_u32 m0, s62, 4608
s_nop 0
buffer_load_dwordx4 v47, s[8:11], s61 offen offset:512 lds
s_add_u32 m0, s62, 5632
s_nop 0
buffer_load_dwordx4 v48, s[8:11], s61 offen offset:512 lds
s_add_u32 m0, s62, 6656
s_nop 0
buffer_load_dwordx4 v49, s[8:11], s61 offen offset:512 lds
s_waitcnt vmcnt(16)
ds_read_b128 a[0:3], v192 offset:0
ds_read_b128 a[4:7], v192 offset:4096
ds_read_b128 a[8:11], v193 offset:0
ds_read_b128 a[12:15], v193 offset:4096
ds_read_b128 a[16:19], v194 offset:0
ds_read_b128 a[20:23], v194 offset:4096
ds_read_b128 a[24:27], v195 offset:0
ds_read_b128 a[28:31], v195 offset:4096
s_waitcnt lgkmcnt(0)
s_add_u32 m0, s92, 4294966528
s_nop 0
buffer_load_dwordx4 v46, s[8:11], s60 offen offset:768 lds
s_add_u32 m0, s92, 256
s_nop 0
buffer_load_dwordx4 v47, s[8:11], s60 offen offset:768 lds
s_add_u32 m0, s92, 1280
s_nop 0
buffer_load_dwordx4 v48, s[8:11], s60 offen offset:768 lds
s_add_u32 m0, s92, 2304
s_nop 0
buffer_load_dwordx4 v49, s[8:11], s60 offen offset:768 lds
s_add_u32 m0, s92, 3328
s_nop 0
buffer_load_dwordx4 v46, s[8:11], s61 offen offset:768 lds
s_add_u32 m0, s92, 4352
s_nop 0
buffer_load_dwordx4 v47, s[8:11], s61 offen offset:768 lds
s_add_u32 m0, s92, 5376
s_nop 0
buffer_load_dwordx4 v48, s[8:11], s61 offen offset:768 lds
s_add_u32 m0, s92, 6400
s_nop 0
buffer_load_dwordx4 v49, s[8:11], s61 offen offset:768 lds
s_mov_b64 exec, 3
buffer_load_dword v15, v137, s[4:7], 0 offen sc1
s_mov_b64 exec, -1
s_waitcnt vmcnt(17)
ds_read_b128 a[32:35], v192 offset:32768
ds_read_b128 a[36:39], v192 offset:36864
ds_read_b128 a[40:43], v193 offset:32768
ds_read_b128 a[44:47], v193 offset:36864
ds_read_b128 a[48:51], v194 offset:32768
ds_read_b128 a[52:55], v194 offset:36864
ds_read_b128 a[56:59], v195 offset:32768
ds_read_b128 a[60:63], v195 offset:36864
s_waitcnt lgkmcnt(0)
s_add_u32 m0, s92, 31744
s_nop 0
buffer_load_dwordx4 v46, s[8:11], s60 offen offset:1024 lds
s_add_u32 m0, s92, 32768
s_nop 0
buffer_load_dwordx4 v47, s[8:11], s60 offen offset:1024 lds
s_add_u32 m0, s92, 33792
s_nop 0
buffer_load_dwordx4 v48, s[8:11], s60 offen offset:1024 lds
s_add_u32 m0, s92, 34816
s_nop 0
buffer_load_dwordx4 v49, s[8:11], s60 offen offset:1024 lds
s_add_u32 m0, s92, 35840
s_nop 0
buffer_load_dwordx4 v46, s[8:11], s61 offen offset:1024 lds
s_add_u32 m0, s92, 36864
s_nop 0
buffer_load_dwordx4 v47, s[8:11], s61 offen offset:1024 lds
s_add_u32 m0, s92, 37888
s_nop 0
buffer_load_dwordx4 v48, s[8:11], s61 offen offset:1024 lds
s_add_u32 m0, s92, 38912
s_nop 0
buffer_load_dwordx4 v49, s[8:11], s61 offen offset:1024 lds
s_waitcnt vmcnt(8)
v_and_b32 v15, 0xff, v15
v_cmp_gt_u32 s[58:59], 16, v15
s_nop 0
s_and_b32 s58, s58, 3
s_cbranch_scc1 Lq3
Lr4:
s_mul_i32 s53, s18, 4096
s_add_u32 m0, s53, 6144
s_add_u32 s52, s28, s53
buffer_load_dwordx4 v1, s[4:7], s52 offen offset:0 sc1 lds
buffer_load_dwordx4 v1, s[4:7], s52 offen offset:1024 sc1 lds
buffer_load_dwordx4 v1, s[4:7], s52 offen offset:2048 sc1 lds
buffer_load_dwordx4 v1, s[4:7], s52 offen offset:3072 sc1 lds
s_mul_i32 s53, s18, 4096
s_add_u32 m0, s53, 22528
s_add_u32 s52, s28, s53
s_add_u32 s52, s52, 16384
buffer_load_dwordx4 v1, s[4:7], s52 offen offset:0 sc1 lds
buffer_load_dwordx4 v1, s[4:7], s52 offen offset:1024 sc1 lds
buffer_load_dwordx4 v1, s[4:7], s52 offen offset:2048 sc1 lds
buffer_load_dwordx4 v1, s[4:7], s52 offen offset:3072 sc1 lds
ds_read_b128 a[64:67], v196 offset:0
ds_read_b128 a[68:71], v196 offset:4096
ds_read_b128 a[72:75], v197 offset:0
ds_read_b128 a[76:79], v197 offset:4096
ds_read_b128 a[80:83], v198 offset:0
ds_read_b128 a[84:87], v198 offset:4096
ds_read_b128 a[88:91], v199 offset:0
ds_read_b128 a[92:95], v199 offset:4096
ds_read_b128 a[96:99], v192 offset:0
ds_read_b128 a[100:103], v192 offset:4096
ds_read_b128 a[104:107], v193 offset:0
ds_read_b128 a[108:111], v193 offset:4096
ds_read_b128 a[112:115], v194 offset:0
ds_read_b128 a[116:119], v194 offset:4096
ds_read_b128 a[120:123], v195 offset:0
ds_read_b128 a[124:127], v195 offset:4096
s_waitcnt vmcnt(8)
ds_read_b128 a[128:131], v192 offset:32768
ds_read_b128 a[132:135], v192 offset:36864
ds_read_b128 a[136:139], v193 offset:32768
ds_read_b128 a[140:143], v193 offset:36864
ds_read_b128 a[144:147], v194 offset:32768
ds_read_b128 a[148:151], v194 offset:36864
ds_read_b128 a[152:155], v195 offset:32768
ds_read_b128 a[156:159], v195 offset:36864
s_waitcnt lgkmcnt(0)
v_lshrrev_b32 v36, 1, v1
v_and_b32 v36, 0x180, v36
v_and_b32 v15, 0x70, v1
v_add_u32 v36, v36, v15
v_add_u32 v36, 9216, v36
s_andn2_b64 s[68:69], 1, s[98:99]
buffer_load_dwordx4 v[140:143], v72, s[4:7], s76 offen offset:0 sc1
buffer_load_dwordx4 v[144:147], v72, s[4:7], s76 offen offset:512 sc1
buffer_load_dword v224, v6, s[4:7], s33 offen offset:0 sc1
buffer_load_dword v225, v6, s[4:7], s33 offen offset:128 sc1
buffer_load_dword v226, v6, s[4:7], s33 offen offset:256 sc1
buffer_load_dword v227, v6, s[4:7], s33 offen offset:384 sc1
buffer_load_dword v228, v6, s[4:7], s33 offen offset:512 sc1
buffer_load_dword v229, v6, s[4:7], s33 offen offset:640 sc1
buffer_load_dword v230, v6, s[4:7], s33 offen offset:768 sc1
buffer_load_dword v231, v6, s[4:7], s33 offen offset:896 sc1
s_waitcnt vmcnt(14)
s_barrier
ds_read_b128 v[104:107], v1 offset:6144
ds_read_b128 v[108:111], v1 offset:7168
ds_read_b128 v[112:115], v1 offset:8192
ds_read_b128 v[116:119], v36 offset:0
ds_read_b128 v[120:123], v1 offset:9728
ds_read_b128 v[124:127], v1 offset:10752
s_waitcnt lgkmcnt(5)
v_mfma_f32_16x16x32_bf16 v[40:43], v[104:107], a[0:3], 0
s_mul_i32 s53, s18, 4096
s_add_u32 m0, s53, 38912
s_add_u32 s52, s28, s53
v_mfma_f32_16x16x32_bf16 v[44:47], v[104:107], a[4:7], 0
s_add_u32 s52, s52, 32768
ds_read_b128 v[128:131], v1 offset:11776
s_waitcnt lgkmcnt(5)
v_mfma_f32_16x16x32_bf16 v[52:55], v[108:111], a[4:7], 0
buffer_load_dwordx4 v1, s[4:7], s52 offen offset:0 sc1 lds
v_mfma_f32_16x16x32_bf16 v[48:51], v[108:111], a[0:3], 0
s_waitcnt lgkmcnt(3)
ds_read_b128 v[132:135], v36 offset:3584
v_mfma_f32_16x16x32_bf16 v[56:59], v[112:115], a[0:3], 0
buffer_load_dwordx4 v1, s[4:7], s52 offen offset:1024 sc1 lds
v_mfma_f32_16x16x32_bf16 v[60:63], v[112:115], a[4:7], 0
ds_read_b128 v[104:107], v1 offset:13312
v_mfma_f32_16x16x32_bf16 v[68:71], v[116:119], a[4:7], 0
buffer_load_dwordx4 v1, s[4:7], s52 offen offset:2048 sc1 lds
v_mfma_f32_16x16x32_bf16 v[64:67], v[116:119], a[0:3], 0
s_waitcnt lgkmcnt(3)
ds_read_b128 v[108:111], v1 offset:14336
v_mfma_f32_16x16x32_bf16 v[40:43], v[120:123], a[8:11], v[40:43]
buffer_load_dwordx4 v1, s[4:7], s52 offen offset:3072 sc1 lds
v_mfma_f32_16x16x32_bf16 v[44:47], v[120:123], a[12:15], v[44:47]
s_mul_i32 s53, s18, 4096
ds_read_b128 v[112:115], v1 offset:15360
s_add_u32 m0, s53, 55296
v_mfma_f32_16x16x32_bf16 v[52:55], v[124:127], a[12:15], v[52:55]
s_add_u32 s52, s28, s53
buffer_store_dwordx4 v[80:83], v212, s[4:7], 0 offen sc1
v_mfma_f32_16x16x32_bf16 v[48:51], v[124:127], a[8:11], v[48:51]
s_waitcnt lgkmcnt(3)
ds_read_b128 v[116:119], v36 offset:7168
s_add_u32 s52, s52, 49152
v_mfma_f32_16x16x32_bf16 v[56:59], v[128:131], a[8:11], v[56:59]
buffer_load_dwordx4 v1, s[4:7], s52 offen offset:0 sc1 lds
v_mfma_f32_16x16x32_bf16 v[60:63], v[128:131], a[12:15], v[60:63]
ds_read_b128 v[120:123], v1 offset:16896
v_mfma_f32_16x16x32_bf16 v[68:71], v[132:135], a[12:15], v[68:71]
buffer_load_dwordx4 v1, s[4:7], s52 offen offset:1024 sc1 lds
v_mfma_f32_16x16x32_bf16 v[64:67], v[132:135], a[8:11], v[64:67]
s_waitcnt lgkmcnt(3)
ds_read_b128 v[124:127], v1 offset:17920
v_mfma_f32_16x16x32_bf16 v[40:43], v[104:107], a[16:19], v[40:43]
s_waitcnt vmcnt(15)
v_add_f32 v140, v140, v144
v_add_f32 v141, v141, v145
v_mfma_f32_16x16x32_bf16 v[44:47], v[104:107], a[20:23], v[44:47]
ds_read_b128 v[128:131], v1 offset:18944
v_add_f32 v142, v142, v146
v_mfma_f32_16x16x32_bf16 v[52:55], v[108:111], a[20:23], v[52:55]
v_add_f32 v143, v143, v147
v_mfma_f32_16x16x32_bf16 v[48:51], v[108:111], a[16:19], v[48:51]
s_waitcnt lgkmcnt(3)
ds_read_b128 v[132:135], v36 offset:10752
v_mfma_f32_16x16x32_bf16 v[56:59], v[112:115], a[16:19], v[56:59]
s_barrier
buffer_store_dwordx4 v[84:87], v213, s[4:7], 0 offen sc1
v_mfma_f32_16x16x32_bf16 v[60:63], v[112:115], a[20:23], v[60:63]
ds_read_b128 v[104:107], v1 offset:20480
v_mfma_f32_16x16x32_bf16 v[68:71], v[116:119], a[20:23], v[68:71]
buffer_load_dwordx4 v1, s[4:7], s52 offen offset:2048 sc1 lds
v_mfma_f32_16x16x32_bf16 v[64:67], v[116:119], a[16:19], v[64:67]
s_waitcnt lgkmcnt(3)
ds_read_b128 v[108:111], v1 offset:21504
v_mfma_f32_16x16x32_bf16 v[40:43], v[120:123], a[24:27], v[40:43]
v_permlane32_swap_b32 v140, v141
v_mfma_f32_16x16x32_bf16 v[44:47], v[120:123], a[28:31], v[44:47]
ds_read_b128 v[112:115], v1 offset:22528
s_waitcnt vmcnt(15)
v_add_f32 v224, v224, v225
v_mfma_f32_16x16x32_bf16 v[52:55], v[124:127], a[28:31], v[52:55]
v_permlane32_swap_b32 v142, v143
v_mfma_f32_16x16x32_bf16 v[48:51], v[124:127], a[24:27], v[48:51]
s_waitcnt lgkmcnt(3)
ds_read_b128 v[116:119], v36 offset:14336
v_add_f32 v140, v140, v141
v_mfma_f32_16x16x32_bf16 v[56:59], v[128:131], a[24:27], v[56:59]
buffer_load_dwordx4 v1, s[4:7], s52 offen offset:3072 sc1 lds
v_mfma_f32_16x16x32_bf16 v[60:63], v[128:131], a[28:31], v[60:63]
ds_read_b128 v[120:123], v1 offset:24064
v_add_f32 v142, v142, v143
v_mfma_f32_16x16x32_bf16 v[68:71], v[132:135], a[28:31], v[68:71]
s_mul_i32 s53, s18, 4096
v_permlane16_swap_b32 v140, v142
v_mfma_f32_16x16x32_bf16 v[64:67], v[132:135], a[24:27], v[64:67]
s_waitcnt lgkmcnt(3)
ds_read_b128 v[124:127], v1 offset:25088
s_add_u32 m0, s53, 71680
v_mfma_f32_16x16x32_bf16 v[40:43], v[104:107], a[32:35], v[40:43]
s_add_u32 s52, s28, s53
v_add_f32 v140, v140, v142
s_waitcnt vmcnt(14)
v_add_f32 v226, v226, v227
v_mfma_f32_16x16x32_bf16 v[44:47], v[104:107], a[36:39], v[44:47]
s_add_u32 s52, s52, 65536
ds_read_b128 v[128:131], v1 offset:26112
v_add_f32_dpp v140, v140, v140 row_ror:8 row_mask:0xf bank_mask:0xf
v_mfma_f32_16x16x32_bf16 v[52:55], v[108:111], a[36:39], v[52:55]
buffer_load_dwordx4 v1, s[4:7], s52 offen offset:0 sc1 lds
v_mfma_f32_16x16x32_bf16 v[48:51], v[108:111], a[32:35], v[48:51]
s_waitcnt lgkmcnt(3)
ds_read_b128 v[132:135], v36 offset:17920
s_waitcnt vmcnt(13)
v_add_f32 v228, v228, v229
v_mfma_f32_16x16x32_bf16 v[56:59], v[112:115], a[32:35], v[56:59]
ds_write_b32 v73, v140
v_mfma_f32_16x16x32_bf16 v[60:63], v[112:115], a[36:39], v[60:63]
ds_read_b128 v[104:107], v1 offset:27648
s_waitcnt vmcnt(11)
v_add_f32 v230, v230, v231
v_mfma_f32_16x16x32_bf16 v[68:71], v[116:119], a[36:39], v[68:71]
buffer_store_dwordx4 v[88:91], v214, s[4:7], 0 offen sc1
v_mfma_f32_16x16x32_bf16 v[64:67], v[116:119], a[32:35], v[64:67]
s_waitcnt lgkmcnt(4)
ds_read_b128 v[108:111], v1 offset:28672
v_add_f32 v224, v224, v226
v_mfma_f32_16x16x32_bf16 v[40:43], v[120:123], a[40:43], v[40:43]
buffer_load_dwordx4 v1, s[4:7], s52 offen offset:1024 sc1 lds
v_mfma_f32_16x16x32_bf16 v[44:47], v[120:123], a[44:47], v[44:47]
ds_read_b128 v[112:115], v1 offset:29696
v_add_f32 v228, v228, v230
v_mfma_f32_16x16x32_bf16 v[52:55], v[124:127], a[44:47], v[52:55]
v_add_f32 v224, v224, v228
v_mul_f32 v224, 986500301, v224
v_mfma_f32_16x16x32_bf16 v[48:51], v[124:127], a[40:43], v[48:51]
s_waitcnt lgkmcnt(4)
ds_read_b128 v[116:119], v36 offset:21504
v_mov_b32 v225, v224
v_mfma_f32_16x16x32_bf16 v[56:59], v[128:131], a[40:43], v[56:59]
s_nop 0
v_permlane32_swap_b32 v224, v225
v_mfma_f32_16x16x32_bf16 v[60:63], v[128:131], a[44:47], v[60:63]
ds_read_b128 v[120:123], v1 offset:31232
v_fma_f32 v225, -v224, v224, v225
v_mfma_f32_16x16x32_bf16 v[68:71], v[132:135], a[44:47], v[68:71]
buffer_store_dwordx4 v[92:95], v215, s[4:7], 0 offen sc1
v_mfma_f32_16x16x32_bf16 v[64:67], v[132:135], a[40:43], v[64:67]
s_waitcnt lgkmcnt(3)
ds_read_b128 v[124:127], v1 offset:32256
v_max_f32 v225, 0, v225
v_mfma_f32_16x16x32_bf16 v[40:43], v[104:107], a[48:51], v[40:43]
buffer_load_dwordx4 v1, s[4:7], s52 offen offset:2048 sc1 lds
v_mfma_f32_16x16x32_bf16 v[44:47], v[104:107], a[52:55], v[44:47]
ds_read_b128 v[128:131], v1 offset:33280
v_add_f32 v225, 925353388, v225
v_mfma_f32_16x16x32_bf16 v[52:55], v[108:111], a[52:55], v[52:55]
v_rsq_f32 v232, v225
v_mfma_f32_16x16x32_bf16 v[48:51], v[108:111], a[48:51], v[48:51]
s_waitcnt lgkmcnt(3)
ds_read_b128 v[132:135], v36 offset:25088
v_sub_f32 v230, 0, v224
v_mfma_f32_16x16x32_bf16 v[56:59], v[112:115], a[48:51], v[56:59]
v_mov_b32 v233, v232
v_mov_b32 v231, v230
v_mfma_f32_16x16x32_bf16 v[60:63], v[112:115], a[52:55], v[60:63]
ds_read_b128 v[104:107], v1 offset:34816
v_lshrrev_b32 v224, 9, v1
v_mfma_f32_16x16x32_bf16 v[68:71], v[116:119], a[52:55], v[68:71]
buffer_load_dwordx4 v1, s[4:7], s52 offen offset:3072 sc1 lds
v_mfma_f32_16x16x32_bf16 v[64:67], v[116:119], a[48:51], v[64:67]
s_waitcnt lgkmcnt(3)
ds_read_b128 v[108:111], v1 offset:35840
v_mfma_f32_16x16x32_bf16 v[40:43], v[120:123], a[56:59], v[40:43]
s_waitcnt vmcnt(12)
s_barrier
buffer_store_dwordx4 v[96:99], v216, s[4:7], 0 offen sc1
v_mfma_f32_16x16x32_bf16 v[44:47], v[120:123], a[60:63], v[44:47]
s_mul_i32 s53, s18, 4096
ds_read_b128 v[112:115], v1 offset:36864
s_add_u32 m0, s53, 88064
v_mfma_f32_16x16x32_bf16 v[52:55], v[124:127], a[60:63], v[52:55]
s_add_u32 s52, s28, s53
ds_read_b128 v[136:139], v8 offset:0
s_add_u32 s52, s52, 81920
v_mfma_f32_16x16x32_bf16 v[48:51], v[124:127], a[56:59], v[48:51]
s_waitcnt lgkmcnt(4)
ds_read_b128 v[116:119], v36 offset:28672
v_mfma_f32_16x16x32_bf16 v[56:59], v[128:131], a[56:59], v[56:59]
buffer_load_dwordx4 v1, s[4:7], s52 offen offset:0 sc1 lds
v_mfma_f32_16x16x32_bf16 v[60:63], v[128:131], a[60:63], v[60:63]
ds_read_b128 v[120:123], v1 offset:38400
v_mfma_f32_16x16x32_bf16 v[68:71], v[132:135], a[60:63], v[68:71]
ds_read_b128 v[144:147], v8 offset:64
v_mfma_f32_16x16x32_bf16 v[64:67], v[132:135], a[56:59], v[64:67]
s_waitcnt lgkmcnt(5)
ds_read_b128 v[124:127], v1 offset:39424
v_mfma_f32_16x16x32_bf16 v[40:43], v[104:107], a[64:67], v[40:43]
buffer_store_dwordx4 v[100:103], v217, s[4:7], 0 offen sc1
v_mfma_f32_16x16x32_bf16 v[44:47], v[104:107], a[68:71], v[44:47]
ds_read_b128 v[128:131], v1 offset:40448
v_mfma_f32_16x16x32_bf16 v[52:55], v[108:111], a[68:71], v[52:55]
ds_read_b128 v[152:155], v8 offset:128
v_mfma_f32_16x16x32_bf16 v[48:51], v[108:111], a[64:67], v[48:51]
s_waitcnt lgkmcnt(5)
ds_read_b128 v[132:135], v36 offset:32256
v_mfma_f32_16x16x32_bf16 v[56:59], v[112:115], a[64:67], v[56:59]
ds_read_b128 v[160:163], v8 offset:192
v_add_u32 v36, 32768, v36
v_mfma_f32_16x16x32_bf16 v[60:63], v[112:115], a[68:71], v[60:63]
ds_read_b128 v[104:107], v1 offset:41984
v_mfma_f32_16x16x32_bf16 v[68:71], v[116:119], a[68:71], v[68:71]
buffer_load_dwordx4 v1, s[4:7], s52 offen offset:1024 sc1 lds
v_mfma_f32_16x16x32_bf16 v[64:67], v[116:119], a[64:67], v[64:67]
s_waitcnt lgkmcnt(5)
ds_read_b128 v[108:111], v1 offset:43008
v_mfma_f32_16x16x32_bf16 v[40:43], v[120:123], a[72:75], v[40:43]
buffer_store_dwordx4 v[200:203], v218, s[4:7], 0 offen sc1
v_mfma_f32_16x16x32_bf16 v[44:47], v[120:123], a[76:79], v[44:47]
ds_read_b128 v[112:115], v1 offset:44032
v_mfma_f32_16x16x32_bf16 v[52:55], v[124:127], a[76:79], v[52:55]
buffer_load_dwordx4 v1, s[4:7], s52 offen offset:2048 sc1 lds
v_mfma_f32_16x16x32_bf16 v[48:51], v[124:127], a[72:75], v[48:51]
s_waitcnt lgkmcnt(4)
ds_read_b128 v[116:119], v36 offset:3072
v_mfma_f32_16x16x32_bf16 v[56:59], v[128:131], a[72:75], v[56:59]
ds_read_b128 v[168:171], v8 offset:256
v_mfma_f32_16x16x32_bf16 v[60:63], v[128:131], a[76:79], v[60:63]
ds_read_b128 v[120:123], v1 offset:45568
v_mfma_f32_16x16x32_bf16 v[68:71], v[132:135], a[76:79], v[68:71]
ds_read_b128 v[176:179], v8 offset:320
v_mfma_f32_16x16x32_bf16 v[64:67], v[132:135], a[72:75], v[64:67]
s_waitcnt lgkmcnt(5)
ds_read_b128 v[124:127], v1 offset:46592
v_mfma_f32_16x16x32_bf16 v[40:43], v[104:107], a[80:83], v[40:43]
buffer_load_dwordx4 v1, s[4:7], s52 offen offset:3072 sc1 lds
v_mfma_f32_16x16x32_bf16 v[44:47], v[104:107], a[84:87], v[44:47]
ds_read_b128 v[128:131], v1 offset:47616
v_mfma_f32_16x16x32_bf16 v[52:55], v[108:111], a[84:87], v[52:55]
buffer_store_dwordx4 v[204:207], v219, s[4:7], 0 offen sc1
v_mfma_f32_16x16x32_bf16 v[48:51], v[108:111], a[80:83], v[48:51]
s_waitcnt lgkmcnt(5)
ds_read_b128 v[132:135], v36 offset:6656
v_mfma_f32_16x16x32_bf16 v[56:59], v[112:115], a[80:83], v[56:59]
s_mul_i32 s53, s18, 4096
ds_read_b128 v[184:187], v8 offset:384
s_add_u32 m0, s53, 104448
v_mfma_f32_16x16x32_bf16 v[60:63], v[112:115], a[84:87], v[60:63]
s_add_u32 s52, s28, s53
ds_read_b128 v[104:107], v1 offset:49152
s_add_u32 s52, s52, 98304
v_mfma_f32_16x16x32_bf16 v[68:71], v[116:119], a[84:87], v[68:71]
ds_read_b128 v[192:195], v8 offset:448
v_mfma_f32_16x16x32_bf16 v[64:67], v[116:119], a[80:83], v[64:67]
s_waitcnt lgkmcnt(5)
ds_read_b128 v[108:111], v1 offset:50176
v_mfma_f32_16x16x32_bf16 v[40:43], v[120:123], a[88:91], v[40:43]
buffer_load_dwordx4 v1, s[4:7], s52 offen offset:0 sc1 lds
v_mfma_f32_16x16x32_bf16 v[44:47], v[120:123], a[92:95], v[44:47]
ds_read_b128 v[112:115], v1 offset:51200
v_mfma_f32_16x16x32_bf16 v[52:55], v[124:127], a[92:95], v[52:55]
buffer_store_dwordx4 v[240:243], v220, s[4:7], 0 offen sc1
v_mfma_f32_16x16x32_bf16 v[48:51], v[124:127], a[88:91], v[48:51]
s_waitcnt lgkmcnt(5)
ds_read_b128 v[116:119], v36 offset:10240
v_mfma_f32_16x16x32_bf16 v[56:59], v[128:131], a[88:91], v[56:59]
s_waitcnt vmcnt(16)
s_barrier
v_mfma_f32_16x16x32_bf16 v[60:63], v[128:131], a[92:95], v[60:63]
ds_read_b128 v[120:123], v1 offset:52736
v_mfma_f32_16x16x32_bf16 v[68:71], v[132:135], a[92:95], v[68:71]
buffer_load_dwordx4 v1, s[4:7], s52 offen offset:1024 sc1 lds
v_mfma_f32_16x16x32_bf16 v[64:67], v[132:135], a[88:91], v[64:67]
s_waitcnt lgkmcnt(3)
ds_read_b128 v[124:127], v1 offset:53760
v_mfma_f32_16x16x32_bf16 v[40:43], v[104:107], a[96:99], v[40:43]
v_permlane16_swap_b32 v232, v233
v_mfma_f32_16x16x32_bf16 v[44:47], v[104:107], a[100:103], v[44:47]
ds_read_b128 v[128:131], v1 offset:54784
v_mfma_f32_16x16x32_bf16 v[52:55], v[108:111], a[100:103], v[52:55]
buffer_store_dword v244, v221, s[4:7], 0 offen sc1
v_mfma_f32_16x16x32_bf16 v[48:51], v[108:111], a[96:99], v[48:51]
s_waitcnt lgkmcnt(3)
ds_read_b128 v[132:135], v36 offset:13824
v_mfma_f32_16x16x32_bf16 v[56:59], v[112:115], a[96:99], v[56:59]
buffer_load_dwordx4 v1, s[4:7], s52 offen offset:2048 sc1 lds
v_mfma_f32_16x16x32_bf16 v[60:63], v[112:115], a[100:103], v[60:63]
ds_read_b128 v[104:107], v1 offset:56320
v_mfma_f32_16x16x32_bf16 v[68:71], v[116:119], a[100:103], v[68:71]
v_permlane16_swap_b32 v230, v231
v_mfma_f32_16x16x32_bf16 v[64:67], v[116:119], a[96:99], v[64:67]
s_waitcnt lgkmcnt(3)
ds_read_b128 v[108:111], v1 offset:57344
v_mul_f32 v226, v230, v232
v_mfma_f32_16x16x32_bf16 v[40:43], v[120:123], a[104:107], v[40:43]
v_mul_f32 v227, v231, v233
v_mul_u32_u24 v234, 768, v224
v_mfma_f32_16x16x32_bf16 v[44:47], v[120:123], a[108:111], v[44:47]
ds_read_b128 v[112:115], v1 offset:58368
v_sub_u32 v234, v4, v234
v_mfma_f32_16x16x32_bf16 v[52:55], v[124:127], a[108:111], v[52:55]
v_sub_u32 v225, v9, v1
v_add_u32 v225, 25600, v225
v_mfma_f32_16x16x32_bf16 v[48:51], v[124:127], a[104:107], v[48:51]
s_waitcnt lgkmcnt(3)
ds_read_b128 v[116:119], v36 offset:17408
v_add_u32 v238, v234, v225
v_mfma_f32_16x16x32_bf16 v[56:59], v[128:131], a[104:107], v[56:59]
buffer_load_dwordx4 v1, s[4:7], s52 offen offset:3072 sc1 lds
v_mfma_f32_16x16x32_bf16 v[60:63], v[128:131], a[108:111], v[60:63]
ds_read_b128 v[120:123], v1 offset:59904
v_add_u32 v237, v225, v39
v_mfma_f32_16x16x32_bf16 v[68:71], v[132:135], a[108:111], v[68:71]
v_mov_b32 v210, 0x3f803f80
v_mov_b32 v211, 0
v_mfma_f32_16x16x32_bf16 v[64:67], v[132:135], a[104:107], v[64:67]
s_waitcnt lgkmcnt(3)
ds_read_b128 v[124:127], v1 offset:60928
v_mov_b32 v222, 0x3f803f80
v_mfma_f32_16x16x32_bf16 v[40:43], v[104:107], a[112:115], v[40:43]
v_mov_b32 v223, 0
s_add_u32 s56, s36, 3200
v_mfma_f32_16x16x32_bf16 v[44:47], v[104:107], a[116:119], v[44:47]
s_mov_b32 s72, 528482304
ds_read_b128 v[128:131], v1 offset:61952
s_mov_b32 s73, 1602224128
v_mfma_f32_16x16x32_bf16 v[52:55], v[108:111], a[116:119], v[52:55]
v_mul_f32 v140, v136, v227
v_mul_f32 v141, v137, v227
v_mfma_f32_16x16x32_bf16 v[48:51], v[108:111], a[112:115], v[48:51]
s_waitcnt lgkmcnt(3)
ds_read_b128 v[132:135], v36 offset:20992
v_mul_f32 v142, v138, v227
v_mfma_f32_16x16x32_bf16 v[56:59], v[112:115], a[112:115], v[56:59]
v_mul_f32 v143, v139, v227
v_mul_f32 v136, v136, v226
v_mfma_f32_16x16x32_bf16 v[60:63], v[112:115], a[116:119], v[60:63]
ds_read_b128 v[104:107], v1 offset:63488
v_mul_f32 v137, v137, v226
v_mfma_f32_16x16x32_bf16 v[68:71], v[116:119], a[116:119], v[68:71]
v_mul_f32 v138, v138, v226
v_mul_f32 v139, v139, v226
v_mfma_f32_16x16x32_bf16 v[64:67], v[116:119], a[112:115], v[64:67]
s_waitcnt lgkmcnt(3)
ds_read_b128 v[108:111], v1 offset:64512
v_mul_f32 v148, v144, v227
v_mfma_f32_16x16x32_bf16 v[40:43], v[120:123], a[120:123], v[40:43]
v_mul_f32 v149, v145, v227
v_mul_f32 v150, v146, v227
v_mfma_f32_16x16x32_bf16 v[44:47], v[120:123], a[124:127], v[44:47]
ds_read_b128 v[112:115], v2 offset:0
v_mul_f32 v151, v147, v227
v_mfma_f32_16x16x32_bf16 v[52:55], v[124:127], a[124:127], v[52:55]
v_mul_f32 v144, v144, v226
v_mul_f32 v145, v145, v226
v_mfma_f32_16x16x32_bf16 v[48:51], v[124:127], a[120:123], v[48:51]
s_waitcnt lgkmcnt(3)
ds_read_b128 v[116:119], v36 offset:24576
v_mul_f32 v146, v146, v226
v_mfma_f32_16x16x32_bf16 v[56:59], v[128:131], a[120:123], v[56:59]
v_mul_f32 v147, v147, v226
v_mul_f32 v156, v152, v227
v_mfma_f32_16x16x32_bf16 v[60:63], v[128:131], a[124:127], v[60:63]
ds_read_b128 v[120:123], v2 offset:1536
v_mul_f32 v157, v153, v227
v_mfma_f32_16x16x32_bf16 v[68:71], v[132:135], a[124:127], v[68:71]
v_mul_f32 v158, v154, v227
v_mul_f32 v159, v155, v227
v_mfma_f32_16x16x32_bf16 v[64:67], v[132:135], a[120:123], v[64:67]
s_waitcnt lgkmcnt(3)
ds_read_b128 v[124:127], v2 offset:2560
v_mul_f32 v152, v152, v226
v_mfma_f32_16x16x32_bf16 v[40:43], v[104:107], a[128:131], v[40:43]
s_waitcnt vmcnt(14)
s_barrier
v_mfma_f32_16x16x32_bf16 v[44:47], v[104:107], a[132:135], v[44:47]
ds_read_b128 v[128:131], v2 offset:3584
v_mul_f32 v153, v153, v226
v_mfma_f32_16x16x32_bf16 v[52:55], v[108:111], a[132:135], v[52:55]
v_mul_f32 v154, v154, v226
v_mul_f32 v155, v155, v226
v_mfma_f32_16x16x32_bf16 v[48:51], v[108:111], a[128:131], v[48:51]
s_waitcnt lgkmcnt(3)
ds_read_b128 v[132:135], v36 offset:28160
v_mul_f32 v172, v168, v227
v_mfma_f32_16x16x32_bf16 v[56:59], v[112:115], a[128:131], v[56:59]
v_mul_f32 v173, v169, v227
v_mul_f32 v174, v170, v227
v_mfma_f32_16x16x32_bf16 v[60:63], v[112:115], a[132:135], v[60:63]
ds_read_b128 v[104:107], v2 offset:5120
v_mul_f32 v175, v171, v227
v_mfma_f32_16x16x32_bf16 v[68:71], v[116:119], a[132:135], v[68:71]
v_mul_f32 v168, v168, v226
v_mul_f32 v169, v169, v226
v_mfma_f32_16x16x32_bf16 v[64:67], v[116:119], a[128:131], v[64:67]
s_waitcnt lgkmcnt(3)
ds_read_b128 v[108:111], v2 offset:6144
v_mul_f32 v170, v170, v226
v_mfma_f32_16x16x32_bf16 v[40:43], v[120:123], a[136:139], v[40:43]
v_mul_f32 v171, v171, v226
v_mul_f32 v180, v176, v227
v_mfma_f32_16x16x32_bf16 v[44:47], v[120:123], a[140:143], v[44:47]
ds_read_b128 v[112:115], v2 offset:7168
v_mul_f32 v181, v177, v227
v_mfma_f32_16x16x32_bf16 v[52:55], v[124:127], a[140:143], v[52:55]
v_mul_f32 v182, v178, v227
v_mul_f32 v183, v179, v227
v_mfma_f32_16x16x32_bf16 v[48:51], v[124:127], a[136:139], v[48:51]
s_waitcnt lgkmcnt(3)
ds_read_b128 v[116:119], v36 offset:31744
v_mul_f32 v176, v176, v226
v_mfma_f32_16x16x32_bf16 v[56:59], v[128:131], a[136:139], v[56:59]
s_waitcnt vmcnt(2)
s_barrier
s_andn2_b64 exec, 1, s[98:99]
buffer_atomic_add v13, v37, s[4:7], 0 offen sc1
s_mov_b64 exec, -1
v_mfma_f32_16x16x32_bf16 v[60:63], v[128:131], a[140:143], v[60:63]
ds_read_b128 v[120:123], v2 offset:8704
v_mul_f32 v177, v177, v226
v_mfma_f32_16x16x32_bf16 v[68:71], v[132:135], a[140:143], v[68:71]
v_mul_f32 v178, v178, v226
v_mul_f32 v179, v179, v226
v_mfma_f32_16x16x32_bf16 v[64:67], v[132:135], a[136:139], v[64:67]
s_waitcnt lgkmcnt(3)
ds_read_b128 v[124:127], v2 offset:9728
v_mul_f32 v230, 1051011932, v232
v_mfma_f32_16x16x32_bf16 v[40:43], v[104:107], a[144:147], v[40:43]
v_mul_f32 v228, 1051011932, v226
v_mul_f32 v231, 1051011932, v233
v_mfma_f32_16x16x32_bf16 v[44:47], v[104:107], a[148:151], v[44:47]
ds_read_b128 v[128:131], v2 offset:10752
v_mul_f32 v229, 1051011932, v227
v_mfma_f32_16x16x32_bf16 v[52:55], v[108:111], a[148:151], v[52:55]
v_mov_b32 v224, 61769
v_cndmask_b32 v247, v224, 0, s[44:45]
v_mfma_f32_16x16x32_bf16 v[48:51], v[108:111], a[144:147], v[48:51]
s_waitcnt lgkmcnt(3)
ds_read_b128 v[132:135], v36 offset:35328
v_cndmask_b32 v255, v224, 0, s[44:45]
v_mfma_f32_16x16x32_bf16 v[56:59], v[112:115], a[144:147], v[56:59]
v_add_u32 v239, 38400, v9
v_add_u32 v38, 38400, v10
v_mfma_f32_16x16x32_bf16 v[60:63], v[112:115], a[148:151], v[60:63]
ds_read_b128 v[104:107], v2 offset:12288
v_mul_f32 v164, v160, v229
v_mfma_f32_16x16x32_bf16 v[68:71], v[116:119], a[148:151], v[68:71]
v_mul_f32 v165, v161, v229
v_mul_f32 v166, v162, v229
v_mfma_f32_16x16x32_bf16 v[64:67], v[116:119], a[144:147], v[64:67]
s_waitcnt lgkmcnt(3)
ds_read_b128 v[108:111], v2 offset:13312
v_mul_f32 v167, v163, v229
v_mfma_f32_16x16x32_bf16 v[40:43], v[120:123], a[152:155], v[40:43]
v_mul_f32 v160, v160, v228
v_mul_f32 v161, v161, v228
v_mfma_f32_16x16x32_bf16 v[44:47], v[120:123], a[156:159], v[44:47]
ds_read_b128 v[112:115], v2 offset:14336
v_mul_f32 v162, v162, v228
v_mfma_f32_16x16x32_bf16 v[52:55], v[124:127], a[156:159], v[52:55]
v_mul_f32 v163, v163, v228
v_mul_f32 v188, v184, v229
v_mfma_f32_16x16x32_bf16 v[48:51], v[124:127], a[152:155], v[48:51]
s_waitcnt lgkmcnt(3)
ds_read_b128 v[116:119], v2 offset:15360
v_mul_f32 v189, v185, v229
v_mfma_f32_16x16x32_bf16 v[56:59], v[128:131], a[152:155], v[56:59]
v_mul_f32 v190, v186, v229
v_mul_f32 v191, v187, v229
v_mfma_f32_16x16x32_bf16 v[60:63], v[128:131], a[156:159], v[60:63]
ds_read_b128 v[120:123], v2 offset:16384
v_mul_f32 v184, v184, v228
v_mfma_f32_16x16x32_bf16 v[68:71], v[132:135], a[156:159], v[68:71]
v_mul_f32 v185, v185, v228
v_mul_f32 v186, v186, v228
v_mfma_f32_16x16x32_bf16 v[64:67], v[132:135], a[152:155], v[64:67]
ds_read_b128 v[124:127], v2 offset:17408
v_mul_f32 v187, v187, v228
v_mul_f32 v196, v192, v229
v_mul_f32 v197, v193, v229
v_mul_f32 v198, v194, v229
v_mul_f32 v199, v195, v229
v_mul_f32 v192, v192, v228
v_mul_f32 v193, v193, v228
v_mul_f32 v194, v194, v228
v_mul_f32 v195, v195, v228
s_barrier
v_pk_fma_f32 v[40:41], v[40:41], v[232:233], v[136:137] op_sel:[0,0,0] op_sel_hi:[1,0,1]
v_pk_fma_f32 v[42:43], v[42:43], v[232:233], v[138:139] op_sel:[0,0,0] op_sel_hi:[1,0,1]
v_cvt_pk_bf16_f32 v200, v40, v41
v_cvt_pk_bf16_f32 v201, v42, v43
v_pk_fma_f32 v[48:49], v[48:49], v[232:233], v[144:145] op_sel:[0,0,0] op_sel_hi:[1,0,1]
v_pk_fma_f32 v[50:51], v[50:51], v[232:233], v[146:147] op_sel:[0,0,0] op_sel_hi:[1,0,1]
v_cvt_pk_bf16_f32 v202, v48, v49
v_cvt_pk_bf16_f32 v203, v50, v51
buffer_store_dwordx4 v[200:203], v39, s[4:7], s36 offen offset:0 sc1
v_pk_fma_f32 v[56:57], v[56:57], v[232:233], v[152:153] op_sel:[0,0,0] op_sel_hi:[1,0,1]
v_pk_fma_f32 v[58:59], v[58:59], v[232:233], v[154:155] op_sel:[0,0,0] op_sel_hi:[1,0,1]
v_cvt_pk_bf16_f32 v208, v56, v57
v_cvt_pk_bf16_f32 v209, v58, v59
v_pk_fma_f32 v[60:61], v[60:61], v[232:233], v[156:157] op_sel:[0,1,0] op_sel_hi:[1,1,1]
v_pk_fma_f32 v[62:63], v[62:63], v[232:233], v[158:159] op_sel:[0,1,0] op_sel_hi:[1,1,1]
v_cvt_pk_bf16_f32 v220, v60, v61
v_cvt_pk_bf16_f32 v221, v62, v63
v_pk_fma_f32 v[44:45], v[44:45], v[232:233], v[140:141] op_sel:[0,1,0] op_sel_hi:[1,1,1]
v_pk_fma_f32 v[46:47], v[46:47], v[232:233], v[142:143] op_sel:[0,1,0] op_sel_hi:[1,1,1]
v_cvt_pk_bf16_f32 v204, v44, v45
v_cvt_pk_bf16_f32 v205, v46, v47
v_permlane32_swap_b32 v208, v220
v_permlane32_swap_b32 v209, v221
v_pk_fma_f32 v[52:53], v[52:53], v[232:233], v[148:149] op_sel:[0,1,0] op_sel_hi:[1,1,1]
v_pk_fma_f32 v[54:55], v[54:55], v[232:233], v[150:151] op_sel:[0,1,0] op_sel_hi:[1,1,1]
v_cvt_pk_bf16_f32 v206, v52, v53
v_cvt_pk_bf16_f32 v207, v54, v55
buffer_store_dwordx4 v[204:207], v39, s[4:7], s36 offen offset:256 sc1
buffer_store_dwordx4 v[208:211], v234, s[4:7], s36 offen offset:2176 sc1
s_waitcnt lgkmcnt(5)
v_mfma_f32_16x16x32_bf16 v[72:75], v[104:107], a[0:3], 0
s_mul_i32 s53, s18, 4096
v_fma_f32 v64, v64, v230, v160
s_add_u32 m0, s53, 120832
v_mfma_f32_16x16x32_bf16 v[76:79], v[104:107], a[4:7], 0
s_add_u32 s52, s28, s53
ds_read_b128 v[128:131], v2 offset:18432
v_fma_f32 v65, v65, v230, v161
s_waitcnt lgkmcnt(5)
v_mfma_f32_16x16x32_bf16 v[84:87], v[108:111], a[4:7], 0
s_add_u32 s52, s52, 114688
v_fma_f32 v66, v66, v230, v162
v_fma_f32 v67, v67, v230, v163
v_mfma_f32_16x16x32_bf16 v[80:83], v[108:111], a[0:3], 0
s_waitcnt lgkmcnt(3)
ds_read_b128 v[132:135], v2 offset:19456
v_cvt_pk_bf16_f32 v244, v64, v65
v_mfma_f32_16x16x32_bf16 v[72:75], v[112:115], a[8:11], v[72:75]
s_barrier
v_mfma_f32_16x16x32_bf16 v[76:79], v[112:115], a[12:15], v[76:79]
ds_read_b128 v[104:107], v2 offset:20480
v_cvt_pk_bf16_f32 v245, v66, v67
v_mfma_f32_16x16x32_bf16 v[84:87], v[116:119], a[12:15], v[84:87]
buffer_load_dwordx4 v1, s[4:7], s52 offen offset:0 sc1 lds
v_mfma_f32_16x16x32_bf16 v[80:83], v[116:119], a[8:11], v[80:83]
s_waitcnt lgkmcnt(3)
ds_read_b128 v[108:111], v2 offset:21504
v_fma_f32 v68, v68, v231, v164
v_mfma_f32_16x16x32_bf16 v[72:75], v[120:123], a[16:19], v[72:75]
buffer_load_dwordx4 v[26:29], v16, s[8:11], s46 offen
v_mfma_f32_16x16x32_bf16 v[76:79], v[120:123], a[20:23], v[76:79]
ds_read_b128 v[112:115], v2 offset:22528
v_fma_f32 v69, v69, v231, v165
v_mfma_f32_16x16x32_bf16 v[84:87], v[124:127], a[20:23], v[84:87]
buffer_load_dwordx4 v[30:33], v16, s[8:11], s46 offen offset:64
v_mfma_f32_16x16x32_bf16 v[80:83], v[124:127], a[16:19], v[80:83]
s_waitcnt lgkmcnt(3)
ds_read_b128 v[116:119], v2 offset:23552
v_fma_f32 v70, v70, v231, v166
v_mfma_f32_16x16x32_bf16 v[72:75], v[128:131], a[24:27], v[72:75]
buffer_load_dwordx4 v1, s[4:7], s52 offen offset:1024 sc1 lds
v_mfma_f32_16x16x32_bf16 v[76:79], v[128:131], a[28:31], v[76:79]
ds_read_b128 v[120:123], v2 offset:24576
v_fma_f32 v71, v71, v231, v167
v_mfma_f32_16x16x32_bf16 v[84:87], v[132:135], a[28:31], v[84:87]
buffer_load_dwordx2 v[34:35], v17, s[8:11], s46 offen offset:128
v_mfma_f32_16x16x32_bf16 v[80:83], v[132:135], a[24:27], v[80:83]
s_waitcnt lgkmcnt(3)
ds_read_b128 v[124:127], v2 offset:25600
v_cvt_pk_bf16_f32 v252, v68, v69
v_mfma_f32_16x16x32_bf16 v[72:75], v[104:107], a[32:35], v[72:75]
ds_write_b128 v237, v[200:203] offset:0
v_mfma_f32_16x16x32_bf16 v[76:79], v[104:107], a[36:39], v[76:79]
ds_read_b128 v[128:131], v2 offset:26624
v_cvt_pk_bf16_f32 v253, v70, v71
v_mfma_f32_16x16x32_bf16 v[84:87], v[108:111], a[36:39], v[84:87]
buffer_load_dwordx4 v1, s[4:7], s52 offen offset:2048 sc1 lds
v_mfma_f32_16x16x32_bf16 v[80:83], v[108:111], a[32:35], v[80:83]
s_waitcnt lgkmcnt(4)
ds_read_b128 v[132:135], v2 offset:27648
v_lshrrev_b32 v224, 9, v1
v_mfma_f32_16x16x32_bf16 v[72:75], v[112:115], a[40:43], v[72:75]
v_lshlrev_b32 v224, 2, v224
v_bfe_u32 v225, v1, 4, 5
v_mfma_f32_16x16x32_bf16 v[76:79], v[112:115], a[44:47], v[76:79]
ds_read_b128 v[104:107], v2 offset:28672
v_sub_u32 v224, v225, v224
v_mfma_f32_16x16x32_bf16 v[84:87], v[116:119], a[44:47], v[84:87]
v_mov_b32 v225, 4048155338
v_mfma_f32_16x16x32_bf16 v[80:83], v[116:119], a[40:43], v[80:83]
s_waitcnt lgkmcnt(4)
ds_read_b128 v[108:111], v2 offset:29696
v_mfma_f32_16x16x32_bf16 v[72:75], v[120:123], a[48:51], v[72:75]
buffer_load_dwordx4 v1, s[4:7], s52 offen offset:3072 sc1 lds
v_mfma_f32_16x16x32_bf16 v[76:79], v[120:123], a[52:55], v[76:79]
s_mul_i32 s53, s18, 4096
ds_read_b128 v[112:115], v2 offset:30720
ds_write_b128 v237, v[204:207] offset:256
v_mfma_f32_16x16x32_bf16 v[84:87], v[124:127], a[52:55], v[84:87]
s_add_u32 m0, s53, 137216
v_permlane16_swap_b32 v244, v252
v_mfma_f32_16x16x32_bf16 v[80:83], v[124:127], a[48:51], v[80:83]
s_waitcnt lgkmcnt(4)
ds_read_b128 v[116:119], v2 offset:31744
s_add_u32 s52, s28, s53
v_mfma_f32_16x16x32_bf16 v[72:75], v[128:131], a[56:59], v[72:75]
s_add_u32 s52, s52, 131072
s_waitcnt vmcnt(7)
s_mov_b64 exec, 1
buffer_atomic_add v13, v12, s[4:7], s25 offen sc1
s_mov_b64 exec, -1
v_mfma_f32_16x16x32_bf16 v[76:79], v[128:131], a[60:63], v[76:79]
ds_read_b128 v[120:123], v2 offset:32768
v_mfma_f32_16x16x32_bf16 v[84:87], v[132:135], a[60:63], v[84:87]
buffer_load_dwordx4 v1, s[4:7], s52 offen offset:0 sc1 lds
v_mfma_f32_16x16x32_bf16 v[80:83], v[132:135], a[56:59], v[80:83]
s_waitcnt lgkmcnt(4)
ds_read_b128 v[124:127], v2 offset:33792
v_mfma_f32_16x16x32_bf16 v[72:75], v[104:107], a[64:67], v[72:75]
v_permlane16_swap_b32 v245, v253
v_mfma_f32_16x16x32_bf16 v[76:79], v[104:107], a[68:71], v[76:79]
ds_read_b128 v[128:131], v2 offset:34816
ds_write_b128 v238, v[208:211] offset:2176
v_mfma_f32_16x16x32_bf16 v[84:87], v[108:111], a[68:71], v[84:87]
v_cndmask_b32 v244, v244, 0, s[44:45]
v_cndmask_b32 v245, v245, 0, s[44:45]
v_mfma_f32_16x16x32_bf16 v[80:83], v[108:111], a[64:67], v[80:83]
s_waitcnt lgkmcnt(4)
ds_read_b128 v[132:135], v2 offset:35840
v_cndmask_b32 v252, v252, 0, s[44:45]
v_mfma_f32_16x16x32_bf16 v[72:75], v[112:115], a[72:75], v[72:75]
s_barrier
v_mfma_f32_16x16x32_bf16 v[76:79], v[112:115], a[76:79], v[76:79]
ds_read_b128 v[104:107], v2 offset:36864
v_cndmask_b32 v253, v253, 0, s[44:45]
v_mfma_f32_16x16x32_bf16 v[84:87], v[116:119], a[76:79], v[84:87]
buffer_load_dwordx4 v1, s[4:7], s52 offen offset:1024 sc1 lds
v_mfma_f32_16x16x32_bf16 v[80:83], v[116:119], a[72:75], v[80:83]
s_waitcnt lgkmcnt(4)
ds_read_b128 v[108:111], v2 offset:37888
v_cmp_le_i32 s[62:63], 0, v224
v_mfma_f32_16x16x32_bf16 v[72:75], v[120:123], a[80:83], v[72:75]
v_cmp_le_i32 s[64:65], 1, v224
v_cndmask_b32 v136, 0, v225, s[62:63]
v_mfma_f32_16x16x32_bf16 v[76:79], v[120:123], a[84:87], v[76:79]
ds_read_b128 v[112:115], v2 offset:38912
ds_write_b128 v238, v[220:223] offset:40576
v_mfma_f32_16x16x32_bf16 v[84:87], v[124:127], a[84:87], v[84:87]
v_cndmask_b32 v152, v225, 0, s[62:63]
v_cmp_le_i32 s[62:63], 2, v224
v_mfma_f32_16x16x32_bf16 v[80:83], v[124:127], a[80:83], v[80:83]
s_waitcnt lgkmcnt(4)
ds_read_b128 v[116:119], v2 offset:39936
v_cndmask_b32 v137, 0, v225, s[64:65]
v_mfma_f32_16x16x32_bf16 v[72:75], v[128:131], a[88:91], v[72:75]
buffer_load_dwordx4 v1, s[4:7], s52 offen offset:2048 sc1 lds
v_mfma_f32_16x16x32_bf16 v[76:79], v[128:131], a[92:95], v[76:79]
ds_read_b128 v[120:123], v2 offset:40960
v_cndmask_b32 v153, v225, 0, s[64:65]
v_mfma_f32_16x16x32_bf16 v[84:87], v[132:135], a[92:95], v[84:87]
v_cmp_le_i32 s[64:65], 3, v224
v_cndmask_b32 v138, 0, v225, s[62:63]
v_mfma_f32_16x16x32_bf16 v[80:83], v[132:135], a[88:91], v[80:83]
s_waitcnt lgkmcnt(4)
ds_read_b128 v[124:127], v2 offset:41984
v_cndmask_b32 v154, v225, 0, s[62:63]
v_mfma_f32_16x16x32_bf16 v[72:75], v[104:107], a[96:99], v[72:75]
v_cmp_le_i32 s[62:63], 8, v224
v_cndmask_b32 v139, 0, v225, s[64:65]
v_mfma_f32_16x16x32_bf16 v[76:79], v[104:107], a[100:103], v[76:79]
ds_read_b128 v[128:131], v2 offset:43008
v_cndmask_b32 v155, v225, 0, s[64:65]
v_mfma_f32_16x16x32_bf16 v[84:87], v[108:111], a[100:103], v[84:87]
buffer_load_dwordx4 v1, s[4:7], s52 offen offset:3072 sc1 lds
v_mfma_f32_16x16x32_bf16 v[80:83], v[108:111], a[96:99], v[80:83]
s_waitcnt lgkmcnt(3)
ds_read_b128 v[132:135], v2 offset:44032
s_mul_i32 s53, s18, 2048
v_mfma_f32_16x16x32_bf16 v[72:75], v[112:115], a[104:107], v[72:75]
s_add_u32 m0, s53, 151552
v_cmp_le_i32 s[64:65], 9, v224
s_add_u32 s52, s28, s53
v_mfma_f32_16x16x32_bf16 v[76:79], v[112:115], a[108:111], v[76:79]
s_add_u32 s52, s52, 145408
ds_read_b128 v[104:107], v2 offset:45056
v_cndmask_b32 v140, 0, v225, s[62:63]
v_mfma_f32_16x16x32_bf16 v[84:87], v[116:119], a[108:111], v[84:87]
v_cndmask_b32 v156, v225, 0, s[62:63]
v_cmp_le_i32 s[62:63], 10, v224
v_mfma_f32_16x16x32_bf16 v[80:83], v[116:119], a[104:107], v[80:83]
s_waitcnt lgkmcnt(3)
ds_read_b128 v[108:111], v2 offset:46080
v_cndmask_b32 v141, 0, v225, s[64:65]
v_mfma_f32_16x16x32_bf16 v[72:75], v[120:123], a[112:115], v[72:75]
buffer_load_dwordx4 v1, s[4:7], s52 offen offset:0 sc1 lds
v_mfma_f32_16x16x32_bf16 v[76:79], v[120:123], a[116:119], v[76:79]
ds_read_b128 v[112:115], v2 offset:47104
v_cndmask_b32 v157, v225, 0, s[64:65]
v_mfma_f32_16x16x32_bf16 v[84:87], v[124:127], a[116:119], v[84:87]
v_cmp_le_i32 s[64:65], 11, v224
v_cndmask_b32 v142, 0, v225, s[62:63]
v_mfma_f32_16x16x32_bf16 v[80:83], v[124:127], a[112:115], v[80:83]
s_waitcnt lgkmcnt(3)
ds_read_b128 v[116:119], v2 offset:48128
v_cndmask_b32 v158, v225, 0, s[62:63]
v_mfma_f32_16x16x32_bf16 v[72:75], v[128:131], a[120:123], v[72:75]
s_mov_b32 s70, Lc11-C_pc+2048
buffer_store_dwordx4 v[220:223], v234, s[4:7], s56 offen offset:2176 sc1
v_mfma_f32_16x16x32_bf16 v[76:79], v[128:131], a[124:127], v[76:79]
s_min_u32 s70, s70, M_text_end-C_pc-16384
ds_read_b128 v[120:123], v2 offset:49152
v_cmp_le_i32 s[62:63], 16, v224
v_mfma_f32_16x16x32_bf16 v[84:87], v[132:135], a[124:127], v[84:87]
buffer_load_dwordx4 v1, s[4:7], s52 offen offset:1024 sc1 lds
v_mfma_f32_16x16x32_bf16 v[80:83], v[132:135], a[120:123], v[80:83]
s_waitcnt lgkmcnt(3)
ds_read_b128 v[124:127], v2 offset:50176
v_cndmask_b32 v143, 0, v225, s[64:65]
v_mfma_f32_16x16x32_bf16 v[72:75], v[104:107], a[128:131], v[72:75]
v_cndmask_b32 v159, v225, 0, s[64:65]
v_cmp_le_i32 s[64:65], 17, v224
v_mfma_f32_16x16x32_bf16 v[76:79], v[104:107], a[132:135], v[76:79]
ds_read_b128 v[128:131], v2 offset:51200
v_cndmask_b32 v144, 0, v225, s[62:63]
v_mfma_f32_16x16x32_bf16 v[84:87], v[108:111], a[132:135], v[84:87]
v_cndmask_b32 v160, v225, 0, s[62:63]
v_cmp_le_i32 s[62:63], 18, v224
v_mfma_f32_16x16x32_bf16 v[80:83], v[108:111], a[128:131], v[80:83]
s_waitcnt lgkmcnt(3)
ds_read_b128 v[132:135], v2 offset:52224
v_cndmask_b32 v145, 0, v225, s[64:65]
v_mfma_f32_16x16x32_bf16 v[72:75], v[112:115], a[136:139], v[72:75]
s_waitcnt vmcnt(8)
s_barrier
v_mfma_f32_16x16x32_bf16 v[76:79], v[112:115], a[140:143], v[76:79]
ds_read_b128 v[104:107], v2 offset:53248
v_cndmask_b32 v161, v225, 0, s[64:65]
v_mfma_f32_16x16x32_bf16 v[84:87], v[116:119], a[140:143], v[84:87]
v_cmp_le_i32 s[64:65], 19, v224
v_cndmask_b32 v146, 0, v225, s[62:63]
v_mfma_f32_16x16x32_bf16 v[80:83], v[116:119], a[136:139], v[80:83]
s_waitcnt lgkmcnt(3)
ds_read_b128 v[108:111], v2 offset:54272
v_cndmask_b32 v162, v225, 0, s[62:63]
v_mfma_f32_16x16x32_bf16 v[72:75], v[120:123], a[144:147], v[72:75]
v_cmp_le_i32 s[62:63], 24, v224
v_cndmask_b32 v147, 0, v225, s[64:65]
v_mfma_f32_16x16x32_bf16 v[76:79], v[120:123], a[148:151], v[76:79]
ds_read_b128 v[112:115], v2 offset:55296
v_cndmask_b32 v163, v225, 0, s[64:65]
v_mfma_f32_16x16x32_bf16 v[84:87], v[124:127], a[148:151], v[84:87]
v_cmp_le_i32 s[64:65], 25, v224
v_cndmask_b32 v148, 0, v225, s[62:63]
v_mfma_f32_16x16x32_bf16 v[80:83], v[124:127], a[144:147], v[80:83]
s_waitcnt lgkmcnt(3)
ds_read_b128 v[116:119], v2 offset:56320
v_cndmask_b32 v164, v225, 0, s[62:63]
v_mfma_f32_16x16x32_bf16 v[72:75], v[128:131], a[152:155], v[72:75]
v_cmp_le_i32 s[62:63], 26, v224
v_cndmask_b32 v149, 0, v225, s[64:65]
v_mfma_f32_16x16x32_bf16 v[76:79], v[128:131], a[156:159], v[76:79]
ds_read_b128 v[120:123], v2 offset:57344
v_cndmask_b32 v165, v225, 0, s[64:65]
v_mfma_f32_16x16x32_bf16 v[84:87], v[132:135], a[156:159], v[84:87]
v_cmp_le_i32 s[64:65], 27, v224
v_cndmask_b32 v150, 0, v225, s[62:63]
v_mfma_f32_16x16x32_bf16 v[80:83], v[132:135], a[152:155], v[80:83]
s_waitcnt lgkmcnt(3)
ds_read_b128 v[124:127], v2 offset:58368
v_cndmask_b32 v166, v225, 0, s[62:63]
v_mfma_f32_16x16x32_bf16 v[88:91], v[104:107], a[0:3], 0
v_cndmask_b32 v151, 0, v225, s[64:65]
v_cndmask_b32 v167, v225, 0, s[64:65]
v_mfma_f32_16x16x32_bf16 v[92:95], v[104:107], a[4:7], 0
s_add_u32 s36, s36, 6553600
ds_read_b128 v[128:131], v2 offset:59392
v_mfma_f32_16x16x32_bf16 v[100:103], v[108:111], a[4:7], 0
s_add_u32 s70, s70, s74
s_addc_u32 s71, s75, 0
v_mfma_f32_16x16x32_bf16 v[96:99], v[108:111], a[0:3], 0
s_waitcnt lgkmcnt(3)
ds_read_b128 v[132:135], v2 offset:60416
v_mfma_f32_16x16x32_bf16 v[88:91], v[112:115], a[8:11], v[88:91]
s_mov_b64 exec, 24
buffer_load_dword v15, v37, s[4:7], 0 offen sc1
s_mov_b64 exec, -1
v_mfma_f32_16x16x32_bf16 v[92:95], v[112:115], a[12:15], v[92:95]
ds_read_b128 v[104:107], v2 offset:61440
v_fma_f32 v72, v72, v232, v168
v_mfma_f32_16x16x32_bf16 v[100:103], v[116:119], a[12:15], v[100:103]
v_fma_f32 v73, v73, v232, v169
v_fma_f32 v74, v74, v232, v170
v_mfma_f32_16x16x32_bf16 v[96:99], v[116:119], a[8:11], v[96:99]
s_waitcnt lgkmcnt(3)
ds_read_b128 v[108:111], v2 offset:62464
v_fma_f32 v75, v75, v232, v171
v_mfma_f32_16x16x32_bf16 v[88:91], v[120:123], a[16:19], v[88:91]
v_cvt_pk_bf16_f32 v212, v72, v73
v_cvt_pk_bf16_f32 v213, v74, v75
v_mfma_f32_16x16x32_bf16 v[92:95], v[120:123], a[20:23], v[92:95]
ds_read_b128 v[112:115], v2 offset:63488
v_fma_f32 v80, v80, v232, v176
v_mfma_f32_16x16x32_bf16 v[100:103], v[124:127], a[20:23], v[100:103]
v_fma_f32 v81, v81, v232, v177
v_fma_f32 v82, v82, v232, v178
v_mfma_f32_16x16x32_bf16 v[96:99], v[124:127], a[16:19], v[96:99]
s_waitcnt lgkmcnt(3)
ds_read_b128 v[116:119], v2 offset:64512
v_fma_f32 v83, v83, v232, v179
v_mfma_f32_16x16x32_bf16 v[88:91], v[128:131], a[24:27], v[88:91]
v_cvt_pk_bf16_f32 v214, v80, v81
v_cvt_pk_bf16_f32 v215, v82, v83
v_mfma_f32_16x16x32_bf16 v[92:95], v[128:131], a[28:31], v[92:95]
ds_read_b128 v[120:123], v3 offset:0
ds_write_b128 v237, v[212:215] offset:38400
v_mfma_f32_16x16x32_bf16 v[100:103], v[132:135], a[28:31], v[100:103]
buffer_store_dwordx4 v[212:215], v39, s[4:7], s56 offen offset:0 sc1
v_mfma_f32_16x16x32_bf16 v[96:99], v[132:135], a[24:27], v[96:99]
s_waitcnt lgkmcnt(4)
ds_read_b128 v[124:127], v3 offset:1024
v_fma_f32 v76, v76, v233, v172
v_mfma_f32_16x16x32_bf16 v[88:91], v[104:107], a[32:35], v[88:91]
v_fma_f32 v77, v77, v233, v173
v_fma_f32 v78, v78, v233, v174
v_mfma_f32_16x16x32_bf16 v[92:95], v[104:107], a[36:39], v[92:95]
ds_read_b128 v[128:131], v3 offset:2048
v_fma_f32 v79, v79, v233, v175
v_mfma_f32_16x16x32_bf16 v[100:103], v[108:111], a[36:39], v[100:103]
v_cvt_pk_bf16_f32 v216, v76, v77
v_cvt_pk_bf16_f32 v217, v78, v79
v_mfma_f32_16x16x32_bf16 v[96:99], v[108:111], a[32:35], v[96:99]
s_waitcnt lgkmcnt(4)
ds_read_b128 v[132:135], v3 offset:3072
v_fma_f32 v84, v84, v233, v180
v_mfma_f32_16x16x32_bf16 v[88:91], v[112:115], a[40:43], v[88:91]
s_waitcnt vmcnt(5)
s_barrier
s_mov_b64 exec, 1
Lc11:
global_load_dword v235, v0, s[70:71]
s_mov_b64 exec, -1
v_mfma_f32_16x16x32_bf16 v[92:95], v[112:115], a[44:47], v[92:95]
ds_read_b128 v[104:107], v3 offset:4096
v_fma_f32 v85, v85, v233, v181
v_mfma_f32_16x16x32_bf16 v[100:103], v[116:119], a[44:47], v[100:103]
v_fma_f32 v86, v86, v233, v182
v_fma_f32 v87, v87, v233, v183
v_mfma_f32_16x16x32_bf16 v[96:99], v[116:119], a[40:43], v[96:99]
s_waitcnt lgkmcnt(3)
ds_read_b128 v[108:111], v3 offset:5120
v_cvt_pk_bf16_f32 v218, v84, v85
v_mfma_f32_16x16x32_bf16 v[88:91], v[120:123], a[48:51], v[88:91]
v_cvt_pk_bf16_f32 v219, v86, v87
v_mfma_f32_16x16x32_bf16 v[92:95], v[120:123], a[52:55], v[92:95]
ds_read_b128 v[112:115], v3 offset:6144
ds_write_b128 v237, v[216:219] offset:38656
v_mfma_f32_16x16x32_bf16 v[100:103], v[124:127], a[52:55], v[100:103]
buffer_store_dwordx4 v[216:219], v39, s[4:7], s56 offen offset:256 sc1
v_mfma_f32_16x16x32_bf16 v[96:99], v[124:127], a[48:51], v[96:99]
s_waitcnt lgkmcnt(4)
ds_read_b128 v[116:119], v3 offset:7168
s_waitcnt vmcnt(3)
v_cmp_gt_u32 s[58:59], 4, v15
v_mfma_f32_16x16x32_bf16 v[88:91], v[128:131], a[56:59], v[88:91]
ds_read_b128 v[40:43], v9 offset:25600
v_mfma_f32_16x16x32_bf16 v[92:95], v[128:131], a[60:63], v[92:95]
ds_read_b128 v[120:123], v3 offset:8192
v_mfma_f32_16x16x32_bf16 v[100:103], v[132:135], a[60:63], v[100:103]
ds_read_b128 v[44:47], v9 offset:27776
v_mfma_f32_16x16x32_bf16 v[96:99], v[132:135], a[56:59], v[96:99]
s_waitcnt lgkmcnt(6)
ds_read_b128 v[124:127], v3 offset:9216
s_and_b32 s58, s58, s26
s_cbranch_scc1 Lq7
Lr8:
v_mfma_f32_16x16x32_bf16 v[88:91], v[104:107], a[64:67], v[88:91]
s_mul_i32 s51, s18, 3200
ds_read_b128 v[48:51], v239 offset:25600
s_add_u32 m0, s51, 12800
v_mfma_f32_16x16x32_bf16 v[92:95], v[104:107], a[68:71], v[92:95]
ds_read_b128 v[128:131], v3 offset:10240
v_mfma_f32_16x16x32_bf16 v[100:103], v[108:111], a[68:71], v[100:103]
ds_read_b128 v[52:55], v239 offset:27776
v_mfma_f32_16x16x32_bf16 v[96:99], v[108:111], a[64:67], v[96:99]
s_waitcnt lgkmcnt(7)
ds_read_b128 v[132:135], v3 offset:11264
v_mfma_f32_16x16x32_bf16 v[88:91], v[112:115], a[72:75], v[88:91]
buffer_load_dwordx4 v1, s[4:7], s37 offen offset:0 sc1 lds
v_mfma_f32_16x16x32_bf16 v[92:95], v[112:115], a[76:79], v[92:95]
ds_read_b128 v[104:107], v3 offset:12288
v_mfma_f32_16x16x32_bf16 v[100:103], v[116:119], a[76:79], v[100:103]
v_mfma_f32_16x16x32_bf16 v[96:99], v[116:119], a[72:75], v[96:99]
s_waitcnt lgkmcnt(5)
ds_read_b128 v[108:111], v3 offset:13312
v_mfma_f32_16x16x32_bf16 v[88:91], v[120:123], a[80:83], v[88:91]
buffer_load_dwordx4 v1, s[4:7], s37 offen offset:2176 sc1 lds
v_mfma_f32_16x16x32_bf16 v[92:95], v[120:123], a[84:87], v[92:95]
ds_read_b128 v[112:115], v3 offset:14336
v_mfma_f32_16x16x32_bf16 v[100:103], v[124:127], a[84:87], v[100:103]
v_mfma_f32_16x16x32_bf16 v[96:99], v[124:127], a[80:83], v[96:99]
s_waitcnt lgkmcnt(3)
ds_read_b128 v[116:119], v3 offset:15360
v_mfma_f32_16x16x32_bf16 v[88:91], v[128:131], a[88:91], v[88:91]
buffer_load_dwordx4 v1, s[4:7], s37 offen offset:1024 sc1 lds
v_mfma_f32_16x16x32_bf16 v[92:95], v[128:131], a[92:95], v[92:95]
s_sub_u32 m0, m0, 12800
ds_read_b128 v[120:123], v3 offset:16384
v_mfma_f32_16x16x32_bf16 v[100:103], v[132:135], a[92:95], v[100:103]
v_mfma_f32_16x16x32_bf16 v[96:99], v[132:135], a[88:91], v[96:99]
s_waitcnt lgkmcnt(3)
ds_read_b128 v[124:127], v3 offset:17408
v_mfma_f32_16x16x32_bf16 v[88:91], v[104:107], a[96:99], v[88:91]
buffer_load_dwordx4 v1, s[4:7], s79 offen offset:0 sc1 lds
v_mfma_f32_16x16x32_bf16 v[92:95], v[104:107], a[100:103], v[92:95]
ds_read_b128 v[128:131], v3 offset:18432
v_mfma_f32_16x16x32_bf16 v[100:103], v[108:111], a[100:103], v[100:103]
v_mfma_f32_16x16x32_bf16 v[96:99], v[108:111], a[96:99], v[96:99]
s_waitcnt lgkmcnt(3)
ds_read_b128 v[132:135], v3 offset:19456
v_mfma_f32_16x16x32_bf16 v[88:91], v[112:115], a[104:107], v[88:91]
s_barrier
v_mfma_f32_16x16x32_bf16 v[92:95], v[112:115], a[108:111], v[92:95]
ds_read_b128 v[104:107], v3 offset:20480
v_lshlrev_b32 v16, 16, v26
v_mfma_f32_16x16x32_bf16 v[100:103], v[116:119], a[108:111], v[100:103]
buffer_load_dwordx4 v1, s[4:7], s79 offen offset:2176 sc1 lds
v_mfma_f32_16x16x32_bf16 v[96:99], v[116:119], a[104:107], v[96:99]
s_waitcnt lgkmcnt(3)
ds_read_b128 v[108:111], v3 offset:21504
v_and_b32 v17, 0xffff0000, v26
v_mfma_f32_16x16x32_bf16 v[88:91], v[120:123], a[112:115], v[88:91]
v_lshlrev_b32 v18, 16, v27
v_and_b32 v19, 0xffff0000, v27
v_mfma_f32_16x16x32_bf16 v[92:95], v[120:123], a[116:119], v[92:95]
ds_read_b128 v[112:115], v3 offset:22528
v_lshlrev_b32 v20, 16, v28
v_mfma_f32_16x16x32_bf16 v[100:103], v[124:127], a[116:119], v[100:103]
buffer_load_dwordx4 v1, s[4:7], s79 offen offset:1024 sc1 lds
v_mfma_f32_16x16x32_bf16 v[96:99], v[124:127], a[112:115], v[96:99]
s_waitcnt lgkmcnt(3)
ds_read_b128 v[116:119], v3 offset:23552
s_mul_i32 s51, s42, 3200
v_mfma_f32_16x16x32_bf16 v[88:91], v[128:131], a[120:123], v[88:91]
s_add_u32 s37, s37, s51
v_and_b32 v21, 0xffff0000, v28
s_mul_i32 s51, s43, 3200
v_mfma_f32_16x16x32_bf16 v[92:95], v[128:131], a[124:127], v[92:95]
s_add_u32 s79, s79, s51
ds_read_b128 v[120:123], v3 offset:24576
v_lshlrev_b32 v22, 16, v29
v_mfma_f32_16x16x32_bf16 v[100:103], v[132:135], a[124:127], v[100:103]
s_mov_b64 exec, 7
buffer_load_dword v15, v37, s[4:7], 0 offen sc1
s_mov_b64 exec, -1
v_mfma_f32_16x16x32_bf16 v[96:99], v[132:135], a[120:123], v[96:99]
s_waitcnt lgkmcnt(3)
ds_read_b128 v[124:127], v3 offset:25600
v_and_b32 v23, 0xffff0000, v29
v_mfma_f32_16x16x32_bf16 v[88:91], v[104:107], a[128:131], v[88:91]
v_lshlrev_b32 v24, 16, v30
v_and_b32 v25, 0xffff0000, v30
v_mfma_f32_16x16x32_bf16 v[92:95], v[104:107], a[132:135], v[92:95]
ds_read_b128 v[128:131], v3 offset:26624
v_lshlrev_b32 v26, 16, v31
v_mfma_f32_16x16x32_bf16 v[100:103], v[108:111], a[132:135], v[100:103]
s_waitcnt vmcnt(7)
s_mov_b64 exec, 1
buffer_atomic_add v13, v12, s[4:7], s25 offen sc1
s_mov_b64 exec, -1
v_mfma_f32_16x16x32_bf16 v[96:99], v[108:111], a[128:131], v[96:99]
s_waitcnt lgkmcnt(3)
ds_read_b128 v[132:135], v3 offset:27648
v_and_b32 v27, 0xffff0000, v31
v_mfma_f32_16x16x32_bf16 v[88:91], v[112:115], a[136:139], v[88:91]
v_lshlrev_b32 v28, 16, v32
v_and_b32 v29, 0xffff0000, v32
v_mfma_f32_16x16x32_bf16 v[92:95], v[112:115], a[140:143], v[92:95]
v_lshlrev_b32 v30, 16, v33
v_and_b32 v31, 0xffff0000, v33
v_mfma_f32_16x16x32_bf16 v[100:103], v[116:119], a[140:143], v[100:103]
v_lshlrev_b32 v32, 16, v34
v_and_b32 v33, 0xffff0000, v34
v_mfma_f32_16x16x32_bf16 v[96:99], v[116:119], a[136:139], v[96:99]
s_waitcnt lgkmcnt(2)
v_lshlrev_b32 v34, 16, v35
v_and_b32 v35, 0xffff0000, v35
v_mfma_f32_16x16x32_bf16 v[88:91], v[120:123], a[144:147], v[88:91]
v_mfma_f32_16x16x32_bf16 v[92:95], v[120:123], a[148:151], v[92:95]
v_mfma_f32_16x16x32_bf16 v[100:103], v[124:127], a[148:151], v[100:103]
v_mfma_f32_16x16x32_bf16 v[96:99], v[124:127], a[144:147], v[96:99]
s_waitcnt lgkmcnt(0)
v_mfma_f32_16x16x32_bf16 v[88:91], v[128:131], a[152:155], v[88:91]
v_mfma_f32_16x16x32_bf16 v[92:95], v[128:131], a[156:159], v[92:95]
v_mfma_f32_16x16x32_bf16 v[100:103], v[132:135], a[156:159], v[100:103]
v_mfma_f32_16x16x32_bf16 v[96:99], v[132:135], a[152:155], v[96:99]
v_mov_b32 v224, 0
v_mov_b32 v225, 0
s_nop 2
v_pk_fma_f32 v[88:89], v[88:89], v[230:231], v[184:185] op_sel:[0,0,0] op_sel_hi:[1,0,1]
v_pk_fma_f32 v[90:91], v[90:91], v[230:231], v[186:187] op_sel:[0,0,0] op_sel_hi:[1,0,1]
v_cvt_pk_bf16_f32 v240, v88, v89
v_cvt_pk_bf16_f32 v241, v90, v91
v_pk_fma_f32 v[92:93], v[92:93], v[230:231], v[188:189] op_sel:[0,1,0] op_sel_hi:[1,1,1]
v_pk_fma_f32 v[94:95], v[94:95], v[230:231], v[190:191] op_sel:[0,1,0] op_sel_hi:[1,1,1]
v_cvt_pk_bf16_f32 v248, v92, v93
v_cvt_pk_bf16_f32 v249, v94, v95
v_pk_fma_f32 v[96:97], v[96:97], v[230:231], v[192:193] op_sel:[0,0,0] op_sel_hi:[1,0,1]
v_pk_fma_f32 v[98:99], v[98:99], v[230:231], v[194:195] op_sel:[0,0,0] op_sel_hi:[1,0,1]
v_cvt_pk_bf16_f32 v242, v96, v97
v_cvt_pk_bf16_f32 v243, v98, v99
v_pk_fma_f32 v[100:101], v[100:101], v[230:231], v[196:197] op_sel:[0,1,0] op_sel_hi:[1,1,1]
v_pk_fma_f32 v[102:103], v[102:103], v[230:231], v[198:199] op_sel:[0,1,0] op_sel_hi:[1,1,1]
v_cvt_pk_bf16_f32 v250, v100, v101
v_cvt_pk_bf16_f32 v251, v102, v103
v_dot2c_f32_bf16 v224, v44, v244
v_dot2c_f32_bf16 v225, v52, v252
v_dot2c_f32_bf16 v224, v45, v245
v_dot2c_f32_bf16 v225, v53, v253
v_permlane16_swap_b32 v240, v248
v_permlane16_swap_b32 v241, v249
v_permlane16_swap_b32 v242, v250
v_permlane16_swap_b32 v243, v251
v_dot2c_f32_bf16 v224, v40, v240
v_dot2c_f32_bf16 v225, v48, v248
v_dot2c_f32_bf16 v224, v41, v241
v_dot2c_f32_bf16 v225, v49, v249
v_dot2c_f32_bf16 v224, v42, v242
v_dot2c_f32_bf16 v225, v50, v250
v_dot2c_f32_bf16 v224, v43, v243
v_dot2c_f32_bf16 v225, v51, v251
v_mfma_f32_32x32x16_bf16 v[64:79], v[40:43], v[240:243], v[152:167]
ds_read_b64_tr_b16 v[200:201], v10 offset:25600
ds_read_b64_tr_b16 v[202:203], v10 offset:25728
v_permlane32_swap_b32 v224, v225
v_add_f32 v224, v224, v225
v_cvt_pk_bf16_f32 v224, -v224, 0
v_cndmask_b32 v246, v224, 0, s[44:45]
v_cndmask_b32 v254, 0, v224, s[44:45]
s_nop 0
v_mfma_f32_32x32x16_bf16 v[64:79], v[44:47], v[244:247], v[64:79]
v_mfma_f32_32x32x16_bf16 v[80:95], v[48:51], v[248:251], v[152:167]
v_mfma_f32_32x32x16_bf16 v[80:95], v[52:55], v[252:255], v[80:95]
s_nop 9
v_exp_f32 v64, v64
v_exp_f32 v65, v65
v_exp_f32 v66, v66
v_exp_f32 v67, v67
v_cvt_pk_bf16_f32 v128, v64, v65
v_cvt_pk_bf16_f32 v129, v66, v67
s_waitcnt lgkmcnt(0)
v_exp_f32 v68, v68
v_exp_f32 v69, v69
v_exp_f32 v70, v70
v_exp_f32 v71, v71
v_cvt_pk_bf16_f32 v130, v68, v69
v_cvt_pk_bf16_f32 v131, v70, v71
s_waitcnt vmcnt(5)
s_barrier
ds_read_b128 v[56:59], v9 offset:22400
ds_read_b128 v[60:63], v9 offset:24576
Lr19:
s_waitcnt vmcnt(1)
v_and_b32 v238, 0xff, v15
v_readlane_b32 s56, v15, 2
v_cmp_gt_u32 s[58:59], 16, v238
s_lshl_b32 s57, s89, 4
s_and_b32 s58, s58, 7
s_cbranch_scc1 Lq18
Lr19a:
s_cmp_lg_u32 s56, s57
s_cselect_b64 vcc, -1, 0
ds_read_b64_tr_b16 v[204:205], v10 offset:25856
ds_read_b64_tr_b16 v[206:207], v10 offset:25984
v_exp_f32 v72, v72
v_exp_f32 v73, v73
v_exp_f32 v74, v74
v_exp_f32 v75, v75
v_cvt_pk_bf16_f32 v132, v72, v73
v_cvt_pk_bf16_f32 v133, v74, v75
v_mfma_f32_32x32x16_bf16 v[96:111], v[200:203], v[128:131], 0
ds_read_b64_tr_b16 v[200:201], v38 offset:25600
ds_read_b64_tr_b16 v[202:203], v38 offset:25728
s_mov_b64 exec, 24
buffer_load_dword v15, v37, s[4:7], 0 offen sc1
s_mov_b64 exec, -1
v_exp_f32 v76, v76
v_exp_f32 v77, v77
v_exp_f32 v78, v78
v_exp_f32 v79, v79
v_cvt_pk_bf16_f32 v134, v76, v77
v_cvt_pk_bf16_f32 v135, v78, v79
s_waitcnt lgkmcnt(5)
v_mfma_f32_32x32x16_bf16 v[64:79], v[56:59], v[240:243], 0
ds_read_b128 v[40:43], v9 offset:19200
ds_read_b128 v[44:47], v9 offset:21376
v_exp_f32 v80, v80
v_exp_f32 v81, v81
v_exp_f32 v82, v82
v_exp_f32 v83, v83
v_cvt_pk_bf16_f32 v128, v80, v81
v_cvt_pk_bf16_f32 v129, v82, v83
s_waitcnt lgkmcnt(6)
v_mfma_f32_32x32x16_bf16 v[64:79], v[60:63], v[244:247], v[64:79]
s_waitcnt lgkmcnt(2)
v_exp_f32 v84, v84
v_exp_f32 v85, v85
v_exp_f32 v86, v86
v_exp_f32 v87, v87
v_cvt_pk_bf16_f32 v130, v84, v85
v_cvt_pk_bf16_f32 v131, v86, v87
v_mfma_f32_32x32x16_bf16 v[96:111], v[204:207], v[132:135], v[96:111]
ds_read_b64_tr_b16 v[204:205], v38 offset:25856
ds_read_b64_tr_b16 v[206:207], v38 offset:25984
v_exp_f32 v88, v88
v_exp_f32 v89, v89
v_exp_f32 v90, v90
v_exp_f32 v91, v91
v_cvt_pk_bf16_f32 v132, v88, v89
v_cvt_pk_bf16_f32 v133, v90, v91
v_mfma_f32_32x32x16_bf16 v[112:127], v[200:203], v[128:131], 0
s_waitcnt lgkmcnt(2)
ds_read_b64_tr_b16 v[200:201], v10 offset:22400
ds_read_b64_tr_b16 v[202:203], v10 offset:22528
v_exp_f32 v92, v92
v_exp_f32 v93, v93
v_exp_f32 v94, v94
v_exp_f32 v95, v95
v_cvt_pk_bf16_f32 v134, v92, v93
v_cvt_pk_bf16_f32 v135, v94, v95
v_mfma_f32_32x32x16_bf16 v[80:95], v[40:43], v[240:243], 0
ds_read_b128 v[48:51], v9 offset:16000
ds_read_b128 v[52:55], v9 offset:18176
v_exp_f32 v64, v64
v_exp_f32 v65, v65
v_exp_f32 v66, v66
v_exp_f32 v67, v67
v_cvt_pk_bf16_f32 v128, v64, v65
v_cvt_pk_bf16_f32 v129, v66, v67
v_mfma_f32_32x32x16_bf16 v[80:95], v[44:47], v[244:247], v[80:95]
s_waitcnt lgkmcnt(2)
s_waitcnt vmcnt(0)
v_cmp_gt_u32 s[58:59], 8, v15
v_exp_f32 v68, v68
v_exp_f32 v69, v69
v_exp_f32 v70, v70
v_exp_f32 v71, v71
v_cvt_pk_bf16_f32 v130, v68, v69
v_cvt_pk_bf16_f32 v131, v70, v71
v_mfma_f32_32x32x16_bf16 v[112:127], v[204:207], v[132:135], v[112:127]
ds_read_b64_tr_b16 v[204:205], v10 offset:22656
ds_read_b64_tr_b16 v[206:207], v10 offset:22784
s_and_b32 s58, s58, s26
s_cbranch_scc1 Lq12
Lr13:
s_mul_i32 s51, s18, 3200
s_add_u32 m0, s51, 51200
v_exp_f32 v72, v72
v_exp_f32 v73, v73
v_exp_f32 v74, v74
v_exp_f32 v75, v75
v_cvt_pk_bf16_f32 v132, v72, v73
v_cvt_pk_bf16_f32 v133, v74, v75
v_mfma_f32_32x32x16_bf16 v[96:111], v[200:203], v[128:131], v[96:111]
s_waitcnt lgkmcnt(2)
ds_read_b64_tr_b16 v[200:201], v10 offset:19200
ds_read_b64_tr_b16 v[202:203], v10 offset:19328
buffer_load_dwordx4 v1, s[4:7], s37 offen offset:0 sc1 lds
buffer_load_dwordx4 v1, s[4:7], s37 offen offset:2176 sc1 lds
v_exp_f32 v76, v76
v_exp_f32 v77, v77
v_exp_f32 v78, v78
v_exp_f32 v79, v79
v_cvt_pk_bf16_f32 v134, v76, v77
v_cvt_pk_bf16_f32 v135, v78, v79
v_mfma_f32_32x32x16_bf16 v[64:79], v[48:51], v[240:243], 0
ds_read_b128 v[56:59], v9 offset:12800
ds_read_b128 v[60:63], v9 offset:14976
v_exp_f32 v80, v80
v_exp_f32 v81, v81
v_exp_f32 v82, v82
v_exp_f32 v83, v83
v_cvt_pk_bf16_f32 v128, v80, v81
v_cvt_pk_bf16_f32 v129, v82, v83
v_mfma_f32_32x32x16_bf16 v[64:79], v[52:55], v[244:247], v[64:79]
s_waitcnt lgkmcnt(2)
buffer_load_dwordx4 v1, s[4:7], s37 offen offset:1024 sc1 lds
v_exp_f32 v84, v84
v_exp_f32 v85, v85
v_exp_f32 v86, v86
v_exp_f32 v87, v87
v_cvt_pk_bf16_f32 v130, v84, v85
v_cvt_pk_bf16_f32 v131, v86, v87
v_mfma_f32_32x32x16_bf16 v[96:111], v[204:207], v[132:135], v[96:111]
s_sub_u32 m0, m0, 12800
ds_read_b64_tr_b16 v[204:205], v10 offset:19456
ds_read_b64_tr_b16 v[206:207], v10 offset:19584
v_exp_f32 v88, v88
v_exp_f32 v89, v89
v_exp_f32 v90, v90
v_exp_f32 v91, v91
v_cvt_pk_bf16_f32 v132, v88, v89
v_cvt_pk_bf16_f32 v133, v90, v91
v_mfma_f32_32x32x16_bf16 v[96:111], v[200:203], v[128:131], v[96:111]
s_waitcnt lgkmcnt(2)
ds_read_b64_tr_b16 v[200:201], v10 offset:16000
ds_read_b64_tr_b16 v[202:203], v10 offset:16128
buffer_load_dwordx4 v1, s[4:7], s79 offen offset:0 sc1 lds
buffer_load_dwordx4 v1, s[4:7], s79 offen offset:2176 sc1 lds
v_exp_f32 v92, v92
v_exp_f32 v93, v93
v_exp_f32 v94, v94
v_exp_f32 v95, v95
v_cvt_pk_bf16_f32 v134, v92, v93
v_cvt_pk_bf16_f32 v135, v94, v95
v_mfma_f32_32x32x16_bf16 v[80:95], v[56:59], v[240:243], 0
buffer_load_dwordx4 v1, s[4:7], s79 offen offset:1024 sc1 lds
s_mul_i32 s51, s42, 6550400
s_add_u32 s37, s37, s51
s_mul_i32 s51, s43, 6550400
s_add_u32 s79, s79, s51
s_add_u32 s54, s30, 0
v_exp_f32 v64, v64
v_exp_f32 v65, v65
v_exp_f32 v66, v66
v_exp_f32 v67, v67
v_cvt_pk_bf16_f32 v128, v64, v65
v_cvt_pk_bf16_f32 v129, v66, v67
v_mfma_f32_32x32x16_bf16 v[80:95], v[60:63], v[244:247], v[80:95]
s_waitcnt lgkmcnt(0)
buffer_load_dwordx4 a[0:3], v1, s[4:7], s54 offen offset:0 sc1
buffer_load_dwordx4 a[4:7], v1, s[4:7], s54 offen offset:1024 sc1
v_exp_f32 v68, v68
v_exp_f32 v69, v69
v_exp_f32 v70, v70
v_exp_f32 v71, v71
v_cvt_pk_bf16_f32 v130, v68, v69
v_cvt_pk_bf16_f32 v131, v70, v71
v_mfma_f32_32x32x16_bf16 v[96:111], v[204:207], v[132:135], v[96:111]
s_barrier
ds_read_b128 v[40:43], v9 offset:9600
ds_read_b128 v[44:47], v9 offset:11776
ds_read_b64_tr_b16 v[204:205], v10 offset:16256
ds_read_b64_tr_b16 v[206:207], v10 offset:16384
v_exp_f32 v72, v72
v_exp_f32 v73, v73
v_exp_f32 v74, v74
v_exp_f32 v75, v75
v_cvt_pk_bf16_f32 v132, v72, v73
v_cvt_pk_bf16_f32 v133, v74, v75
v_mfma_f32_32x32x16_bf16 v[96:111], v[200:203], v[128:131], v[96:111]
ds_read_b64_tr_b16 v[200:201], v10 offset:12800
ds_read_b64_tr_b16 v[202:203], v10 offset:12928
buffer_load_dwordx4 a[8:11], v1, s[4:7], s54 offen offset:2048 sc1
buffer_load_dwordx4 a[12:15], v1, s[4:7], s54 offen offset:3072 sc1
v_exp_f32 v76, v76
v_exp_f32 v77, v77
v_exp_f32 v78, v78
v_exp_f32 v79, v79
v_cvt_pk_bf16_f32 v134, v76, v77
v_cvt_pk_bf16_f32 v135, v78, v79
s_waitcnt lgkmcnt(5)
v_mfma_f32_32x32x16_bf16 v[64:79], v[40:43], v[240:243], 0
s_add_u32 s54, s54, 4096
ds_read_b128 v[48:51], v9 offset:6400
ds_read_b128 v[52:55], v9 offset:8576
v_exp_f32 v80, v80
v_exp_f32 v81, v81
v_exp_f32 v82, v82
v_exp_f32 v83, v83
v_cvt_pk_bf16_f32 v128, v80, v81
v_cvt_pk_bf16_f32 v129, v82, v83
s_waitcnt lgkmcnt(6)
v_mfma_f32_32x32x16_bf16 v[64:79], v[44:47], v[244:247], v[64:79]
s_waitcnt lgkmcnt(2)
buffer_load_dwordx4 a[16:19], v1, s[4:7], s54 offen offset:0 sc1
buffer_load_dwordx4 a[20:23], v1, s[4:7], s54 offen offset:1024 sc1
v_exp_f32 v84, v84
v_exp_f32 v85, v85
v_exp_f32 v86, v86
v_exp_f32 v87, v87
v_cvt_pk_bf16_f32 v130, v84, v85
v_cvt_pk_bf16_f32 v131, v86, v87
v_mfma_f32_32x32x16_bf16 v[96:111], v[204:207], v[132:135], v[96:111]
ds_read_b64_tr_b16 v[204:205], v10 offset:13056
ds_read_b64_tr_b16 v[206:207], v10 offset:13184
buffer_load_dwordx4 a[24:27], v1, s[4:7], s54 offen offset:2048 sc1
buffer_load_dwordx4 a[28:31], v1, s[4:7], s54 offen offset:3072 sc1
v_exp_f32 v88, v88
v_exp_f32 v89, v89
v_exp_f32 v90, v90
v_exp_f32 v91, v91
v_cvt_pk_bf16_f32 v132, v88, v89
v_cvt_pk_bf16_f32 v133, v90, v91
v_mfma_f32_32x32x16_bf16 v[96:111], v[200:203], v[128:131], v[96:111]
s_waitcnt lgkmcnt(2)
ds_read_b64_tr_b16 v[200:201], v10 offset:9600
ds_read_b64_tr_b16 v[202:203], v10 offset:9728
v_exp_f32 v92, v92
v_exp_f32 v93, v93
v_exp_f32 v94, v94
v_exp_f32 v95, v95
v_cvt_pk_bf16_f32 v134, v92, v93
v_cvt_pk_bf16_f32 v135, v94, v95
v_mfma_f32_32x32x16_bf16 v[80:95], v[48:51], v[240:243], 0
s_add_u32 s54, s54, 4096
ds_read_b128 v[56:59], v9 offset:3200
ds_read_b128 v[60:63], v9 offset:5376
v_exp_f32 v64, v64
v_exp_f32 v65, v65
v_exp_f32 v66, v66
v_exp_f32 v67, v67
v_cvt_pk_bf16_f32 v128, v64, v65
v_cvt_pk_bf16_f32 v129, v66, v67
v_mfma_f32_32x32x16_bf16 v[80:95], v[52:55], v[244:247], v[80:95]
s_waitcnt lgkmcnt(2)
buffer_load_dwordx4 a[32:35], v1, s[4:7], s54 offen offset:0 sc1
buffer_load_dwordx4 a[36:39], v1, s[4:7], s54 offen offset:1024 sc1
v_exp_f32 v68, v68
v_exp_f32 v69, v69
v_exp_f32 v70, v70
v_exp_f32 v71, v71
v_cvt_pk_bf16_f32 v130, v68, v69
v_cvt_pk_bf16_f32 v131, v70, v71
v_mfma_f32_32x32x16_bf16 v[96:111], v[204:207], v[132:135], v[96:111]
ds_read_b64_tr_b16 v[204:205], v10 offset:9856
ds_read_b64_tr_b16 v[206:207], v10 offset:9984
buffer_load_dwordx4 a[40:43], v1, s[4:7], s54 offen offset:2048 sc1
v_exp_f32 v72, v72
v_exp_f32 v73, v73
v_exp_f32 v74, v74
v_exp_f32 v75, v75
v_cvt_pk_bf16_f32 v132, v72, v73
v_cvt_pk_bf16_f32 v133, v74, v75
v_mfma_f32_32x32x16_bf16 v[96:111], v[200:203], v[128:131], v[96:111]
s_waitcnt lgkmcnt(2)
ds_read_b64_tr_b16 v[200:201], v10 offset:6400
ds_read_b64_tr_b16 v[202:203], v10 offset:6528
v_exp_f32 v76, v76
v_exp_f32 v77, v77
v_exp_f32 v78, v78
v_exp_f32 v79, v79
v_cvt_pk_bf16_f32 v134, v76, v77
v_cvt_pk_bf16_f32 v135, v78, v79
v_mfma_f32_32x32x16_bf16 v[64:79], v[56:59], v[240:243], 0
ds_read_b128 v[40:43], v9 offset:0
ds_read_b128 v[44:47], v9 offset:2176
v_exp_f32 v80, v80
v_exp_f32 v81, v81
v_exp_f32 v82, v82
v_exp_f32 v83, v83
v_cvt_pk_bf16_f32 v128, v80, v81
v_cvt_pk_bf16_f32 v129, v82, v83
v_mfma_f32_32x32x16_bf16 v[64:79], v[60:63], v[244:247], v[64:79]
s_waitcnt lgkmcnt(2)
buffer_load_dwordx4 a[44:47], v1, s[4:7], s54 offen offset:3072 sc1
v_exp_f32 v84, v84
v_exp_f32 v85, v85
v_exp_f32 v86, v86
v_exp_f32 v87, v87
v_cvt_pk_bf16_f32 v130, v84, v85
v_cvt_pk_bf16_f32 v131, v86, v87
v_mfma_f32_32x32x16_bf16 v[96:111], v[204:207], v[132:135], v[96:111]
s_add_u32 s54, s54, 4096
ds_read_b64_tr_b16 v[204:205], v10 offset:6656
ds_read_b64_tr_b16 v[206:207], v10 offset:6784
v_exp_f32 v88, v88
v_exp_f32 v89, v89
v_exp_f32 v90, v90
v_exp_f32 v91, v91
v_cvt_pk_bf16_f32 v132, v88, v89
v_cvt_pk_bf16_f32 v133, v90, v91
v_mfma_f32_32x32x16_bf16 v[96:111], v[200:203], v[128:131], v[96:111]
s_waitcnt lgkmcnt(2)
ds_read_b64_tr_b16 v[200:201], v10 offset:3200
ds_read_b64_tr_b16 v[202:203], v10 offset:3328
buffer_load_dwordx4 a[48:51], v1, s[4:7], s54 offen offset:0 sc1
buffer_load_dwordx4 a[52:55], v1, s[4:7], s54 offen offset:1024 sc1
v_exp_f32 v92, v92
v_exp_f32 v93, v93
v_exp_f32 v94, v94
v_exp_f32 v95, v95
v_cvt_pk_bf16_f32 v134, v92, v93
v_cvt_pk_bf16_f32 v135, v94, v95
v_mfma_f32_32x32x16_bf16 v[80:95], v[40:43], v[240:243], v[136:151]
buffer_load_dwordx4 a[56:59], v1, s[4:7], s54 offen offset:2048 sc1
v_exp_f32 v64, v64
v_exp_f32 v65, v65
v_exp_f32 v66, v66
v_exp_f32 v67, v67
v_cvt_pk_bf16_f32 v128, v64, v65
v_cvt_pk_bf16_f32 v129, v66, v67
v_mfma_f32_32x32x16_bf16 v[80:95], v[44:47], v[244:247], v[80:95]
s_waitcnt lgkmcnt(0)
buffer_load_dwordx4 a[60:63], v1, s[4:7], s54 offen offset:3072 sc1
v_exp_f32 v68, v68
v_exp_f32 v69, v69
v_exp_f32 v70, v70
v_exp_f32 v71, v71
v_cvt_pk_bf16_f32 v130, v68, v69
v_cvt_pk_bf16_f32 v131, v70, v71
v_mfma_f32_32x32x16_bf16 v[96:111], v[204:207], v[132:135], v[96:111]
s_waitcnt vmcnt(19)
s_barrier
ds_read_b128 v[48:51], v239 offset:22400
ds_read_b128 v[52:55], v239 offset:24576
ds_read_b64_tr_b16 v[204:205], v10 offset:3456
ds_read_b64_tr_b16 v[206:207], v10 offset:3584
s_add_u32 s54, s54, 4096
v_exp_f32 v72, v72
v_exp_f32 v73, v73
v_exp_f32 v74, v74
v_exp_f32 v75, v75
v_cvt_pk_bf16_f32 v132, v72, v73
v_cvt_pk_bf16_f32 v133, v74, v75
v_mfma_f32_32x32x16_bf16 v[96:111], v[200:203], v[128:131], v[96:111]
ds_read_b64_tr_b16 v[200:201], v10 offset:0
ds_read_b64_tr_b16 v[202:203], v10 offset:128
buffer_load_dwordx4 a[64:67], v1, s[4:7], s54 offen offset:0 sc1
buffer_load_dwordx4 a[68:71], v1, s[4:7], s54 offen offset:1024 sc1
v_exp_f32 v76, v76
v_exp_f32 v77, v77
v_exp_f32 v78, v78
v_exp_f32 v79, v79
v_cvt_pk_bf16_f32 v134, v76, v77
v_cvt_pk_bf16_f32 v135, v78, v79
s_waitcnt lgkmcnt(5)
v_mfma_f32_32x32x16_bf16 v[64:79], v[48:51], v[248:251], 0
ds_read_b128 v[56:59], v239 offset:19200
ds_read_b128 v[60:63], v239 offset:21376
v_exp_f32 v80, v80
v_exp_f32 v81, v81
v_exp_f32 v82, v82
v_exp_f32 v83, v83
v_cvt_pk_bf16_f32 v128, v80, v81
v_cvt_pk_bf16_f32 v129, v82, v83
s_waitcnt lgkmcnt(6)
v_mfma_f32_32x32x16_bf16 v[64:79], v[52:55], v[252:255], v[64:79]
s_waitcnt lgkmcnt(2)
buffer_load_dwordx4 a[72:75], v1, s[4:7], s54 offen offset:2048 sc1
v_exp_f32 v84, v84
v_exp_f32 v85, v85
v_exp_f32 v86, v86
v_exp_f32 v87, v87
v_cvt_pk_bf16_f32 v130, v84, v85
v_cvt_pk_bf16_f32 v131, v86, v87
v_mfma_f32_32x32x16_bf16 v[96:111], v[204:207], v[132:135], v[96:111]
ds_read_b64_tr_b16 v[204:205], v10 offset:256
ds_read_b64_tr_b16 v[206:207], v10 offset:384
buffer_load_dwordx4 a[76:79], v1, s[4:7], s54 offen offset:3072 sc1
s_mul_i32 s53, s18, 5120
s_add_u32 m0, s53, 77824
s_add_u32 s52, s29, s53
v_exp_f32 v88, v88
v_exp_f32 v89, v89
v_exp_f32 v90, v90
v_exp_f32 v91, v91
v_cvt_pk_bf16_f32 v132, v88, v89
v_cvt_pk_bf16_f32 v133, v90, v91
v_mfma_f32_32x32x16_bf16 v[96:111], v[200:203], v[128:131], v[96:111]
s_waitcnt lgkmcnt(2)
ds_read_b64_tr_b16 v[200:201], v38 offset:22400
ds_read_b64_tr_b16 v[202:203], v38 offset:22528
buffer_load_dwordx4 v1, s[4:7], s52 offen offset:0 sc1 lds
v_exp_f32 v92, v92
v_exp_f32 v93, v93
v_exp_f32 v94, v94
v_exp_f32 v95, v95
v_cvt_pk_bf16_f32 v134, v92, v93
v_cvt_pk_bf16_f32 v135, v94, v95
v_mfma_f32_32x32x16_bf16 v[80:95], v[56:59], v[248:251], 0
ds_read_b128 v[40:43], v239 offset:16000
ds_read_b128 v[44:47], v239 offset:18176
v_exp_f32 v64, v64
v_exp_f32 v65, v65
v_exp_f32 v66, v66
v_exp_f32 v67, v67
v_cvt_pk_bf16_f32 v128, v64, v65
v_cvt_pk_bf16_f32 v129, v66, v67
v_mfma_f32_32x32x16_bf16 v[80:95], v[60:63], v[252:255], v[80:95]
s_waitcnt lgkmcnt(2)
buffer_load_dwordx4 v1, s[4:7], s52 offen offset:1024 sc1 lds
v_exp_f32 v68, v68
v_exp_f32 v69, v69
v_exp_f32 v70, v70
v_exp_f32 v71, v71
v_cvt_pk_bf16_f32 v130, v68, v69
v_cvt_pk_bf16_f32 v131, v70, v71
v_mfma_f32_32x32x16_bf16 v[96:111], v[204:207], v[132:135], v[96:111]
ds_read_b64_tr_b16 v[204:205], v38 offset:22656
ds_read_b64_tr_b16 v[206:207], v38 offset:22784
buffer_load_dwordx4 v1, s[4:7], s52 offen offset:2048 sc1 lds
v_exp_f32 v72, v72
v_exp_f32 v73, v73
v_exp_f32 v74, v74
v_exp_f32 v75, v75
v_cvt_pk_bf16_f32 v132, v72, v73
v_cvt_pk_bf16_f32 v133, v74, v75
v_mfma_f32_32x32x16_bf16 v[112:127], v[200:203], v[128:131], v[112:127]
s_waitcnt lgkmcnt(2)
ds_read_b64_tr_b16 v[200:201], v38 offset:19200
ds_read_b64_tr_b16 v[202:203], v38 offset:19328
buffer_load_dwordx4 v1, s[4:7], s52 offen offset:3072 sc1 lds
s_add_u32 m0, m0, 4096
v_exp_f32 v76, v76
v_exp_f32 v77, v77
v_exp_f32 v78, v78
v_exp_f32 v79, v79
v_cvt_pk_bf16_f32 v134, v76, v77
v_cvt_pk_bf16_f32 v135, v78, v79
v_rcp_f32 v210, v108
v_cmp_nlt_f32 s[58:59], s72, v108
v_cmp_ngt_f32 s[60:61], s73, v108
v_mul_f32 v96, v96, v210
v_mul_f32 v97, v97, v210
v_mul_f32 v98, v98, v210
v_mul_f32 v99, v99, v210
v_mul_f32 v100, v100, v210
v_mul_f32 v101, v101, v210
v_mul_f32 v102, v102, v210
v_mul_f32 v103, v103, v210
v_mul_f32 v104, v104, v210
v_mul_f32 v105, v105, v210
v_mul_f32 v106, v106, v210
v_mul_f32 v107, v107, v210
v_cvt_pk_bf16_f32 v216, v96, v97
v_cvt_pk_bf16_f32 v217, v98, v99
v_cvt_pk_bf16_f32 v218, v100, v101
v_cvt_pk_bf16_f32 v219, v102, v103
v_cvt_pk_bf16_f32 v220, v104, v105
v_cvt_pk_bf16_f32 v221, v106, v107
s_or_b64 s[58:59], s[58:59], s[60:61]
s_cbranch_scc1 Lfb16
Lfr17:
s_barrier
v_mfma_f32_32x32x16_bf16 v[64:79], v[40:43], v[248:251], 0
s_add_u32 s52, s52, 4096
ds_read_b128 v[48:51], v239 offset:12800
ds_read_b128 v[52:55], v239 offset:14976
v_exp_f32 v80, v80
v_exp_f32 v81, v81
v_exp_f32 v82, v82
v_exp_f32 v83, v83
v_cvt_pk_bf16_f32 v128, v80, v81
v_cvt_pk_bf16_f32 v129, v82, v83
v_mfma_f32_32x32x16_bf16 v[64:79], v[44:47], v[252:255], v[64:79]
s_waitcnt lgkmcnt(2)
buffer_store_dwordx4 v[216:219], v1, s[4:7], s38 offen offset:0 sc1
buffer_load_dwordx4 v1, s[4:7], s52 offen offset:0 sc1 lds
v_and_b32 v236, 0xffffff00, v0
v_add_u32 v236, v236, v0
v_exp_f32 v84, v84
v_exp_f32 v85, v85
v_exp_f32 v86, v86
v_exp_f32 v87, v87
v_cvt_pk_bf16_f32 v130, v84, v85
v_cvt_pk_bf16_f32 v131, v86, v87
v_mfma_f32_32x32x16_bf16 v[112:127], v[204:207], v[132:135], v[112:127]
ds_read_b64_tr_b16 v[204:205], v38 offset:19456
ds_read_b64_tr_b16 v[206:207], v38 offset:19584
s_mov_b64 exec, 0xfffff
buffer_load_dword v235, v236, s[12:15], s34 offen sc1
s_mov_b64 exec, 1
buffer_load_dword v235, v12, s[4:7], s35 offen sc1
s_mov_b64 exec, -1
s_add_u32 s54, s30, 20480
v_exp_f32 v88, v88
v_exp_f32 v89, v89
v_exp_f32 v90, v90
v_exp_f32 v91, v91
v_cvt_pk_bf16_f32 v132, v88, v89
v_cvt_pk_bf16_f32 v133, v90, v91
v_mfma_f32_32x32x16_bf16 v[112:127], v[200:203], v[128:131], v[112:127]
s_waitcnt lgkmcnt(2)
ds_read_b64_tr_b16 v[200:201], v38 offset:16000
ds_read_b64_tr_b16 v[202:203], v38 offset:16128
buffer_load_dwordx4 a[80:83], v1, s[4:7], s54 offen offset:0 sc1
v_exp_f32 v92, v92
v_exp_f32 v93, v93
v_exp_f32 v94, v94
v_exp_f32 v95, v95
v_cvt_pk_bf16_f32 v134, v92, v93
v_cvt_pk_bf16_f32 v135, v94, v95
v_mfma_f32_32x32x16_bf16 v[80:95], v[48:51], v[248:251], 0
v_exp_f32 v64, v64
v_exp_f32 v65, v65
v_exp_f32 v66, v66
v_exp_f32 v67, v67
v_cvt_pk_bf16_f32 v128, v64, v65
v_cvt_pk_bf16_f32 v129, v66, v67
v_mfma_f32_32x32x16_bf16 v[80:95], v[52:55], v[252:255], v[80:95]
s_waitcnt lgkmcnt(0)
v_exp_f32 v68, v68
v_exp_f32 v69, v69
v_exp_f32 v70, v70
v_exp_f32 v71, v71
v_cvt_pk_bf16_f32 v130, v68, v69
v_cvt_pk_bf16_f32 v131, v70, v71
v_mfma_f32_32x32x16_bf16 v[112:127], v[204:207], v[132:135], v[112:127]
s_waitcnt vmcnt(29)
s_barrier
ds_read_b128 v[56:59], v239 offset:9600
ds_read_b128 v[60:63], v239 offset:11776
ds_read_b64_tr_b16 v[204:205], v38 offset:16256
ds_read_b64_tr_b16 v[206:207], v38 offset:16384
v_exp_f32 v72, v72
v_exp_f32 v73, v73
v_exp_f32 v74, v74
v_exp_f32 v75, v75
v_cvt_pk_bf16_f32 v132, v72, v73
v_cvt_pk_bf16_f32 v133, v74, v75
v_mfma_f32_32x32x16_bf16 v[112:127], v[200:203], v[128:131], v[112:127]
ds_read_b64_tr_b16 v[200:201], v38 offset:12800
ds_read_b64_tr_b16 v[202:203], v38 offset:12928
buffer_load_dwordx4 a[84:87], v1, s[4:7], s54 offen offset:1024 sc1
v_exp_f32 v76, v76
v_exp_f32 v77, v77
v_exp_f32 v78, v78
v_exp_f32 v79, v79
v_cvt_pk_bf16_f32 v134, v76, v77
v_cvt_pk_bf16_f32 v135, v78, v79
s_waitcnt lgkmcnt(5)
v_mfma_f32_32x32x16_bf16 v[64:79], v[56:59], v[248:251], 0
ds_read_b128 v[40:43], v239 offset:6400
ds_read_b128 v[44:47], v239 offset:8576
v_exp_f32 v80, v80
v_exp_f32 v81, v81
v_exp_f32 v82, v82
v_exp_f32 v83, v83
v_cvt_pk_bf16_f32 v128, v80, v81
v_cvt_pk_bf16_f32 v129, v82, v83
s_waitcnt lgkmcnt(6)
v_mfma_f32_32x32x16_bf16 v[64:79], v[60:63], v[252:255], v[64:79]
s_waitcnt lgkmcnt(2)
v_exp_f32 v84, v84
v_exp_f32 v85, v85
v_exp_f32 v86, v86
v_exp_f32 v87, v87
v_cvt_pk_bf16_f32 v130, v84, v85
v_cvt_pk_bf16_f32 v131, v86, v87
v_mfma_f32_32x32x16_bf16 v[112:127], v[204:207], v[132:135], v[112:127]
ds_read_b64_tr_b16 v[204:205], v38 offset:13056
ds_read_b64_tr_b16 v[206:207], v38 offset:13184
v_exp_f32 v88, v88
v_exp_f32 v89, v89
v_exp_f32 v90, v90
v_exp_f32 v91, v91
v_cvt_pk_bf16_f32 v132, v88, v89
v_cvt_pk_bf16_f32 v133, v90, v91
v_mfma_f32_32x32x16_bf16 v[112:127], v[200:203], v[128:131], v[112:127]
s_waitcnt lgkmcnt(2)
ds_read_b64_tr_b16 v[200:201], v38 offset:9600
ds_read_b64_tr_b16 v[202:203], v38 offset:9728
buffer_load_dwordx4 a[88:91], v1, s[4:7], s54 offen offset:2048 sc1
v_exp_f32 v92, v92
v_exp_f32 v93, v93
v_exp_f32 v94, v94
v_exp_f32 v95, v95
v_cvt_pk_bf16_f32 v134, v92, v93
v_cvt_pk_bf16_f32 v135, v94, v95
v_mfma_f32_32x32x16_bf16 v[80:95], v[40:43], v[248:251], 0
ds_read_b128 v[48:51], v239 offset:3200
ds_read_b128 v[52:55], v239 offset:5376
v_exp_f32 v64, v64
v_exp_f32 v65, v65
v_exp_f32 v66, v66
v_exp_f32 v67, v67
v_cvt_pk_bf16_f32 v128, v64, v65
v_cvt_pk_bf16_f32 v129, v66, v67
v_mfma_f32_32x32x16_bf16 v[80:95], v[44:47], v[252:255], v[80:95]
s_waitcnt lgkmcnt(2)
v_exp_f32 v68, v68
v_exp_f32 v69, v69
v_exp_f32 v70, v70
v_exp_f32 v71, v71
v_cvt_pk_bf16_f32 v130, v68, v69
v_cvt_pk_bf16_f32 v131, v70, v71
v_mfma_f32_32x32x16_bf16 v[112:127], v[204:207], v[132:135], v[112:127]
ds_read_b64_tr_b16 v[204:205], v38 offset:9856
ds_read_b64_tr_b16 v[206:207], v38 offset:9984
v_exp_f32 v72, v72
v_exp_f32 v73, v73
v_exp_f32 v74, v74
v_exp_f32 v75, v75
v_cvt_pk_bf16_f32 v132, v72, v73
v_cvt_pk_bf16_f32 v133, v74, v75
v_mfma_f32_32x32x16_bf16 v[112:127], v[200:203], v[128:131], v[112:127]
s_waitcnt lgkmcnt(2)
ds_read_b64_tr_b16 v[200:201], v38 offset:6400
ds_read_b64_tr_b16 v[202:203], v38 offset:6528
buffer_load_dwordx4 a[92:95], v1, s[4:7], s54 offen offset:3072 sc1
v_exp_f32 v76, v76
v_exp_f32 v77, v77
v_exp_f32 v78, v78
v_exp_f32 v79, v79
v_cvt_pk_bf16_f32 v134, v76, v77
v_cvt_pk_bf16_f32 v135, v78, v79
v_mfma_f32_32x32x16_bf16 v[64:79], v[48:51], v[248:251], 0
ds_read_b128 v[56:59], v239 offset:0
ds_read_b128 v[60:63], v239 offset:2176
v_exp_f32 v80, v80
v_exp_f32 v81, v81
v_exp_f32 v82, v82
v_exp_f32 v83, v83
v_cvt_pk_bf16_f32 v128, v80, v81
v_cvt_pk_bf16_f32 v129, v82, v83
v_mfma_f32_32x32x16_bf16 v[64:79], v[52:55], v[252:255], v[64:79]
s_waitcnt lgkmcnt(2)
v_exp_f32 v84, v84
v_exp_f32 v85, v85
v_exp_f32 v86, v86
v_exp_f32 v87, v87
v_cvt_pk_bf16_f32 v130, v84, v85
v_cvt_pk_bf16_f32 v131, v86, v87
v_mfma_f32_32x32x16_bf16 v[112:127], v[204:207], v[132:135], v[112:127]
s_add_u32 s54, s54, 4096
ds_read_b64_tr_b16 v[204:205], v38 offset:6656
ds_read_b64_tr_b16 v[206:207], v38 offset:6784
v_exp_f32 v88, v88
v_exp_f32 v89, v89
v_exp_f32 v90, v90
v_exp_f32 v91, v91
v_cvt_pk_bf16_f32 v132, v88, v89
v_cvt_pk_bf16_f32 v133, v90, v91
v_mfma_f32_32x32x16_bf16 v[112:127], v[200:203], v[128:131], v[112:127]
s_waitcnt lgkmcnt(2)
ds_read_b64_tr_b16 v[200:201], v38 offset:3200
ds_read_b64_tr_b16 v[202:203], v38 offset:3328
v_exp_f32 v92, v92
v_exp_f32 v93, v93
v_exp_f32 v94, v94
v_exp_f32 v95, v95
v_cvt_pk_bf16_f32 v134, v92, v93
v_cvt_pk_bf16_f32 v135, v94, v95
v_mfma_f32_32x32x16_bf16 v[80:95], v[56:59], v[248:251], v[136:151]
buffer_load_dwordx4 a[96:99], v1, s[4:7], s54 offen offset:0 sc1
v_exp_f32 v64, v64
v_exp_f32 v65, v65
v_exp_f32 v66, v66
v_exp_f32 v67, v67
v_cvt_pk_bf16_f32 v128, v64, v65
v_cvt_pk_bf16_f32 v129, v66, v67
v_mfma_f32_32x32x16_bf16 v[80:95], v[60:63], v[252:255], v[80:95]
s_waitcnt lgkmcnt(0)
v_exp_f32 v68, v68
v_exp_f32 v69, v69
v_exp_f32 v70, v70
v_exp_f32 v71, v71
v_cvt_pk_bf16_f32 v130, v68, v69
v_cvt_pk_bf16_f32 v131, v70, v71
v_mfma_f32_32x32x16_bf16 v[112:127], v[204:207], v[132:135], v[112:127]
ds_read_b64_tr_b16 v[204:205], v38 offset:3456
ds_read_b64_tr_b16 v[206:207], v38 offset:3584
v_exp_f32 v72, v72
v_exp_f32 v73, v73
v_exp_f32 v74, v74
v_exp_f32 v75, v75
v_cvt_pk_bf16_f32 v132, v72, v73
v_cvt_pk_bf16_f32 v133, v74, v75
v_mfma_f32_32x32x16_bf16 v[112:127], v[200:203], v[128:131], v[112:127]
ds_read_b64_tr_b16 v[200:201], v38 offset:0
ds_read_b64_tr_b16 v[202:203], v38 offset:128
v_exp_f32 v76, v76
v_exp_f32 v77, v77
v_exp_f32 v78, v78
v_exp_f32 v79, v79
v_cvt_pk_bf16_f32 v134, v76, v77
v_cvt_pk_bf16_f32 v135, v78, v79
v_exp_f32 v80, v80
v_exp_f32 v81, v81
v_exp_f32 v82, v82
v_exp_f32 v83, v83
v_cvt_pk_bf16_f32 v128, v80, v81
v_cvt_pk_bf16_f32 v129, v82, v83
s_waitcnt lgkmcnt(0)
v_exp_f32 v84, v84
v_exp_f32 v85, v85
v_exp_f32 v86, v86
v_exp_f32 v87, v87
v_cvt_pk_bf16_f32 v130, v84, v85
v_cvt_pk_bf16_f32 v131, v86, v87
v_mfma_f32_32x32x16_bf16 v[112:127], v[204:207], v[132:135], v[112:127]
ds_read_b64_tr_b16 v[204:205], v38 offset:256
ds_read_b64_tr_b16 v[206:207], v38 offset:384
v_exp_f32 v88, v88
v_exp_f32 v89, v89
v_exp_f32 v90, v90
v_exp_f32 v91, v91
v_cvt_pk_bf16_f32 v132, v88, v89
v_cvt_pk_bf16_f32 v133, v90, v91
v_mfma_f32_32x32x16_bf16 v[112:127], v[200:203], v[128:131], v[112:127]
v_exp_f32 v92, v92
v_exp_f32 v93, v93
v_exp_f32 v94, v94
v_exp_f32 v95, v95
v_cvt_pk_bf16_f32 v134, v92, v93
v_cvt_pk_bf16_f32 v135, v94, v95
s_waitcnt lgkmcnt(0)
s_nop 0
v_mfma_f32_32x32x16_bf16 v[112:127], v[204:207], v[132:135], v[112:127]
s_nop 11
v_rcp_f32 v210, v124
v_cmp_nlt_f32 s[58:59], s72, v124
v_cmp_ngt_f32 s[60:61], s73, v124
v_pk_mul_f32 v[112:113], v[112:113], v[210:211] op_sel_hi:[1,0]
v_pk_mul_f32 v[114:115], v[114:115], v[210:211] op_sel_hi:[1,0]
v_pk_mul_f32 v[116:117], v[116:117], v[210:211] op_sel_hi:[1,0]
v_pk_mul_f32 v[118:119], v[118:119], v[210:211] op_sel_hi:[1,0]
v_pk_mul_f32 v[120:121], v[120:121], v[210:211] op_sel_hi:[1,0]
v_pk_mul_f32 v[122:123], v[122:123], v[210:211] op_sel_hi:[1,0]
v_cvt_pk_bf16_f32 v224, v112, v113
v_cvt_pk_bf16_f32 v225, v114, v115
v_cvt_pk_bf16_f32 v226, v116, v117
v_cvt_pk_bf16_f32 v227, v118, v119
v_cvt_pk_bf16_f32 v222, v120, v121
v_cvt_pk_bf16_f32 v223, v122, v123
s_or_b64 s[58:59], s[58:59], s[60:61]
s_cbranch_scc1 Lfb22
Lfr23:
buffer_store_dwordx4 v[224:227], v1, s[4:7], s38 offen offset:1024 sc1
s_mov_b32 exec_hi, 0
buffer_store_dwordx4 v[220:223], v1, s[4:7], s38 offen offset:2048 sc1
s_mov_b64 exec, -1
s_add_u32 s66, s18, 1
s_and_b32 s66, s66, 3
s_lshr_b32 s67, s66, 1
s_mul_i32 s67, s67, 40448
s_lshl_b32 s62, s66, 8
s_add_u32 s62, s62, s67
s_add_u32 s62, s62, s39
s_mul_i32 s66, s66, 5120
s_add_u32 s66, s66, 36864
v_add_u32 v246, s66, v1
s_add_u32 s66, s18, 2
s_and_b32 s66, s66, 3
s_lshr_b32 s67, s66, 1
s_mul_i32 s67, s67, 40448
s_lshl_b32 s63, s66, 8
s_add_u32 s63, s63, s67
s_add_u32 s63, s63, s39
s_mul_i32 s66, s66, 5120
s_add_u32 s66, s66, 57344
v_add_u32 v247, s66, v1
s_add_u32 s66, s18, 3
s_and_b32 s66, s66, 3
s_lshr_b32 s67, s66, 1
s_mul_i32 s67, s67, 40448
s_lshl_b32 s64, s66, 8
s_add_u32 s64, s64, s67
s_add_u32 s64, s64, s39
s_mul_i32 s66, s66, 5120
s_add_u32 s66, s66, 36864
v_add_u32 v248, s66, v1
s_add_u32 s66, s18, 4
s_and_b32 s66, s66, 3
s_lshr_b32 s67, s66, 1
s_mul_i32 s67, s67, 40448
s_lshl_b32 s65, s66, 8
s_add_u32 s65, s65, s67
s_add_u32 s65, s65, s39
s_mul_i32 s66, s66, 5120
s_add_u32 s66, s66, 36864
v_add_u32 v249, s66, v1
s_mul_i32 s54, s17, 12288
s_lshl_b32 s55, s93, 8
s_add_u32 s54, s54, s55
s_add_u32 s54, s54, 278528
s_add_u32 s55, s55, 161792
v_lshrrev_b32 v185, 8, v1
v_and_b32 v186, 0xf0, v1
v_mul_u32_u24 v184, 3072, v185
v_add_u32 v184, v184, v186
buffer_load_dwordx4 v[168:171], v184, s[4:7], s54 offen offset:0 sc1
buffer_load_dwordx4 v[172:175], v184, s[4:7], s54 offen offset:768 sc1
buffer_load_dwordx4 v[176:179], v184, s[4:7], s54 offen offset:1536 sc1
buffer_load_dwordx4 v[180:183], v184, s[4:7], s54 offen offset:2304 sc1
v_bfrev_b32 v185, v185
v_lshrrev_b32 v185, 28, v185
v_add3_u32 v185, v185, v186, s55
s_mul_i32 s53, s18, 6144
s_add_u32 m0, s53, 98304
s_add_u32 s52, s29, s53
s_add_u32 s52, s52, 20480
buffer_load_dwordx4 v1, s[4:7], s52 offen offset:0 sc1 lds
buffer_load_dwordx4 v1, s[4:7], s52 offen offset:1024 sc1 lds
buffer_load_dwordx4 v1, s[4:7], s52 offen offset:2048 sc1 lds
buffer_load_dwordx4 v1, s[4:7], s52 offen offset:3072 sc1 lds
s_add_u32 m0, m0, 4096
s_add_u32 s52, s52, 4096
buffer_load_dwordx4 v1, s[4:7], s52 offen offset:0 sc1 lds
buffer_load_dwordx4 v1, s[4:7], s52 offen offset:1024 sc1 lds
s_add_u32 s54, s31, 0
buffer_load_dwordx4 a[160:163], v1, s[4:7], s54 offen offset:0 sc1
buffer_load_dwordx4 a[164:167], v1, s[4:7], s54 offen offset:1024 sc1
buffer_load_dwordx4 a[168:171], v1, s[4:7], s54 offen offset:2048 sc1
buffer_load_dwordx4 a[172:175], v1, s[4:7], s54 offen offset:3072 sc1
v_mov_b32 v15, 1
s_cmp_eq_u32 s18, 0
s_cbranch_scc1 Lo24
s_waitcnt vmcnt(14) lgkmcnt(0)
s_barrier
s_sub_u32 s60, s18, 1
s_mul_i32 s53, s60, 12288
s_add_u32 m0, s53, 122880
s_add_u32 s52, s29, s53
s_add_u32 s52, s52, 45056
buffer_load_dwordx4 v1, s[4:7], s52 offen offset:0 sc1 lds
buffer_load_dwordx4 v1, s[4:7], s52 offen offset:1024 sc1 lds
buffer_load_dwordx4 v1, s[4:7], s52 offen offset:2048 sc1 lds
buffer_load_dwordx4 v1, s[4:7], s52 offen offset:3072 sc1 lds
s_add_u32 m0, m0, 4096
s_add_u32 s52, s52, 4096
buffer_load_dwordx4 v1, s[4:7], s52 offen offset:0 sc1 lds
buffer_load_dwordx4 v1, s[4:7], s52 offen offset:1024 sc1 lds
buffer_load_dwordx4 v1, s[4:7], s52 offen offset:2048 sc1 lds
buffer_load_dwordx4 v1, s[4:7], s52 offen offset:3072 sc1 lds
s_add_u32 m0, m0, 4096
s_add_u32 s52, s52, 4096
buffer_load_dwordx4 v1, s[4:7], s52 offen offset:0 sc1 lds
buffer_load_dwordx4 v1, s[4:7], s52 offen offset:1024 sc1 lds
buffer_load_dwordx4 v1, s[4:7], s52 offen offset:2048 sc1 lds
buffer_load_dwordx4 v1, s[4:7], s52 offen offset:3072 sc1 lds
s_branch Lj25
Lr27_x:
s_add_u32 s57, s57, 1
s_cmp_lt_u32 s57, 1048576
s_cbranch_scc1 Lr27_0
s_mov_b64 vcc, 0
s_branch Lr27_d
Lo24:
s_cbranch_vccnz Lw26
s_mov_b32 s57, 0
s_mov_b64 exec, 1
s_waitcnt vmcnt(14) lgkmcnt(0)
s_barrier
buffer_store_dword v15, v12, s[4:7], s49 offen
s_mov_b64 exec, 0xffff
Lr27_0:
buffer_load_dword v15, v7, s[4:7], s23 offen sc1
Lr27_w:
s_waitcnt vmcnt(0)
v_cmp_gt_u32 vcc, 1, v15
s_nop 0
s_cbranch_vccnz Lr27_x
Lr27_d:
s_mov_b64 exec, -1
Lj25:
s_barrier
buffer_load_dwordx4 v[40:43], v4, s[4:7], s62 offen offset:0 sc1
buffer_load_dwordx4 v[44:47], v4, s[4:7], s62 offen offset:2048 sc1
s_add_u32 s66, s62, 4096
buffer_load_dwordx4 v[48:51], v4, s[4:7], s66 offen offset:0 sc1
s_add_u32 s66, s62, 6144
buffer_load_dwordx4 v[52:55], v4, s[4:7], s66 offen offset:0 sc1
s_add_u32 s66, s62, 8192
buffer_load_dwordx4 v[56:59], v4, s[4:7], s66 offen offset:0 sc1
buffer_load_dwordx4 v[60:63], v4, s[4:7], s63 offen offset:0 sc1
buffer_load_dwordx4 v[64:67], v4, s[4:7], s63 offen offset:2048 sc1
s_waitcnt vmcnt(6)
v_mfma_f32_16x16x32_bf16 v[88:91], a[0:3], v[40:43], 0
s_add_u32 s66, s63, 4096
s_add_u32 s54, s31, 4096
v_mfma_f32_16x16x32_bf16 v[92:95], a[4:7], v[40:43], 0
buffer_load_dwordx4 v[68:71], v4, s[4:7], s66 offen offset:0 sc1
v_mfma_f32_16x16x32_bf16 v[96:99], a[8:11], v[40:43], 0
s_add_u32 s66, s63, 6144
buffer_load_dwordx4 a[176:179], v1, s[4:7], s54 offen offset:0 sc1
v_mfma_f32_16x16x32_bf16 v[100:103], a[12:15], v[40:43], 0
v_add_f32 v168, v168, v176
v_add_f32 v169, v169, v177
v_mfma_f32_16x16x32_bf16 v[104:107], a[16:19], v[40:43], 0
s_waitcnt vmcnt(7)
v_add_f32 v170, v170, v178
v_add_f32 v171, v171, v179
v_mfma_f32_16x16x32_bf16 v[88:91], a[20:23], v[44:47], v[88:91]
buffer_load_dwordx4 v[72:75], v4, s[4:7], s66 offen offset:0 sc1
v_mfma_f32_16x16x32_bf16 v[92:95], a[24:27], v[44:47], v[92:95]
s_add_u32 s66, s63, 8192
s_add_u32 s54, s31, 15360
v_add_f32 v172, v172, v180
v_mfma_f32_16x16x32_bf16 v[96:99], a[28:31], v[44:47], v[96:99]
v_add_f32 v173, v173, v181
v_add_f32 v174, v174, v182
v_mfma_f32_16x16x32_bf16 v[100:103], a[32:35], v[44:47], v[100:103]
v_add_f32 v175, v175, v183
v_add_f32 v168, v168, v172
v_mfma_f32_16x16x32_bf16 v[104:107], a[36:39], v[44:47], v[104:107]
s_waitcnt vmcnt(7)
buffer_load_dwordx4 v[76:79], v4, s[4:7], s66 offen offset:0 sc1
v_mfma_f32_16x16x32_bf16 v[88:91], a[40:43], v[48:51], v[88:91]
buffer_load_dwordx4 a[180:183], v1, s[4:7], s54 offen offset:0 sc1
v_mfma_f32_16x16x32_bf16 v[92:95], a[44:47], v[48:51], v[92:95]
s_mov_b32 s70, Lc30-C_pc+2048
v_add_f32 v169, v169, v173
s_min_u32 s70, s70, M_text_end-C_pc-16384
v_mfma_f32_16x16x32_bf16 v[96:99], a[48:51], v[48:51], v[96:99]
s_add_u32 s70, s70, s74
s_addc_u32 s71, s75, 0
v_mfma_f32_16x16x32_bf16 v[100:103], a[52:55], v[48:51], v[100:103]
buffer_load_dwordx4 v[80:83], v4, s[4:7], s64 offen offset:0 sc1
v_mfma_f32_16x16x32_bf16 v[104:107], a[56:59], v[48:51], v[104:107]
s_waitcnt vmcnt(9)
s_mov_b64 exec, 1
Lc30:
global_load_dword v250, v0, s[70:71]
s_mov_b64 exec, -1
v_mfma_f32_16x16x32_bf16 v[88:91], a[60:63], v[52:55], v[88:91]
v_add_f32 v170, v170, v174
v_add_f32 v171, v171, v175
v_mfma_f32_16x16x32_bf16 v[92:95], a[64:67], v[52:55], v[92:95]
v_permlane32_swap_b32 v168, v169
v_mfma_f32_16x16x32_bf16 v[96:99], a[68:71], v[52:55], v[96:99]
buffer_load_dwordx4 v[84:87], v4, s[4:7], s64 offen offset:2048 sc1
v_mfma_f32_16x16x32_bf16 v[100:103], a[72:75], v[52:55], v[100:103]
s_add_u32 s66, s64, 4096
buffer_load_dwordx4 a[184:187], v1, s[4:7], s54 offen offset:1024 sc1
v_mfma_f32_16x16x32_bf16 v[104:107], a[76:79], v[52:55], v[104:107]
s_waitcnt vmcnt(11)
v_permlane32_swap_b32 v170, v171
v_mfma_f32_16x16x32_bf16 v[88:91], a[80:83], v[56:59], v[88:91]
v_add_f32 v168, v168, v169
v_add_f32 v170, v170, v171
v_mfma_f32_16x16x32_bf16 v[92:95], a[84:87], v[56:59], v[92:95]
buffer_load_dwordx4 v[40:43], v4, s[4:7], s66 offen offset:0 sc1
v_mfma_f32_16x16x32_bf16 v[96:99], a[88:91], v[56:59], v[96:99]
s_add_u32 s66, s64, 6144
v_permlane16_swap_b32 v168, v170
v_mfma_f32_16x16x32_bf16 v[100:103], a[92:95], v[56:59], v[100:103]
v_add_f32 v168, v168, v170
v_mfma_f32_16x16x32_bf16 v[104:107], a[96:99], v[56:59], v[104:107]
s_waitcnt vmcnt(11)
ds_write_b32 v185, v168
v_mfma_f32_16x16x32_bf16 v[108:111], a[0:3], v[60:63], 0
buffer_load_dwordx4 v[44:47], v4, s[4:7], s66 offen offset:0 sc1
v_mfma_f32_16x16x32_bf16 v[112:115], a[4:7], v[60:63], 0
s_add_u32 s66, s64, 8192
buffer_load_dwordx4 a[188:191], v1, s[4:7], s54 offen offset:2048 sc1
v_mfma_f32_16x16x32_bf16 v[116:119], a[8:11], v[60:63], 0
v_mfma_f32_16x16x32_bf16 v[120:123], a[12:15], v[60:63], 0
ds_write_b128 v246, v[88:91] offset:0
v_mfma_f32_16x16x32_bf16 v[124:127], a[16:19], v[60:63], 0
s_waitcnt vmcnt(12)
buffer_load_dwordx4 v[48:51], v4, s[4:7], s66 offen offset:0 sc1
v_mfma_f32_16x16x32_bf16 v[108:111], a[20:23], v[64:67], v[108:111]
ds_write_b128 v246, v[92:95] offset:1024
v_mfma_f32_16x16x32_bf16 v[112:115], a[24:27], v[64:67], v[112:115]
v_mfma_f32_16x16x32_bf16 v[116:119], a[28:31], v[64:67], v[116:119]
ds_write_b128 v246, v[96:99] offset:2048
v_mfma_f32_16x16x32_bf16 v[120:123], a[32:35], v[64:67], v[120:123]
buffer_load_dwordx4 v[52:55], v4, s[4:7], s65 offen offset:0 sc1
v_mfma_f32_16x16x32_bf16 v[124:127], a[36:39], v[64:67], v[124:127]
s_waitcnt vmcnt(13)
buffer_load_dwordx4 a[192:195], v1, s[4:7], s54 offen offset:3072 sc1
v_mfma_f32_16x16x32_bf16 v[108:111], a[40:43], v[68:71], v[108:111]
ds_write_b128 v246, v[100:103] offset:3072
v_mfma_f32_16x16x32_bf16 v[112:115], a[44:47], v[68:71], v[112:115]
ds_write_b128 v246, v[104:107] offset:4096
v_mfma_f32_16x16x32_bf16 v[116:119], a[48:51], v[68:71], v[116:119]
buffer_load_dwordx4 v[56:59], v4, s[4:7], s65 offen offset:2048 sc1
v_mfma_f32_16x16x32_bf16 v[120:123], a[52:55], v[68:71], v[120:123]
s_add_u32 s66, s65, 4096
s_add_u32 s54, s31, 19456
v_mfma_f32_16x16x32_bf16 v[124:127], a[56:59], v[68:71], v[124:127]
s_waitcnt vmcnt(13)
v_mfma_f32_16x16x32_bf16 v[108:111], a[60:63], v[72:75], v[108:111]
s_waitcnt lgkmcnt(0)
s_barrier
ds_read_b128 v[200:203], v249 offset:0
v_mfma_f32_16x16x32_bf16 v[112:115], a[64:67], v[72:75], v[112:115]
buffer_load_dwordx4 v[60:63], v4, s[4:7], s66 offen offset:0 sc1
v_mfma_f32_16x16x32_bf16 v[116:119], a[68:71], v[72:75], v[116:119]
s_add_u32 s66, s65, 6144
buffer_load_dwordx4 a[196:199], v1, s[4:7], s54 offen offset:0 sc1
v_mfma_f32_16x16x32_bf16 v[120:123], a[72:75], v[72:75], v[120:123]
ds_read_b128 v[204:207], v249 offset:1024
v_mfma_f32_16x16x32_bf16 v[124:127], a[76:79], v[72:75], v[124:127]
s_waitcnt vmcnt(14)
ds_read_b128 v[208:211], v249 offset:2048
v_mfma_f32_16x16x32_bf16 v[108:111], a[80:83], v[76:79], v[108:111]
buffer_load_dwordx4 v[64:67], v4, s[4:7], s66 offen offset:0 sc1
v_mfma_f32_16x16x32_bf16 v[112:115], a[84:87], v[76:79], v[112:115]
s_add_u32 s66, s65, 8192
ds_read_b128 v[212:215], v249 offset:3072
s_add_u32 s54, s31, 30720
v_mfma_f32_16x16x32_bf16 v[116:119], a[88:91], v[76:79], v[116:119]
ds_read_b128 v[216:219], v249 offset:4096
v_mfma_f32_16x16x32_bf16 v[120:123], a[92:95], v[76:79], v[120:123]
v_mfma_f32_16x16x32_bf16 v[124:127], a[96:99], v[76:79], v[124:127]
s_waitcnt vmcnt(13)
buffer_load_dwordx4 v[68:71], v4, s[4:7], s66 offen offset:0 sc1
v_mfma_f32_16x16x32_bf16 v[128:131], a[0:3], v[80:83], 0
buffer_load_dwordx4 a[200:203], v1, s[4:7], s54 offen offset:0 sc1
v_mfma_f32_16x16x32_bf16 v[132:135], a[4:7], v[80:83], 0
s_waitcnt lgkmcnt(0)
v_add_f32 v16, v16, v200
v_mfma_f32_16x16x32_bf16 v[136:139], a[8:11], v[80:83], 0
v_add_f32 v17, v17, v201
v_add_f32 v18, v18, v202
v_mfma_f32_16x16x32_bf16 v[140:143], a[12:15], v[80:83], 0
ds_write_b128 v247, v[108:111] offset:0
v_mfma_f32_16x16x32_bf16 v[144:147], a[16:19], v[80:83], 0
s_waitcnt vmcnt(13)
v_add_f32 v19, v19, v203
v_add_f32 v20, v20, v204
v_mfma_f32_16x16x32_bf16 v[128:131], a[20:23], v[84:87], v[128:131]
ds_write_b128 v247, v[112:115] offset:1024
v_mfma_f32_16x16x32_bf16 v[132:135], a[24:27], v[84:87], v[132:135]
v_add_f32 v21, v21, v205
v_add_f32 v22, v22, v206
v_mfma_f32_16x16x32_bf16 v[136:139], a[28:31], v[84:87], v[136:139]
ds_write_b128 v247, v[116:119] offset:2048
v_mfma_f32_16x16x32_bf16 v[140:143], a[32:35], v[84:87], v[140:143]
buffer_load_dwordx4 a[204:207], v1, s[4:7], s54 offen offset:1024 sc1
v_mfma_f32_16x16x32_bf16 v[144:147], a[36:39], v[84:87], v[144:147]
s_waitcnt vmcnt(12)
s_mul_i32 s53, s18, 8192
v_add_f32 v23, v23, v207
v_mfma_f32_16x16x32_bf16 v[128:131], a[40:43], v[40:43], v[128:131]
s_add_u32 m0, s53, 0
ds_write_b128 v247, v[120:123] offset:3072
v_mfma_f32_16x16x32_bf16 v[132:135], a[44:47], v[40:43], v[132:135]
s_add_u32 s52, s29, s53
ds_write_b128 v247, v[124:127] offset:4096
v_mfma_f32_16x16x32_bf16 v[136:139], a[48:51], v[40:43], v[136:139]
s_add_u32 s52, s52, 81920
v_add_f32 v24, v24, v208
v_add_f32 v25, v25, v209
v_mfma_f32_16x16x32_bf16 v[140:143], a[52:55], v[40:43], v[140:143]
buffer_load_dwordx4 v1, s[4:7], s52 offen offset:0 sc1 lds
v_mfma_f32_16x16x32_bf16 v[144:147], a[56:59], v[40:43], v[144:147]
s_waitcnt vmcnt(12)
v_add_f32 v26, v26, v210
v_add_f32 v27, v27, v211
v_mfma_f32_16x16x32_bf16 v[128:131], a[60:63], v[44:47], v[128:131]
s_waitcnt lgkmcnt(0)
s_barrier
ds_read_b128 v[220:223], v249 offset:20480
v_mfma_f32_16x16x32_bf16 v[132:135], a[64:67], v[44:47], v[132:135]
ds_read_b128 v[224:227], v249 offset:21504
v_add_f32 v28, v28, v212
v_mfma_f32_16x16x32_bf16 v[136:139], a[68:71], v[44:47], v[136:139]
buffer_load_dwordx4 v1, s[4:7], s52 offen offset:1024 sc1 lds
v_mfma_f32_16x16x32_bf16 v[140:143], a[72:75], v[44:47], v[140:143]
ds_read_b128 v[228:231], v249 offset:22528
v_add_f32 v29, v29, v213
v_mfma_f32_16x16x32_bf16 v[144:147], a[76:79], v[44:47], v[144:147]
s_waitcnt vmcnt(11)
ds_read_b128 v[232:235], v249 offset:23552
v_add_f32 v30, v30, v214
v_mfma_f32_16x16x32_bf16 v[128:131], a[80:83], v[48:51], v[128:131]
ds_read_b128 v[236:239], v249 offset:24576
v_add_f32 v31, v31, v215
v_mfma_f32_16x16x32_bf16 v[132:135], a[84:87], v[48:51], v[132:135]
buffer_load_dwordx4 v1, s[4:7], s52 offen offset:2048 sc1 lds
v_mfma_f32_16x16x32_bf16 v[136:139], a[88:91], v[48:51], v[136:139]
v_add_f32 v32, v32, v216
v_add_f32 v33, v33, v217
v_mfma_f32_16x16x32_bf16 v[140:143], a[92:95], v[48:51], v[140:143]
v_add_f32 v34, v34, v218
v_add_f32 v35, v35, v219
v_mfma_f32_16x16x32_bf16 v[144:147], a[96:99], v[48:51], v[144:147]
s_waitcnt vmcnt(11)
v_mfma_f32_16x16x32_bf16 v[148:151], a[0:3], v[52:55], 0
buffer_load_dwordx4 v1, s[4:7], s52 offen offset:3072 sc1 lds
v_mfma_f32_16x16x32_bf16 v[152:155], a[4:7], v[52:55], 0
s_add_u32 m0, m0, 4096
s_waitcnt lgkmcnt(0)
v_add_f32 v16, v16, v220
v_mfma_f32_16x16x32_bf16 v[156:159], a[8:11], v[52:55], 0
s_add_u32 s52, s52, 4096
v_add_f32 v17, v17, v221
v_add_f32 v18, v18, v222
v_mfma_f32_16x16x32_bf16 v[160:163], a[12:15], v[52:55], 0
ds_write_b128 v248, v[128:131] offset:0
v_mfma_f32_16x16x32_bf16 v[164:167], a[16:19], v[52:55], 0
s_waitcnt vmcnt(10)
buffer_load_dwordx4 v1, s[4:7], s52 offen offset:0 sc1 lds
v_mfma_f32_16x16x32_bf16 v[148:151], a[20:23], v[56:59], v[148:151]
ds_write_b128 v248, v[132:135] offset:1024
v_mfma_f32_16x16x32_bf16 v[152:155], a[24:27], v[56:59], v[152:155]
v_add_f32 v19, v19, v223
v_add_f32 v20, v20, v224
v_mfma_f32_16x16x32_bf16 v[156:159], a[28:31], v[56:59], v[156:159]
ds_write_b128 v248, v[136:139] offset:2048
v_mfma_f32_16x16x32_bf16 v[160:163], a[32:35], v[56:59], v[160:163]
buffer_load_dwordx4 v1, s[4:7], s52 offen offset:1024 sc1 lds
v_mfma_f32_16x16x32_bf16 v[164:167], a[36:39], v[56:59], v[164:167]
s_waitcnt vmcnt(11)
ds_write_b128 v248, v[140:143] offset:3072
v_mfma_f32_16x16x32_bf16 v[148:151], a[40:43], v[60:63], v[148:151]
v_add_f32 v21, v21, v225
v_add_f32 v22, v22, v226
v_mfma_f32_16x16x32_bf16 v[152:155], a[44:47], v[60:63], v[152:155]
ds_write_b128 v248, v[144:147] offset:4096
v_mfma_f32_16x16x32_bf16 v[156:159], a[48:51], v[60:63], v[156:159]
buffer_load_dwordx4 v1, s[4:7], s52 offen offset:2048 sc1 lds
v_mfma_f32_16x16x32_bf16 v[160:163], a[52:55], v[60:63], v[160:163]
v_add_f32 v23, v23, v227
v_add_f32 v24, v24, v228
v_mfma_f32_16x16x32_bf16 v[164:167], a[56:59], v[60:63], v[164:167]
s_waitcnt vmcnt(10)
v_add_f32 v25, v25, v229
v_add_f32 v26, v26, v230
v_mfma_f32_16x16x32_bf16 v[148:151], a[60:63], v[64:67], v[148:151]
s_waitcnt lgkmcnt(0)
s_barrier
ds_read_b128 v[200:203], v249 offset:0
v_mfma_f32_16x16x32_bf16 v[152:155], a[64:67], v[64:67], v[152:155]
buffer_load_dwordx4 v1, s[4:7], s52 offen offset:3072 sc1 lds
v_mfma_f32_16x16x32_bf16 v[156:159], a[68:71], v[64:67], v[156:159]
ds_read_b128 v[204:207], v249 offset:1024
v_add_f32 v27, v27, v231
v_mfma_f32_16x16x32_bf16 v[160:163], a[72:75], v[64:67], v[160:163]
ds_read_b128 v[208:211], v249 offset:2048
v_add_f32 v28, v28, v232
v_mfma_f32_16x16x32_bf16 v[164:167], a[76:79], v[64:67], v[164:167]
s_waitcnt vmcnt(10)
ds_read_b128 v[212:215], v249 offset:3072
v_add_f32 v29, v29, v233
v_mfma_f32_16x16x32_bf16 v[148:151], a[80:83], v[68:71], v[148:151]
ds_read_b128 v[216:219], v249 offset:4096
v_add_f32 v30, v30, v234
v_mfma_f32_16x16x32_bf16 v[152:155], a[84:87], v[68:71], v[152:155]
v_add_f32 v31, v31, v235
v_add_f32 v32, v32, v236
v_mfma_f32_16x16x32_bf16 v[156:159], a[88:91], v[68:71], v[156:159]
v_add_f32 v33, v33, v237
v_add_f32 v34, v34, v238
v_mfma_f32_16x16x32_bf16 v[160:163], a[92:95], v[68:71], v[160:163]
v_add_f32 v35, v35, v239
v_mfma_f32_16x16x32_bf16 v[164:167], a[96:99], v[68:71], v[164:167]
s_mov_b32 s64, 0xffff
s_mov_b32 s65, 0xffff
s_cbranch_vccnz Ls31
v_pk_add_f32 v[16:17], v[16:17], v[148:149]
v_pk_add_f32 v[18:19], v[18:19], v[150:151]
v_pk_add_f32 v[20:21], v[20:21], v[152:153]
v_pk_add_f32 v[22:23], v[22:23], v[154:155]
v_pk_add_f32 v[24:25], v[24:25], v[156:157]
v_pk_add_f32 v[26:27], v[26:27], v[158:159]
v_pk_add_f32 v[28:29], v[28:29], v[160:161]
v_pk_add_f32 v[30:31], v[30:31], v[162:163]
v_pk_add_f32 v[32:33], v[32:33], v[164:165]
v_pk_add_f32 v[34:35], v[34:35], v[166:167]
s_waitcnt lgkmcnt(0)
v_pk_add_f32 v[16:17], v[16:17], v[200:201]
v_pk_add_f32 v[18:19], v[18:19], v[202:203]
v_pk_add_f32 v[20:21], v[20:21], v[204:205]
v_pk_add_f32 v[22:23], v[22:23], v[206:207]
v_pk_add_f32 v[24:25], v[24:25], v[208:209]
v_pk_add_f32 v[26:27], v[26:27], v[210:211]
v_pk_add_f32 v[28:29], v[28:29], v[212:213]
v_pk_add_f32 v[30:31], v[30:31], v[214:215]
v_pk_add_f32 v[32:33], v[32:33], v[216:217]
v_pk_add_f32 v[34:35], v[34:35], v[218:219]
v_cvt_pk_bf16_f32 v40, v16, v17
v_cvt_pk_bf16_f32 v41, v18, v19
v_cvt_pk_bf16_f32 v42, v20, v21
v_cvt_pk_bf16_f32 v43, v22, v23
v_cvt_pk_bf16_f32 v44, v24, v25
v_cvt_pk_bf16_f32 v45, v26, v27
v_cvt_pk_bf16_f32 v46, v28, v29
v_cvt_pk_bf16_f32 v47, v30, v31
v_cvt_pk_bf16_f32 v48, v32, v33
v_cvt_pk_bf16_f32 v49, v34, v35
v_cvt_pk_bf16_f32 v50, v32, v33
v_cvt_pk_bf16_f32 v51, v34, v35
buffer_store_dwordx4 v[40:43], v4, s[12:15], s34 offen
buffer_store_dwordx4 v[44:47], v4, s[12:15], s34 offen offset:2048
v_permlane16_swap_b32 v48, v50
v_permlane16_swap_b32 v49, v51
v_pk_add_f32 v[52:53], v[16:17], v[18:19]
v_pk_mul_f32 v[54:55], v[16:17], v[16:17]
v_pk_fma_f32 v[54:55], v[18:19], v[18:19], v[54:55]
v_pk_add_f32 v[52:53], v[52:53], v[20:21]
v_pk_fma_f32 v[54:55], v[20:21], v[20:21], v[54:55]
v_pk_add_f32 v[52:53], v[52:53], v[22:23]
v_pk_fma_f32 v[54:55], v[22:23], v[22:23], v[54:55]
v_pk_add_f32 v[52:53], v[52:53], v[24:25]
v_pk_fma_f32 v[54:55], v[24:25], v[24:25], v[54:55]
v_pk_add_f32 v[52:53], v[52:53], v[26:27]
v_pk_fma_f32 v[54:55], v[26:27], v[26:27], v[54:55]
v_pk_add_f32 v[52:53], v[52:53], v[28:29]
v_pk_fma_f32 v[54:55], v[28:29], v[28:29], v[54:55]
v_pk_add_f32 v[52:53], v[52:53], v[30:31]
v_pk_fma_f32 v[54:55], v[30:31], v[30:31], v[54:55]
v_pk_add_f32 v[52:53], v[52:53], v[32:33]
v_pk_fma_f32 v[54:55], v[32:33], v[32:33], v[54:55]
v_pk_add_f32 v[52:53], v[52:53], v[34:35]
v_pk_fma_f32 v[54:55], v[34:35], v[34:35], v[54:55]
v_add_f32 v52, v52, v53
v_add_f32 v54, v54, v55
s_mov_b64 exec, s[64:65]
buffer_store_dwordx4 v[48:51], v5, s[12:15], s34 offen
s_mov_b64 exec, -1
v_permlane32_swap_b32 v52, v54
v_add_f32 v53, v52, v54
v_add_f32 v52, v52, v54
s_nop 1
v_permlane16_swap_b32 v52, v53
v_add_f32 v52, v52, v53
s_mov_b64 exec, s[64:65]
buffer_store_dword v52, v7, s[4:7], s35 offen
s_mov_b64 exec, -1
Lt32:
s_mul_i32 s53, s18, 1024
s_add_u32 m0, s53, 32768
s_add_u32 s52, s29, s53
s_add_u32 s52, s52, 114688
buffer_load_dwordx4 v1, s[4:7], s52 offen offset:0 sc1 lds
s_add_u32 s54, s31, 32768
buffer_load_dwordx4 a[208:211], v1, s[4:7], s54 offen offset:0 sc1
buffer_load_dwordx4 a[212:215], v1, s[4:7], s54 offen offset:1024 sc1
buffer_load_dwordx4 a[216:219], v1, s[4:7], s54 offen offset:2048 sc1
s_add_u32 s54, s31, 46080
buffer_load_dwordx4 a[220:223], v1, s[4:7], s54 offen offset:0 sc1
buffer_load_dwordx4 a[224:227], v1, s[4:7], s54 offen offset:1024 sc1
buffer_load_dwordx4 a[228:231], v1, s[4:7], s54 offen offset:2048 sc1
buffer_load_dwordx4 a[232:235], v1, s[4:7], s54 offen offset:3072 sc1
s_add_u32 s54, s31, 50176
buffer_load_dwordx4 a[236:239], v1, s[4:7], s54 offen offset:0 sc1
s_mov_b32 s50, s32
s_add_u32 s78, s40, 4096
v_mov_b32 v15, 2
s_cmp_eq_u32 s18, 0
s_cbranch_scc1 Lo33
s_waitcnt vmcnt(9) lgkmcnt(0)
s_barrier
s_sub_u32 s60, s18, 1
s_mul_i32 s53, s60, 8192
s_add_u32 m0, s53, 36864
s_add_u32 s52, s29, s53
s_add_u32 s52, s52, 118784
buffer_load_dwordx4 v1, s[4:7], s52 offen offset:0 sc1 lds
buffer_load_dwordx4 v1, s[4:7], s52 offen offset:1024 sc1 lds
buffer_load_dwordx4 v1, s[4:7], s52 offen offset:2048 sc1 lds
buffer_load_dwordx4 v1, s[4:7], s52 offen offset:3072 sc1 lds
s_add_u32 m0, m0, 4096
s_add_u32 s52, s52, 4096
buffer_load_dwordx4 v1, s[4:7], s52 offen offset:0 sc1 lds
buffer_load_dwordx4 v1, s[4:7], s52 offen offset:1024 sc1 lds
buffer_load_dwordx4 v1, s[4:7], s52 offen offset:2048 sc1 lds
buffer_load_dwordx4 v1, s[4:7], s52 offen offset:3072 sc1 lds
s_branch Lj34
Lr36_x:
s_add_u32 s57, s57, 1
s_cmp_lt_u32 s57, 1048576
s_cbranch_scc1 Lr36_0
s_mov_b64 vcc, 0
s_branch Lr36_d
Lo33:
s_cbranch_vccnz Lw35
s_mov_b32 s57, 0
s_mov_b64 exec, 1
s_waitcnt vmcnt(9) lgkmcnt(0)
s_barrier
buffer_store_dword v15, v12, s[4:7], s49 offen
s_mov_b64 exec, 0xffff
Lr36_0:
buffer_load_dword v15, v7, s[4:7], s23 offen sc1
Lr36_w:
s_waitcnt vmcnt(0)
v_cmp_gt_u32 vcc, 2, v15
s_nop 0
s_cbranch_vccnz Lr36_x
Lr36_d:
s_mov_b64 exec, -1
Lj34:
s_barrier
buffer_load_dwordx4 a[0:3], v4, s[12:15], s50 offen offset:0 sc1
buffer_load_dwordx4 a[4:7], v4, s[12:15], s50 offen offset:256 sc1
buffer_load_dwordx4 a[8:11], v4, s[12:15], s50 offen offset:2048 sc1
buffer_load_dwordx4 a[12:15], v4, s[12:15], s50 offen offset:2304 sc1
s_add_u32 s50, s50, 4096
buffer_load_dwordx4 a[16:19], v4, s[12:15], s50 offen offset:0 sc1
buffer_load_dwordx4 a[20:23], v4, s[12:15], s50 offen offset:256 sc1
buffer_load_dword v216, v6, s[4:7], s33 offen offset:0 sc1
buffer_load_dword v217, v6, s[4:7], s33 offen offset:128 sc1
buffer_load_dword v218, v6, s[4:7], s33 offen offset:256 sc1
buffer_load_dword v219, v6, s[4:7], s33 offen offset:384 sc1
buffer_load_dword v220, v6, s[4:7], s33 offen offset:512 sc1
buffer_load_dword v221, v6, s[4:7], s33 offen offset:640 sc1
buffer_load_dword v222, v6, s[4:7], s33 offen offset:768 sc1
buffer_load_dword v223, v6, s[4:7], s33 offen offset:896 sc1
buffer_load_dwordx4 a[24:27], v4, s[12:15], s50 offen offset:2048 sc1
buffer_load_dwordx4 a[28:31], v4, s[12:15], s50 offen offset:2304 sc1
s_add_u32 s50, s50, 4096
buffer_load_dwordx4 a[32:35], v4, s[12:15], s50 offen offset:0 sc1
buffer_load_dwordx4 a[36:39], v4, s[12:15], s50 offen offset:256 sc1
buffer_load_dwordx4 a[40:43], v4, s[12:15], s50 offen offset:2048 sc1
buffer_load_dwordx4 a[44:47], v4, s[12:15], s50 offen offset:2304 sc1
s_add_u32 s50, s50, 4096
buffer_load_dwordx4 a[48:51], v4, s[12:15], s50 offen offset:0 sc1
s_waitcnt vmcnt(19)
s_barrier
ds_read_b128 v[136:139], v2 offset:12288
ds_read_b128 v[140:143], v2 offset:13312
ds_read_b128 v[144:147], v2 offset:14336
ds_read_b128 v[148:151], v2 offset:15360
ds_read_b128 v[152:155], v2 offset:16384
ds_read_b128 v[156:159], v2 offset:17408
s_waitcnt lgkmcnt(5)
v_mfma_f32_16x16x32_bf16 v[40:43], v[136:139], a[0:3], 0
buffer_load_dwordx4 a[52:55], v4, s[12:15], s50 offen offset:256 sc1
v_mfma_f32_16x16x32_bf16 v[48:51], v[136:139], a[4:7], 0
ds_read_b128 v[160:163], v2 offset:18432
s_waitcnt lgkmcnt(5)
v_mfma_f32_16x16x32_bf16 v[52:55], v[140:143], a[4:7], 0
v_mfma_f32_16x16x32_bf16 v[44:47], v[140:143], a[0:3], 0
s_waitcnt lgkmcnt(3)
ds_read_b128 v[164:167], v2 offset:19456
v_mfma_f32_16x16x32_bf16 v[56:59], v[144:147], a[0:3], 0
buffer_load_dwordx4 a[56:59], v4, s[12:15], s50 offen offset:2048 sc1
v_mfma_f32_16x16x32_bf16 v[64:67], v[144:147], a[4:7], 0
ds_read_b128 v[136:139], v2 offset:20480
v_mfma_f32_16x16x32_bf16 v[68:71], v[148:151], a[4:7], 0
ds_read_b128 v[200:203], v8 offset:512
v_mfma_f32_16x16x32_bf16 v[60:63], v[148:151], a[0:3], 0
s_waitcnt vmcnt(19) lgkmcnt(4)
ds_read_b128 v[140:143], v2 offset:21504
v_mfma_f32_16x16x32_bf16 v[40:43], v[152:155], a[8:11], v[40:43]
buffer_load_dwordx4 a[60:63], v4, s[12:15], s50 offen offset:2304 sc1
v_mfma_f32_16x16x32_bf16 v[48:51], v[152:155], a[12:15], v[48:51]
s_add_u32 s50, s50, 4096
ds_read_b128 v[144:147], v2 offset:22528
v_mfma_f32_16x16x32_bf16 v[52:55], v[156:159], a[12:15], v[52:55]
ds_read_b128 v[204:207], v8 offset:576
v_mfma_f32_16x16x32_bf16 v[44:47], v[156:159], a[8:11], v[44:47]
s_waitcnt lgkmcnt(5)
ds_read_b128 v[148:151], v2 offset:23552
v_mfma_f32_16x16x32_bf16 v[56:59], v[160:163], a[8:11], v[56:59]
buffer_load_dwordx4 a[64:67], v4, s[12:15], s50 offen offset:0 sc1
v_mfma_f32_16x16x32_bf16 v[64:67], v[160:163], a[12:15], v[64:67]
ds_read_b128 v[152:155], v2 offset:24576
v_mfma_f32_16x16x32_bf16 v[68:71], v[164:167], a[12:15], v[68:71]
ds_read_b128 v[208:211], v8 offset:640
v_mfma_f32_16x16x32_bf16 v[60:63], v[164:167], a[8:11], v[60:63]
s_waitcnt vmcnt(19) lgkmcnt(5)
ds_read_b128 v[156:159], v2 offset:25600
v_mfma_f32_16x16x32_bf16 v[40:43], v[136:139], a[16:19], v[40:43]
buffer_load_dwordx4 a[68:71], v4, s[12:15], s50 offen offset:256 sc1
v_mfma_f32_16x16x32_bf16 v[48:51], v[136:139], a[20:23], v[48:51]
ds_read_b128 v[160:163], v2 offset:26624
v_mfma_f32_16x16x32_bf16 v[52:55], v[140:143], a[20:23], v[52:55]
ds_read_b128 v[212:215], v8 offset:704
v_mfma_f32_16x16x32_bf16 v[44:47], v[140:143], a[16:19], v[44:47]
s_waitcnt lgkmcnt(5)
ds_read_b128 v[164:167], v2 offset:27648
v_mfma_f32_16x16x32_bf16 v[56:59], v[144:147], a[16:19], v[56:59]
buffer_load_dwordx4 a[72:75], v4, s[12:15], s50 offen offset:2048 sc1
v_mfma_f32_16x16x32_bf16 v[64:67], v[144:147], a[20:23], v[64:67]
ds_read_b128 v[136:139], v2 offset:28672
v_mfma_f32_16x16x32_bf16 v[68:71], v[148:151], a[20:23], v[68:71]
ds_read_b128 v[72:75], v8 offset:768
v_mfma_f32_16x16x32_bf16 v[60:63], v[148:151], a[16:19], v[60:63]
s_waitcnt vmcnt(11) lgkmcnt(5)
ds_read_b128 v[140:143], v2 offset:29696
v_mfma_f32_16x16x32_bf16 v[40:43], v[152:155], a[24:27], v[40:43]
buffer_load_dwordx4 a[76:79], v4, s[12:15], s50 offen offset:2304 sc1
v_mfma_f32_16x16x32_bf16 v[48:51], v[152:155], a[28:31], v[48:51]
s_add_u32 s50, s50, 4096
ds_read_b128 v[144:147], v2 offset:30720
v_mfma_f32_16x16x32_bf16 v[52:55], v[156:159], a[28:31], v[52:55]
ds_read_b128 v[76:79], v8 offset:832
v_mfma_f32_16x16x32_bf16 v[44:47], v[156:159], a[24:27], v[44:47]
s_waitcnt lgkmcnt(5)
ds_read_b128 v[148:151], v2 offset:31744
v_mfma_f32_16x16x32_bf16 v[56:59], v[160:163], a[24:27], v[56:59]
buffer_load_dwordx4 a[80:83], v4, s[12:15], s50 offen offset:0 sc1
v_mfma_f32_16x16x32_bf16 v[64:67], v[160:163], a[28:31], v[64:67]
ds_read_b128 v[152:155], v2 offset:32768
v_add_f32 v216, v216, v217
v_mfma_f32_16x16x32_bf16 v[68:71], v[164:167], a[28:31], v[68:71]
ds_read_b128 v[88:91], v8 offset:896
v_add_f32 v218, v218, v219
v_mfma_f32_16x16x32_bf16 v[60:63], v[164:167], a[24:27], v[60:63]
s_waitcnt vmcnt(11) lgkmcnt(5)
ds_read_b128 v[156:159], v2 offset:33792
v_add_f32 v220, v220, v221
v_mfma_f32_16x16x32_bf16 v[40:43], v[136:139], a[32:35], v[40:43]
buffer_load_dwordx4 a[84:87], v4, s[12:15], s50 offen offset:256 sc1
v_mfma_f32_16x16x32_bf16 v[48:51], v[136:139], a[36:39], v[48:51]
ds_read_b128 v[160:163], v2 offset:34816
v_add_f32 v222, v222, v223
v_mfma_f32_16x16x32_bf16 v[52:55], v[140:143], a[36:39], v[52:55]
ds_read_b128 v[92:95], v8 offset:960
v_add_f32 v216, v216, v218
v_mfma_f32_16x16x32_bf16 v[44:47], v[140:143], a[32:35], v[44:47]
s_waitcnt lgkmcnt(5)
ds_read_b128 v[164:167], v2 offset:35840
v_add_f32 v220, v220, v222
v_mfma_f32_16x16x32_bf16 v[56:59], v[144:147], a[32:35], v[56:59]
buffer_load_dwordx4 a[88:91], v4, s[12:15], s50 offen offset:2048 sc1
v_mfma_f32_16x16x32_bf16 v[64:67], v[144:147], a[36:39], v[64:67]
ds_read_b128 v[136:139], v2 offset:36864
v_add_f32 v216, v216, v220
v_mfma_f32_16x16x32_bf16 v[68:71], v[148:151], a[36:39], v[68:71]
ds_read_b128 v[104:107], v8 offset:1024
v_mul_f32 v216, 986500301, v216
v_mfma_f32_16x16x32_bf16 v[60:63], v[148:151], a[32:35], v[60:63]
s_waitcnt vmcnt(11) lgkmcnt(5)
ds_read_b128 v[140:143], v2 offset:37888
v_mov_b32 v217, v216
v_mfma_f32_16x16x32_bf16 v[40:43], v[152:155], a[40:43], v[40:43]
buffer_load_dwordx4 a[92:95], v4, s[12:15], s50 offen offset:2304 sc1
v_mfma_f32_16x16x32_bf16 v[48:51], v[152:155], a[44:47], v[48:51]
s_add_u32 s50, s50, 4096
ds_read_b128 v[144:147], v2 offset:38912
v_mfma_f32_16x16x32_bf16 v[52:55], v[156:159], a[44:47], v[52:55]
ds_read_b128 v[108:111], v8 offset:1088
v_mfma_f32_16x16x32_bf16 v[44:47], v[156:159], a[40:43], v[44:47]
s_waitcnt lgkmcnt(5)
ds_read_b128 v[148:151], v2 offset:39936
v_mfma_f32_16x16x32_bf16 v[56:59], v[160:163], a[40:43], v[56:59]
buffer_load_dwordx4 a[96:99], v4, s[12:15], s50 offen offset:0 sc1
v_mfma_f32_16x16x32_bf16 v[64:67], v[160:163], a[44:47], v[64:67]
ds_read_b128 v[152:155], v2 offset:40960
v_mfma_f32_16x16x32_bf16 v[68:71], v[164:167], a[44:47], v[68:71]
ds_read_b128 v[120:123], v8 offset:1152
v_mfma_f32_16x16x32_bf16 v[60:63], v[164:167], a[40:43], v[60:63]
s_waitcnt vmcnt(11) lgkmcnt(5)
ds_read_b128 v[156:159], v2 offset:41984
v_mfma_f32_16x16x32_bf16 v[40:43], v[136:139], a[48:51], v[40:43]
buffer_load_dwordx4 a[100:103], v4, s[12:15], s50 offen offset:256 sc1
v_mfma_f32_16x16x32_bf16 v[48:51], v[136:139], a[52:55], v[48:51]
ds_read_b128 v[160:163], v2 offset:43008
v_mfma_f32_16x16x32_bf16 v[52:55], v[140:143], a[52:55], v[52:55]
ds_read_b128 v[124:127], v8 offset:1216
v_mfma_f32_16x16x32_bf16 v[44:47], v[140:143], a[48:51], v[44:47]
s_waitcnt lgkmcnt(5)
ds_read_b128 v[164:167], v2 offset:44032
v_mfma_f32_16x16x32_bf16 v[56:59], v[144:147], a[48:51], v[56:59]
buffer_load_dwordx4 a[104:107], v4, s[12:15], s50 offen offset:2048 sc1
v_mfma_f32_16x16x32_bf16 v[64:67], v[144:147], a[52:55], v[64:67]
ds_read_b128 v[136:139], v2 offset:45056
v_mfma_f32_16x16x32_bf16 v[68:71], v[148:151], a[52:55], v[68:71]
v_permlane32_swap_b32 v216, v217
v_mfma_f32_16x16x32_bf16 v[60:63], v[148:151], a[48:51], v[60:63]
s_waitcnt vmcnt(11) lgkmcnt(4)
ds_read_b128 v[140:143], v2 offset:46080
v_fma_f32 v217, -v216, v216, v217
v_mfma_f32_16x16x32_bf16 v[40:43], v[152:155], a[56:59], v[40:43]
buffer_load_dwordx4 a[108:111], v4, s[12:15], s50 offen offset:2304 sc1
v_mfma_f32_16x16x32_bf16 v[48:51], v[152:155], a[60:63], v[48:51]
s_add_u32 s50, s50, 4096
ds_read_b128 v[144:147], v2 offset:47104
v_max_f32 v217, 0, v217
v_mfma_f32_16x16x32_bf16 v[52:55], v[156:159], a[60:63], v[52:55]
v_add_f32 v217, 925353388, v217
v_mfma_f32_16x16x32_bf16 v[44:47], v[156:159], a[56:59], v[44:47]
s_waitcnt lgkmcnt(3)
ds_read_b128 v[148:151], v2 offset:48128
v_mfma_f32_16x16x32_bf16 v[56:59], v[160:163], a[56:59], v[56:59]
buffer_load_dwordx4 a[112:115], v4, s[12:15], s50 offen offset:0 sc1
v_mfma_f32_16x16x32_bf16 v[64:67], v[160:163], a[60:63], v[64:67]
ds_read_b128 v[152:155], v2 offset:49152
v_mfma_f32_16x16x32_bf16 v[68:71], v[164:167], a[60:63], v[68:71]
v_rsq_f32 v36, v217
v_mfma_f32_16x16x32_bf16 v[60:63], v[164:167], a[56:59], v[60:63]
s_waitcnt vmcnt(11) lgkmcnt(3)
ds_read_b128 v[156:159], v2 offset:50176
v_sub_f32 v242, 0, v216
v_mfma_f32_16x16x32_bf16 v[40:43], v[136:139], a[64:67], v[40:43]
buffer_load_dwordx4 a[116:119], v4, s[12:15], s50 offen offset:256 sc1
v_mfma_f32_16x16x32_bf16 v[48:51], v[136:139], a[68:71], v[48:51]
ds_read_b128 v[160:163], v2 offset:51200
v_mul_f32 v236, 3222493025, v36
v_mfma_f32_16x16x32_bf16 v[52:55], v[140:143], a[68:71], v[52:55]
v_mul_f32 v238, v36, v36
v_mov_b32 v240, v217
v_mfma_f32_16x16x32_bf16 v[44:47], v[140:143], a[64:67], v[44:47]
s_waitcnt lgkmcnt(3)
ds_read_b128 v[164:167], v2 offset:52224
v_mul_f32 v238, v238, v36
v_mfma_f32_16x16x32_bf16 v[56:59], v[144:147], a[64:67], v[56:59]
buffer_load_dwordx4 a[120:123], v4, s[12:15], s50 offen offset:2048 sc1
v_mfma_f32_16x16x32_bf16 v[64:67], v[144:147], a[68:71], v[64:67]
ds_read_b128 v[136:139], v2 offset:53248
v_mul_f32 v238, 3184710632, v238
v_mfma_f32_16x16x32_bf16 v[68:71], v[148:151], a[68:71], v[68:71]
v_mov_b32 v237, v236
v_mov_b32 v239, v238
v_mfma_f32_16x16x32_bf16 v[60:63], v[148:151], a[64:67], v[60:63]
s_waitcnt vmcnt(11) lgkmcnt(3)
ds_read_b128 v[140:143], v2 offset:54272
v_mov_b32 v241, v240
v_mfma_f32_16x16x32_bf16 v[40:43], v[152:155], a[72:75], v[40:43]
buffer_load_dwordx4 a[124:127], v4, s[12:15], s50 offen offset:2304 sc1
v_mfma_f32_16x16x32_bf16 v[48:51], v[152:155], a[76:79], v[48:51]
s_add_u32 s50, s50, 4096
ds_read_b128 v[144:147], v2 offset:55296
v_mov_b32 v243, v242
v_mfma_f32_16x16x32_bf16 v[52:55], v[156:159], a[76:79], v[52:55]
v_permlane16_swap_b32 v236, v237
v_mfma_f32_16x16x32_bf16 v[44:47], v[156:159], a[72:75], v[44:47]
s_waitcnt lgkmcnt(3)
ds_read_b128 v[148:151], v2 offset:56320
v_mfma_f32_16x16x32_bf16 v[56:59], v[160:163], a[72:75], v[56:59]
buffer_load_dwordx4 a[128:131], v4, s[12:15], s50 offen offset:0 sc1
v_mfma_f32_16x16x32_bf16 v[64:67], v[160:163], a[76:79], v[64:67]
ds_read_b128 v[152:155], v2 offset:57344
v_mfma_f32_16x16x32_bf16 v[68:71], v[164:167], a[76:79], v[68:71]
v_permlane16_swap_b32 v238, v239
v_mfma_f32_16x16x32_bf16 v[60:63], v[164:167], a[72:75], v[60:63]
s_waitcnt vmcnt(11) lgkmcnt(3)
ds_read_b128 v[156:159], v2 offset:58368
v_mfma_f32_16x16x32_bf16 v[40:43], v[136:139], a[80:83], v[40:43]
buffer_load_dwordx4 a[132:135], v4, s[12:15], s50 offen offset:256 sc1
v_mfma_f32_16x16x32_bf16 v[48:51], v[136:139], a[84:87], v[48:51]
ds_read_b128 v[160:163], v2 offset:59392
v_mfma_f32_16x16x32_bf16 v[52:55], v[140:143], a[84:87], v[52:55]
v_permlane16_swap_b32 v240, v241
v_mfma_f32_16x16x32_bf16 v[44:47], v[140:143], a[80:83], v[44:47]
s_waitcnt lgkmcnt(3)
ds_read_b128 v[164:167], v2 offset:60416
v_mfma_f32_16x16x32_bf16 v[56:59], v[144:147], a[80:83], v[56:59]
buffer_load_dwordx4 a[136:139], v4, s[12:15], s50 offen offset:2048 sc1
v_mfma_f32_16x16x32_bf16 v[64:67], v[144:147], a[84:87], v[64:67]
ds_read_b128 v[136:139], v2 offset:61440
v_mfma_f32_16x16x32_bf16 v[68:71], v[148:151], a[84:87], v[68:71]
v_permlane16_swap_b32 v242, v243
v_mfma_f32_16x16x32_bf16 v[60:63], v[148:151], a[80:83], v[60:63]
s_waitcnt vmcnt(11) lgkmcnt(3)
ds_read_b128 v[140:143], v2 offset:62464
v_mul_f32 v80, v72, v243
v_mfma_f32_16x16x32_bf16 v[40:43], v[152:155], a[88:91], v[40:43]
s_add_u32 s66, s18, 1
buffer_load_dwordx4 a[140:143], v4, s[12:15], s50 offen offset:2304 sc1
v_mfma_f32_16x16x32_bf16 v[48:51], v[152:155], a[92:95], v[48:51]
s_add_u32 s50, s50, 4096
ds_read_b128 v[144:147], v2 offset:63488
v_mul_f32 v81, v73, v243
v_mfma_f32_16x16x32_bf16 v[52:55], v[156:159], a[92:95], v[52:55]
s_and_b32 s66, s66, 3
v_mul_f32 v82, v74, v243
v_mul_f32 v83, v75, v243
v_mfma_f32_16x16x32_bf16 v[44:47], v[156:159], a[88:91], v[44:47]
s_waitcnt lgkmcnt(3)
ds_read_b128 v[148:151], v2 offset:64512
v_mul_f32 v72, v72, v242
v_mfma_f32_16x16x32_bf16 v[56:59], v[160:163], a[88:91], v[56:59]
s_lshr_b32 s67, s66, 1
buffer_load_dwordx4 a[144:147], v4, s[12:15], s50 offen offset:0 sc1
v_mfma_f32_16x16x32_bf16 v[64:67], v[160:163], a[92:95], v[64:67]
s_mul_i32 s67, s67, 101888
ds_read_b128 v[152:155], v3 offset:0
v_mul_f32 v73, v73, v242
v_mfma_f32_16x16x32_bf16 v[68:71], v[164:167], a[92:95], v[68:71]
s_lshl_b32 s62, s66, 8
v_mul_f32 v74, v74, v242
v_mul_f32 v75, v75, v242
v_mfma_f32_16x16x32_bf16 v[60:63], v[164:167], a[88:91], v[60:63]
s_waitcnt vmcnt(11) lgkmcnt(3)
ds_read_b128 v[156:159], v3 offset:1024
v_mul_f32 v84, v76, v243
v_mfma_f32_16x16x32_bf16 v[40:43], v[136:139], a[96:99], v[40:43]
s_add_u32 s62, s62, s67
buffer_load_dwordx4 a[148:151], v4, s[12:15], s50 offen offset:256 sc1
v_mfma_f32_16x16x32_bf16 v[48:51], v[136:139], a[100:103], v[48:51]
s_add_u32 s62, s62, s41
ds_read_b128 v[160:163], v3 offset:2048
v_mul_f32 v85, v77, v243
v_mfma_f32_16x16x32_bf16 v[52:55], v[140:143], a[100:103], v[52:55]
s_mul_i32 s66, s66, 5120
v_mul_f32 v86, v78, v243
v_mul_f32 v87, v79, v243
v_mfma_f32_16x16x32_bf16 v[44:47], v[140:143], a[96:99], v[44:47]
s_waitcnt lgkmcnt(3)
ds_read_b128 v[164:167], v3 offset:3072
v_mul_f32 v76, v76, v242
v_mfma_f32_16x16x32_bf16 v[56:59], v[144:147], a[96:99], v[56:59]
s_add_u32 s66, s66, 118784
buffer_load_dwordx4 a[152:155], v4, s[12:15], s50 offen offset:2048 sc1
v_mfma_f32_16x16x32_bf16 v[64:67], v[144:147], a[100:103], v[64:67]
ds_read_b128 v[136:139], v3 offset:4096
v_mul_f32 v77, v77, v242
v_mfma_f32_16x16x32_bf16 v[68:71], v[148:151], a[100:103], v[68:71]
v_mul_f32 v78, v78, v242
v_add_u32 v246, s66, v1
v_mfma_f32_16x16x32_bf16 v[60:63], v[148:151], a[96:99], v[60:63]
s_waitcnt vmcnt(11) lgkmcnt(3)
ds_read_b128 v[140:143], v3 offset:5120
v_mul_f32 v79, v79, v242
v_mfma_f32_16x16x32_bf16 v[40:43], v[152:155], a[104:107], v[40:43]
s_add_u32 s66, s18, 2
buffer_load_dwordx4 a[156:159], v4, s[12:15], s50 offen offset:2304 sc1
v_mfma_f32_16x16x32_bf16 v[48:51], v[152:155], a[108:111], v[48:51]
s_and_b32 s66, s66, 3
ds_read_b128 v[144:147], v3 offset:6144
v_mul_f32 v96, v88, v243
v_mfma_f32_16x16x32_bf16 v[52:55], v[156:159], a[108:111], v[52:55]
s_lshr_b32 s67, s66, 1
v_mul_f32 v97, v89, v243
v_mul_f32 v98, v90, v243
v_mfma_f32_16x16x32_bf16 v[44:47], v[156:159], a[104:107], v[44:47]
s_waitcnt lgkmcnt(3)
ds_read_b128 v[148:151], v3 offset:7168
v_mul_f32 v99, v91, v243
v_mfma_f32_16x16x32_bf16 v[56:59], v[160:163], a[104:107], v[56:59]
s_mul_i32 s67, s67, 101888
v_mul_f32 v88, v88, v242
v_mul_f32 v89, v89, v242
v_mfma_f32_16x16x32_bf16 v[64:67], v[160:163], a[108:111], v[64:67]
s_lshl_b32 s63, s66, 8
ds_read_b128 v[152:155], v3 offset:8192
v_mul_f32 v90, v90, v242
v_mfma_f32_16x16x32_bf16 v[68:71], v[164:167], a[108:111], v[68:71]
s_add_u32 s63, s63, s67
v_mul_f32 v91, v91, v242
v_mul_f32 v100, v92, v243
v_mfma_f32_16x16x32_bf16 v[60:63], v[164:167], a[104:107], v[60:63]
s_waitcnt vmcnt(10) lgkmcnt(3)
ds_read_b128 v[156:159], v3 offset:9216
v_mul_f32 v101, v93, v243
v_mfma_f32_16x16x32_bf16 v[40:43], v[136:139], a[112:115], v[40:43]
s_add_u32 s63, s63, s41
v_mul_f32 v102, v94, v243
v_mul_f32 v103, v95, v243
v_mfma_f32_16x16x32_bf16 v[48:51], v[136:139], a[116:119], v[48:51]
s_mul_i32 s66, s66, 5120
ds_read_b128 v[160:163], v3 offset:10240
v_mul_f32 v92, v92, v242
v_mfma_f32_16x16x32_bf16 v[52:55], v[140:143], a[116:119], v[52:55]
s_add_u32 s66, s66, 139264
v_mul_f32 v93, v93, v242
v_mul_f32 v94, v94, v242
v_mfma_f32_16x16x32_bf16 v[44:47], v[140:143], a[112:115], v[44:47]
s_waitcnt lgkmcnt(3)
ds_read_b128 v[164:167], v3 offset:11264
v_mul_f32 v95, v95, v242
v_mfma_f32_16x16x32_bf16 v[56:59], v[144:147], a[112:115], v[56:59]
v_mul_f32 v112, v104, v243
v_add_u32 v247, s66, v1
v_mfma_f32_16x16x32_bf16 v[64:67], v[144:147], a[116:119], v[64:67]
s_add_u32 s66, s18, 3
ds_read_b128 v[136:139], v3 offset:12288
v_mul_f32 v113, v105, v243
v_mfma_f32_16x16x32_bf16 v[68:71], v[148:151], a[116:119], v[68:71]
s_mul_i32 s53, s18, 5120
v_mul_f32 v114, v106, v243
s_and_b32 s66, s66, 3
v_mfma_f32_16x16x32_bf16 v[60:63], v[148:151], a[112:115], v[60:63]
s_waitcnt vmcnt(8) lgkmcnt(3)
ds_read_b128 v[140:143], v3 offset:13312
s_add_u32 m0, s53, 77824
v_mfma_f32_16x16x32_bf16 v[40:43], v[152:155], a[120:123], v[40:43]
s_add_u32 s52, s29, s53
s_barrier
v_mfma_f32_16x16x32_bf16 v[48:51], v[152:155], a[124:127], v[48:51]
s_add_u32 s52, s52, 143360
ds_read_b128 v[144:147], v3 offset:14336
v_mul_f32 v115, v107, v243
v_mfma_f32_16x16x32_bf16 v[52:55], v[156:159], a[124:127], v[52:55]
s_lshr_b32 s67, s66, 1
buffer_load_dwordx4 v1, s[4:7], s52 offen offset:0 sc1 lds
v_mfma_f32_16x16x32_bf16 v[44:47], v[156:159], a[120:123], v[44:47]
s_waitcnt lgkmcnt(3)
ds_read_b128 v[148:151], v3 offset:15360
v_mul_f32 v104, v104, v242
v_mfma_f32_16x16x32_bf16 v[56:59], v[160:163], a[120:123], v[56:59]
s_mul_i32 s67, s67, 101888
v_mul_f32 v105, v105, v242
v_mul_f32 v106, v106, v242
v_mfma_f32_16x16x32_bf16 v[64:67], v[160:163], a[124:127], v[64:67]
s_lshl_b32 s64, s66, 8
ds_read_b128 v[152:155], v3 offset:16384
v_mul_f32 v107, v107, v242
v_mfma_f32_16x16x32_bf16 v[68:71], v[164:167], a[124:127], v[68:71]
s_add_u32 s64, s64, s67
buffer_load_dwordx4 v1, s[4:7], s52 offen offset:1024 sc1 lds
v_mfma_f32_16x16x32_bf16 v[60:63], v[164:167], a[120:123], v[60:63]
s_waitcnt vmcnt(8) lgkmcnt(3)
ds_read_b128 v[156:159], v3 offset:17408
v_mul_f32 v116, v108, v243
v_mfma_f32_16x16x32_bf16 v[40:43], v[136:139], a[128:131], v[40:43]
s_add_u32 s64, s64, s41
v_mul_f32 v117, v109, v243
v_mul_f32 v118, v110, v243
v_mfma_f32_16x16x32_bf16 v[48:51], v[136:139], a[132:135], v[48:51]
s_mul_i32 s66, s66, 5120
ds_read_b128 v[160:163], v3 offset:18432
v_mul_f32 v119, v111, v243
v_mfma_f32_16x16x32_bf16 v[52:55], v[140:143], a[132:135], v[52:55]
s_add_u32 s66, s66, 118784
buffer_load_dwordx4 v1, s[4:7], s52 offen offset:2048 sc1 lds
v_mfma_f32_16x16x32_bf16 v[44:47], v[140:143], a[128:131], v[44:47]
s_waitcnt lgkmcnt(3)
ds_read_b128 v[164:167], v3 offset:19456
v_mul_f32 v108, v108, v242
v_mfma_f32_16x16x32_bf16 v[56:59], v[144:147], a[128:131], v[56:59]
v_mul_f32 v109, v109, v242
v_add_u32 v248, s66, v1
v_mfma_f32_16x16x32_bf16 v[64:67], v[144:147], a[132:135], v[64:67]
s_add_u32 s66, s18, 4
ds_read_b128 v[136:139], v3 offset:20480
v_mul_f32 v110, v110, v242
v_mfma_f32_16x16x32_bf16 v[68:71], v[148:151], a[132:135], v[68:71]
s_and_b32 s66, s66, 3
buffer_load_dwordx4 v1, s[4:7], s52 offen offset:3072 sc1 lds
v_mfma_f32_16x16x32_bf16 v[60:63], v[148:151], a[128:131], v[60:63]
s_waitcnt vmcnt(8) lgkmcnt(3)
ds_read_b128 v[140:143], v3 offset:21504
s_add_u32 m0, m0, 4096
v_mfma_f32_16x16x32_bf16 v[40:43], v[152:155], a[136:139], v[40:43]
s_add_u32 s52, s52, 4096
v_mul_f32 v111, v111, v242
s_lshr_b32 s67, s66, 1
v_mfma_f32_16x16x32_bf16 v[48:51], v[152:155], a[140:143], v[48:51]
s_mul_i32 s67, s67, 101888
ds_read_b128 v[144:147], v3 offset:22528
v_mul_f32 v128, v120, v243
v_mfma_f32_16x16x32_bf16 v[52:55], v[156:159], a[140:143], v[52:55]
s_lshl_b32 s65, s66, 8
buffer_load_dwordx4 v1, s[4:7], s52 offen offset:0 sc1 lds
v_mfma_f32_16x16x32_bf16 v[44:47], v[156:159], a[136:139], v[44:47]
s_waitcnt lgkmcnt(3)
ds_read_b128 v[148:151], v3 offset:23552
s_mul_i32 s53, s18, 5120
v_mfma_f32_16x16x32_bf16 v[56:59], v[160:163], a[136:139], v[56:59]
s_add_u32 m0, s53, 98304
v_mul_f32 v129, v121, v243
s_add_u32 s65, s65, s67
v_mfma_f32_16x16x32_bf16 v[64:67], v[160:163], a[140:143], v[64:67]
s_add_u32 s52, s29, s53
ds_read_b128 v[152:155], v3 offset:24576
v_mul_f32 v130, v122, v243
v_mfma_f32_16x16x32_bf16 v[68:71], v[164:167], a[140:143], v[68:71]
s_add_u32 s52, s52, 163840
v_mul_f32 v131, v123, v243
s_add_u32 s65, s65, s41
v_mfma_f32_16x16x32_bf16 v[60:63], v[164:167], a[136:139], v[60:63]
s_waitcnt vmcnt(7) lgkmcnt(3)
ds_read_b128 v[156:159], v3 offset:25600
v_mul_f32 v120, v120, v242
v_mfma_f32_16x16x32_bf16 v[40:43], v[136:139], a[144:147], v[40:43]
s_mul_i32 s66, s66, 5120
buffer_load_dwordx4 v1, s[4:7], s52 offen offset:0 sc1 lds
v_mfma_f32_16x16x32_bf16 v[48:51], v[136:139], a[148:151], v[48:51]
s_add_u32 s66, s66, 118784
ds_read_b128 v[160:163], v3 offset:26624
v_mul_f32 v121, v121, v242
v_mfma_f32_16x16x32_bf16 v[52:55], v[140:143], a[148:151], v[52:55]
v_mul_f32 v122, v122, v242
v_add_u32 v249, s66, v1
v_mfma_f32_16x16x32_bf16 v[44:47], v[140:143], a[144:147], v[44:47]
s_waitcnt lgkmcnt(3)
ds_read_b128 v[164:167], v3 offset:27648
v_mul_f32 v123, v123, v242
v_mfma_f32_16x16x32_bf16 v[56:59], v[144:147], a[144:147], v[56:59]
buffer_load_dwordx4 v1, s[4:7], s52 offen offset:1024 sc1 lds
v_mfma_f32_16x16x32_bf16 v[64:67], v[144:147], a[148:151], v[64:67]
ds_read_b128 v[136:139], v1 offset:0
v_mul_f32 v132, v124, v243
v_mfma_f32_16x16x32_bf16 v[68:71], v[148:151], a[148:151], v[68:71]
v_mul_f32 v133, v125, v243
v_mul_f32 v134, v126, v243
v_mfma_f32_16x16x32_bf16 v[60:63], v[148:151], a[144:147], v[60:63]
s_waitcnt vmcnt(7) lgkmcnt(3)
ds_read_b128 v[140:143], v1 offset:1024
v_mul_f32 v135, v127, v243
v_mfma_f32_16x16x32_bf16 v[40:43], v[152:155], a[152:155], v[40:43]
buffer_load_dwordx4 v1, s[4:7], s52 offen offset:2048 sc1 lds
v_mfma_f32_16x16x32_bf16 v[48:51], v[152:155], a[156:159], v[48:51]
ds_read_b128 v[144:147], v1 offset:2048
v_mul_f32 v124, v124, v242
v_mfma_f32_16x16x32_bf16 v[52:55], v[156:159], a[156:159], v[52:55]
v_mul_f32 v125, v125, v242
v_mul_f32 v126, v126, v242
v_mfma_f32_16x16x32_bf16 v[44:47], v[156:159], a[152:155], v[44:47]
s_waitcnt lgkmcnt(3)
ds_read_b128 v[148:151], v1 offset:3072
v_mul_f32 v127, v127, v242
v_mfma_f32_16x16x32_bf16 v[56:59], v[160:163], a[152:155], v[56:59]
buffer_load_dwordx4 v1, s[4:7], s52 offen offset:3072 sc1 lds
v_mfma_f32_16x16x32_bf16 v[64:67], v[160:163], a[156:159], v[64:67]
s_add_u32 m0, m0, 4096
ds_read_b128 v[152:155], v1 offset:4096
s_add_u32 s52, s52, 4096
v_mfma_f32_16x16x32_bf16 v[68:71], v[164:167], a[156:159], v[68:71]
v_mfma_f32_16x16x32_bf16 v[60:63], v[164:167], a[152:155], v[60:63]
s_waitcnt lgkmcnt(3)
ds_read_b128 v[156:159], v1 offset:5120
v_mfma_f32_16x16x32_bf16 v[72:75], v[136:139], a[0:3], v[72:75]
buffer_load_dwordx4 v1, s[4:7], s52 offen offset:0 sc1 lds
v_mfma_f32_16x16x32_bf16 v[80:83], v[136:139], a[4:7], v[80:83]
s_mul_i32 s53, s18, 5120
ds_read_b128 v[160:163], v1 offset:6144
s_add_u32 m0, s53, 118784
v_mfma_f32_16x16x32_bf16 v[84:87], v[140:143], a[4:7], v[84:87]
s_add_u32 s52, s29, s53
s_add_u32 s52, s52, 184320
v_mfma_f32_16x16x32_bf16 v[76:79], v[140:143], a[0:3], v[76:79]
s_waitcnt lgkmcnt(3)
ds_read_b128 v[164:167], v1 offset:7168
v_mfma_f32_16x16x32_bf16 v[88:91], v[144:147], a[0:3], v[88:91]
buffer_load_dwordx4 v1, s[4:7], s52 offen offset:0 sc1 lds
v_mfma_f32_16x16x32_bf16 v[96:99], v[144:147], a[4:7], v[96:99]
ds_read_b128 v[136:139], v1 offset:8192
v_mfma_f32_16x16x32_bf16 v[100:103], v[148:151], a[4:7], v[100:103]
v_mfma_f32_16x16x32_bf16 v[92:95], v[148:151], a[0:3], v[92:95]
s_waitcnt lgkmcnt(3)
ds_read_b128 v[140:143], v1 offset:9216
v_mfma_f32_16x16x32_bf16 v[72:75], v[152:155], a[8:11], v[72:75]
v_fma_f32 v40, v200, v242, v40
v_fma_f32 v42, v202, v242, v42
v_mfma_f32_16x16x32_bf16 v[80:83], v[152:155], a[12:15], v[80:83]
ds_read_b128 v[144:147], v1 offset:10240
v_fma_f32 v41, v201, v242, v41
v_mfma_f32_16x16x32_bf16 v[84:87], v[156:159], a[12:15], v[84:87]
buffer_load_dwordx4 v1, s[4:7], s52 offen offset:1024 sc1 lds
v_mfma_f32_16x16x32_bf16 v[76:79], v[156:159], a[8:11], v[76:79]
s_waitcnt lgkmcnt(3)
ds_read_b128 v[148:151], v1 offset:11264
v_mul_f32 v216, v40, v40
v_mfma_f32_16x16x32_bf16 v[88:91], v[160:163], a[8:11], v[88:91]
v_mul_f32 v217, v41, v41
v_fma_f32 v43, v203, v242, v43
v_mfma_f32_16x16x32_bf16 v[96:99], v[160:163], a[12:15], v[96:99]
ds_read_b128 v[152:155], v1 offset:12288
v_fma_f32 v216, v216, v238, v236
v_mfma_f32_16x16x32_bf16 v[100:103], v[164:167], a[12:15], v[100:103]
v_fma_f32 v217, v217, v238, v236
v_mul_f32 v218, v42, v42
v_mfma_f32_16x16x32_bf16 v[92:95], v[164:167], a[8:11], v[92:95]
s_waitcnt lgkmcnt(3)
ds_read_b128 v[156:159], v1 offset:13312
v_mul_f32 v216, v216, v40
v_mfma_f32_16x16x32_bf16 v[72:75], v[136:139], a[16:19], v[72:75]
buffer_load_dwordx4 v1, s[4:7], s52 offen offset:2048 sc1 lds
v_mfma_f32_16x16x32_bf16 v[80:83], v[136:139], a[20:23], v[80:83]
ds_read_b128 v[160:163], v1 offset:14336
v_mul_f32 v217, v217, v41
v_mfma_f32_16x16x32_bf16 v[84:87], v[140:143], a[20:23], v[84:87]
v_exp_f32 v216, v216
v_mfma_f32_16x16x32_bf16 v[76:79], v[140:143], a[16:19], v[76:79]
s_waitcnt lgkmcnt(3)
ds_read_b128 v[164:167], v1 offset:15360
v_fma_f32 v56, v208, v242, v56
v_mfma_f32_16x16x32_bf16 v[88:91], v[144:147], a[16:19], v[88:91]
v_fma_f32 v57, v209, v242, v57
v_mul_f32 v219, v43, v43
v_mfma_f32_16x16x32_bf16 v[96:99], v[144:147], a[20:23], v[96:99]
ds_read_b128 v[136:139], v1 offset:16384
v_mul_f32 v56, v56, v40
v_mfma_f32_16x16x32_bf16 v[100:103], v[148:151], a[20:23], v[100:103]
buffer_load_dwordx4 v1, s[4:7], s52 offen offset:3072 sc1 lds
v_mfma_f32_16x16x32_bf16 v[92:95], v[148:151], a[16:19], v[92:95]
s_waitcnt lgkmcnt(3)
ds_read_b128 v[140:143], v1 offset:17408
v_fma_f32 v218, v218, v238, v236
v_mfma_f32_16x16x32_bf16 v[72:75], v[152:155], a[24:27], v[72:75]
s_add_u32 m0, m0, 4096
v_exp_f32 v217, v217
v_mfma_f32_16x16x32_bf16 v[80:83], v[152:155], a[28:31], v[80:83]
s_add_u32 s52, s52, 4096
ds_read_b128 v[144:147], v1 offset:18432
v_fma_f32 v216, v216, v240, v240
v_mfma_f32_16x16x32_bf16 v[84:87], v[156:159], a[28:31], v[84:87]
v_rcp_f32 v216, v216
v_mfma_f32_16x16x32_bf16 v[76:79], v[156:159], a[24:27], v[76:79]
s_waitcnt lgkmcnt(3)
ds_read_b128 v[148:151], v1 offset:19456
v_fma_f32 v217, v217, v240, v240
v_mfma_f32_16x16x32_bf16 v[88:91], v[160:163], a[24:27], v[88:91]
buffer_load_dwordx4 v1, s[4:7], s52 offen offset:0 sc1 lds
v_mfma_f32_16x16x32_bf16 v[96:99], v[160:163], a[28:31], v[96:99]
ds_read_b128 v[152:155], v1 offset:20480
v_mul_f32 v57, v57, v41
v_mfma_f32_16x16x32_bf16 v[100:103], v[164:167], a[28:31], v[100:103]
v_rcp_f32 v217, v217
v_mfma_f32_16x16x32_bf16 v[92:95], v[164:167], a[24:27], v[92:95]
s_waitcnt lgkmcnt(3)
ds_read_b128 v[156:159], v1 offset:21504
v_mul_f32 v56, v56, v216
v_mfma_f32_16x16x32_bf16 v[72:75], v[136:139], a[32:35], v[72:75]
v_mul_f32 v57, v57, v217
v_fma_f32 v219, v219, v238, v236
v_mfma_f32_16x16x32_bf16 v[80:83], v[136:139], a[36:39], v[80:83]
ds_read_b128 v[160:163], v1 offset:22528
v_cvt_pk_bf16_f32 v228, v56, v57
v_mfma_f32_16x16x32_bf16 v[84:87], v[140:143], a[36:39], v[84:87]
v_fma_f32 v52, v204, v243, v52
v_mul_f32 v218, v218, v42
v_mfma_f32_16x16x32_bf16 v[76:79], v[140:143], a[32:35], v[76:79]
s_waitcnt lgkmcnt(3)
ds_read_b128 v[164:167], v1 offset:23552
v_fma_f32 v53, v205, v243, v53
v_mfma_f32_16x16x32_bf16 v[88:91], v[144:147], a[32:35], v[88:91]
v_mul_f32 v216, v52, v52
v_mul_f32 v219, v219, v43
v_mfma_f32_16x16x32_bf16 v[96:99], v[144:147], a[36:39], v[96:99]
ds_read_b128 v[136:139], v1 offset:24576
v_mul_f32 v217, v53, v53
v_mfma_f32_16x16x32_bf16 v[100:103], v[148:151], a[36:39], v[100:103]
s_mul_i32 s53, s18, 5120
v_fma_f32 v216, v216, v239, v237
v_fma_f32 v44, v204, v242, v44
v_mfma_f32_16x16x32_bf16 v[92:95], v[148:151], a[32:35], v[92:95]
s_waitcnt lgkmcnt(3)
ds_read_b128 v[140:143], v1 offset:25600
s_add_u32 m0, s53, 139264
v_mfma_f32_16x16x32_bf16 v[72:75], v[152:155], a[40:43], v[72:75]
s_add_u32 s52, s29, s53
s_barrier
v_mfma_f32_16x16x32_bf16 v[80:83], v[152:155], a[44:47], v[80:83]
s_add_u32 s52, s52, 204800
ds_read_b128 v[144:147], v1 offset:26624
v_fma_f32 v217, v217, v239, v237
v_mfma_f32_16x16x32_bf16 v[84:87], v[156:159], a[44:47], v[84:87]
buffer_load_dwordx4 v1, s[4:7], s52 offen offset:0 sc1 lds
v_mfma_f32_16x16x32_bf16 v[76:79], v[156:159], a[40:43], v[76:79]
s_waitcnt lgkmcnt(3)
ds_read_b128 v[148:151], v1 offset:27648
v_mul_f32 v216, v216, v52
v_mfma_f32_16x16x32_bf16 v[88:91], v[160:163], a[40:43], v[88:91]
v_mul_f32 v217, v217, v53
v_fma_f32 v45, v205, v242, v45
v_mfma_f32_16x16x32_bf16 v[96:99], v[160:163], a[44:47], v[96:99]
ds_read_b128 v[152:155], v1 offset:28672
v_mul_f32 v220, v44, v44
v_mfma_f32_16x16x32_bf16 v[100:103], v[164:167], a[44:47], v[100:103]
buffer_load_dwordx4 v1, s[4:7], s52 offen offset:1024 sc1 lds
v_mfma_f32_16x16x32_bf16 v[92:95], v[164:167], a[40:43], v[92:95]
s_waitcnt lgkmcnt(3)
ds_read_b128 v[156:159], v1 offset:29696
v_mul_f32 v221, v45, v45
v_mfma_f32_16x16x32_bf16 v[72:75], v[136:139], a[48:51], v[72:75]
v_exp_f32 v216, v216
v_mfma_f32_16x16x32_bf16 v[80:83], v[136:139], a[52:55], v[80:83]
ds_read_b128 v[160:163], v1 offset:30720
v_fma_f32 v68, v212, v243, v68
v_mfma_f32_16x16x32_bf16 v[84:87], v[140:143], a[52:55], v[84:87]
buffer_load_dwordx4 v1, s[4:7], s52 offen offset:2048 sc1 lds
v_mfma_f32_16x16x32_bf16 v[76:79], v[140:143], a[48:51], v[76:79]
s_waitcnt lgkmcnt(3)
ds_read_b128 v[164:167], v1 offset:31744
v_fma_f32 v69, v213, v243, v69
v_mfma_f32_16x16x32_bf16 v[88:91], v[144:147], a[48:51], v[88:91]
v_mul_f32 v68, v68, v52
v_fma_f32 v220, v220, v238, v236
v_mfma_f32_16x16x32_bf16 v[96:99], v[144:147], a[52:55], v[96:99]
ds_read_b128 v[136:139], v1 offset:32768
v_fma_f32 v221, v221, v238, v236
v_mfma_f32_16x16x32_bf16 v[100:103], v[148:151], a[52:55], v[100:103]
buffer_load_dwordx4 v1, s[4:7], s52 offen offset:3072 sc1 lds
v_mfma_f32_16x16x32_bf16 v[92:95], v[148:151], a[48:51], v[92:95]
s_waitcnt lgkmcnt(3)
ds_read_b128 v[140:143], v1 offset:33792
s_add_u32 m0, m0, 4096
v_mfma_f32_16x16x32_bf16 v[72:75], v[152:155], a[56:59], v[72:75]
s_add_u32 s52, s52, 4096
v_exp_f32 v217, v217
v_mfma_f32_16x16x32_bf16 v[80:83], v[152:155], a[60:63], v[80:83]
ds_read_b128 v[144:147], v1 offset:34816
v_fma_f32 v216, v216, v241, v241
v_mfma_f32_16x16x32_bf16 v[84:87], v[156:159], a[60:63], v[84:87]
buffer_load_dwordx4 v1, s[4:7], s52 offen offset:0 sc1 lds
v_mfma_f32_16x16x32_bf16 v[76:79], v[156:159], a[56:59], v[76:79]
s_waitcnt lgkmcnt(3)
ds_read_b128 v[148:151], v1 offset:35840
s_mov_b32 s70, Lc39-C_pc+2048
v_mfma_f32_16x16x32_bf16 v[88:91], v[160:163], a[56:59], v[88:91]
s_mul_i32 s53, s18, 5120
s_min_u32 s70, s70, M_text_end-C_pc-16384
v_mul_f32 v220, v220, v44
v_mfma_f32_16x16x32_bf16 v[96:99], v[160:163], a[60:63], v[96:99]
s_add_u32 m0, s53, 0
ds_read_b128 v[152:155], v1 offset:36864
v_mul_f32 v221, v221, v45
v_mfma_f32_16x16x32_bf16 v[100:103], v[164:167], a[60:63], v[100:103]
s_add_u32 s52, s29, s53
s_add_u32 s70, s70, s74
s_addc_u32 s71, s75, 0
v_mfma_f32_16x16x32_bf16 v[92:95], v[164:167], a[56:59], v[92:95]
s_waitcnt lgkmcnt(3)
ds_read_b128 v[156:159], v1 offset:37888
s_add_u32 s52, s52, 225280
v_mfma_f32_16x16x32_bf16 v[72:75], v[136:139], a[64:67], v[72:75]
buffer_load_dwordx4 v1, s[4:7], s52 offen offset:0 sc1 lds
v_mfma_f32_16x16x32_bf16 v[80:83], v[136:139], a[68:71], v[80:83]
ds_read_b128 v[160:163], v1 offset:38912
v_fma_f32 v46, v206, v242, v46
v_mfma_f32_16x16x32_bf16 v[84:87], v[140:143], a[68:71], v[84:87]
s_mov_b64 exec, 1
Lc39:
global_load_dword v250, v0, s[70:71]
s_mov_b64 exec, -1
v_mfma_f32_16x16x32_bf16 v[76:79], v[140:143], a[64:67], v[76:79]
s_waitcnt lgkmcnt(3)
ds_read_b128 v[164:167], v1 offset:39936
v_fma_f32 v47, v207, v242, v47
v_mfma_f32_16x16x32_bf16 v[88:91], v[144:147], a[64:67], v[88:91]
v_rcp_f32 v216, v216
v_mfma_f32_16x16x32_bf16 v[96:99], v[144:147], a[68:71], v[96:99]
ds_read_b128 v[136:139], v1 offset:40960
v_fma_f32 v217, v217, v241, v241
v_mfma_f32_16x16x32_bf16 v[100:103], v[148:151], a[68:71], v[100:103]
buffer_load_dwordx4 v1, s[4:7], s52 offen offset:1024 sc1 lds
v_mfma_f32_16x16x32_bf16 v[92:95], v[148:151], a[64:67], v[92:95]
s_waitcnt lgkmcnt(3)
ds_read_b128 v[140:143], v1 offset:41984
v_mul_f32 v69, v69, v53
v_mfma_f32_16x16x32_bf16 v[72:75], v[152:155], a[72:75], v[72:75]
v_rcp_f32 v217, v217
v_mfma_f32_16x16x32_bf16 v[80:83], v[152:155], a[76:79], v[80:83]
ds_read_b128 v[144:147], v1 offset:43008
v_mul_f32 v68, v68, v216
v_mfma_f32_16x16x32_bf16 v[84:87], v[156:159], a[76:79], v[84:87]
v_mul_f32 v69, v69, v217
v_mul_f32 v222, v46, v46
v_mfma_f32_16x16x32_bf16 v[76:79], v[156:159], a[72:75], v[76:79]
s_waitcnt lgkmcnt(3)
ds_read_b128 v[148:151], v1 offset:44032
v_cvt_pk_bf16_f32 v234, v68, v69
v_mfma_f32_16x16x32_bf16 v[88:91], v[160:163], a[72:75], v[88:91]
buffer_load_dwordx4 v1, s[4:7], s52 offen offset:2048 sc1 lds
v_mfma_f32_16x16x32_bf16 v[96:99], v[160:163], a[76:79], v[96:99]
ds_read_b128 v[152:155], v1 offset:45056
v_mul_f32 v223, v47, v47
v_mfma_f32_16x16x32_bf16 v[100:103], v[164:167], a[76:79], v[100:103]
v_exp_f32 v218, v218
v_mfma_f32_16x16x32_bf16 v[92:95], v[164:167], a[72:75], v[92:95]
s_waitcnt lgkmcnt(3)
ds_read_b128 v[156:159], v1 offset:46080
v_fma_f32 v58, v210, v242, v58
v_mfma_f32_16x16x32_bf16 v[72:75], v[136:139], a[80:83], v[72:75]
v_fma_f32 v59, v211, v242, v59
v_fma_f32 v222, v222, v238, v236
v_mfma_f32_16x16x32_bf16 v[80:83], v[136:139], a[84:87], v[80:83]
ds_read_b128 v[160:163], v1 offset:47104
v_mul_f32 v58, v58, v42
v_mfma_f32_16x16x32_bf16 v[84:87], v[140:143], a[84:87], v[84:87]
buffer_load_dwordx4 v1, s[4:7], s52 offen offset:3072 sc1 lds
v_mfma_f32_16x16x32_bf16 v[76:79], v[140:143], a[80:83], v[76:79]
s_waitcnt lgkmcnt(3)
ds_read_b128 v[164:167], v1 offset:48128
v_fma_f32 v223, v223, v238, v236
v_mfma_f32_16x16x32_bf16 v[88:91], v[144:147], a[80:83], v[88:91]
s_add_u32 m0, m0, 4096
v_exp_f32 v219, v219
v_mfma_f32_16x16x32_bf16 v[96:99], v[144:147], a[84:87], v[96:99]
s_add_u32 s52, s52, 4096
ds_read_b128 v[136:139], v1 offset:49152
v_fma_f32 v218, v218, v240, v240
v_mfma_f32_16x16x32_bf16 v[100:103], v[148:151], a[84:87], v[100:103]
v_rcp_f32 v218, v218
v_mfma_f32_16x16x32_bf16 v[92:95], v[148:151], a[80:83], v[92:95]
s_waitcnt lgkmcnt(3)
ds_read_b128 v[140:143], v1 offset:50176
v_fma_f32 v219, v219, v240, v240
v_mfma_f32_16x16x32_bf16 v[72:75], v[152:155], a[88:91], v[72:75]
buffer_load_dwordx4 v1, s[4:7], s52 offen offset:0 sc1 lds
v_mfma_f32_16x16x32_bf16 v[80:83], v[152:155], a[92:95], v[80:83]
ds_read_b128 v[144:147], v1 offset:51200
v_mul_f32 v59, v59, v43
v_mfma_f32_16x16x32_bf16 v[84:87], v[156:159], a[92:95], v[84:87]
s_add_u32 s54, s31, 5120
v_rcp_f32 v219, v219
v_mfma_f32_16x16x32_bf16 v[76:79], v[156:159], a[88:91], v[76:79]
s_waitcnt lgkmcnt(3)
ds_read_b128 v[148:151], v1 offset:52224
v_mul_f32 v58, v58, v218
v_mfma_f32_16x16x32_bf16 v[88:91], v[160:163], a[88:91], v[88:91]
v_mul_f32 v59, v59, v219
v_mul_f32 v222, v222, v46
v_mfma_f32_16x16x32_bf16 v[96:99], v[160:163], a[92:95], v[96:99]
ds_read_b128 v[152:155], v1 offset:53248
v_cvt_pk_bf16_f32 v229, v58, v59
v_mfma_f32_16x16x32_bf16 v[100:103], v[164:167], a[92:95], v[100:103]
buffer_load_dwordx4 a[240:243], v1, s[4:7], s54 offen offset:0 sc1
v_mfma_f32_16x16x32_bf16 v[92:95], v[164:167], a[88:91], v[92:95]
s_waitcnt lgkmcnt(3)
ds_read_b128 v[156:159], v1 offset:54272
v_fma_f32 v54, v206, v243, v54
v_mfma_f32_16x16x32_bf16 v[72:75], v[136:139], a[96:99], v[72:75]
v_fma_f32 v55, v207, v243, v55
v_mul_f32 v223, v223, v47
v_mfma_f32_16x16x32_bf16 v[80:83], v[136:139], a[100:103], v[80:83]
ds_read_b128 v[160:163], v1 offset:55296
v_mul_f32 v218, v54, v54
v_mfma_f32_16x16x32_bf16 v[84:87], v[140:143], a[100:103], v[84:87]
v_mul_f32 v219, v55, v55
v_fma_f32 v48, v200, v243, v48
v_mfma_f32_16x16x32_bf16 v[76:79], v[140:143], a[96:99], v[76:79]
s_waitcnt lgkmcnt(3)
ds_read_b128 v[164:167], v1 offset:56320
v_fma_f32 v218, v218, v239, v237
v_mfma_f32_16x16x32_bf16 v[88:91], v[144:147], a[96:99], v[88:91]
buffer_load_dwordx4 a[244:247], v1, s[4:7], s54 offen offset:1024 sc1
v_mfma_f32_16x16x32_bf16 v[96:99], v[144:147], a[100:103], v[96:99]
ds_read_b128 v[136:139], v1 offset:57344
v_fma_f32 v219, v219, v239, v237
v_mfma_f32_16x16x32_bf16 v[100:103], v[148:151], a[100:103], v[100:103]
v_mul_f32 v218, v218, v54
v_fma_f32 v49, v201, v243, v49
v_mfma_f32_16x16x32_bf16 v[92:95], v[148:151], a[96:99], v[92:95]
s_waitcnt lgkmcnt(3)
ds_read_b128 v[140:143], v1 offset:58368
v_mul_f32 v219, v219, v55
v_mfma_f32_16x16x32_bf16 v[72:75], v[152:155], a[104:107], v[72:75]
s_waitcnt vmcnt(18)
s_barrier
v_mfma_f32_16x16x32_bf16 v[80:83], v[152:155], a[108:111], v[80:83]
ds_read_b128 v[144:147], v1 offset:59392
v_mul_f32 v224, v48, v48
v_mfma_f32_16x16x32_bf16 v[84:87], v[156:159], a[108:111], v[84:87]
buffer_load_dwordx4 a[248:251], v1, s[4:7], s54 offen offset:2048 sc1
v_mfma_f32_16x16x32_bf16 v[76:79], v[156:159], a[104:107], v[76:79]
s_waitcnt lgkmcnt(3)
ds_read_b128 v[148:151], v1 offset:60416
v_mul_f32 v225, v49, v49
v_mfma_f32_16x16x32_bf16 v[88:91], v[160:163], a[104:107], v[88:91]
v_exp_f32 v218, v218
v_mfma_f32_16x16x32_bf16 v[96:99], v[160:163], a[108:111], v[96:99]
ds_read_b128 v[152:155], v2 offset:12288
v_fma_f32 v70, v214, v243, v70
v_mfma_f32_16x16x32_bf16 v[100:103], v[164:167], a[108:111], v[100:103]
v_fma_f32 v71, v215, v243, v71
v_fma_f32 v224, v224, v239, v237
v_mfma_f32_16x16x32_bf16 v[92:95], v[164:167], a[104:107], v[92:95]
s_waitcnt lgkmcnt(3)
ds_read_b128 v[156:159], v2 offset:13312
v_mul_f32 v70, v70, v54
v_mfma_f32_16x16x32_bf16 v[72:75], v[136:139], a[112:115], v[72:75]
buffer_load_dwordx4 a[252:255], v1, s[4:7], s54 offen offset:3072 sc1
v_mfma_f32_16x16x32_bf16 v[80:83], v[136:139], a[116:119], v[80:83]
ds_read_b128 v[160:163], v2 offset:14336
v_fma_f32 v225, v225, v239, v237
v_mfma_f32_16x16x32_bf16 v[84:87], v[140:143], a[116:119], v[84:87]
s_add_u32 s54, s31, 9216
v_exp_f32 v219, v219
v_mfma_f32_16x16x32_bf16 v[76:79], v[140:143], a[112:115], v[76:79]
s_waitcnt lgkmcnt(3)
ds_read_b128 v[164:167], v2 offset:15360
v_fma_f32 v218, v218, v241, v241
v_mfma_f32_16x16x32_bf16 v[88:91], v[144:147], a[112:115], v[88:91]
v_rcp_f32 v218, v218
v_mfma_f32_16x16x32_bf16 v[96:99], v[144:147], a[116:119], v[96:99]
ds_read_b128 v[136:139], v2 offset:16384
v_fma_f32 v219, v219, v241, v241
v_exp_f32 v220, v220
v_fma_f32 v60, v212, v242, v60
v_mfma_f32_16x16x32_bf16 v[100:103], v[148:151], a[116:119], v[100:103]
buffer_load_dwordx4 v[168:171], v1, s[4:7], s54 offen offset:0 sc1
v_mfma_f32_16x16x32_bf16 v[92:95], v[148:151], a[112:115], v[92:95]
s_waitcnt lgkmcnt(3)
ds_read_b128 v[140:143], v2 offset:17408
v_mul_f32 v71, v71, v55
v_fma_f32 v61, v213, v242, v61
v_mul_f32 v60, v60, v44
v_mfma_f32_16x16x32_bf16 v[72:75], v[152:155], a[120:123], v[72:75]
s_add_u32 s54, s31, 20480
v_rcp_f32 v219, v219
v_mfma_f32_16x16x32_bf16 v[80:83], v[152:155], a[124:127], v[80:83]
ds_read_b128 v[144:147], v2 offset:18432
v_mul_f32 v70, v70, v218
v_exp_f32 v221, v221
v_exp_f32 v222, v222
v_fma_f32 v50, v202, v243, v50
v_fma_f32 v220, v220, v240, v240
v_fma_f32 v62, v214, v242, v62
v_fma_f32 v51, v203, v243, v51
v_mfma_f32_16x16x32_bf16 v[84:87], v[156:159], a[124:127], v[84:87]
v_mul_f32 v71, v71, v219
v_fma_f32 v63, v215, v242, v63
v_mfma_f32_16x16x32_bf16 v[76:79], v[156:159], a[120:123], v[76:79]
s_waitcnt lgkmcnt(3)
ds_read_b128 v[148:151], v2 offset:19456
v_cvt_pk_bf16_f32 v235, v70, v71
v_rcp_f32 v220, v220
v_mul_f32 v62, v62, v46
v_mul_f32 v224, v224, v48
v_mul_f32 v226, v50, v50
v_fma_f32 v221, v221, v240, v240
v_mul_f32 v225, v225, v49
v_mul_f32 v227, v51, v51
v_mfma_f32_16x16x32_bf16 v[88:91], v[160:163], a[120:123], v[88:91]
buffer_load_dwordx4 v[172:175], v1, s[4:7], s54 offen offset:0 sc1
v_mfma_f32_16x16x32_bf16 v[96:99], v[160:163], a[124:127], v[96:99]
ds_read_b128 v[152:155], v2 offset:20480
v_mul_f32 v61, v61, v45
v_exp_f32 v223, v223
v_exp_f32 v224, v224
v_fma_f32 v226, v226, v239, v237
v_rcp_f32 v221, v221
v_fma_f32 v222, v222, v240, v240
v_fma_f32 v64, v208, v243, v64
v_fma_f32 v227, v227, v239, v237
v_mfma_f32_16x16x32_bf16 v[100:103], v[164:167], a[124:127], v[100:103]
v_mul_f32 v60, v60, v220
v_fma_f32 v65, v209, v243, v65
v_mfma_f32_16x16x32_bf16 v[92:95], v[164:167], a[120:123], v[92:95]
s_waitcnt lgkmcnt(3)
ds_read_b128 v[156:159], v2 offset:21504
v_mul_f32 v61, v61, v221
v_rcp_f32 v222, v222
v_mul_f32 v64, v64, v48
v_mul_f32 v226, v226, v50
v_fma_f32 v223, v223, v240, v240
v_mul_f32 v227, v227, v51
v_mfma_f32_16x16x32_bf16 v[72:75], v[136:139], a[128:131], v[72:75]
v_cvt_pk_bf16_f32 v230, v60, v61
v_mul_f32 v63, v63, v47
v_mfma_f32_16x16x32_bf16 v[80:83], v[136:139], a[132:135], v[80:83]
ds_read_b128 v[160:163], v2 offset:22528
v_rcp_f32 v223, v223
v_exp_f32 v225, v225
v_exp_f32 v226, v226
v_fma_f32 v224, v224, v241, v241
v_fma_f32 v66, v210, v243, v66
v_mfma_f32_16x16x32_bf16 v[84:87], v[140:143], a[132:135], v[84:87]
buffer_load_dwordx4 v[176:179], v1, s[4:7], s54 offen offset:1024 sc1
v_mfma_f32_16x16x32_bf16 v[76:79], v[140:143], a[128:131], v[76:79]
s_waitcnt lgkmcnt(3)
ds_read_b128 v[164:167], v2 offset:23552
v_mul_f32 v62, v62, v222
v_rcp_f32 v224, v224
v_fma_f32 v67, v211, v243, v67
v_mul_f32 v63, v63, v223
v_fma_f32 v225, v225, v241, v241
v_mul_f32 v66, v66, v50
v_mfma_f32_16x16x32_bf16 v[88:91], v[144:147], a[128:131], v[88:91]
v_cvt_pk_bf16_f32 v231, v62, v63
v_mul_f32 v65, v65, v49
v_mfma_f32_16x16x32_bf16 v[96:99], v[144:147], a[132:135], v[96:99]
ds_read_b128 v[136:139], v2 offset:24576
v_rcp_f32 v225, v225
v_exp_f32 v227, v227
v_fma_f32 v226, v226, v241, v241
v_mfma_f32_16x16x32_bf16 v[100:103], v[148:151], a[132:135], v[100:103]
buffer_store_dwordx4 v[228:231], v4, s[4:7], s40 offen offset:0 sc1
v_mfma_f32_16x16x32_bf16 v[92:95], v[148:151], a[128:131], v[92:95]
s_waitcnt lgkmcnt(3)
ds_read_b128 v[140:143], v2 offset:25600
v_mul_f32 v64, v64, v224
v_rcp_f32 v226, v226
v_mul_f32 v65, v65, v225
v_fma_f32 v227, v227, v241, v241
v_mfma_f32_16x16x32_bf16 v[72:75], v[152:155], a[136:139], v[72:75]
buffer_load_dwordx4 v[180:183], v1, s[4:7], s54 offen offset:2048 sc1
v_mfma_f32_16x16x32_bf16 v[80:83], v[152:155], a[140:143], v[80:83]
ds_read_b128 v[144:147], v2 offset:26624
v_cvt_pk_bf16_f32 v232, v64, v65
v_mul_f32 v67, v67, v51
v_rcp_f32 v227, v227
v_mfma_f32_16x16x32_bf16 v[84:87], v[156:159], a[140:143], v[84:87]
v_mul_f32 v66, v66, v226
v_mul_f32 v67, v67, v227
v_mfma_f32_16x16x32_bf16 v[76:79], v[156:159], a[136:139], v[76:79]
s_waitcnt lgkmcnt(3)
ds_read_b128 v[148:151], v2 offset:27648
v_cvt_pk_bf16_f32 v233, v66, v67
v_mfma_f32_16x16x32_bf16 v[88:91], v[160:163], a[136:139], v[88:91]
buffer_store_dwordx4 v[232:235], v4, s[4:7], s40 offen offset:256 sc1
v_mfma_f32_16x16x32_bf16 v[96:99], v[160:163], a[140:143], v[96:99]
ds_read_b128 v[152:155], v2 offset:28672
v_mfma_f32_16x16x32_bf16 v[100:103], v[164:167], a[140:143], v[100:103]
buffer_load_dwordx4 v[184:187], v1, s[4:7], s54 offen offset:3072 sc1
v_mfma_f32_16x16x32_bf16 v[92:95], v[164:167], a[136:139], v[92:95]
s_waitcnt lgkmcnt(3)
ds_read_b128 v[156:159], v2 offset:29696
v_mfma_f32_16x16x32_bf16 v[72:75], v[136:139], a[144:147], v[72:75]
s_add_u32 s54, s31, 24576
v_and_b32 v251, 0xffffff00, v0
v_add_u32 v251, v251, v0
v_mfma_f32_16x16x32_bf16 v[80:83], v[136:139], a[148:151], v[80:83]
ds_read_b128 v[160:163], v2 offset:30720
v_mfma_f32_16x16x32_bf16 v[84:87], v[140:143], a[148:151], v[84:87]
s_mov_b64 exec, 0xfffff
buffer_load_dword v250, v251, s[12:15], s34 offen sc1
s_mov_b64 exec, 1
buffer_load_dword v250, v12, s[4:7], s35 offen sc1
s_mov_b64 exec, -1
v_mfma_f32_16x16x32_bf16 v[76:79], v[140:143], a[144:147], v[76:79]
s_waitcnt lgkmcnt(3)
ds_read_b128 v[164:167], v2 offset:31744
v_mfma_f32_16x16x32_bf16 v[88:91], v[144:147], a[144:147], v[88:91]
buffer_load_dwordx4 v[188:191], v1, s[4:7], s54 offen offset:0 sc1
v_mfma_f32_16x16x32_bf16 v[96:99], v[144:147], a[148:151], v[96:99]
ds_read_b128 v[136:139], v2 offset:32768
v_mfma_f32_16x16x32_bf16 v[100:103], v[148:151], a[148:151], v[100:103]
s_add_u32 s54, s31, 35840
v_mfma_f32_16x16x32_bf16 v[92:95], v[148:151], a[144:147], v[92:95]
s_waitcnt lgkmcnt(3)
ds_read_b128 v[140:143], v2 offset:33792
v_mfma_f32_16x16x32_bf16 v[72:75], v[152:155], a[152:155], v[72:75]
v_mfma_f32_16x16x32_bf16 v[80:83], v[152:155], a[156:159], v[80:83]
ds_read_b128 v[144:147], v2 offset:34816
v_mfma_f32_16x16x32_bf16 v[84:87], v[156:159], a[156:159], v[84:87]
buffer_load_dwordx4 v[192:195], v1, s[4:7], s54 offen offset:0 sc1
v_mfma_f32_16x16x32_bf16 v[76:79], v[156:159], a[152:155], v[76:79]
s_waitcnt lgkmcnt(3)
ds_read_b128 v[148:151], v2 offset:35840
v_mfma_f32_16x16x32_bf16 v[88:91], v[160:163], a[152:155], v[88:91]
v_mfma_f32_16x16x32_bf16 v[96:99], v[160:163], a[156:159], v[96:99]
ds_read_b128 v[152:155], v2 offset:36864
v_mfma_f32_16x16x32_bf16 v[100:103], v[164:167], a[156:159], v[100:103]
v_mfma_f32_16x16x32_bf16 v[92:95], v[164:167], a[152:155], v[92:95]
s_waitcnt lgkmcnt(3)
ds_read_b128 v[156:159], v2 offset:37888
v_mfma_f32_16x16x32_bf16 v[104:107], v[136:139], a[0:3], v[104:107]
buffer_load_dwordx4 v[196:199], v1, s[4:7], s54 offen offset:1024 sc1
v_mfma_f32_16x16x32_bf16 v[112:115], v[136:139], a[4:7], v[112:115]
ds_read_b128 v[160:163], v2 offset:38912
v_mfma_f32_16x16x32_bf16 v[116:119], v[140:143], a[4:7], v[116:119]
s_mul_i32 s53, s18, 3072
s_add_u32 m0, s53, 20480
s_add_u32 s52, s28, s53
v_mfma_f32_16x16x32_bf16 v[108:111], v[140:143], a[0:3], v[108:111]
s_waitcnt lgkmcnt(3)
ds_read_b128 v[164:167], v2 offset:39936
s_add_u32 s52, s52, 14336
v_mfma_f32_16x16x32_bf16 v[120:123], v[144:147], a[0:3], v[120:123]
s_add_u32 s61, s31, 37888
v_mfma_f32_16x16x32_bf16 v[128:131], v[144:147], a[4:7], v[128:131]
ds_read_b128 v[136:139], v2 offset:40960
v_mfma_f32_16x16x32_bf16 v[132:135], v[148:151], a[4:7], v[132:135]
buffer_load_dwordx4 v1, s[4:7], s52 offen offset:0 sc1 lds
v_mfma_f32_16x16x32_bf16 v[124:127], v[148:151], a[0:3], v[124:127]
s_waitcnt lgkmcnt(3)
ds_read_b128 v[140:143], v2 offset:41984
v_mfma_f32_16x16x32_bf16 v[104:107], v[152:155], a[8:11], v[104:107]
buffer_load_dwordx4 a[0:3], v1, s[4:7], s61 offen offset:0 sc1
v_mfma_f32_16x16x32_bf16 v[112:115], v[152:155], a[12:15], v[112:115]
ds_read_b128 v[144:147], v2 offset:43008
v_mul_f32 v216, v72, v72
v_mfma_f32_16x16x32_bf16 v[116:119], v[156:159], a[12:15], v[116:119]
v_mul_f32 v217, v73, v73
v_mul_f32 v218, v74, v74
v_mfma_f32_16x16x32_bf16 v[108:111], v[156:159], a[8:11], v[108:111]
s_waitcnt lgkmcnt(3)
ds_read_b128 v[148:151], v2 offset:44032
v_fma_f32 v216, v216, v238, v236
v_mfma_f32_16x16x32_bf16 v[120:123], v[160:163], a[8:11], v[120:123]
buffer_load_dwordx4 v1, s[4:7], s52 offen offset:1024 sc1 lds
v_mfma_f32_16x16x32_bf16 v[128:131], v[160:163], a[12:15], v[128:131]
ds_read_b128 v[152:155], v2 offset:45056
v_fma_f32 v217, v217, v238, v236
v_mfma_f32_16x16x32_bf16 v[132:135], v[164:167], a[12:15], v[132:135]
buffer_load_dwordx4 a[4:7], v1, s[4:7], s61 offen offset:1024 sc1
v_mfma_f32_16x16x32_bf16 v[124:127], v[164:167], a[8:11], v[124:127]
s_waitcnt lgkmcnt(3)
ds_read_b128 v[156:159], v2 offset:46080
v_mul_f32 v216, v216, v72
v_mfma_f32_16x16x32_bf16 v[104:107], v[136:139], a[16:19], v[104:107]
v_mul_f32 v217, v217, v73
v_mul_f32 v219, v75, v75
v_mfma_f32_16x16x32_bf16 v[112:115], v[136:139], a[20:23], v[112:115]
ds_read_b128 v[160:163], v2 offset:47104
v_fma_f32 v218, v218, v238, v236
v_mfma_f32_16x16x32_bf16 v[116:119], v[140:143], a[20:23], v[116:119]
buffer_load_dwordx4 v1, s[4:7], s52 offen offset:2048 sc1 lds
v_mfma_f32_16x16x32_bf16 v[108:111], v[140:143], a[16:19], v[108:111]
s_waitcnt lgkmcnt(3)
ds_read_b128 v[164:167], v2 offset:48128
v_fma_f32 v219, v219, v238, v236
v_mfma_f32_16x16x32_bf16 v[120:123], v[144:147], a[16:19], v[120:123]
buffer_load_dwordx4 a[8:11], v1, s[4:7], s61 offen offset:2048 sc1
v_mfma_f32_16x16x32_bf16 v[128:131], v[144:147], a[20:23], v[128:131]
s_add_u32 s61, s31, 51200
ds_read_b128 v[136:139], v2 offset:49152
v_mul_f32 v218, v218, v74
v_mfma_f32_16x16x32_bf16 v[132:135], v[148:151], a[20:23], v[132:135]
v_exp_f32 v216, v216
v_mfma_f32_16x16x32_bf16 v[124:127], v[148:151], a[16:19], v[124:127]
s_waitcnt lgkmcnt(3)
ds_read_b128 v[140:143], v2 offset:50176
v_mul_f32 v88, v88, v72
v_mfma_f32_16x16x32_bf16 v[104:107], v[152:155], a[24:27], v[104:107]
s_waitcnt vmcnt(28)
s_barrier
v_mfma_f32_16x16x32_bf16 v[112:115], v[152:155], a[28:31], v[112:115]
ds_read_b128 v[144:147], v2 offset:51200
v_mul_f32 v219, v219, v75
v_mfma_f32_16x16x32_bf16 v[116:119], v[156:159], a[28:31], v[116:119]
buffer_load_dwordx4 a[12:15], v1, s[4:7], s61 offen offset:0 sc1
v_mfma_f32_16x16x32_bf16 v[108:111], v[156:159], a[24:27], v[108:111]
s_waitcnt lgkmcnt(3)
ds_read_b128 v[148:151], v2 offset:52224
v_mul_f32 v220, v76, v76
v_mfma_f32_16x16x32_bf16 v[120:123], v[160:163], a[24:27], v[120:123]
v_exp_f32 v217, v217
v_mfma_f32_16x16x32_bf16 v[128:131], v[160:163], a[28:31], v[128:131]
ds_read_b128 v[152:155], v2 offset:53248
v_fma_f32 v216, v216, v240, v240
v_mfma_f32_16x16x32_bf16 v[132:135], v[164:167], a[28:31], v[132:135]
buffer_load_dwordx4 a[16:19], v1, s[4:7], s61 offen offset:1024 sc1
v_mfma_f32_16x16x32_bf16 v[124:127], v[164:167], a[24:27], v[124:127]
s_waitcnt lgkmcnt(3)
ds_read_b128 v[156:159], v2 offset:54272
v_mul_f32 v221, v77, v77
v_mfma_f32_16x16x32_bf16 v[104:107], v[136:139], a[32:35], v[104:107]
v_rcp_f32 v216, v216
v_mfma_f32_16x16x32_bf16 v[112:115], v[136:139], a[36:39], v[112:115]
ds_read_b128 v[160:163], v2 offset:55296
v_fma_f32 v217, v217, v240, v240
v_mfma_f32_16x16x32_bf16 v[116:119], v[140:143], a[36:39], v[116:119]
buffer_load_dwordx4 a[20:23], v1, s[4:7], s61 offen offset:2048 sc1
v_mfma_f32_16x16x32_bf16 v[108:111], v[140:143], a[32:35], v[108:111]
s_waitcnt lgkmcnt(3)
ds_read_b128 v[164:167], v2 offset:56320
v_mul_f32 v89, v89, v73
v_mfma_f32_16x16x32_bf16 v[120:123], v[144:147], a[32:35], v[120:123]
v_rcp_f32 v217, v217
v_mfma_f32_16x16x32_bf16 v[128:131], v[144:147], a[36:39], v[128:131]
ds_read_b128 v[136:139], v2 offset:57344
v_mul_f32 v88, v88, v216
v_mfma_f32_16x16x32_bf16 v[132:135], v[148:151], a[36:39], v[132:135]
buffer_load_dwordx4 a[24:27], v1, s[4:7], s61 offen offset:3072 sc1
v_mfma_f32_16x16x32_bf16 v[124:127], v[148:151], a[32:35], v[124:127]
s_waitcnt lgkmcnt(3)
ds_read_b128 v[140:143], v2 offset:58368
s_add_u32 s61, s31, 55296
v_mfma_f32_16x16x32_bf16 v[104:107], v[152:155], a[40:43], v[104:107]
v_mul_f32 v89, v89, v217
v_fma_f32 v220, v220, v238, v236
v_mfma_f32_16x16x32_bf16 v[112:115], v[152:155], a[44:47], v[112:115]
ds_read_b128 v[144:147], v2 offset:59392
v_cvt_pk_bf16_f32 v200, v88, v89
v_mfma_f32_16x16x32_bf16 v[116:119], v[156:159], a[44:47], v[116:119]
v_mul_f32 v216, v84, v84
v_fma_f32 v221, v221, v238, v236
v_mfma_f32_16x16x32_bf16 v[108:111], v[156:159], a[40:43], v[108:111]
s_waitcnt lgkmcnt(3)
ds_read_b128 v[148:151], v2 offset:60416
v_mul_f32 v217, v85, v85
v_mfma_f32_16x16x32_bf16 v[120:123], v[160:163], a[40:43], v[120:123]
buffer_load_dwordx4 a[28:31], v1, s[4:7], s61 offen offset:0 sc1
v_mfma_f32_16x16x32_bf16 v[128:131], v[160:163], a[44:47], v[128:131]
s_add_u32 s61, s31, 10240
ds_read_b128 v[152:155], v2 offset:61440
v_fma_f32 v216, v216, v239, v237
v_mfma_f32_16x16x32_bf16 v[132:135], v[164:167], a[44:47], v[132:135]
v_fma_f32 v217, v217, v239, v237
v_mul_f32 v220, v220, v76
v_mfma_f32_16x16x32_bf16 v[124:127], v[164:167], a[40:43], v[124:127]
s_waitcnt lgkmcnt(3)
ds_read_b128 v[156:159], v2 offset:62464
v_mul_f32 v216, v216, v84
v_mfma_f32_16x16x32_bf16 v[104:107], v[136:139], a[48:51], v[104:107]
buffer_load_dwordx4 a[32:35], v1, s[4:7], s61 offen offset:0 sc1
v_mfma_f32_16x16x32_bf16 v[112:115], v[136:139], a[52:55], v[112:115]
ds_read_b128 v[160:163], v2 offset:63488
v_mul_f32 v217, v217, v85
v_mfma_f32_16x16x32_bf16 v[116:119], v[140:143], a[52:55], v[116:119]
v_exp_f32 v216, v216
v_mfma_f32_16x16x32_bf16 v[108:111], v[140:143], a[48:51], v[108:111]
s_waitcnt lgkmcnt(3)
ds_read_b128 v[164:167], v2 offset:64512
v_mul_f32 v100, v100, v84
v_mfma_f32_16x16x32_bf16 v[120:123], v[144:147], a[48:51], v[120:123]
v_exp_f32 v217, v217
v_mfma_f32_16x16x32_bf16 v[128:131], v[144:147], a[52:55], v[128:131]
ds_read_b128 v[136:139], v3 offset:0
v_fma_f32 v216, v216, v241, v241
v_mfma_f32_16x16x32_bf16 v[132:135], v[148:151], a[52:55], v[132:135]
buffer_load_dwordx4 a[36:39], v1, s[4:7], s61 offen offset:1024 sc1
v_mfma_f32_16x16x32_bf16 v[124:127], v[148:151], a[48:51], v[124:127]
s_waitcnt lgkmcnt(3)
ds_read_b128 v[140:143], v3 offset:1024
v_mul_f32 v221, v221, v77
v_mfma_f32_16x16x32_bf16 v[104:107], v[152:155], a[56:59], v[104:107]
v_rcp_f32 v216, v216
v_mfma_f32_16x16x32_bf16 v[112:115], v[152:155], a[60:63], v[112:115]
ds_read_b128 v[144:147], v3 offset:2048
v_fma_f32 v217, v217, v241, v241
v_mfma_f32_16x16x32_bf16 v[116:119], v[156:159], a[60:63], v[116:119]
buffer_load_dwordx4 a[40:43], v1, s[4:7], s61 offen offset:2048 sc1
v_mfma_f32_16x16x32_bf16 v[108:111], v[156:159], a[56:59], v[108:111]
s_waitcnt lgkmcnt(3)
ds_read_b128 v[148:151], v3 offset:3072
v_mul_f32 v101, v101, v85
v_mfma_f32_16x16x32_bf16 v[120:123], v[160:163], a[56:59], v[120:123]
v_rcp_f32 v217, v217
v_mfma_f32_16x16x32_bf16 v[128:131], v[160:163], a[60:63], v[128:131]
ds_read_b128 v[152:155], v3 offset:4096
v_mul_f32 v100, v100, v216
v_mfma_f32_16x16x32_bf16 v[132:135], v[164:167], a[60:63], v[132:135]
v_mul_f32 v101, v101, v217
v_mul_f32 v222, v78, v78
v_mfma_f32_16x16x32_bf16 v[124:127], v[164:167], a[56:59], v[124:127]
s_waitcnt lgkmcnt(3)
ds_read_b128 v[156:159], v3 offset:5120
v_cvt_pk_bf16_f32 v206, v100, v101
v_mfma_f32_16x16x32_bf16 v[104:107], v[136:139], a[64:67], v[104:107]
buffer_load_dwordx4 a[44:47], v1, s[4:7], s61 offen offset:3072 sc1
v_mfma_f32_16x16x32_bf16 v[112:115], v[136:139], a[68:71], v[112:115]
s_add_u32 s61, s31, 14336
ds_read_b128 v[160:163], v3 offset:6144
v_mul_f32 v223, v79, v79
v_mfma_f32_16x16x32_bf16 v[116:119], v[140:143], a[68:71], v[116:119]
v_exp_f32 v218, v218
v_mfma_f32_16x16x32_bf16 v[108:111], v[140:143], a[64:67], v[108:111]
s_waitcnt lgkmcnt(3)
ds_read_b128 v[164:167], v3 offset:7168
v_mul_f32 v90, v90, v74
v_mfma_f32_16x16x32_bf16 v[120:123], v[144:147], a[64:67], v[120:123]
buffer_load_dwordx4 a[48:51], v1, s[4:7], s61 offen offset:0 sc1
v_mfma_f32_16x16x32_bf16 v[128:131], v[144:147], a[68:71], v[128:131]
s_add_u32 s61, s31, 25600
ds_read_b128 v[136:139], v3 offset:8192
v_fma_f32 v222, v222, v238, v236
v_mfma_f32_16x16x32_bf16 v[132:135], v[148:151], a[68:71], v[132:135]
v_exp_f32 v219, v219
v_mfma_f32_16x16x32_bf16 v[124:127], v[148:151], a[64:67], v[124:127]
s_waitcnt lgkmcnt(3)
ds_read_b128 v[140:143], v3 offset:9216
v_fma_f32 v218, v218, v240, v240
v_mfma_f32_16x16x32_bf16 v[104:107], v[152:155], a[72:75], v[104:107]
v_rcp_f32 v218, v218
v_mfma_f32_16x16x32_bf16 v[112:115], v[152:155], a[76:79], v[112:115]
ds_read_b128 v[144:147], v3 offset:10240
v_fma_f32 v219, v219, v240, v240
v_mfma_f32_16x16x32_bf16 v[116:119], v[156:159], a[76:79], v[116:119]
buffer_load_dwordx4 a[52:55], v1, s[4:7], s61 offen offset:0 sc1
v_mfma_f32_16x16x32_bf16 v[108:111], v[156:159], a[72:75], v[108:111]
s_waitcnt lgkmcnt(3)
ds_read_b128 v[148:151], v3 offset:11264
v_mul_f32 v91, v91, v75
v_mfma_f32_16x16x32_bf16 v[120:123], v[160:163], a[72:75], v[120:123]
v_rcp_f32 v219, v219
v_mfma_f32_16x16x32_bf16 v[128:131], v[160:163], a[76:79], v[128:131]
ds_read_b128 v[152:155], v3 offset:12288
v_mul_f32 v90, v90, v218
v_mfma_f32_16x16x32_bf16 v[132:135], v[164:167], a[76:79], v[132:135]
buffer_load_dwordx4 a[56:59], v1, s[4:7], s61 offen offset:1024 sc1
v_mfma_f32_16x16x32_bf16 v[124:127], v[164:167], a[72:75], v[124:127]
s_waitcnt lgkmcnt(3)
ds_read_b128 v[156:159], v3 offset:13312
v_mul_f32 v91, v91, v219
v_mfma_f32_16x16x32_bf16 v[104:107], v[136:139], a[80:83], v[104:107]
v_cvt_pk_bf16_f32 v201, v90, v91
v_fma_f32 v223, v223, v238, v236
v_mfma_f32_16x16x32_bf16 v[112:115], v[136:139], a[84:87], v[112:115]
ds_read_b128 v[160:163], v3 offset:14336
v_mul_f32 v218, v86, v86
v_mfma_f32_16x16x32_bf16 v[116:119], v[140:143], a[84:87], v[116:119]
v_mul_f32 v219, v87, v87
v_mul_f32 v222, v222, v78
v_mfma_f32_16x16x32_bf16 v[108:111], v[140:143], a[80:83], v[108:111]
s_waitcnt lgkmcnt(3)
ds_read_b128 v[164:167], v3 offset:15360
v_fma_f32 v218, v218, v239, v237
v_mfma_f32_16x16x32_bf16 v[120:123], v[144:147], a[80:83], v[120:123]
buffer_load_dwordx4 a[60:63], v1, s[4:7], s61 offen offset:2048 sc1
v_mfma_f32_16x16x32_bf16 v[128:131], v[144:147], a[84:87], v[128:131]
ds_read_b128 v[136:139], v3 offset:16384
v_fma_f32 v219, v219, v239, v237
v_mfma_f32_16x16x32_bf16 v[132:135], v[148:151], a[84:87], v[132:135]
v_mul_f32 v218, v218, v86
v_mul_f32 v223, v223, v79
v_mfma_f32_16x16x32_bf16 v[124:127], v[148:151], a[80:83], v[124:127]
s_waitcnt lgkmcnt(3)
ds_read_b128 v[140:143], v3 offset:17408
v_mul_f32 v219, v219, v87
v_mfma_f32_16x16x32_bf16 v[104:107], v[152:155], a[88:91], v[104:107]
buffer_load_dwordx4 a[64:67], v1, s[4:7], s61 offen offset:3072 sc1
v_mfma_f32_16x16x32_bf16 v[112:115], v[152:155], a[92:95], v[112:115]
s_add_u32 s61, s31, 29696
ds_read_b128 v[144:147], v3 offset:18432
v_mul_f32 v224, v80, v80
v_mfma_f32_16x16x32_bf16 v[116:119], v[156:159], a[92:95], v[116:119]
v_exp_f32 v218, v218
v_mfma_f32_16x16x32_bf16 v[108:111], v[156:159], a[88:91], v[108:111]
s_waitcnt lgkmcnt(3)
ds_read_b128 v[148:151], v3 offset:19456
v_mul_f32 v102, v102, v86
v_mfma_f32_16x16x32_bf16 v[120:123], v[160:163], a[88:91], v[120:123]
v_exp_f32 v219, v219
v_mfma_f32_16x16x32_bf16 v[128:131], v[160:163], a[92:95], v[128:131]
ds_read_b128 v[152:155], v3 offset:20480
v_fma_f32 v218, v218, v241, v241
v_mfma_f32_16x16x32_bf16 v[132:135], v[164:167], a[92:95], v[132:135]
buffer_load_dwordx4 a[68:71], v1, s[4:7], s61 offen offset:0 sc1
v_mfma_f32_16x16x32_bf16 v[124:127], v[164:167], a[88:91], v[124:127]
s_waitcnt lgkmcnt(3)
ds_read_b128 v[156:159], v3 offset:21504
s_add_u32 s61, s31, 40960
v_mfma_f32_16x16x32_bf16 v[104:107], v[136:139], a[96:99], v[104:107]
v_rcp_f32 v218, v218
v_mfma_f32_16x16x32_bf16 v[112:115], v[136:139], a[100:103], v[112:115]
ds_read_b128 v[160:163], v3 offset:22528
v_fma_f32 v219, v219, v241, v241
v_mfma_f32_16x16x32_bf16 v[116:119], v[140:143], a[100:103], v[116:119]
buffer_load_dwordx4 a[72:75], v1, s[4:7], s61 offen offset:0 sc1
v_mfma_f32_16x16x32_bf16 v[108:111], v[140:143], a[96:99], v[108:111]
s_waitcnt lgkmcnt(3)
ds_read_b128 v[164:167], v3 offset:23552
v_mul_f32 v103, v103, v87
v_mfma_f32_16x16x32_bf16 v[120:123], v[144:147], a[96:99], v[120:123]
v_rcp_f32 v219, v219
v_mfma_f32_16x16x32_bf16 v[128:131], v[144:147], a[100:103], v[128:131]
ds_read_b128 v[136:139], v3 offset:24576
v_mul_f32 v102, v102, v218
v_mfma_f32_16x16x32_bf16 v[132:135], v[148:151], a[100:103], v[132:135]
v_mul_f32 v103, v103, v219
v_mul_f32 v225, v81, v81
v_mfma_f32_16x16x32_bf16 v[124:127], v[148:151], a[96:99], v[124:127]
s_waitcnt lgkmcnt(3)
ds_read_b128 v[140:143], v3 offset:25600
v_cvt_pk_bf16_f32 v207, v102, v103
v_mfma_f32_16x16x32_bf16 v[104:107], v[152:155], a[104:107], v[104:107]
s_waitcnt vmcnt(38)
s_barrier
v_mfma_f32_16x16x32_bf16 v[112:115], v[152:155], a[108:111], v[112:115]
ds_read_b128 v[144:147], v3 offset:26624
v_fma_f32 v224, v224, v239, v237
v_mfma_f32_16x16x32_bf16 v[116:119], v[156:159], a[108:111], v[116:119]
buffer_load_dwordx4 a[76:79], v1, s[4:7], s61 offen offset:1024 sc1
v_mfma_f32_16x16x32_bf16 v[108:111], v[156:159], a[104:107], v[108:111]
s_waitcnt lgkmcnt(3)
ds_read_b128 v[148:151], v3 offset:27648
v_exp_f32 v220, v220
v_mul_f32 v92, v92, v76
v_mfma_f32_16x16x32_bf16 v[120:123], v[160:163], a[104:107], v[120:123]
v_exp_f32 v221, v221
v_mfma_f32_16x16x32_bf16 v[128:131], v[160:163], a[108:111], v[128:131]
ds_read_b128 v[152:155], v1 offset:0
v_fma_f32 v220, v220, v240, v240
v_mfma_f32_16x16x32_bf16 v[132:135], v[164:167], a[108:111], v[132:135]
buffer_load_dwordx4 a[80:83], v1, s[4:7], s61 offen offset:2048 sc1
v_mfma_f32_16x16x32_bf16 v[124:127], v[164:167], a[104:107], v[124:127]
s_waitcnt lgkmcnt(3)
ds_read_b128 v[156:159], v1 offset:1024
v_rcp_f32 v220, v220
v_exp_f32 v222, v222
v_fma_f32 v225, v225, v239, v237
v_fma_f32 v221, v221, v240, v240
v_mul_f32 v94, v94, v78
v_mfma_f32_16x16x32_bf16 v[104:107], v[136:139], a[112:115], v[104:107]
v_mul_f32 v93, v93, v77
v_mul_f32 v224, v224, v80
v_mfma_f32_16x16x32_bf16 v[112:115], v[136:139], a[116:119], v[112:115]
ds_read_b128 v[160:163], v1 offset:2048
v_rcp_f32 v221, v221
v_exp_f32 v223, v223
v_mul_f32 v225, v225, v81
v_mul_f32 v226, v82, v82
v_fma_f32 v222, v222, v240, v240
v_mul_f32 v227, v83, v83
v_mfma_f32_16x16x32_bf16 v[116:119], v[140:143], a[116:119], v[116:119]
buffer_load_dwordx4 a[84:87], v1, s[4:7], s61 offen offset:3072 sc1
v_mfma_f32_16x16x32_bf16 v[108:111], v[140:143], a[112:115], v[108:111]
s_waitcnt lgkmcnt(3)
ds_read_b128 v[164:167], v1 offset:3072
s_add_u32 s61, s31, 45056
v_mul_f32 v92, v92, v220
v_rcp_f32 v222, v222
v_exp_f32 v224, v224
v_fma_f32 v226, v226, v239, v237
v_mul_f32 v93, v93, v221
v_fma_f32 v223, v223, v240, v240
v_mul_f32 v96, v96, v80
v_fma_f32 v227, v227, v239, v237
v_mfma_f32_16x16x32_bf16 v[120:123], v[144:147], a[112:115], v[120:123]
v_cvt_pk_bf16_f32 v202, v92, v93
v_mul_f32 v95, v95, v79
v_mfma_f32_16x16x32_bf16 v[128:131], v[144:147], a[116:119], v[128:131]
ds_read_b128 v[136:139], v1 offset:4096
v_rcp_f32 v223, v223
v_exp_f32 v225, v225
v_mul_f32 v226, v226, v82
v_fma_f32 v224, v224, v241, v241
v_mul_f32 v227, v227, v83
v_mfma_f32_16x16x32_bf16 v[132:135], v[148:151], a[116:119], v[132:135]
buffer_load_dwordx4 a[88:91], v1, s[4:7], s61 offen offset:0 sc1
v_mfma_f32_16x16x32_bf16 v[124:127], v[148:151], a[112:115], v[124:127]
s_waitcnt lgkmcnt(3)
ds_read_b128 v[140:143], v1 offset:5120
s_add_u32 s61, s31, 56320
v_mul_f32 v94, v94, v222
v_rcp_f32 v224, v224
v_exp_f32 v226, v226
v_mul_f32 v95, v95, v223
v_fma_f32 v225, v225, v241, v241
v_mul_f32 v98, v98, v82
v_mfma_f32_16x16x32_bf16 v[104:107], v[152:155], a[120:123], v[104:107]
v_cvt_pk_bf16_f32 v203, v94, v95
v_mul_f32 v97, v97, v81
v_mfma_f32_16x16x32_bf16 v[112:115], v[152:155], a[124:127], v[112:115]
ds_read_b128 v[144:147], v1 offset:6144
v_rcp_f32 v225, v225
v_exp_f32 v227, v227
v_fma_f32 v226, v226, v241, v241
v_mfma_f32_16x16x32_bf16 v[116:119], v[156:159], a[124:127], v[116:119]
buffer_store_dwordx4 v[200:203], v4, s[4:7], s40 offen offset:2048 sc1
v_mfma_f32_16x16x32_bf16 v[108:111], v[156:159], a[120:123], v[108:111]
s_waitcnt lgkmcnt(3)
ds_read_b128 v[148:151], v1 offset:7168
v_mul_f32 v96, v96, v224
v_rcp_f32 v226, v226
v_mul_f32 v97, v97, v225
v_fma_f32 v227, v227, v241, v241
v_mfma_f32_16x16x32_bf16 v[120:123], v[160:163], a[120:123], v[120:123]
buffer_load_dwordx4 a[92:95], v1, s[4:7], s61 offen offset:0 sc1
v_mfma_f32_16x16x32_bf16 v[128:131], v[160:163], a[124:127], v[128:131]
ds_read_b128 v[152:155], v1 offset:8192
v_cvt_pk_bf16_f32 v204, v96, v97
v_mul_f32 v99, v99, v83
v_rcp_f32 v227, v227
v_mfma_f32_16x16x32_bf16 v[132:135], v[164:167], a[124:127], v[132:135]
v_mul_f32 v98, v98, v226
v_mul_f32 v99, v99, v227
v_mfma_f32_16x16x32_bf16 v[124:127], v[164:167], a[120:123], v[124:127]
s_waitcnt lgkmcnt(3)
ds_read_b128 v[156:159], v1 offset:9216
v_cvt_pk_bf16_f32 v205, v98, v99
v_mfma_f32_16x16x32_bf16 v[104:107], v[136:139], a[128:131], v[104:107]
buffer_store_dwordx4 v[204:207], v4, s[4:7], s40 offen offset:2304 sc1
v_mfma_f32_16x16x32_bf16 v[112:115], v[136:139], a[132:135], v[112:115]
ds_read_b128 v[160:163], v1 offset:10240
v_mfma_f32_16x16x32_bf16 v[116:119], v[140:143], a[132:135], v[116:119]
buffer_load_dwordx4 a[96:99], v1, s[4:7], s61 offen offset:1024 sc1
v_mfma_f32_16x16x32_bf16 v[108:111], v[140:143], a[128:131], v[108:111]
s_waitcnt lgkmcnt(3)
ds_read_b128 v[164:167], v1 offset:11264
v_mfma_f32_16x16x32_bf16 v[120:123], v[144:147], a[128:131], v[120:123]
v_mfma_f32_16x16x32_bf16 v[128:131], v[144:147], a[132:135], v[128:131]
ds_read_b128 v[136:139], v1 offset:12288
v_mfma_f32_16x16x32_bf16 v[132:135], v[148:151], a[132:135], v[132:135]
buffer_load_dwordx4 a[100:103], v1, s[4:7], s61 offen offset:2048 sc1
v_mfma_f32_16x16x32_bf16 v[124:127], v[148:151], a[128:131], v[124:127]
s_waitcnt lgkmcnt(3)
ds_read_b128 v[140:143], v1 offset:13312
v_mfma_f32_16x16x32_bf16 v[104:107], v[152:155], a[136:139], v[104:107]
v_mfma_f32_16x16x32_bf16 v[112:115], v[152:155], a[140:143], v[112:115]
ds_read_b128 v[144:147], v1 offset:14336
v_mfma_f32_16x16x32_bf16 v[116:119], v[156:159], a[140:143], v[116:119]
buffer_load_dwordx4 a[104:107], v1, s[4:7], s61 offen offset:3072 sc1
v_mfma_f32_16x16x32_bf16 v[108:111], v[156:159], a[136:139], v[108:111]
s_waitcnt lgkmcnt(3)
ds_read_b128 v[148:151], v1 offset:15360
s_add_u32 s61, s31, 60416
v_mfma_f32_16x16x32_bf16 v[120:123], v[160:163], a[136:139], v[120:123]
v_mfma_f32_16x16x32_bf16 v[128:131], v[160:163], a[140:143], v[128:131]
ds_read_b128 v[152:155], v1 offset:16384
v_mfma_f32_16x16x32_bf16 v[132:135], v[164:167], a[140:143], v[132:135]
v_mfma_f32_16x16x32_bf16 v[124:127], v[164:167], a[136:139], v[124:127]
s_waitcnt lgkmcnt(3)
ds_read_b128 v[156:159], v1 offset:17408
v_mfma_f32_16x16x32_bf16 v[104:107], v[136:139], a[144:147], v[104:107]
buffer_load_dwordx4 a[108:111], v1, s[4:7], s61 offen offset:0 sc1
v_mfma_f32_16x16x32_bf16 v[112:115], v[136:139], a[148:151], v[112:115]
ds_read_b128 v[160:163], v1 offset:18432
v_mfma_f32_16x16x32_bf16 v[116:119], v[140:143], a[148:151], v[116:119]
v_mfma_f32_16x16x32_bf16 v[108:111], v[140:143], a[144:147], v[108:111]
s_waitcnt lgkmcnt(3)
ds_read_b128 v[164:167], v1 offset:19456
v_mfma_f32_16x16x32_bf16 v[120:123], v[144:147], a[144:147], v[120:123]
v_mfma_f32_16x16x32_bf16 v[128:131], v[144:147], a[148:151], v[128:131]
v_mfma_f32_16x16x32_bf16 v[132:135], v[148:151], a[148:151], v[132:135]
v_mfma_f32_16x16x32_bf16 v[124:127], v[148:151], a[144:147], v[124:127]
s_waitcnt lgkmcnt(2)
v_mfma_f32_16x16x32_bf16 v[104:107], v[152:155], a[152:155], v[104:107]
v_mfma_f32_16x16x32_bf16 v[112:115], v[152:155], a[156:159], v[112:115]
v_mfma_f32_16x16x32_bf16 v[116:119], v[156:159], a[156:159], v[116:119]
v_mfma_f32_16x16x32_bf16 v[108:111], v[156:159], a[152:155], v[108:111]
s_waitcnt lgkmcnt(0)
v_mfma_f32_16x16x32_bf16 v[120:123], v[160:163], a[152:155], v[120:123]
v_mfma_f32_16x16x32_bf16 v[128:131], v[160:163], a[156:159], v[128:131]
v_mfma_f32_16x16x32_bf16 v[132:135], v[164:167], a[156:159], v[132:135]
v_mfma_f32_16x16x32_bf16 v[124:127], v[164:167], a[152:155], v[124:127]
v_pk_mul_f32 v[216:217], v[104:105], v[104:105]
v_pk_mul_f32 v[218:219], v[106:107], v[106:107]
v_pk_fma_f32 v[216:217], v[216:217], v[238:239], v[236:237] op_sel:[0,0,0] op_sel_hi:[1,0,0]
v_pk_fma_f32 v[218:219], v[218:219], v[238:239], v[236:237] op_sel:[0,0,0] op_sel_hi:[1,0,0]
v_pk_mul_f32 v[216:217], v[216:217], v[104:105]
v_pk_mul_f32 v[218:219], v[218:219], v[106:107]
v_exp_f32 v216, v216
v_exp_f32 v217, v217
v_exp_f32 v218, v218
v_exp_f32 v219, v219
v_pk_mul_f32 v[120:121], v[120:121], v[104:105]
v_pk_mul_f32 v[122:123], v[122:123], v[106:107]
v_pk_fma_f32 v[216:217], v[216:217], v[240:241], v[240:241] op_sel:[0,0,0] op_sel_hi:[1,0,0]
v_pk_fma_f32 v[218:219], v[218:219], v[240:241], v[240:241] op_sel:[0,0,0] op_sel_hi:[1,0,0]
v_rcp_f32 v216, v216
v_rcp_f32 v217, v217
v_rcp_f32 v218, v218
v_rcp_f32 v219, v219
v_pk_mul_f32 v[120:121], v[120:121], v[216:217]
v_pk_mul_f32 v[122:123], v[122:123], v[218:219]
v_cvt_pk_bf16_f32 v228, v120, v121
v_cvt_pk_bf16_f32 v229, v122, v123
v_pk_mul_f32 v[216:217], v[108:109], v[108:109]
v_pk_mul_f32 v[218:219], v[110:111], v[110:111]
v_pk_fma_f32 v[216:217], v[216:217], v[238:239], v[236:237] op_sel:[0,0,0] op_sel_hi:[1,0,0]
v_pk_fma_f32 v[218:219], v[218:219], v[238:239], v[236:237] op_sel:[0,0,0] op_sel_hi:[1,0,0]
v_pk_mul_f32 v[216:217], v[216:217], v[108:109]
v_pk_mul_f32 v[218:219], v[218:219], v[110:111]
v_exp_f32 v216, v216
v_exp_f32 v217, v217
v_exp_f32 v218, v218
v_exp_f32 v219, v219
v_pk_mul_f32 v[124:125], v[124:125], v[108:109]
v_pk_mul_f32 v[126:127], v[126:127], v[110:111]
v_pk_fma_f32 v[216:217], v[216:217], v[240:241], v[240:241] op_sel:[0,0,0] op_sel_hi:[1,0,0]
v_pk_fma_f32 v[218:219], v[218:219], v[240:241], v[240:241] op_sel:[0,0,0] op_sel_hi:[1,0,0]
v_rcp_f32 v216, v216
v_rcp_f32 v217, v217
v_rcp_f32 v218, v218
v_rcp_f32 v219, v219
v_pk_mul_f32 v[124:125], v[124:125], v[216:217]
v_pk_mul_f32 v[126:127], v[126:127], v[218:219]
v_cvt_pk_bf16_f32 v230, v124, v125
v_cvt_pk_bf16_f32 v231, v126, v127
buffer_store_dwordx4 v[228:231], v4, s[4:7], s78 offen offset:0 sc1
v_pk_mul_f32 v[216:217], v[112:113], v[112:113]
v_pk_mul_f32 v[218:219], v[114:115], v[114:115]
v_pk_fma_f32 v[216:217], v[216:217], v[238:239], v[236:237] op_sel:[0,1,1] op_sel_hi:[1,1,1]
v_pk_fma_f32 v[218:219], v[218:219], v[238:239], v[236:237] op_sel:[0,1,1] op_sel_hi:[1,1,1]
v_pk_mul_f32 v[216:217], v[216:217], v[112:113]
v_pk_mul_f32 v[218:219], v[218:219], v[114:115]
v_exp_f32 v216, v216
v_exp_f32 v217, v217
v_exp_f32 v218, v218
v_exp_f32 v219, v219
v_pk_mul_f32 v[128:129], v[128:129], v[112:113]
v_pk_mul_f32 v[130:131], v[130:131], v[114:115]
v_pk_fma_f32 v[216:217], v[216:217], v[240:241], v[240:241] op_sel:[0,1,1] op_sel_hi:[1,1,1]
v_pk_fma_f32 v[218:219], v[218:219], v[240:241], v[240:241] op_sel:[0,1,1] op_sel_hi:[1,1,1]
v_rcp_f32 v216, v216
v_rcp_f32 v217, v217
v_rcp_f32 v218, v218
v_rcp_f32 v219, v219
v_pk_mul_f32 v[128:129], v[128:129], v[216:217]
v_pk_mul_f32 v[130:131], v[130:131], v[218:219]
v_cvt_pk_bf16_f32 v232, v128, v129
v_cvt_pk_bf16_f32 v233, v130, v131
v_pk_mul_f32 v[216:217], v[116:117], v[116:117]
v_pk_mul_f32 v[218:219], v[118:119], v[118:119]
v_pk_fma_f32 v[216:217], v[216:217], v[238:239], v[236:237] op_sel:[0,1,1] op_sel_hi:[1,1,1]
v_pk_fma_f32 v[218:219], v[218:219], v[238:239], v[236:237] op_sel:[0,1,1] op_sel_hi:[1,1,1]
v_pk_mul_f32 v[216:217], v[216:217], v[116:117]
v_pk_mul_f32 v[218:219], v[218:219], v[118:119]
v_exp_f32 v216, v216
v_exp_f32 v217, v217
v_exp_f32 v218, v218
v_exp_f32 v219, v219
v_pk_mul_f32 v[132:133], v[132:133], v[116:117]
v_pk_mul_f32 v[134:135], v[134:135], v[118:119]
v_pk_fma_f32 v[216:217], v[216:217], v[240:241], v[240:241] op_sel:[0,1,1] op_sel_hi:[1,1,1]
v_pk_fma_f32 v[218:219], v[218:219], v[240:241], v[240:241] op_sel:[0,1,1] op_sel_hi:[1,1,1]
v_rcp_f32 v216, v216
v_rcp_f32 v217, v217
v_rcp_f32 v218, v218
v_rcp_f32 v219, v219
v_pk_mul_f32 v[132:133], v[132:133], v[216:217]
v_pk_mul_f32 v[134:135], v[134:135], v[218:219]
v_cvt_pk_bf16_f32 v234, v132, v133
v_cvt_pk_bf16_f32 v235, v134, v135
buffer_store_dwordx4 v[232:235], v4, s[4:7], s78 offen offset:256 sc1
v_mov_b32 v15, 3
s_cmp_eq_u32 s18, 0
s_cbranch_scc1 Lo40
s_waitcnt vmcnt(0) lgkmcnt(0)
s_barrier
s_sub_u32 s60, s18, 1
s_mul_i32 s53, s60, 3072
s_add_u32 m0, s53, 31744
s_add_u32 s52, s28, s53
s_add_u32 s52, s52, 25600
buffer_load_dwordx4 v1, s[4:7], s52 offen offset:0 sc1 lds
buffer_load_dwordx4 v1, s[4:7], s52 offen offset:1024 sc1 lds
buffer_load_dwordx4 v1, s[4:7], s52 offen offset:2048 sc1 lds
s_mul_i32 s53, s60, 6144
s_add_u32 m0, s53, 59392
s_add_u32 s52, s28, s53
s_add_u32 s52, s52, 53248
buffer_load_dwordx4 v1, s[4:7], s52 offen offset:0 sc1 lds
buffer_load_dwordx4 v1, s[4:7], s52 offen offset:1024 sc1 lds
buffer_load_dwordx4 v1, s[4:7], s52 offen offset:2048 sc1 lds
buffer_load_dwordx4 v1, s[4:7], s52 offen offset:3072 sc1 lds
s_add_u32 m0, m0, 4096
s_add_u32 s52, s52, 4096
buffer_load_dwordx4 v1, s[4:7], s52 offen offset:0 sc1 lds
buffer_load_dwordx4 v1, s[4:7], s52 offen offset:1024 sc1 lds
s_branch Lj41
Lr43_x:
s_add_u32 s57, s57, 1
s_cmp_lt_u32 s57, 1048576
s_cbranch_scc1 Lr43_0
s_mov_b64 vcc, 0
s_branch Lr43_d
Lo40:
s_cbranch_vccnz Lw42
s_mov_b32 s57, 0
s_mov_b64 exec, 1
s_waitcnt vmcnt(0) lgkmcnt(0)
s_barrier
buffer_store_dword v15, v12, s[4:7], s49 offen
s_mov_b64 exec, 0xffff
Lr43_0:
buffer_load_dword v15, v7, s[4:7], s23 offen sc1
Lr43_w:
s_waitcnt vmcnt(0)
v_cmp_gt_u32 vcc, 3, v15
s_nop 0
s_cbranch_vccnz Lr43_x
Lr43_d:
s_mov_b64 exec, -1
Lj41:
s_barrier
buffer_load_dwordx4 v[40:43], v4, s[4:7], s62 offen offset:0 sc1
s_add_u32 s66, s62, 6400
buffer_load_dwordx4 v[44:47], v4, s[4:7], s66 offen offset:0 sc1
s_add_u32 s66, s62, 12800
buffer_load_dwordx4 v[48:51], v4, s[4:7], s66 offen offset:0 sc1
s_add_u32 s66, s62, 19200
buffer_load_dwordx4 v[52:55], v4, s[4:7], s66 offen offset:0 sc1
buffer_load_dwordx4 v[56:59], v4, s[4:7], s62 offen offset:2048 sc1
s_add_u32 s66, s62, 8448
buffer_load_dwordx4 v[60:63], v4, s[4:7], s66 offen offset:0 sc1
s_add_u32 s66, s62, 14848
buffer_load_dwordx4 v[64:67], v4, s[4:7], s66 offen offset:0 sc1
s_add_u32 s66, s62, 21248
buffer_load_dwordx4 v[68:71], v4, s[4:7], s66 offen offset:0 sc1
s_add_u32 s66, s62, 4096
buffer_load_dwordx4 v[72:75], v4, s[4:7], s66 offen offset:0 sc1
s_add_u32 s66, s62, 10496
buffer_load_dwordx4 v[76:79], v4, s[4:7], s66 offen offset:0 sc1
s_waitcnt vmcnt(9)
v_mfma_f32_16x16x32_bf16 v[88:91], a[160:163], v[40:43], 0
s_add_u32 s66, s62, 16896
s_mul_i32 s53, s18, 4096
s_add_u32 m0, s53, 40960
v_mfma_f32_16x16x32_bf16 v[92:95], a[164:167], v[40:43], 0
s_add_u32 s52, s28, s53
buffer_load_dwordx4 v[80:83], v4, s[4:7], s66 offen offset:0 sc1
v_mfma_f32_16x16x32_bf16 v[96:99], a[168:171], v[40:43], 0
s_add_u32 s66, s62, 23296
s_add_u32 s52, s52, 34816
v_mfma_f32_16x16x32_bf16 v[100:103], a[172:175], v[40:43], 0
buffer_load_dwordx4 v1, s[4:7], s52 offen offset:0 sc1 lds
v_mfma_f32_16x16x32_bf16 v[104:107], a[176:179], v[40:43], 0
s_waitcnt vmcnt(10)
v_mfma_f32_16x16x32_bf16 v[88:91], a[180:183], v[44:47], v[88:91]
buffer_load_dwordx4 v[84:87], v4, s[4:7], s66 offen offset:0 sc1
v_mfma_f32_16x16x32_bf16 v[92:95], a[184:187], v[44:47], v[92:95]
v_mfma_f32_16x16x32_bf16 v[96:99], a[188:191], v[44:47], v[96:99]
v_mfma_f32_16x16x32_bf16 v[100:103], a[192:195], v[44:47], v[100:103]
v_mfma_f32_16x16x32_bf16 v[104:107], a[196:199], v[44:47], v[104:107]
s_waitcnt vmcnt(10)
v_mfma_f32_16x16x32_bf16 v[88:91], a[200:203], v[48:51], v[88:91]
buffer_load_dwordx4 v[40:43], v4, s[4:7], s63 offen offset:0 sc1
v_mfma_f32_16x16x32_bf16 v[92:95], a[204:207], v[48:51], v[92:95]
s_add_u32 s66, s63, 6400
v_mfma_f32_16x16x32_bf16 v[96:99], a[208:211], v[48:51], v[96:99]
v_mfma_f32_16x16x32_bf16 v[100:103], a[212:215], v[48:51], v[100:103]
v_mfma_f32_16x16x32_bf16 v[104:107], a[216:219], v[48:51], v[104:107]
s_waitcnt vmcnt(10)
v_mfma_f32_16x16x32_bf16 v[88:91], a[220:223], v[52:55], v[88:91]
buffer_load_dwordx4 v[44:47], v4, s[4:7], s66 offen offset:0 sc1
v_mfma_f32_16x16x32_bf16 v[92:95], a[224:227], v[52:55], v[92:95]
s_add_u32 s66, s63, 12800
v_mfma_f32_16x16x32_bf16 v[96:99], a[228:231], v[52:55], v[96:99]
v_mfma_f32_16x16x32_bf16 v[100:103], a[232:235], v[52:55], v[100:103]
v_mfma_f32_16x16x32_bf16 v[104:107], a[236:239], v[52:55], v[104:107]
s_waitcnt vmcnt(10)
v_mfma_f32_16x16x32_bf16 v[88:91], a[240:243], v[56:59], v[88:91]
buffer_load_dwordx4 v[48:51], v4, s[4:7], s66 offen offset:0 sc1
v_mfma_f32_16x16x32_bf16 v[92:95], a[244:247], v[56:59], v[92:95]
s_add_u32 s66, s63, 19200
v_mfma_f32_16x16x32_bf16 v[96:99], a[248:251], v[56:59], v[96:99]
v_mfma_f32_16x16x32_bf16 v[100:103], a[252:255], v[56:59], v[100:103]
v_mfma_f32_16x16x32_bf16 v[104:107], v[168:171], v[56:59], v[104:107]
s_waitcnt vmcnt(10)
v_mfma_f32_16x16x32_bf16 v[88:91], v[172:175], v[60:63], v[88:91]
buffer_load_dwordx4 v[52:55], v4, s[4:7], s66 offen offset:0 sc1
v_mfma_f32_16x16x32_bf16 v[92:95], v[176:179], v[60:63], v[92:95]
v_mfma_f32_16x16x32_bf16 v[96:99], v[180:183], v[60:63], v[96:99]
v_mfma_f32_16x16x32_bf16 v[100:103], v[184:187], v[60:63], v[100:103]
v_mfma_f32_16x16x32_bf16 v[104:107], v[188:191], v[60:63], v[104:107]
s_waitcnt vmcnt(10)
v_mfma_f32_16x16x32_bf16 v[88:91], v[192:195], v[64:67], v[88:91]
buffer_load_dwordx4 v[56:59], v4, s[4:7], s63 offen offset:2048 sc1
v_mfma_f32_16x16x32_bf16 v[92:95], v[196:199], v[64:67], v[92:95]
s_add_u32 s66, s63, 8448
v_mfma_f32_16x16x32_bf16 v[96:99], a[0:3], v[64:67], v[96:99]
v_mfma_f32_16x16x32_bf16 v[100:103], a[4:7], v[64:67], v[100:103]
v_mfma_f32_16x16x32_bf16 v[104:107], a[8:11], v[64:67], v[104:107]
s_waitcnt vmcnt(10)
v_mfma_f32_16x16x32_bf16 v[88:91], a[12:15], v[68:71], v[88:91]
buffer_load_dwordx4 v[60:63], v4, s[4:7], s66 offen offset:0 sc1
v_mfma_f32_16x16x32_bf16 v[92:95], a[16:19], v[68:71], v[92:95]
s_add_u32 s66, s63, 14848
v_mfma_f32_16x16x32_bf16 v[96:99], a[20:23], v[68:71], v[96:99]
v_mfma_f32_16x16x32_bf16 v[100:103], a[24:27], v[68:71], v[100:103]
v_mfma_f32_16x16x32_bf16 v[104:107], a[28:31], v[68:71], v[104:107]
s_waitcnt vmcnt(10)
v_mfma_f32_16x16x32_bf16 v[88:91], a[32:35], v[72:75], v[88:91]
buffer_load_dwordx4 v[64:67], v4, s[4:7], s66 offen offset:0 sc1
v_mfma_f32_16x16x32_bf16 v[92:95], a[36:39], v[72:75], v[92:95]
s_add_u32 s66, s63, 21248
v_mfma_f32_16x16x32_bf16 v[96:99], a[40:43], v[72:75], v[96:99]
v_mfma_f32_16x16x32_bf16 v[100:103], a[44:47], v[72:75], v[100:103]
v_mfma_f32_16x16x32_bf16 v[104:107], a[48:51], v[72:75], v[104:107]
s_waitcnt vmcnt(10)
v_mfma_f32_16x16x32_bf16 v[88:91], a[52:55], v[76:79], v[88:91]
buffer_load_dwordx4 v[68:71], v4, s[4:7], s66 offen offset:0 sc1
v_mfma_f32_16x16x32_bf16 v[92:95], a[56:59], v[76:79], v[92:95]
s_add_u32 s66, s63, 4096
v_mfma_f32_16x16x32_bf16 v[96:99], a[60:63], v[76:79], v[96:99]
v_mfma_f32_16x16x32_bf16 v[100:103], a[64:67], v[76:79], v[100:103]
v_mfma_f32_16x16x32_bf16 v[104:107], a[68:71], v[76:79], v[104:107]
s_waitcnt vmcnt(10)
buffer_load_dwordx4 v1, s[4:7], s52 offen offset:1024 sc1 lds
v_mfma_f32_16x16x32_bf16 v[88:91], a[72:75], v[80:83], v[88:91]
buffer_load_dwordx4 v[72:75], v4, s[4:7], s66 offen offset:0 sc1
v_mfma_f32_16x16x32_bf16 v[92:95], a[76:79], v[80:83], v[92:95]
s_add_u32 s66, s63, 10496
v_mfma_f32_16x16x32_bf16 v[96:99], a[80:83], v[80:83], v[96:99]
v_mfma_f32_16x16x32_bf16 v[100:103], a[84:87], v[80:83], v[100:103]
v_mfma_f32_16x16x32_bf16 v[104:107], a[88:91], v[80:83], v[104:107]
s_waitcnt vmcnt(10)
v_mfma_f32_16x16x32_bf16 v[88:91], a[92:95], v[84:87], v[88:91]
buffer_load_dwordx4 v[76:79], v4, s[4:7], s66 offen offset:0 sc1
v_mfma_f32_16x16x32_bf16 v[92:95], a[96:99], v[84:87], v[92:95]
s_add_u32 s66, s63, 16896
v_mfma_f32_16x16x32_bf16 v[96:99], a[100:103], v[84:87], v[96:99]
v_mfma_f32_16x16x32_bf16 v[100:103], a[104:107], v[84:87], v[100:103]
v_mfma_f32_16x16x32_bf16 v[104:107], a[108:111], v[84:87], v[104:107]
s_waitcnt vmcnt(10)
v_mfma_f32_16x16x32_bf16 v[108:111], a[160:163], v[40:43], 0
buffer_load_dwordx4 v[80:83], v4, s[4:7], s66 offen offset:0 sc1
v_mfma_f32_16x16x32_bf16 v[112:115], a[164:167], v[40:43], 0
s_add_u32 s66, s63, 23296
v_mfma_f32_16x16x32_bf16 v[116:119], a[168:171], v[40:43], 0
v_mfma_f32_16x16x32_bf16 v[120:123], a[172:175], v[40:43], 0
ds_write_b128 v246, v[88:91] offset:0
v_mfma_f32_16x16x32_bf16 v[124:127], a[176:179], v[40:43], 0
s_waitcnt vmcnt(10)
v_mfma_f32_16x16x32_bf16 v[108:111], a[180:183], v[44:47], v[108:111]
buffer_load_dwordx4 v[84:87], v4, s[4:7], s66 offen offset:0 sc1
v_mfma_f32_16x16x32_bf16 v[112:115], a[184:187], v[44:47], v[112:115]
ds_write_b128 v246, v[92:95] offset:1024
v_mfma_f32_16x16x32_bf16 v[116:119], a[188:191], v[44:47], v[116:119]
v_mfma_f32_16x16x32_bf16 v[120:123], a[192:195], v[44:47], v[120:123]
v_mfma_f32_16x16x32_bf16 v[124:127], a[196:199], v[44:47], v[124:127]
s_waitcnt vmcnt(10)
ds_write_b128 v246, v[96:99] offset:2048
v_mfma_f32_16x16x32_bf16 v[108:111], a[200:203], v[48:51], v[108:111]
buffer_load_dwordx4 v[40:43], v4, s[4:7], s64 offen offset:0 sc1
v_mfma_f32_16x16x32_bf16 v[112:115], a[204:207], v[48:51], v[112:115]
s_add_u32 s66, s64, 6400
v_mfma_f32_16x16x32_bf16 v[116:119], a[208:211], v[48:51], v[116:119]
ds_write_b128 v246, v[100:103] offset:3072
v_mfma_f32_16x16x32_bf16 v[120:123], a[212:215], v[48:51], v[120:123]
v_mfma_f32_16x16x32_bf16 v[124:127], a[216:219], v[48:51], v[124:127]
s_waitcnt vmcnt(10)
v_mfma_f32_16x16x32_bf16 v[108:111], a[220:223], v[52:55], v[108:111]
buffer_load_dwordx4 v[44:47], v4, s[4:7], s66 offen offset:0 sc1
v_mfma_f32_16x16x32_bf16 v[112:115], a[224:227], v[52:55], v[112:115]
s_add_u32 s66, s64, 12800
ds_write_b128 v246, v[104:107] offset:4096
v_mfma_f32_16x16x32_bf16 v[116:119], a[228:231], v[52:55], v[116:119]
v_mfma_f32_16x16x32_bf16 v[120:123], a[232:235], v[52:55], v[120:123]
v_mfma_f32_16x16x32_bf16 v[124:127], a[236:239], v[52:55], v[124:127]
s_waitcnt vmcnt(10)
v_mfma_f32_16x16x32_bf16 v[108:111], a[240:243], v[56:59], v[108:111]
buffer_load_dwordx4 v[48:51], v4, s[4:7], s66 offen offset:0 sc1
v_mfma_f32_16x16x32_bf16 v[112:115], a[244:247], v[56:59], v[112:115]
s_add_u32 s66, s64, 19200
s_waitcnt lgkmcnt(0)
s_barrier
ds_read_b128 v[200:203], v249 offset:0
v_mfma_f32_16x16x32_bf16 v[116:119], a[248:251], v[56:59], v[116:119]
ds_read_b128 v[204:207], v249 offset:1024
v_mfma_f32_16x16x32_bf16 v[120:123], a[252:255], v[56:59], v[120:123]
ds_read_b128 v[208:211], v249 offset:2048
v_mfma_f32_16x16x32_bf16 v[124:127], v[168:171], v[56:59], v[124:127]
s_waitcnt vmcnt(10)
ds_read_b128 v[212:215], v249 offset:3072
v_mfma_f32_16x16x32_bf16 v[108:111], v[172:175], v[60:63], v[108:111]
buffer_load_dwordx4 v[52:55], v4, s[4:7], s66 offen offset:0 sc1
v_mfma_f32_16x16x32_bf16 v[112:115], v[176:179], v[60:63], v[112:115]
ds_read_b128 v[216:219], v249 offset:4096
v_mfma_f32_16x16x32_bf16 v[116:119], v[180:183], v[60:63], v[116:119]
v_mfma_f32_16x16x32_bf16 v[120:123], v[184:187], v[60:63], v[120:123]
v_mfma_f32_16x16x32_bf16 v[124:127], v[188:191], v[60:63], v[124:127]
s_waitcnt vmcnt(10)
v_mfma_f32_16x16x32_bf16 v[108:111], v[192:195], v[64:67], v[108:111]
buffer_load_dwordx4 v[56:59], v4, s[4:7], s64 offen offset:2048 sc1
v_mfma_f32_16x16x32_bf16 v[112:115], v[196:199], v[64:67], v[112:115]
s_add_u32 s66, s64, 8448
s_waitcnt lgkmcnt(0)
v_add_f32 v16, v16, v200
v_mfma_f32_16x16x32_bf16 v[116:119], a[0:3], v[64:67], v[116:119]
v_add_f32 v17, v17, v201
v_add_f32 v18, v18, v202
v_mfma_f32_16x16x32_bf16 v[120:123], a[4:7], v[64:67], v[120:123]
v_add_f32 v19, v19, v203
v_add_f32 v20, v20, v204
v_mfma_f32_16x16x32_bf16 v[124:127], a[8:11], v[64:67], v[124:127]
s_waitcnt vmcnt(10)
v_add_f32 v21, v21, v205
v_add_f32 v22, v22, v206
v_mfma_f32_16x16x32_bf16 v[108:111], a[12:15], v[68:71], v[108:111]
buffer_load_dwordx4 v[60:63], v4, s[4:7], s66 offen offset:0 sc1
v_mfma_f32_16x16x32_bf16 v[112:115], a[16:19], v[68:71], v[112:115]
s_add_u32 s66, s64, 14848
v_add_f32 v23, v23, v207
v_add_f32 v24, v24, v208
v_mfma_f32_16x16x32_bf16 v[116:119], a[20:23], v[68:71], v[116:119]
buffer_load_dwordx4 v1, s[4:7], s52 offen offset:2048 sc1 lds
v_mfma_f32_16x16x32_bf16 v[120:123], a[24:27], v[68:71], v[120:123]
v_add_f32 v25, v25, v209
v_add_f32 v26, v26, v210
v_mfma_f32_16x16x32_bf16 v[124:127], a[28:31], v[68:71], v[124:127]
s_waitcnt vmcnt(10)
v_add_f32 v27, v27, v211
s_mov_b32 s70, Lc46-C_pc+2048
v_mfma_f32_16x16x32_bf16 v[108:111], a[32:35], v[72:75], v[108:111]
s_min_u32 s70, s70, M_text_end-C_pc-16384
buffer_load_dwordx4 v[64:67], v4, s[4:7], s66 offen offset:0 sc1
v_mfma_f32_16x16x32_bf16 v[112:115], a[36:39], v[72:75], v[112:115]
s_add_u32 s66, s64, 21248
v_add_f32 v28, v28, v212
v_add_f32 v29, v29, v213
v_mfma_f32_16x16x32_bf16 v[116:119], a[40:43], v[72:75], v[116:119]
v_add_f32 v30, v30, v214
v_add_f32 v31, v31, v215
v_mfma_f32_16x16x32_bf16 v[120:123], a[44:47], v[72:75], v[120:123]
v_add_f32 v32, v32, v216
v_add_f32 v33, v33, v217
v_mfma_f32_16x16x32_bf16 v[124:127], a[48:51], v[72:75], v[124:127]
s_waitcnt vmcnt(10)
v_add_f32 v34, v34, v218
v_add_f32 v35, v35, v219
v_mfma_f32_16x16x32_bf16 v[108:111], a[52:55], v[76:79], v[108:111]
buffer_load_dwordx4 v[68:71], v4, s[4:7], s66 offen offset:0 sc1
v_mfma_f32_16x16x32_bf16 v[112:115], a[56:59], v[76:79], v[112:115]
s_add_u32 s66, s64, 4096
s_add_u32 s70, s70, s74
s_addc_u32 s71, s75, 0
v_mfma_f32_16x16x32_bf16 v[116:119], a[60:63], v[76:79], v[116:119]
s_mov_b64 exec, 1
Lc46:
global_load_dword v250, v0, s[70:71]
s_mov_b64 exec, -1
v_mfma_f32_16x16x32_bf16 v[120:123], a[64:67], v[76:79], v[120:123]
v_mfma_f32_16x16x32_bf16 v[124:127], a[68:71], v[76:79], v[124:127]
s_waitcnt vmcnt(11)
v_mfma_f32_16x16x32_bf16 v[108:111], a[72:75], v[80:83], v[108:111]
buffer_load_dwordx4 v[72:75], v4, s[4:7], s66 offen offset:0 sc1
v_mfma_f32_16x16x32_bf16 v[112:115], a[76:79], v[80:83], v[112:115]
s_add_u32 s66, s64, 10496
v_mfma_f32_16x16x32_bf16 v[116:119], a[80:83], v[80:83], v[116:119]
v_mfma_f32_16x16x32_bf16 v[120:123], a[84:87], v[80:83], v[120:123]
v_mfma_f32_16x16x32_bf16 v[124:127], a[88:91], v[80:83], v[124:127]
s_waitcnt vmcnt(11)
v_mfma_f32_16x16x32_bf16 v[108:111], a[92:95], v[84:87], v[108:111]
buffer_load_dwordx4 v[76:79], v4, s[4:7], s66 offen offset:0 sc1
v_mfma_f32_16x16x32_bf16 v[112:115], a[96:99], v[84:87], v[112:115]
s_add_u32 s66, s64, 16896
v_mfma_f32_16x16x32_bf16 v[116:119], a[100:103], v[84:87], v[116:119]
v_mfma_f32_16x16x32_bf16 v[120:123], a[104:107], v[84:87], v[120:123]
v_mfma_f32_16x16x32_bf16 v[124:127], a[108:111], v[84:87], v[124:127]
s_waitcnt vmcnt(11)
v_mfma_f32_16x16x32_bf16 v[128:131], a[160:163], v[40:43], 0
buffer_load_dwordx4 v[80:83], v4, s[4:7], s66 offen offset:0 sc1
v_mfma_f32_16x16x32_bf16 v[132:135], a[164:167], v[40:43], 0
s_add_u32 s66, s64, 23296
v_mfma_f32_16x16x32_bf16 v[136:139], a[168:171], v[40:43], 0
v_mfma_f32_16x16x32_bf16 v[140:143], a[172:175], v[40:43], 0
ds_write_b128 v247, v[108:111] offset:0
v_mfma_f32_16x16x32_bf16 v[144:147], a[176:179], v[40:43], 0
s_waitcnt vmcnt(11)
v_mfma_f32_16x16x32_bf16 v[128:131], a[180:183], v[44:47], v[128:131]
buffer_load_dwordx4 v[84:87], v4, s[4:7], s66 offen offset:0 sc1
v_mfma_f32_16x16x32_bf16 v[132:135], a[184:187], v[44:47], v[132:135]
ds_write_b128 v247, v[112:115] offset:1024
v_mfma_f32_16x16x32_bf16 v[136:139], a[188:191], v[44:47], v[136:139]
v_mfma_f32_16x16x32_bf16 v[140:143], a[192:195], v[44:47], v[140:143]
v_mfma_f32_16x16x32_bf16 v[144:147], a[196:199], v[44:47], v[144:147]
s_waitcnt vmcnt(11)
ds_write_b128 v247, v[116:119] offset:2048
v_mfma_f32_16x16x32_bf16 v[128:131], a[200:203], v[48:51], v[128:131]
buffer_load_dwordx4 v[40:43], v4, s[4:7], s65 offen offset:0 sc1
v_mfma_f32_16x16x32_bf16 v[132:135], a[204:207], v[48:51], v[132:135]
s_add_u32 s66, s65, 6400
v_mfma_f32_16x16x32_bf16 v[136:139], a[208:211], v[48:51], v[136:139]
ds_write_b128 v247, v[120:123] offset:3072
v_mfma_f32_16x16x32_bf16 v[140:143], a[212:215], v[48:51], v[140:143]
v_mfma_f32_16x16x32_bf16 v[144:147], a[216:219], v[48:51], v[144:147]
s_waitcnt vmcnt(11)
v_mfma_f32_16x16x32_bf16 v[128:131], a[220:223], v[52:55], v[128:131]
buffer_load_dwordx4 v[44:47], v4, s[4:7], s66 offen offset:0 sc1
v_mfma_f32_16x16x32_bf16 v[132:135], a[224:227], v[52:55], v[132:135]
s_add_u32 s66, s65, 12800
ds_write_b128 v247, v[124:127] offset:4096
v_mfma_f32_16x16x32_bf16 v[136:139], a[228:231], v[52:55], v[136:139]
v_mfma_f32_16x16x32_bf16 v[140:143], a[232:235], v[52:55], v[140:143]
v_mfma_f32_16x16x32_bf16 v[144:147], a[236:239], v[52:55], v[144:147]
s_waitcnt vmcnt(11)
v_mfma_f32_16x16x32_bf16 v[128:131], a[240:243], v[56:59], v[128:131]
buffer_load_dwordx4 v[48:51], v4, s[4:7], s66 offen offset:0 sc1
v_mfma_f32_16x16x32_bf16 v[132:135], a[244:247], v[56:59], v[132:135]
s_add_u32 s66, s65, 19200
s_waitcnt lgkmcnt(0)
s_barrier
ds_read_b128 v[220:223], v249 offset:20480
v_mfma_f32_16x16x32_bf16 v[136:139], a[248:251], v[56:59], v[136:139]
ds_read_b128 v[224:227], v249 offset:21504
v_mfma_f32_16x16x32_bf16 v[140:143], a[252:255], v[56:59], v[140:143]
ds_read_b128 v[228:231], v249 offset:22528
v_mfma_f32_16x16x32_bf16 v[144:147], v[168:171], v[56:59], v[144:147]
s_waitcnt vmcnt(11)
buffer_load_dwordx4 v1, s[4:7], s52 offen offset:3072 sc1 lds
v_mfma_f32_16x16x32_bf16 v[128:131], v[172:175], v[60:63], v[128:131]
buffer_load_dwordx4 v[52:55], v4, s[4:7], s66 offen offset:0 sc1
v_mfma_f32_16x16x32_bf16 v[132:135], v[176:179], v[60:63], v[132:135]
ds_read_b128 v[232:235], v249 offset:23552
v_mfma_f32_16x16x32_bf16 v[136:139], v[180:183], v[60:63], v[136:139]
ds_read_b128 v[236:239], v249 offset:24576
v_mfma_f32_16x16x32_bf16 v[140:143], v[184:187], v[60:63], v[140:143]
v_mfma_f32_16x16x32_bf16 v[144:147], v[188:191], v[60:63], v[144:147]
s_waitcnt vmcnt(11)
v_mfma_f32_16x16x32_bf16 v[128:131], v[192:195], v[64:67], v[128:131]
buffer_load_dwordx4 v[56:59], v4, s[4:7], s65 offen offset:2048 sc1
v_mfma_f32_16x16x32_bf16 v[132:135], v[196:199], v[64:67], v[132:135]
s_add_u32 s66, s65, 8448
s_waitcnt lgkmcnt(0)
v_add_f32 v16, v16, v220
v_mfma_f32_16x16x32_bf16 v[136:139], a[0:3], v[64:67], v[136:139]
v_add_f32 v17, v17, v221
v_add_f32 v18, v18, v222
v_mfma_f32_16x16x32_bf16 v[140:143], a[4:7], v[64:67], v[140:143]
v_add_f32 v19, v19, v223
v_add_f32 v20, v20, v224
v_mfma_f32_16x16x32_bf16 v[144:147], a[8:11], v[64:67], v[144:147]
s_waitcnt vmcnt(11)
v_add_f32 v21, v21, v225
v_add_f32 v22, v22, v226
v_mfma_f32_16x16x32_bf16 v[128:131], a[12:15], v[68:71], v[128:131]
buffer_load_dwordx4 v[60:63], v4, s[4:7], s66 offen offset:0 sc1
v_mfma_f32_16x16x32_bf16 v[132:135], a[16:19], v[68:71], v[132:135]
s_add_u32 s66, s65, 14848
v_add_f32 v23, v23, v227
v_add_f32 v24, v24, v228
v_mfma_f32_16x16x32_bf16 v[136:139], a[20:23], v[68:71], v[136:139]
v_add_f32 v25, v25, v229
v_add_f32 v26, v26, v230
v_mfma_f32_16x16x32_bf16 v[140:143], a[24:27], v[68:71], v[140:143]
v_add_f32 v27, v27, v231
v_add_f32 v28, v28, v232
v_mfma_f32_16x16x32_bf16 v[144:147], a[28:31], v[68:71], v[144:147]
s_waitcnt vmcnt(10)
v_add_f32 v29, v29, v233
v_add_f32 v30, v30, v234
v_mfma_f32_16x16x32_bf16 v[128:131], a[32:35], v[72:75], v[128:131]
buffer_load_dwordx4 v[64:67], v4, s[4:7], s66 offen offset:0 sc1
v_mfma_f32_16x16x32_bf16 v[132:135], a[36:39], v[72:75], v[132:135]
s_add_u32 s66, s65, 21248
v_add_f32 v31, v31, v235
v_add_f32 v32, v32, v236
v_mfma_f32_16x16x32_bf16 v[136:139], a[40:43], v[72:75], v[136:139]
v_add_f32 v33, v33, v237
v_add_f32 v34, v34, v238
v_mfma_f32_16x16x32_bf16 v[140:143], a[44:47], v[72:75], v[140:143]
v_add_f32 v35, v35, v239
v_mfma_f32_16x16x32_bf16 v[144:147], a[48:51], v[72:75], v[144:147]
s_waitcnt vmcnt(10)
v_mfma_f32_16x16x32_bf16 v[128:131], a[52:55], v[76:79], v[128:131]
buffer_load_dwordx4 v[68:71], v4, s[4:7], s66 offen offset:0 sc1
v_mfma_f32_16x16x32_bf16 v[132:135], a[56:59], v[76:79], v[132:135]
s_add_u32 s66, s65, 4096
v_mfma_f32_16x16x32_bf16 v[136:139], a[60:63], v[76:79], v[136:139]
v_mfma_f32_16x16x32_bf16 v[140:143], a[64:67], v[76:79], v[140:143]
v_mfma_f32_16x16x32_bf16 v[144:147], a[68:71], v[76:79], v[144:147]
s_waitcnt vmcnt(10)
v_mfma_f32_16x16x32_bf16 v[128:131], a[72:75], v[80:83], v[128:131]
buffer_load_dwordx4 v[72:75], v4, s[4:7], s66 offen offset:0 sc1
v_mfma_f32_16x16x32_bf16 v[132:135], a[76:79], v[80:83], v[132:135]
s_add_u32 s66, s65, 10496
v_mfma_f32_16x16x32_bf16 v[136:139], a[80:83], v[80:83], v[136:139]
v_mfma_f32_16x16x32_bf16 v[140:143], a[84:87], v[80:83], v[140:143]
v_mfma_f32_16x16x32_bf16 v[144:147], a[88:91], v[80:83], v[144:147]
s_waitcnt vmcnt(10)
v_mfma_f32_16x16x32_bf16 v[128:131], a[92:95], v[84:87], v[128:131]
buffer_load_dwordx4 v[76:79], v4, s[4:7], s66 offen offset:0 sc1
v_mfma_f32_16x16x32_bf16 v[132:135], a[96:99], v[84:87], v[132:135]
s_add_u32 s66, s65, 16896
v_mfma_f32_16x16x32_bf16 v[136:139], a[100:103], v[84:87], v[136:139]
v_mfma_f32_16x16x32_bf16 v[140:143], a[104:107], v[84:87], v[140:143]
v_mfma_f32_16x16x32_bf16 v[144:147], a[108:111], v[84:87], v[144:147]
s_waitcnt vmcnt(10)
v_mfma_f32_16x16x32_bf16 v[148:151], a[160:163], v[40:43], 0
buffer_load_dwordx4 v[80:83], v4, s[4:7], s66 offen offset:0 sc1
v_mfma_f32_16x16x32_bf16 v[152:155], a[164:167], v[40:43], 0
s_add_u32 s66, s65, 23296
v_mfma_f32_16x16x32_bf16 v[156:159], a[168:171], v[40:43], 0
v_mfma_f32_16x16x32_bf16 v[160:163], a[172:175], v[40:43], 0
ds_write_b128 v248, v[128:131] offset:0
v_mfma_f32_16x16x32_bf16 v[164:167], a[176:179], v[40:43], 0
s_waitcnt vmcnt(10)
v_mfma_f32_16x16x32_bf16 v[148:151], a[180:183], v[44:47], v[148:151]
buffer_load_dwordx4 v[84:87], v4, s[4:7], s66 offen offset:0 sc1
v_mfma_f32_16x16x32_bf16 v[152:155], a[184:187], v[44:47], v[152:155]
s_mul_i32 s53, s18, 1024
ds_write_b128 v248, v[132:135] offset:1024
v_mfma_f32_16x16x32_bf16 v[156:159], a[188:191], v[44:47], v[156:159]
s_add_u32 m0, s53, 57344
s_add_u32 s52, s28, s53
s_add_u32 s52, s52, 51200
v_mfma_f32_16x16x32_bf16 v[160:163], a[192:195], v[44:47], v[160:163]
v_mfma_f32_16x16x32_bf16 v[164:167], a[196:199], v[44:47], v[164:167]
s_waitcnt vmcnt(10)
ds_write_b128 v248, v[136:139] offset:2048
v_mfma_f32_16x16x32_bf16 v[148:151], a[200:203], v[48:51], v[148:151]
buffer_load_dwordx4 v1, s[4:7], s52 offen offset:0 sc1 lds
v_mfma_f32_16x16x32_bf16 v[152:155], a[204:207], v[48:51], v[152:155]
s_mul_i32 s53, s18, 5120
s_add_u32 m0, s53, 77824
s_add_u32 s52, s28, s53
v_mfma_f32_16x16x32_bf16 v[156:159], a[208:211], v[48:51], v[156:159]
s_add_u32 s52, s52, 71680
ds_write_b128 v248, v[140:143] offset:3072
v_mfma_f32_16x16x32_bf16 v[160:163], a[212:215], v[48:51], v[160:163]
v_mfma_f32_16x16x32_bf16 v[164:167], a[216:219], v[48:51], v[164:167]
s_waitcnt vmcnt(9)
buffer_load_dwordx4 v1, s[4:7], s52 offen offset:0 sc1 lds
v_mfma_f32_16x16x32_bf16 v[148:151], a[220:223], v[52:55], v[148:151]
ds_write_b128 v248, v[144:147] offset:4096
v_mfma_f32_16x16x32_bf16 v[152:155], a[224:227], v[52:55], v[152:155]
v_mfma_f32_16x16x32_bf16 v[156:159], a[228:231], v[52:55], v[156:159]
v_mfma_f32_16x16x32_bf16 v[160:163], a[232:235], v[52:55], v[160:163]
buffer_load_dwordx4 v1, s[4:7], s52 offen offset:1024 sc1 lds
v_mfma_f32_16x16x32_bf16 v[164:167], a[236:239], v[52:55], v[164:167]
s_waitcnt vmcnt(10)
v_mfma_f32_16x16x32_bf16 v[148:151], a[240:243], v[56:59], v[148:151]
s_waitcnt lgkmcnt(0)
s_barrier
ds_read_b128 v[200:203], v249 offset:0
v_mfma_f32_16x16x32_bf16 v[152:155], a[244:247], v[56:59], v[152:155]
ds_read_b128 v[204:207], v249 offset:1024
v_mfma_f32_16x16x32_bf16 v[156:159], a[248:251], v[56:59], v[156:159]
buffer_load_dwordx4 v1, s[4:7], s52 offen offset:2048 sc1 lds
v_mfma_f32_16x16x32_bf16 v[160:163], a[252:255], v[56:59], v[160:163]
ds_read_b128 v[208:211], v249 offset:2048
v_mfma_f32_16x16x32_bf16 v[164:167], v[168:171], v[56:59], v[164:167]
s_waitcnt vmcnt(10)
ds_read_b128 v[212:215], v249 offset:3072
v_mfma_f32_16x16x32_bf16 v[148:151], v[172:175], v[60:63], v[148:151]
ds_read_b128 v[216:219], v249 offset:4096
v_mfma_f32_16x16x32_bf16 v[152:155], v[176:179], v[60:63], v[152:155]
buffer_load_dwordx4 v1, s[4:7], s52 offen offset:3072 sc1 lds
v_mfma_f32_16x16x32_bf16 v[156:159], v[180:183], v[60:63], v[156:159]
s_add_u32 m0, m0, 4096
s_add_u32 s52, s52, 4096
v_mfma_f32_16x16x32_bf16 v[160:163], v[184:187], v[60:63], v[160:163]
v_mfma_f32_16x16x32_bf16 v[164:167], v[188:191], v[60:63], v[164:167]
s_waitcnt vmcnt(10)
v_mfma_f32_16x16x32_bf16 v[148:151], v[192:195], v[64:67], v[148:151]
buffer_load_dwordx4 v1, s[4:7], s52 offen offset:0 sc1 lds
v_mfma_f32_16x16x32_bf16 v[152:155], v[196:199], v[64:67], v[152:155]
s_mul_i32 s53, s18, 2048
s_waitcnt lgkmcnt(0)
v_add_f32 v16, v16, v200
v_mfma_f32_16x16x32_bf16 v[156:159], a[0:3], v[64:67], v[156:159]
s_add_u32 m0, s53, 4096
v_add_f32 v17, v17, v201
s_add_u32 s52, s28, s53
v_mfma_f32_16x16x32_bf16 v[160:163], a[4:7], v[64:67], v[160:163]
s_add_u32 s52, s52, 4294965248
v_add_f32 v18, v18, v202
v_add_f32 v19, v19, v203
v_mfma_f32_16x16x32_bf16 v[164:167], a[8:11], v[64:67], v[164:167]
s_waitcnt vmcnt(10)
buffer_load_dwordx4 v1, s[4:7], s52 offen offset:0 sc1 lds
v_mfma_f32_16x16x32_bf16 v[148:151], a[12:15], v[68:71], v[148:151]
v_add_f32 v20, v20, v204
v_add_f32 v21, v21, v205
v_mfma_f32_16x16x32_bf16 v[152:155], a[16:19], v[68:71], v[152:155]
v_add_f32 v22, v22, v206
v_add_f32 v23, v23, v207
v_mfma_f32_16x16x32_bf16 v[156:159], a[20:23], v[68:71], v[156:159]
v_add_f32 v24, v24, v208
v_add_f32 v25, v25, v209
v_mfma_f32_16x16x32_bf16 v[160:163], a[24:27], v[68:71], v[160:163]
buffer_load_dwordx4 v1, s[4:7], s52 offen offset:1024 sc1 lds
v_mfma_f32_16x16x32_bf16 v[164:167], a[28:31], v[68:71], v[164:167]
s_waitcnt vmcnt(11)
v_add_f32 v26, v26, v210
v_add_f32 v27, v27, v211
v_mfma_f32_16x16x32_bf16 v[148:151], a[32:35], v[72:75], v[148:151]
v_add_f32 v28, v28, v212
v_add_f32 v29, v29, v213
v_mfma_f32_16x16x32_bf16 v[152:155], a[36:39], v[72:75], v[152:155]
v_add_f32 v30, v30, v214
v_add_f32 v31, v31, v215
v_mfma_f32_16x16x32_bf16 v[156:159], a[40:43], v[72:75], v[156:159]
v_add_f32 v32, v32, v216
v_add_f32 v33, v33, v217
v_mfma_f32_16x16x32_bf16 v[160:163], a[44:47], v[72:75], v[160:163]
v_add_f32 v34, v34, v218
v_add_f32 v35, v35, v219
v_mfma_f32_16x16x32_bf16 v[164:167], a[48:51], v[72:75], v[164:167]
s_waitcnt vmcnt(10)
v_mfma_f32_16x16x32_bf16 v[148:151], a[52:55], v[76:79], v[148:151]
v_mfma_f32_16x16x32_bf16 v[152:155], a[56:59], v[76:79], v[152:155]
v_mfma_f32_16x16x32_bf16 v[156:159], a[60:63], v[76:79], v[156:159]
v_mfma_f32_16x16x32_bf16 v[160:163], a[64:67], v[76:79], v[160:163]
v_mfma_f32_16x16x32_bf16 v[164:167], a[68:71], v[76:79], v[164:167]
s_waitcnt vmcnt(9)
v_mfma_f32_16x16x32_bf16 v[148:151], a[72:75], v[80:83], v[148:151]
v_mfma_f32_16x16x32_bf16 v[152:155], a[76:79], v[80:83], v[152:155]
v_mfma_f32_16x16x32_bf16 v[156:159], a[80:83], v[80:83], v[156:159]
v_mfma_f32_16x16x32_bf16 v[160:163], a[84:87], v[80:83], v[160:163]
v_mfma_f32_16x16x32_bf16 v[164:167], a[88:91], v[80:83], v[164:167]
s_waitcnt vmcnt(8)
v_mfma_f32_16x16x32_bf16 v[148:151], a[92:95], v[84:87], v[148:151]
v_mfma_f32_16x16x32_bf16 v[152:155], a[96:99], v[84:87], v[152:155]
v_mfma_f32_16x16x32_bf16 v[156:159], a[100:103], v[84:87], v[156:159]
v_mfma_f32_16x16x32_bf16 v[160:163], a[104:107], v[84:87], v[160:163]
v_mfma_f32_16x16x32_bf16 v[164:167], a[108:111], v[84:87], v[164:167]
s_mov_b32 s64, 0xffff
s_mov_b32 s65, 0xffff
s_cbranch_vccnz Ls47
s_nop 0
v_pk_add_f32 v[16:17], v[16:17], v[148:149]
v_pk_add_f32 v[18:19], v[18:19], v[150:151]
v_pk_add_f32 v[20:21], v[20:21], v[152:153]
v_pk_add_f32 v[22:23], v[22:23], v[154:155]
v_pk_add_f32 v[24:25], v[24:25], v[156:157]
v_pk_add_f32 v[26:27], v[26:27], v[158:159]
v_pk_add_f32 v[28:29], v[28:29], v[160:161]
v_pk_add_f32 v[30:31], v[30:31], v[162:163]
v_pk_add_f32 v[32:33], v[32:33], v[164:165]
v_pk_add_f32 v[34:35], v[34:35], v[166:167]
v_cvt_pk_bf16_f32 v40, v16, v17
v_cvt_pk_bf16_f32 v41, v18, v19
v_cvt_pk_bf16_f32 v42, v20, v21
v_cvt_pk_bf16_f32 v43, v22, v23
v_cvt_pk_bf16_f32 v44, v24, v25
v_cvt_pk_bf16_f32 v45, v26, v27
v_cvt_pk_bf16_f32 v46, v28, v29
v_cvt_pk_bf16_f32 v47, v30, v31
v_cvt_pk_bf16_f32 v48, v32, v33
v_cvt_pk_bf16_f32 v49, v34, v35
v_cvt_pk_bf16_f32 v50, v32, v33
v_cvt_pk_bf16_f32 v51, v34, v35
buffer_store_dwordx4 v[40:43], v4, s[12:15], s34 offen
buffer_store_dwordx4 v[44:47], v4, s[12:15], s34 offen offset:2048
v_permlane16_swap_b32 v48, v50
v_permlane16_swap_b32 v49, v51
v_pk_add_f32 v[52:53], v[16:17], v[18:19]
v_pk_mul_f32 v[54:55], v[16:17], v[16:17]
v_pk_fma_f32 v[54:55], v[18:19], v[18:19], v[54:55]
v_pk_add_f32 v[52:53], v[52:53], v[20:21]
v_pk_fma_f32 v[54:55], v[20:21], v[20:21], v[54:55]
v_pk_add_f32 v[52:53], v[52:53], v[22:23]
v_pk_fma_f32 v[54:55], v[22:23], v[22:23], v[54:55]
v_pk_add_f32 v[52:53], v[52:53], v[24:25]
v_pk_fma_f32 v[54:55], v[24:25], v[24:25], v[54:55]
v_pk_add_f32 v[52:53], v[52:53], v[26:27]
v_pk_fma_f32 v[54:55], v[26:27], v[26:27], v[54:55]
v_pk_add_f32 v[52:53], v[52:53], v[28:29]
v_pk_fma_f32 v[54:55], v[28:29], v[28:29], v[54:55]
v_pk_add_f32 v[52:53], v[52:53], v[30:31]
v_pk_fma_f32 v[54:55], v[30:31], v[30:31], v[54:55]
v_pk_add_f32 v[52:53], v[52:53], v[32:33]
v_pk_fma_f32 v[54:55], v[32:33], v[32:33], v[54:55]
v_pk_add_f32 v[52:53], v[52:53], v[34:35]
v_pk_fma_f32 v[54:55], v[34:35], v[34:35], v[54:55]
v_add_f32 v52, v52, v53
v_add_f32 v54, v54, v55
s_mov_b64 exec, s[64:65]
buffer_store_dwordx4 v[48:51], v5, s[12:15], s34 offen
s_mov_b64 exec, -1
v_permlane32_swap_b32 v52, v54
v_add_f32 v53, v52, v54
v_add_f32 v52, v52, v54
s_nop 1
v_permlane16_swap_b32 v52, v53
v_add_f32 v52, v52, v53
s_mov_b64 exec, s[64:65]
buffer_store_dword v52, v7, s[4:7], s35 offen
s_mov_b64 exec, -1
Lt48:
s_mov_b32 s50, s32
v_lshrrev_b32 v36, 1, v1
v_and_b32 v36, 0x180, v36
v_and_b32 v15, 0x70, v1
v_add_u32 v36, v36, v15
v_add_u32 v36, 9216, v36
v_mov_b32 v15, 4
s_cmp_eq_u32 s18, 0
s_cbranch_scc1 Lo49
s_waitcnt vmcnt(0) lgkmcnt(0)
s_barrier
s_sub_u32 s60, s18, 1
s_mul_i32 s53, s60, 3072
s_add_u32 m0, s53, 11264
s_add_u32 s52, s28, s53
s_add_u32 s52, s52, 5120
buffer_load_dwordx4 v1, s[4:7], s52 offen offset:0 sc1 lds
buffer_load_dwordx4 v1, s[4:7], s52 offen offset:1024 sc1 lds
buffer_load_dwordx4 v1, s[4:7], s52 offen offset:2048 sc1 lds
s_mul_i32 s53, s60, 7168
s_add_u32 m0, s53, 97280
s_add_u32 s52, s28, s53
s_add_u32 s52, s52, 91136
buffer_load_dwordx4 v1, s[4:7], s52 offen offset:0 sc1 lds
buffer_load_dwordx4 v1, s[4:7], s52 offen offset:1024 sc1 lds
buffer_load_dwordx4 v1, s[4:7], s52 offen offset:2048 sc1 lds
buffer_load_dwordx4 v1, s[4:7], s52 offen offset:3072 sc1 lds
s_add_u32 m0, m0, 4096
s_add_u32 s52, s52, 4096
buffer_load_dwordx4 v1, s[4:7], s52 offen offset:0 sc1 lds
buffer_load_dwordx4 v1, s[4:7], s52 offen offset:1024 sc1 lds
buffer_load_dwordx4 v1, s[4:7], s52 offen offset:2048 sc1 lds
s_branch Lj50
Lr52_x:
s_add_u32 s57, s57, 1
s_cmp_lt_u32 s57, 1048576
s_cbranch_scc1 Lr52_0
s_mov_b64 vcc, 0
s_branch Lr52_d
Lo49:
s_cbranch_vccnz Lw51
s_mov_b32 s57, 0
s_mov_b64 exec, 1
s_waitcnt vmcnt(0) lgkmcnt(0)
s_barrier
buffer_store_dword v15, v12, s[4:7], s49 offen
s_mov_b64 exec, 0xffff
Lr52_0:
buffer_load_dword v15, v7, s[4:7], s23 offen sc1
Lr52_w:
s_waitcnt vmcnt(0)
v_cmp_gt_u32 vcc, 4, v15
s_nop 0
s_cbranch_vccnz Lr52_x
Lr52_d:
s_mov_b64 exec, -1
Lj50:
s_barrier
buffer_load_dwordx4 a[0:3], v4, s[12:15], s50 offen offset:0 sc1
buffer_load_dwordx4 a[4:7], v4, s[12:15], s50 offen offset:256 sc1
buffer_load_dwordx4 a[8:11], v4, s[12:15], s50 offen offset:2048 sc1
buffer_load_dwordx4 a[12:15], v4, s[12:15], s50 offen offset:2304 sc1
s_add_u32 s50, s50, 4096
buffer_load_dwordx4 a[16:19], v4, s[12:15], s50 offen offset:0 sc1
buffer_load_dwordx4 a[20:23], v4, s[12:15], s50 offen offset:256 sc1
buffer_load_dword v224, v6, s[4:7], s33 offen offset:0 sc1
buffer_load_dword v225, v6, s[4:7], s33 offen offset:128 sc1
buffer_load_dword v226, v6, s[4:7], s33 offen offset:256 sc1
buffer_load_dword v227, v6, s[4:7], s33 offen offset:384 sc1
buffer_load_dword v228, v6, s[4:7], s33 offen offset:512 sc1
buffer_load_dword v229, v6, s[4:7], s33 offen offset:640 sc1
buffer_load_dword v230, v6, s[4:7], s33 offen offset:768 sc1
buffer_load_dword v231, v6, s[4:7], s33 offen offset:896 sc1
buffer_load_dwordx4 a[24:27], v4, s[12:15], s50 offen offset:2048 sc1
buffer_load_dwordx4 a[28:31], v4, s[12:15], s50 offen offset:2304 sc1
s_add_u32 s50, s50, 4096
buffer_load_dwordx4 a[32:35], v4, s[12:15], s50 offen offset:0 sc1
buffer_load_dwordx4 a[36:39], v4, s[12:15], s50 offen offset:256 sc1
buffer_load_dwordx4 a[40:43], v4, s[12:15], s50 offen offset:2048 sc1
buffer_load_dwordx4 a[44:47], v4, s[12:15], s50 offen offset:2304 sc1
s_add_u32 s50, s50, 4096
buffer_load_dwordx4 a[48:51], v4, s[12:15], s50 offen offset:0 sc1
s_waitcnt vmcnt(19)
s_barrier
ds_read_b128 v[104:107], v1 offset:6144
ds_read_b128 v[108:111], v1 offset:7168
ds_read_b128 v[112:115], v1 offset:8192
ds_read_b128 v[116:119], v36 offset:0
ds_read_b128 v[120:123], v1 offset:9728
ds_read_b128 v[124:127], v1 offset:10752
s_waitcnt lgkmcnt(5)
v_mfma_f32_16x16x32_bf16 v[40:43], v[104:107], a[0:3], 0
buffer_load_dwordx4 a[52:55], v4, s[12:15], s50 offen offset:256 sc1
v_mfma_f32_16x16x32_bf16 v[44:47], v[104:107], a[4:7], 0
ds_read_b128 v[128:131], v1 offset:11776
s_waitcnt lgkmcnt(5)
v_mfma_f32_16x16x32_bf16 v[52:55], v[108:111], a[4:7], 0
v_mfma_f32_16x16x32_bf16 v[48:51], v[108:111], a[0:3], 0
s_waitcnt lgkmcnt(3)
ds_read_b128 v[132:135], v36 offset:3584
v_mfma_f32_16x16x32_bf16 v[56:59], v[112:115], a[0:3], 0
buffer_load_dwordx4 a[56:59], v4, s[12:15], s50 offen offset:2048 sc1
v_mfma_f32_16x16x32_bf16 v[60:63], v[112:115], a[4:7], 0
ds_read_b128 v[104:107], v1 offset:13312
v_mfma_f32_16x16x32_bf16 v[68:71], v[116:119], a[4:7], 0
ds_read_b128 v[136:139], v8 offset:0
v_mfma_f32_16x16x32_bf16 v[64:67], v[116:119], a[0:3], 0
s_waitcnt vmcnt(19) lgkmcnt(4)
ds_read_b128 v[108:111], v1 offset:14336
v_mfma_f32_16x16x32_bf16 v[40:43], v[120:123], a[8:11], v[40:43]
buffer_load_dwordx4 a[60:63], v4, s[12:15], s50 offen offset:2304 sc1
v_mfma_f32_16x16x32_bf16 v[44:47], v[120:123], a[12:15], v[44:47]
s_add_u32 s50, s50, 4096
ds_read_b128 v[112:115], v1 offset:15360
v_mfma_f32_16x16x32_bf16 v[52:55], v[124:127], a[12:15], v[52:55]
ds_read_b128 v[144:147], v8 offset:64
v_mfma_f32_16x16x32_bf16 v[48:51], v[124:127], a[8:11], v[48:51]
s_waitcnt lgkmcnt(5)
ds_read_b128 v[116:119], v36 offset:7168
v_mfma_f32_16x16x32_bf16 v[56:59], v[128:131], a[8:11], v[56:59]
buffer_load_dwordx4 a[64:67], v4, s[12:15], s50 offen offset:0 sc1
v_mfma_f32_16x16x32_bf16 v[60:63], v[128:131], a[12:15], v[60:63]
ds_read_b128 v[120:123], v1 offset:16896
v_mfma_f32_16x16x32_bf16 v[68:71], v[132:135], a[12:15], v[68:71]
ds_read_b128 v[152:155], v8 offset:128
v_mfma_f32_16x16x32_bf16 v[64:67], v[132:135], a[8:11], v[64:67]
s_waitcnt vmcnt(19) lgkmcnt(5)
ds_read_b128 v[124:127], v1 offset:17920
v_mfma_f32_16x16x32_bf16 v[40:43], v[104:107], a[16:19], v[40:43]
buffer_load_dwordx4 a[68:71], v4, s[12:15], s50 offen offset:256 sc1
v_mfma_f32_16x16x32_bf16 v[44:47], v[104:107], a[20:23], v[44:47]
ds_read_b128 v[128:131], v1 offset:18944
v_mfma_f32_16x16x32_bf16 v[52:55], v[108:111], a[20:23], v[52:55]
ds_read_b128 v[160:163], v8 offset:192
v_mfma_f32_16x16x32_bf16 v[48:51], v[108:111], a[16:19], v[48:51]
s_waitcnt lgkmcnt(5)
ds_read_b128 v[132:135], v36 offset:10752
v_mfma_f32_16x16x32_bf16 v[56:59], v[112:115], a[16:19], v[56:59]
buffer_load_dwordx4 a[72:75], v4, s[12:15], s50 offen offset:2048 sc1
v_mfma_f32_16x16x32_bf16 v[60:63], v[112:115], a[20:23], v[60:63]
ds_read_b128 v[104:107], v1 offset:20480
v_mfma_f32_16x16x32_bf16 v[68:71], v[116:119], a[20:23], v[68:71]
ds_read_b128 v[72:75], v8 offset:256
v_mfma_f32_16x16x32_bf16 v[64:67], v[116:119], a[16:19], v[64:67]
s_waitcnt vmcnt(11) lgkmcnt(5)
ds_read_b128 v[108:111], v1 offset:21504
v_mfma_f32_16x16x32_bf16 v[40:43], v[120:123], a[24:27], v[40:43]
buffer_load_dwordx4 a[76:79], v4, s[12:15], s50 offen offset:2304 sc1
v_mfma_f32_16x16x32_bf16 v[44:47], v[120:123], a[28:31], v[44:47]
s_add_u32 s50, s50, 4096
ds_read_b128 v[112:115], v1 offset:22528
v_add_f32 v224, v224, v225
v_mfma_f32_16x16x32_bf16 v[52:55], v[124:127], a[28:31], v[52:55]
ds_read_b128 v[80:83], v8 offset:320
v_add_f32 v226, v226, v227
v_mfma_f32_16x16x32_bf16 v[48:51], v[124:127], a[24:27], v[48:51]
s_waitcnt lgkmcnt(5)
ds_read_b128 v[116:119], v36 offset:14336
v_add_f32 v228, v228, v229
v_mfma_f32_16x16x32_bf16 v[56:59], v[128:131], a[24:27], v[56:59]
buffer_load_dwordx4 a[80:83], v4, s[12:15], s50 offen offset:0 sc1
v_mfma_f32_16x16x32_bf16 v[60:63], v[128:131], a[28:31], v[60:63]
ds_read_b128 v[120:123], v1 offset:24064
v_add_f32 v230, v230, v231
v_mfma_f32_16x16x32_bf16 v[68:71], v[132:135], a[28:31], v[68:71]
ds_read_b128 v[88:91], v8 offset:384
v_add_f32 v224, v224, v226
v_mfma_f32_16x16x32_bf16 v[64:67], v[132:135], a[24:27], v[64:67]
s_waitcnt vmcnt(11) lgkmcnt(5)
ds_read_b128 v[124:127], v1 offset:25088
v_add_f32 v228, v228, v230
v_mfma_f32_16x16x32_bf16 v[40:43], v[104:107], a[32:35], v[40:43]
buffer_load_dwordx4 a[84:87], v4, s[12:15], s50 offen offset:256 sc1
v_mfma_f32_16x16x32_bf16 v[44:47], v[104:107], a[36:39], v[44:47]
ds_read_b128 v[128:131], v1 offset:26112
v_add_f32 v224, v224, v228
v_mfma_f32_16x16x32_bf16 v[52:55], v[108:111], a[36:39], v[52:55]
ds_read_b128 v[96:99], v8 offset:448
v_mul_f32 v224, 986500301, v224
v_mfma_f32_16x16x32_bf16 v[48:51], v[108:111], a[32:35], v[48:51]
s_waitcnt lgkmcnt(5)
ds_read_b128 v[132:135], v36 offset:17920
v_mov_b32 v225, v224
v_mfma_f32_16x16x32_bf16 v[56:59], v[112:115], a[32:35], v[56:59]
buffer_load_dwordx4 a[88:91], v4, s[12:15], s50 offen offset:2048 sc1
v_mfma_f32_16x16x32_bf16 v[60:63], v[112:115], a[36:39], v[60:63]
ds_read_b128 v[104:107], v1 offset:27648
v_mfma_f32_16x16x32_bf16 v[68:71], v[116:119], a[36:39], v[68:71]
v_permlane32_swap_b32 v224, v225
v_mfma_f32_16x16x32_bf16 v[64:67], v[116:119], a[32:35], v[64:67]
s_waitcnt vmcnt(11) lgkmcnt(4)
ds_read_b128 v[108:111], v1 offset:28672
v_fma_f32 v225, -v224, v224, v225
v_mfma_f32_16x16x32_bf16 v[40:43], v[120:123], a[40:43], v[40:43]
buffer_load_dwordx4 a[92:95], v4, s[12:15], s50 offen offset:2304 sc1
v_mfma_f32_16x16x32_bf16 v[44:47], v[120:123], a[44:47], v[44:47]
s_add_u32 s50, s50, 4096
ds_read_b128 v[112:115], v1 offset:29696
v_max_f32 v225, 0, v225
v_mfma_f32_16x16x32_bf16 v[52:55], v[124:127], a[44:47], v[52:55]
v_add_f32 v225, 925353388, v225
v_mfma_f32_16x16x32_bf16 v[48:51], v[124:127], a[40:43], v[48:51]
s_waitcnt lgkmcnt(3)
ds_read_b128 v[116:119], v36 offset:21504
v_mfma_f32_16x16x32_bf16 v[56:59], v[128:131], a[40:43], v[56:59]
buffer_load_dwordx4 a[96:99], v4, s[12:15], s50 offen offset:0 sc1
v_mfma_f32_16x16x32_bf16 v[60:63], v[128:131], a[44:47], v[60:63]
ds_read_b128 v[120:123], v1 offset:31232
v_mfma_f32_16x16x32_bf16 v[68:71], v[132:135], a[44:47], v[68:71]
v_rsq_f32 v232, v225
v_mfma_f32_16x16x32_bf16 v[64:67], v[132:135], a[40:43], v[64:67]
s_waitcnt vmcnt(11) lgkmcnt(3)
ds_read_b128 v[124:127], v1 offset:32256
v_sub_f32 v230, 0, v224
v_mfma_f32_16x16x32_bf16 v[40:43], v[104:107], a[48:51], v[40:43]
buffer_load_dwordx4 a[100:103], v4, s[12:15], s50 offen offset:256 sc1
v_mfma_f32_16x16x32_bf16 v[44:47], v[104:107], a[52:55], v[44:47]
ds_read_b128 v[128:131], v1 offset:33280
v_mov_b32 v233, v232
v_mfma_f32_16x16x32_bf16 v[52:55], v[108:111], a[52:55], v[52:55]
v_mov_b32 v231, v230
v_lshrrev_b32 v224, 9, v1
v_mfma_f32_16x16x32_bf16 v[48:51], v[108:111], a[48:51], v[48:51]
s_waitcnt lgkmcnt(3)
ds_read_b128 v[132:135], v36 offset:25088
v_mfma_f32_16x16x32_bf16 v[56:59], v[112:115], a[48:51], v[56:59]
buffer_load_dwordx4 a[104:107], v4, s[12:15], s50 offen offset:2048 sc1
v_mfma_f32_16x16x32_bf16 v[60:63], v[112:115], a[52:55], v[60:63]
ds_read_b128 v[104:107], v1 offset:34816
v_mfma_f32_16x16x32_bf16 v[68:71], v[116:119], a[52:55], v[68:71]
v_permlane16_swap_b32 v232, v233
v_mfma_f32_16x16x32_bf16 v[64:67], v[116:119], a[48:51], v[64:67]
s_waitcnt vmcnt(11) lgkmcnt(3)
ds_read_b128 v[108:111], v1 offset:35840
v_mfma_f32_16x16x32_bf16 v[40:43], v[120:123], a[56:59], v[40:43]
buffer_load_dwordx4 a[108:111], v4, s[12:15], s50 offen offset:2304 sc1
v_mfma_f32_16x16x32_bf16 v[44:47], v[120:123], a[60:63], v[44:47]
s_add_u32 s50, s50, 4096
ds_read_b128 v[112:115], v1 offset:36864
v_mfma_f32_16x16x32_bf16 v[52:55], v[124:127], a[60:63], v[52:55]
v_permlane16_swap_b32 v230, v231
v_mfma_f32_16x16x32_bf16 v[48:51], v[124:127], a[56:59], v[48:51]
s_waitcnt lgkmcnt(3)
ds_read_b128 v[116:119], v36 offset:28672
v_mul_f32 v226, v230, v232
v_mfma_f32_16x16x32_bf16 v[56:59], v[128:131], a[56:59], v[56:59]
buffer_load_dwordx4 a[112:115], v4, s[12:15], s50 offen offset:0 sc1
v_mfma_f32_16x16x32_bf16 v[60:63], v[128:131], a[60:63], v[60:63]
ds_read_b128 v[120:123], v1 offset:38400
v_mul_f32 v227, v231, v233
v_mfma_f32_16x16x32_bf16 v[68:71], v[132:135], a[60:63], v[68:71]
v_mul_u32_u24 v234, 768, v224
v_sub_u32 v234, v4, v234
v_mfma_f32_16x16x32_bf16 v[64:67], v[132:135], a[56:59], v[64:67]
s_waitcnt vmcnt(11) lgkmcnt(3)
ds_read_b128 v[124:127], v1 offset:39424
v_sub_u32 v225, v9, v1
v_mfma_f32_16x16x32_bf16 v[40:43], v[104:107], a[64:67], v[40:43]
buffer_load_dwordx4 a[116:119], v4, s[12:15], s50 offen offset:256 sc1
v_mfma_f32_16x16x32_bf16 v[44:47], v[104:107], a[68:71], v[44:47]
ds_read_b128 v[128:131], v1 offset:40448
v_add_u32 v225, 25600, v225
v_mfma_f32_16x16x32_bf16 v[52:55], v[108:111], a[68:71], v[52:55]
v_add_u32 v238, v234, v225
v_add_u32 v237, v225, v39
v_mfma_f32_16x16x32_bf16 v[48:51], v[108:111], a[64:67], v[48:51]
s_waitcnt lgkmcnt(3)
ds_read_b128 v[132:135], v36 offset:32256
v_mov_b32 v210, 0x3f803f80
v_mfma_f32_16x16x32_bf16 v[56:59], v[112:115], a[64:67], v[56:59]
v_add_u32 v36, 32768, v36
v_mov_b32 v211, 0
v_mfma_f32_16x16x32_bf16 v[60:63], v[112:115], a[68:71], v[60:63]
ds_read_b128 v[104:107], v1 offset:41984
v_mov_b32 v222, 0x3f803f80
v_mfma_f32_16x16x32_bf16 v[68:71], v[116:119], a[68:71], v[68:71]
buffer_load_dwordx4 a[120:123], v4, s[12:15], s50 offen offset:2048 sc1
v_mfma_f32_16x16x32_bf16 v[64:67], v[116:119], a[64:67], v[64:67]
s_waitcnt vmcnt(11) lgkmcnt(3)
ds_read_b128 v[108:111], v1 offset:43008
v_mov_b32 v223, 0
v_mfma_f32_16x16x32_bf16 v[40:43], v[120:123], a[72:75], v[40:43]
s_add_u32 s56, s36, 3200
s_mov_b32 s72, 528482304
s_mov_b32 s73, 1602224128
v_mfma_f32_16x16x32_bf16 v[44:47], v[120:123], a[76:79], v[44:47]
ds_read_b128 v[112:115], v1 offset:44032
v_mul_f32 v140, v136, v227
v_mfma_f32_16x16x32_bf16 v[52:55], v[124:127], a[76:79], v[52:55]
buffer_load_dwordx4 a[124:127], v4, s[12:15], s50 offen offset:2304 sc1
v_mfma_f32_16x16x32_bf16 v[48:51], v[124:127], a[72:75], v[48:51]
s_waitcnt lgkmcnt(3)
ds_read_b128 v[116:119], v36 offset:3072
s_add_u32 s50, s50, 4096
v_mfma_f32_16x16x32_bf16 v[56:59], v[128:131], a[72:75], v[56:59]
v_mul_f32 v141, v137, v227
v_mul_f32 v142, v138, v227
v_mfma_f32_16x16x32_bf16 v[60:63], v[128:131], a[76:79], v[60:63]
ds_read_b128 v[120:123], v1 offset:45568
v_mul_f32 v143, v139, v227
v_mfma_f32_16x16x32_bf16 v[68:71], v[132:135], a[76:79], v[68:71]
buffer_load_dwordx4 a[128:131], v4, s[12:15], s50 offen offset:0 sc1
v_mfma_f32_16x16x32_bf16 v[64:67], v[132:135], a[72:75], v[64:67]
s_waitcnt vmcnt(11) lgkmcnt(3)
ds_read_b128 v[124:127], v1 offset:46592
v_mul_f32 v136, v136, v226
v_mfma_f32_16x16x32_bf16 v[40:43], v[104:107], a[80:83], v[40:43]
v_mul_f32 v137, v137, v226
v_mul_f32 v138, v138, v226
v_mfma_f32_16x16x32_bf16 v[44:47], v[104:107], a[84:87], v[44:47]
ds_read_b128 v[128:131], v1 offset:47616
v_mul_f32 v139, v139, v226
v_mfma_f32_16x16x32_bf16 v[52:55], v[108:111], a[84:87], v[52:55]
buffer_load_dwordx4 a[132:135], v4, s[12:15], s50 offen offset:256 sc1
v_mfma_f32_16x16x32_bf16 v[48:51], v[108:111], a[80:83], v[48:51]
s_waitcnt lgkmcnt(3)
ds_read_b128 v[132:135], v36 offset:6656
v_mul_f32 v148, v144, v227
v_mfma_f32_16x16x32_bf16 v[56:59], v[112:115], a[80:83], v[56:59]
v_mul_f32 v149, v145, v227
v_mul_f32 v150, v146, v227
v_mfma_f32_16x16x32_bf16 v[60:63], v[112:115], a[84:87], v[60:63]
ds_read_b128 v[104:107], v1 offset:49152
v_mul_f32 v151, v147, v227
v_mfma_f32_16x16x32_bf16 v[68:71], v[116:119], a[84:87], v[68:71]
buffer_load_dwordx4 a[136:139], v4, s[12:15], s50 offen offset:2048 sc1
v_mfma_f32_16x16x32_bf16 v[64:67], v[116:119], a[80:83], v[64:67]
s_waitcnt vmcnt(11) lgkmcnt(3)
ds_read_b128 v[108:111], v1 offset:50176
v_mul_f32 v144, v144, v226
v_mfma_f32_16x16x32_bf16 v[40:43], v[120:123], a[88:91], v[40:43]
v_mul_f32 v145, v145, v226
v_mul_f32 v146, v146, v226
v_mfma_f32_16x16x32_bf16 v[44:47], v[120:123], a[92:95], v[44:47]
ds_read_b128 v[112:115], v1 offset:51200
v_mul_f32 v147, v147, v226
v_mfma_f32_16x16x32_bf16 v[52:55], v[124:127], a[92:95], v[52:55]
buffer_load_dwordx4 a[140:143], v4, s[12:15], s50 offen offset:2304 sc1
v_mfma_f32_16x16x32_bf16 v[48:51], v[124:127], a[88:91], v[48:51]
s_waitcnt lgkmcnt(3)
ds_read_b128 v[116:119], v36 offset:10240
s_add_u32 s50, s50, 4096
v_mfma_f32_16x16x32_bf16 v[56:59], v[128:131], a[88:91], v[56:59]
v_mul_f32 v156, v152, v227
v_mul_f32 v157, v153, v227
v_mfma_f32_16x16x32_bf16 v[60:63], v[128:131], a[92:95], v[60:63]
ds_read_b128 v[120:123], v1 offset:52736
v_mul_f32 v158, v154, v227
v_mfma_f32_16x16x32_bf16 v[68:71], v[132:135], a[92:95], v[68:71]
buffer_load_dwordx4 a[144:147], v4, s[12:15], s50 offen offset:0 sc1
v_mfma_f32_16x16x32_bf16 v[64:67], v[132:135], a[88:91], v[64:67]
s_waitcnt vmcnt(11) lgkmcnt(3)
ds_read_b128 v[124:127], v1 offset:53760
v_mul_f32 v159, v155, v227
v_mfma_f32_16x16x32_bf16 v[40:43], v[104:107], a[96:99], v[40:43]
v_mul_f32 v152, v152, v226
v_mul_f32 v153, v153, v226
v_mfma_f32_16x16x32_bf16 v[44:47], v[104:107], a[100:103], v[44:47]
ds_read_b128 v[128:131], v1 offset:54784
v_mul_f32 v154, v154, v226
v_mfma_f32_16x16x32_bf16 v[52:55], v[108:111], a[100:103], v[52:55]
buffer_load_dwordx4 a[148:151], v4, s[12:15], s50 offen offset:256 sc1
v_mfma_f32_16x16x32_bf16 v[48:51], v[108:111], a[96:99], v[48:51]
s_waitcnt lgkmcnt(3)
ds_read_b128 v[132:135], v36 offset:13824
v_mul_f32 v155, v155, v226
v_mfma_f32_16x16x32_bf16 v[56:59], v[112:115], a[96:99], v[56:59]
v_mul_f32 v76, v72, v231
v_mul_f32 v77, v73, v231
v_mfma_f32_16x16x32_bf16 v[60:63], v[112:115], a[100:103], v[60:63]
ds_read_b128 v[104:107], v1 offset:56320
v_mul_f32 v78, v74, v231
v_mfma_f32_16x16x32_bf16 v[68:71], v[116:119], a[100:103], v[68:71]
buffer_load_dwordx4 a[152:155], v4, s[12:15], s50 offen offset:2048 sc1
v_mfma_f32_16x16x32_bf16 v[64:67], v[116:119], a[96:99], v[64:67]
s_waitcnt vmcnt(11) lgkmcnt(3)
ds_read_b128 v[108:111], v1 offset:57344
v_mul_f32 v79, v75, v231
v_mfma_f32_16x16x32_bf16 v[40:43], v[120:123], a[104:107], v[40:43]
v_mul_f32 v72, v72, v230
v_mul_f32 v73, v73, v230
v_mfma_f32_16x16x32_bf16 v[44:47], v[120:123], a[108:111], v[44:47]
ds_read_b128 v[112:115], v1 offset:58368
v_mul_f32 v74, v74, v230
v_mfma_f32_16x16x32_bf16 v[52:55], v[124:127], a[108:111], v[52:55]
buffer_load_dwordx4 a[156:159], v4, s[12:15], s50 offen offset:2304 sc1
v_mfma_f32_16x16x32_bf16 v[48:51], v[124:127], a[104:107], v[48:51]
s_waitcnt lgkmcnt(3)
ds_read_b128 v[116:119], v36 offset:17408
s_mul_i32 s53, s18, 8192
v_mfma_f32_16x16x32_bf16 v[56:59], v[128:131], a[104:107], v[56:59]
s_add_u32 m0, s53, 118784
v_mul_f32 v75, v75, v230
s_add_u32 s52, s28, s53
v_mfma_f32_16x16x32_bf16 v[60:63], v[128:131], a[108:111], v[60:63]
s_add_u32 s52, s52, 112640
ds_read_b128 v[120:123], v1 offset:59904
v_mul_f32 v84, v80, v231
v_mfma_f32_16x16x32_bf16 v[68:71], v[132:135], a[108:111], v[68:71]
buffer_load_dwordx4 v1, s[4:7], s52 offen offset:0 sc1 lds
v_mfma_f32_16x16x32_bf16 v[64:67], v[132:135], a[104:107], v[64:67]
s_waitcnt vmcnt(11) lgkmcnt(3)
ds_read_b128 v[124:127], v1 offset:60928
v_mul_f32 v85, v81, v231
v_mfma_f32_16x16x32_bf16 v[40:43], v[104:107], a[112:115], v[40:43]
v_mul_f32 v86, v82, v231
v_mul_f32 v87, v83, v231
v_mfma_f32_16x16x32_bf16 v[44:47], v[104:107], a[116:119], v[44:47]
ds_read_b128 v[128:131], v1 offset:61952
v_mul_f32 v80, v80, v230
v_mfma_f32_16x16x32_bf16 v[52:55], v[108:111], a[116:119], v[52:55]
buffer_load_dwordx4 v1, s[4:7], s52 offen offset:1024 sc1 lds
v_mfma_f32_16x16x32_bf16 v[48:51], v[108:111], a[112:115], v[48:51]
s_waitcnt lgkmcnt(3)
ds_read_b128 v[132:135], v36 offset:20992
v_mul_f32 v81, v81, v230
v_mfma_f32_16x16x32_bf16 v[56:59], v[112:115], a[112:115], v[56:59]
v_mul_f32 v82, v82, v230
v_mul_f32 v83, v83, v230
v_mfma_f32_16x16x32_bf16 v[60:63], v[112:115], a[116:119], v[60:63]
ds_read_b128 v[104:107], v1 offset:63488
v_mul_f32 v92, v88, v231
v_mfma_f32_16x16x32_bf16 v[68:71], v[116:119], a[116:119], v[68:71]
buffer_load_dwordx4 v1, s[4:7], s52 offen offset:2048 sc1 lds
v_mfma_f32_16x16x32_bf16 v[64:67], v[116:119], a[112:115], v[64:67]
s_waitcnt vmcnt(11) lgkmcnt(3)
ds_read_b128 v[108:111], v1 offset:64512
v_mul_f32 v93, v89, v231
v_mfma_f32_16x16x32_bf16 v[40:43], v[120:123], a[120:123], v[40:43]
v_mul_f32 v94, v90, v231
v_mul_f32 v95, v91, v231
v_mfma_f32_16x16x32_bf16 v[44:47], v[120:123], a[124:127], v[44:47]
ds_read_b128 v[112:115], v2 offset:0
v_mul_f32 v88, v88, v230
v_mfma_f32_16x16x32_bf16 v[52:55], v[124:127], a[124:127], v[52:55]
buffer_load_dwordx4 v1, s[4:7], s52 offen offset:3072 sc1 lds
v_mfma_f32_16x16x32_bf16 v[48:51], v[124:127], a[120:123], v[48:51]
s_waitcnt lgkmcnt(3)
ds_read_b128 v[116:119], v36 offset:24576
v_mul_f32 v89, v89, v230
v_mfma_f32_16x16x32_bf16 v[56:59], v[128:131], a[120:123], v[56:59]
s_add_u32 m0, m0, 4096
v_mul_f32 v90, v90, v230
s_add_u32 s52, s52, 4096
v_mfma_f32_16x16x32_bf16 v[60:63], v[128:131], a[124:127], v[60:63]
ds_read_b128 v[120:123], v2 offset:1536
v_mul_f32 v91, v91, v230
v_mfma_f32_16x16x32_bf16 v[68:71], v[132:135], a[124:127], v[68:71]
v_mul_f32 v100, v96, v231
v_mul_f32 v101, v97, v231
v_mfma_f32_16x16x32_bf16 v[64:67], v[132:135], a[120:123], v[64:67]
s_waitcnt vmcnt(10) lgkmcnt(3)
ds_read_b128 v[124:127], v2 offset:2560
v_mul_f32 v102, v98, v231
v_mfma_f32_16x16x32_bf16 v[40:43], v[104:107], a[128:131], v[40:43]
buffer_load_dwordx4 v1, s[4:7], s52 offen offset:0 sc1 lds
v_mfma_f32_16x16x32_bf16 v[44:47], v[104:107], a[132:135], v[44:47]
ds_read_b128 v[128:131], v2 offset:3584
v_mul_f32 v103, v99, v231
v_mfma_f32_16x16x32_bf16 v[52:55], v[108:111], a[132:135], v[52:55]
v_mul_f32 v96, v96, v230
v_mul_f32 v97, v97, v230
v_mfma_f32_16x16x32_bf16 v[48:51], v[108:111], a[128:131], v[48:51]
s_waitcnt lgkmcnt(3)
ds_read_b128 v[132:135], v36 offset:28160
v_mul_f32 v98, v98, v230
v_mfma_f32_16x16x32_bf16 v[56:59], v[112:115], a[128:131], v[56:59]
v_mul_f32 v99, v99, v230
v_mul_f32 v230, 1051011932, v232
v_mfma_f32_16x16x32_bf16 v[60:63], v[112:115], a[132:135], v[60:63]
ds_read_b128 v[104:107], v2 offset:5120
v_mul_f32 v228, 1051011932, v226
v_mfma_f32_16x16x32_bf16 v[68:71], v[116:119], a[132:135], v[68:71]
buffer_load_dwordx4 v1, s[4:7], s52 offen offset:1024 sc1 lds
v_mfma_f32_16x16x32_bf16 v[64:67], v[116:119], a[128:131], v[64:67]
s_waitcnt vmcnt(10) lgkmcnt(3)
ds_read_b128 v[108:111], v2 offset:6144
v_mul_f32 v231, 1051011932, v233
v_mfma_f32_16x16x32_bf16 v[40:43], v[120:123], a[136:139], v[40:43]
v_mul_f32 v229, 1051011932, v227
v_mov_b32 v224, 61769
v_mfma_f32_16x16x32_bf16 v[44:47], v[120:123], a[140:143], v[44:47]
ds_read_b128 v[112:115], v2 offset:7168
v_cndmask_b32 v247, v224, 0, s[44:45]
v_mfma_f32_16x16x32_bf16 v[52:55], v[124:127], a[140:143], v[52:55]
v_cndmask_b32 v255, v224, 0, s[44:45]
v_add_u32 v239, 38400, v9
v_mfma_f32_16x16x32_bf16 v[48:51], v[124:127], a[136:139], v[48:51]
s_waitcnt lgkmcnt(3)
ds_read_b128 v[116:119], v36 offset:31744
v_add_u32 v38, 38400, v10
v_mfma_f32_16x16x32_bf16 v[56:59], v[128:131], a[136:139], v[56:59]
buffer_load_dwordx4 v1, s[4:7], s52 offen offset:2048 sc1 lds
v_mfma_f32_16x16x32_bf16 v[60:63], v[128:131], a[140:143], v[60:63]
ds_read_b128 v[120:123], v2 offset:8704
v_mul_f32 v164, v160, v229
v_mfma_f32_16x16x32_bf16 v[68:71], v[132:135], a[140:143], v[68:71]
v_mul_f32 v165, v161, v229
v_mul_f32 v166, v162, v229
v_mfma_f32_16x16x32_bf16 v[64:67], v[132:135], a[136:139], v[64:67]
s_waitcnt vmcnt(9) lgkmcnt(3)
ds_read_b128 v[124:127], v2 offset:9728
v_mul_f32 v167, v163, v229
v_mfma_f32_16x16x32_bf16 v[40:43], v[104:107], a[144:147], v[40:43]
v_mul_f32 v160, v160, v228
v_mul_f32 v161, v161, v228
v_mfma_f32_16x16x32_bf16 v[44:47], v[104:107], a[148:151], v[44:47]
ds_read_b128 v[128:131], v2 offset:10752
v_mul_f32 v162, v162, v228
v_mfma_f32_16x16x32_bf16 v[52:55], v[108:111], a[148:151], v[52:55]
buffer_load_dwordx4 v1, s[4:7], s52 offen offset:3072 sc1 lds
v_mfma_f32_16x16x32_bf16 v[48:51], v[108:111], a[144:147], v[48:51]
s_waitcnt lgkmcnt(3)
ds_read_b128 v[132:135], v36 offset:35328
v_mul_f32 v163, v163, v228
v_mfma_f32_16x16x32_bf16 v[56:59], v[112:115], a[144:147], v[56:59]
v_mfma_f32_16x16x32_bf16 v[60:63], v[112:115], a[148:151], v[60:63]
ds_read_b128 v[104:107], v2 offset:12288
v_mfma_f32_16x16x32_bf16 v[68:71], v[116:119], a[148:151], v[68:71]
v_mfma_f32_16x16x32_bf16 v[64:67], v[116:119], a[144:147], v[64:67]
s_waitcnt vmcnt(8) lgkmcnt(3)
ds_read_b128 v[108:111], v2 offset:13312
v_mfma_f32_16x16x32_bf16 v[40:43], v[120:123], a[152:155], v[40:43]
v_mfma_f32_16x16x32_bf16 v[44:47], v[120:123], a[156:159], v[44:47]
ds_read_b128 v[112:115], v2 offset:14336
v_mfma_f32_16x16x32_bf16 v[52:55], v[124:127], a[156:159], v[52:55]
v_mfma_f32_16x16x32_bf16 v[48:51], v[124:127], a[152:155], v[48:51]
s_waitcnt lgkmcnt(3)
ds_read_b128 v[116:119], v2 offset:15360
v_mfma_f32_16x16x32_bf16 v[56:59], v[128:131], a[152:155], v[56:59]
v_mfma_f32_16x16x32_bf16 v[60:63], v[128:131], a[156:159], v[60:63]
ds_read_b128 v[120:123], v2 offset:16384
v_mfma_f32_16x16x32_bf16 v[68:71], v[132:135], a[156:159], v[68:71]
v_mfma_f32_16x16x32_bf16 v[64:67], v[132:135], a[152:155], v[64:67]
ds_read_b128 v[124:127], v2 offset:17408
s_barrier
v_pk_fma_f32 v[40:41], v[40:41], v[232:233], v[136:137] op_sel:[0,0,0] op_sel_hi:[1,0,1]
v_pk_fma_f32 v[42:43], v[42:43], v[232:233], v[138:139] op_sel:[0,0,0] op_sel_hi:[1,0,1]
v_cvt_pk_bf16_f32 v200, v40, v41
v_cvt_pk_bf16_f32 v201, v42, v43
v_pk_fma_f32 v[48:49], v[48:49], v[232:233], v[144:145] op_sel:[0,0,0] op_sel_hi:[1,0,1]
v_pk_fma_f32 v[50:51], v[50:51], v[232:233], v[146:147] op_sel:[0,0,0] op_sel_hi:[1,0,1]
v_cvt_pk_bf16_f32 v202, v48, v49
v_cvt_pk_bf16_f32 v203, v50, v51
buffer_store_dwordx4 v[200:203], v39, s[4:7], s36 offen offset:0 sc1
v_pk_fma_f32 v[56:57], v[56:57], v[232:233], v[152:153] op_sel:[0,0,0] op_sel_hi:[1,0,1]
v_pk_fma_f32 v[58:59], v[58:59], v[232:233], v[154:155] op_sel:[0,0,0] op_sel_hi:[1,0,1]
v_cvt_pk_bf16_f32 v208, v56, v57
v_cvt_pk_bf16_f32 v209, v58, v59
v_pk_fma_f32 v[60:61], v[60:61], v[232:233], v[156:157] op_sel:[0,1,0] op_sel_hi:[1,1,1]
v_pk_fma_f32 v[62:63], v[62:63], v[232:233], v[158:159] op_sel:[0,1,0] op_sel_hi:[1,1,1]
v_cvt_pk_bf16_f32 v220, v60, v61
v_cvt_pk_bf16_f32 v221, v62, v63
v_pk_fma_f32 v[44:45], v[44:45], v[232:233], v[140:141] op_sel:[0,1,0] op_sel_hi:[1,1,1]
v_pk_fma_f32 v[46:47], v[46:47], v[232:233], v[142:143] op_sel:[0,1,0] op_sel_hi:[1,1,1]
v_cvt_pk_bf16_f32 v204, v44, v45
v_cvt_pk_bf16_f32 v205, v46, v47
v_permlane32_swap_b32 v208, v220
v_permlane32_swap_b32 v209, v221
v_pk_fma_f32 v[52:53], v[52:53], v[232:233], v[148:149] op_sel:[0,1,0] op_sel_hi:[1,1,1]
v_pk_fma_f32 v[54:55], v[54:55], v[232:233], v[150:151] op_sel:[0,1,0] op_sel_hi:[1,1,1]
v_cvt_pk_bf16_f32 v206, v52, v53
v_cvt_pk_bf16_f32 v207, v54, v55
buffer_store_dwordx4 v[204:207], v39, s[4:7], s36 offen offset:256 sc1
buffer_store_dwordx4 v[208:211], v234, s[4:7], s36 offen offset:2176 sc1
s_waitcnt lgkmcnt(5)
v_mfma_f32_16x16x32_bf16 v[72:75], v[104:107], a[0:3], v[72:75]
v_fma_f32 v64, v64, v230, v160
v_fma_f32 v65, v65, v230, v161
v_mfma_f32_16x16x32_bf16 v[76:79], v[104:107], a[4:7], v[76:79]
ds_read_b128 v[128:131], v2 offset:18432
v_fma_f32 v66, v66, v230, v162
s_waitcnt lgkmcnt(5)
v_mfma_f32_16x16x32_bf16 v[84:87], v[108:111], a[4:7], v[84:87]
v_fma_f32 v67, v67, v230, v163
v_cvt_pk_bf16_f32 v244, v64, v65
v_mfma_f32_16x16x32_bf16 v[80:83], v[108:111], a[0:3], v[80:83]
s_waitcnt lgkmcnt(3)
ds_read_b128 v[132:135], v2 offset:19456
v_cvt_pk_bf16_f32 v245, v66, v67
v_mfma_f32_16x16x32_bf16 v[72:75], v[112:115], a[8:11], v[72:75]
v_fma_f32 v68, v68, v231, v164
v_fma_f32 v69, v69, v231, v165
v_mfma_f32_16x16x32_bf16 v[76:79], v[112:115], a[12:15], v[76:79]
ds_read_b128 v[104:107], v2 offset:20480
v_fma_f32 v70, v70, v231, v166
v_mfma_f32_16x16x32_bf16 v[84:87], v[116:119], a[12:15], v[84:87]
v_fma_f32 v71, v71, v231, v167
v_cvt_pk_bf16_f32 v252, v68, v69
v_mfma_f32_16x16x32_bf16 v[80:83], v[116:119], a[8:11], v[80:83]
s_waitcnt lgkmcnt(3)
ds_read_b128 v[108:111], v2 offset:21504
s_mul_i32 s53, s18, 2048
v_mfma_f32_16x16x32_bf16 v[72:75], v[120:123], a[16:19], v[72:75]
s_add_u32 m0, s53, 151552
v_cvt_pk_bf16_f32 v253, v70, v71
s_add_u32 s52, s28, s53
v_mfma_f32_16x16x32_bf16 v[76:79], v[120:123], a[20:23], v[76:79]
s_add_u32 s52, s52, 145408
ds_read_b128 v[112:115], v2 offset:22528
v_lshrrev_b32 v224, 9, v1
v_mfma_f32_16x16x32_bf16 v[84:87], v[124:127], a[20:23], v[84:87]
buffer_load_dwordx4 v1, s[4:7], s52 offen offset:0 sc1 lds
v_mfma_f32_16x16x32_bf16 v[80:83], v[124:127], a[16:19], v[80:83]
s_waitcnt lgkmcnt(3)
ds_read_b128 v[116:119], v2 offset:23552
v_lshlrev_b32 v224, 2, v224
v_mfma_f32_16x16x32_bf16 v[72:75], v[128:131], a[24:27], v[72:75]
v_bfe_u32 v225, v1, 4, 5
v_sub_u32 v224, v225, v224
v_mfma_f32_16x16x32_bf16 v[76:79], v[128:131], a[28:31], v[76:79]
ds_read_b128 v[120:123], v2 offset:24576
v_mov_b32 v225, 4048155338
v_mfma_f32_16x16x32_bf16 v[84:87], v[132:135], a[28:31], v[84:87]
buffer_load_dwordx4 v1, s[4:7], s52 offen offset:1024 sc1 lds
v_mfma_f32_16x16x32_bf16 v[80:83], v[132:135], a[24:27], v[80:83]
s_waitcnt lgkmcnt(3)
ds_read_b128 v[124:127], v2 offset:25600
v_mfma_f32_16x16x32_bf16 v[72:75], v[104:107], a[32:35], v[72:75]
ds_write_b128 v237, v[200:203] offset:0
v_mfma_f32_16x16x32_bf16 v[76:79], v[104:107], a[36:39], v[76:79]
ds_read_b128 v[128:131], v2 offset:26624
v_mfma_f32_16x16x32_bf16 v[84:87], v[108:111], a[36:39], v[84:87]
v_permlane16_swap_b32 v244, v252
v_mfma_f32_16x16x32_bf16 v[80:83], v[108:111], a[32:35], v[80:83]
s_waitcnt lgkmcnt(4)
ds_read_b128 v[132:135], v2 offset:27648
v_mfma_f32_16x16x32_bf16 v[72:75], v[112:115], a[40:43], v[72:75]
v_permlane16_swap_b32 v245, v253
v_mfma_f32_16x16x32_bf16 v[76:79], v[112:115], a[44:47], v[76:79]
ds_read_b128 v[104:107], v2 offset:28672
v_cndmask_b32 v244, v244, 0, s[44:45]
v_mfma_f32_16x16x32_bf16 v[84:87], v[116:119], a[44:47], v[84:87]
v_cndmask_b32 v245, v245, 0, s[44:45]
v_cndmask_b32 v252, v252, 0, s[44:45]
v_mfma_f32_16x16x32_bf16 v[80:83], v[116:119], a[40:43], v[80:83]
s_waitcnt lgkmcnt(4)
ds_read_b128 v[108:111], v2 offset:29696
v_cndmask_b32 v253, v253, 0, s[44:45]
v_mfma_f32_16x16x32_bf16 v[72:75], v[120:123], a[48:51], v[72:75]
ds_write_b128 v237, v[204:207] offset:256
v_mfma_f32_16x16x32_bf16 v[76:79], v[120:123], a[52:55], v[76:79]
ds_read_b128 v[112:115], v2 offset:30720
v_cmp_le_i32 s[62:63], 0, v224
v_mfma_f32_16x16x32_bf16 v[84:87], v[124:127], a[52:55], v[84:87]
v_cmp_le_i32 s[64:65], 1, v224
v_cndmask_b32 v136, 0, v225, s[62:63]
v_mfma_f32_16x16x32_bf16 v[80:83], v[124:127], a[48:51], v[80:83]
s_waitcnt lgkmcnt(4)
ds_read_b128 v[116:119], v2 offset:31744
v_cndmask_b32 v152, v225, 0, s[62:63]
v_mfma_f32_16x16x32_bf16 v[72:75], v[128:131], a[56:59], v[72:75]
v_cmp_le_i32 s[62:63], 2, v224
v_cndmask_b32 v137, 0, v225, s[64:65]
v_mfma_f32_16x16x32_bf16 v[76:79], v[128:131], a[60:63], v[76:79]
ds_read_b128 v[120:123], v2 offset:32768
v_cndmask_b32 v153, v225, 0, s[64:65]
v_mfma_f32_16x16x32_bf16 v[84:87], v[132:135], a[60:63], v[84:87]
v_cmp_le_i32 s[64:65], 3, v224
v_cndmask_b32 v138, 0, v225, s[62:63]
v_mfma_f32_16x16x32_bf16 v[80:83], v[132:135], a[56:59], v[80:83]
s_waitcnt lgkmcnt(4)
ds_read_b128 v[124:127], v2 offset:33792
v_cndmask_b32 v154, v225, 0, s[62:63]
v_mfma_f32_16x16x32_bf16 v[72:75], v[104:107], a[64:67], v[72:75]
ds_write_b128 v238, v[208:211] offset:2176
v_mfma_f32_16x16x32_bf16 v[76:79], v[104:107], a[68:71], v[76:79]
ds_read_b128 v[128:131], v2 offset:34816
v_cmp_le_i32 s[62:63], 8, v224
v_mfma_f32_16x16x32_bf16 v[84:87], v[108:111], a[68:71], v[84:87]
v_cndmask_b32 v139, 0, v225, s[64:65]
v_cndmask_b32 v155, v225, 0, s[64:65]
v_mfma_f32_16x16x32_bf16 v[80:83], v[108:111], a[64:67], v[80:83]
s_waitcnt lgkmcnt(4)
ds_read_b128 v[132:135], v2 offset:35840
v_cmp_le_i32 s[64:65], 9, v224
v_mfma_f32_16x16x32_bf16 v[72:75], v[112:115], a[72:75], v[72:75]
v_cndmask_b32 v140, 0, v225, s[62:63]
v_cndmask_b32 v156, v225, 0, s[62:63]
v_mfma_f32_16x16x32_bf16 v[76:79], v[112:115], a[76:79], v[76:79]
ds_read_b128 v[104:107], v2 offset:36864
v_cmp_le_i32 s[62:63], 10, v224
v_mfma_f32_16x16x32_bf16 v[84:87], v[116:119], a[76:79], v[84:87]
v_cndmask_b32 v141, 0, v225, s[64:65]
v_cndmask_b32 v157, v225, 0, s[64:65]
v_mfma_f32_16x16x32_bf16 v[80:83], v[116:119], a[72:75], v[80:83]
s_waitcnt lgkmcnt(4)
ds_read_b128 v[108:111], v2 offset:37888
v_cmp_le_i32 s[64:65], 11, v224
v_mfma_f32_16x16x32_bf16 v[72:75], v[120:123], a[80:83], v[72:75]
ds_write_b128 v238, v[220:223] offset:40576
v_mfma_f32_16x16x32_bf16 v[76:79], v[120:123], a[84:87], v[76:79]
ds_read_b128 v[112:115], v2 offset:38912
v_cndmask_b32 v142, 0, v225, s[62:63]
v_mfma_f32_16x16x32_bf16 v[84:87], v[124:127], a[84:87], v[84:87]
v_cndmask_b32 v158, v225, 0, s[62:63]
v_cmp_le_i32 s[62:63], 16, v224
v_mfma_f32_16x16x32_bf16 v[80:83], v[124:127], a[80:83], v[80:83]
s_waitcnt lgkmcnt(4)
ds_read_b128 v[116:119], v2 offset:39936
v_cndmask_b32 v143, 0, v225, s[64:65]
v_mfma_f32_16x16x32_bf16 v[72:75], v[128:131], a[88:91], v[72:75]
s_waitcnt vmcnt(2)
s_mov_b64 exec, 1
buffer_atomic_add v13, v12, s[4:7], s25 offen sc1
s_mov_b64 exec, -1
v_mfma_f32_16x16x32_bf16 v[76:79], v[128:131], a[92:95], v[76:79]
ds_read_b128 v[120:123], v2 offset:40960
v_cndmask_b32 v159, v225, 0, s[64:65]
v_mfma_f32_16x16x32_bf16 v[84:87], v[132:135], a[92:95], v[84:87]
v_cmp_le_i32 s[64:65], 17, v224
v_cndmask_b32 v144, 0, v225, s[62:63]
v_mfma_f32_16x16x32_bf16 v[80:83], v[132:135], a[88:91], v[80:83]
s_waitcnt lgkmcnt(4)
ds_read_b128 v[124:127], v2 offset:41984
v_cndmask_b32 v160, v225, 0, s[62:63]
v_mfma_f32_16x16x32_bf16 v[72:75], v[104:107], a[96:99], v[72:75]
v_cmp_le_i32 s[62:63], 18, v224
v_cndmask_b32 v145, 0, v225, s[64:65]
v_mfma_f32_16x16x32_bf16 v[76:79], v[104:107], a[100:103], v[76:79]
ds_read_b128 v[128:131], v2 offset:43008
v_cndmask_b32 v161, v225, 0, s[64:65]
v_mfma_f32_16x16x32_bf16 v[84:87], v[108:111], a[100:103], v[84:87]
v_cmp_le_i32 s[64:65], 19, v224
v_cndmask_b32 v146, 0, v225, s[62:63]
v_mfma_f32_16x16x32_bf16 v[80:83], v[108:111], a[96:99], v[80:83]
s_waitcnt lgkmcnt(3)
ds_read_b128 v[132:135], v2 offset:44032
v_cndmask_b32 v162, v225, 0, s[62:63]
v_mfma_f32_16x16x32_bf16 v[72:75], v[112:115], a[104:107], v[72:75]
v_cmp_le_i32 s[62:63], 24, v224
v_cndmask_b32 v147, 0, v225, s[64:65]
v_mfma_f32_16x16x32_bf16 v[76:79], v[112:115], a[108:111], v[76:79]
ds_read_b128 v[104:107], v2 offset:45056
v_cndmask_b32 v163, v225, 0, s[64:65]
v_mfma_f32_16x16x32_bf16 v[84:87], v[116:119], a[108:111], v[84:87]
v_cmp_le_i32 s[64:65], 25, v224
v_cndmask_b32 v148, 0, v225, s[62:63]
v_mfma_f32_16x16x32_bf16 v[80:83], v[116:119], a[104:107], v[80:83]
s_waitcnt lgkmcnt(3)
ds_read_b128 v[108:111], v2 offset:46080
v_cndmask_b32 v164, v225, 0, s[62:63]
v_mfma_f32_16x16x32_bf16 v[72:75], v[120:123], a[112:115], v[72:75]
v_cmp_le_i32 s[62:63], 26, v224
v_cndmask_b32 v149, 0, v225, s[64:65]
v_mfma_f32_16x16x32_bf16 v[76:79], v[120:123], a[116:119], v[76:79]
ds_read_b128 v[112:115], v2 offset:47104
v_cndmask_b32 v165, v225, 0, s[64:65]
v_mfma_f32_16x16x32_bf16 v[84:87], v[124:127], a[116:119], v[84:87]
v_cmp_le_i32 s[64:65], 27, v224
v_cndmask_b32 v150, 0, v225, s[62:63]
v_mfma_f32_16x16x32_bf16 v[80:83], v[124:127], a[112:115], v[80:83]
s_waitcnt lgkmcnt(3)
ds_read_b128 v[116:119], v2 offset:48128
v_cndmask_b32 v166, v225, 0, s[62:63]
v_mfma_f32_16x16x32_bf16 v[72:75], v[128:131], a[120:123], v[72:75]
s_mov_b32 s70, Lc59-C_pc+2048
buffer_store_dwordx4 v[220:223], v234, s[4:7], s56 offen offset:2176 sc1
v_mfma_f32_16x16x32_bf16 v[76:79], v[128:131], a[124:127], v[76:79]
s_min_u32 s70, s70, M_text_end-C_pc-16384
ds_read_b128 v[120:123], v2 offset:49152
v_cndmask_b32 v151, 0, v225, s[64:65]
v_mfma_f32_16x16x32_bf16 v[84:87], v[132:135], a[124:127], v[84:87]
v_cndmask_b32 v167, v225, 0, s[64:65]
s_add_u32 s36, s36, 6553600
v_mfma_f32_16x16x32_bf16 v[80:83], v[132:135], a[120:123], v[80:83]
s_waitcnt lgkmcnt(3)
ds_read_b128 v[124:127], v2 offset:50176
v_mfma_f32_16x16x32_bf16 v[72:75], v[104:107], a[128:131], v[72:75]
s_barrier
v_mfma_f32_16x16x32_bf16 v[76:79], v[104:107], a[132:135], v[76:79]
ds_read_b128 v[128:131], v2 offset:51200
v_mfma_f32_16x16x32_bf16 v[84:87], v[108:111], a[132:135], v[84:87]
s_add_u32 s70, s70, s74
s_addc_u32 s71, s75, 0
v_mfma_f32_16x16x32_bf16 v[80:83], v[108:111], a[128:131], v[80:83]
s_waitcnt lgkmcnt(3)
ds_read_b128 v[132:135], v2 offset:52224
v_mfma_f32_16x16x32_bf16 v[72:75], v[112:115], a[136:139], v[72:75]
s_mov_b64 exec, 1
Lc59:
global_load_dword v235, v0, s[70:71]
s_mov_b64 exec, -1
v_mfma_f32_16x16x32_bf16 v[76:79], v[112:115], a[140:143], v[76:79]
ds_read_b128 v[104:107], v2 offset:53248
v_mfma_f32_16x16x32_bf16 v[84:87], v[116:119], a[140:143], v[84:87]
v_mfma_f32_16x16x32_bf16 v[80:83], v[116:119], a[136:139], v[80:83]
s_waitcnt lgkmcnt(3)
ds_read_b128 v[108:111], v2 offset:54272
v_mfma_f32_16x16x32_bf16 v[72:75], v[120:123], a[144:147], v[72:75]
v_mfma_f32_16x16x32_bf16 v[76:79], v[120:123], a[148:151], v[76:79]
ds_read_b128 v[112:115], v2 offset:55296
v_mfma_f32_16x16x32_bf16 v[84:87], v[124:127], a[148:151], v[84:87]
v_mfma_f32_16x16x32_bf16 v[80:83], v[124:127], a[144:147], v[80:83]
s_waitcnt lgkmcnt(3)
ds_read_b128 v[116:119], v2 offset:56320
v_mfma_f32_16x16x32_bf16 v[72:75], v[128:131], a[152:155], v[72:75]
v_mfma_f32_16x16x32_bf16 v[76:79], v[128:131], a[156:159], v[76:79]
ds_read_b128 v[120:123], v2 offset:57344
v_mfma_f32_16x16x32_bf16 v[84:87], v[132:135], a[156:159], v[84:87]
v_mfma_f32_16x16x32_bf16 v[80:83], v[132:135], a[152:155], v[80:83]
s_waitcnt lgkmcnt(3)
ds_read_b128 v[124:127], v2 offset:58368
v_mfma_f32_16x16x32_bf16 v[88:91], v[104:107], a[0:3], v[88:91]
v_mfma_f32_16x16x32_bf16 v[92:95], v[104:107], a[4:7], v[92:95]
ds_read_b128 v[128:131], v2 offset:59392
v_mfma_f32_16x16x32_bf16 v[100:103], v[108:111], a[4:7], v[100:103]
v_mfma_f32_16x16x32_bf16 v[96:99], v[108:111], a[0:3], v[96:99]
s_waitcnt lgkmcnt(3)
ds_read_b128 v[132:135], v2 offset:60416
v_mfma_f32_16x16x32_bf16 v[88:91], v[112:115], a[8:11], v[88:91]
s_mov_b64 exec, 24
buffer_load_dword v15, v37, s[4:7], 0 offen sc1
s_mov_b64 exec, -1
v_mfma_f32_16x16x32_bf16 v[92:95], v[112:115], a[12:15], v[92:95]
ds_read_b128 v[104:107], v2 offset:61440
v_mul_f32 v72, v72, v232
v_mfma_f32_16x16x32_bf16 v[100:103], v[116:119], a[12:15], v[100:103]
v_mul_f32 v73, v73, v232
v_mul_f32 v74, v74, v232
v_mfma_f32_16x16x32_bf16 v[96:99], v[116:119], a[8:11], v[96:99]
s_waitcnt lgkmcnt(3)
ds_read_b128 v[108:111], v2 offset:62464
v_mul_f32 v75, v75, v232
v_mfma_f32_16x16x32_bf16 v[88:91], v[120:123], a[16:19], v[88:91]
v_cvt_pk_bf16_f32 v212, v72, v73
v_cvt_pk_bf16_f32 v213, v74, v75
v_mfma_f32_16x16x32_bf16 v[92:95], v[120:123], a[20:23], v[92:95]
ds_read_b128 v[112:115], v2 offset:63488
v_mul_f32 v80, v80, v232
v_mfma_f32_16x16x32_bf16 v[100:103], v[124:127], a[20:23], v[100:103]
v_mul_f32 v81, v81, v232
v_mul_f32 v82, v82, v232
v_mfma_f32_16x16x32_bf16 v[96:99], v[124:127], a[16:19], v[96:99]
s_waitcnt lgkmcnt(3)
ds_read_b128 v[116:119], v2 offset:64512
v_mul_f32 v83, v83, v232
v_mfma_f32_16x16x32_bf16 v[88:91], v[128:131], a[24:27], v[88:91]
v_cvt_pk_bf16_f32 v214, v80, v81
v_cvt_pk_bf16_f32 v215, v82, v83
v_mfma_f32_16x16x32_bf16 v[92:95], v[128:131], a[28:31], v[92:95]
ds_read_b128 v[120:123], v3 offset:0
ds_write_b128 v237, v[212:215] offset:38400
v_mfma_f32_16x16x32_bf16 v[100:103], v[132:135], a[28:31], v[100:103]
buffer_store_dwordx4 v[212:215], v39, s[4:7], s56 offen offset:0 sc1
v_mfma_f32_16x16x32_bf16 v[96:99], v[132:135], a[24:27], v[96:99]
s_waitcnt lgkmcnt(4)
ds_read_b128 v[124:127], v3 offset:1024
v_mul_f32 v76, v76, v233
v_mfma_f32_16x16x32_bf16 v[88:91], v[104:107], a[32:35], v[88:91]
v_mul_f32 v77, v77, v233
v_mul_f32 v78, v78, v233
v_mfma_f32_16x16x32_bf16 v[92:95], v[104:107], a[36:39], v[92:95]
ds_read_b128 v[128:131], v3 offset:2048
v_mul_f32 v79, v79, v233
v_mfma_f32_16x16x32_bf16 v[100:103], v[108:111], a[36:39], v[100:103]
v_cvt_pk_bf16_f32 v216, v76, v77
v_cvt_pk_bf16_f32 v217, v78, v79
v_mfma_f32_16x16x32_bf16 v[96:99], v[108:111], a[32:35], v[96:99]
s_waitcnt lgkmcnt(4)
ds_read_b128 v[132:135], v3 offset:3072
v_mul_f32 v84, v84, v233
v_mfma_f32_16x16x32_bf16 v[88:91], v[112:115], a[40:43], v[88:91]
v_mul_f32 v85, v85, v233
v_mul_f32 v86, v86, v233
v_mfma_f32_16x16x32_bf16 v[92:95], v[112:115], a[44:47], v[92:95]
ds_read_b128 v[104:107], v3 offset:4096
v_mul_f32 v87, v87, v233
v_mfma_f32_16x16x32_bf16 v[100:103], v[116:119], a[44:47], v[100:103]
v_cvt_pk_bf16_f32 v218, v84, v85
v_cvt_pk_bf16_f32 v219, v86, v87
v_mfma_f32_16x16x32_bf16 v[96:99], v[116:119], a[40:43], v[96:99]
s_waitcnt lgkmcnt(3)
ds_read_b128 v[108:111], v3 offset:5120
ds_write_b128 v237, v[216:219] offset:38656
v_mfma_f32_16x16x32_bf16 v[88:91], v[120:123], a[48:51], v[88:91]
buffer_store_dwordx4 v[216:219], v39, s[4:7], s56 offen offset:256 sc1
v_mfma_f32_16x16x32_bf16 v[92:95], v[120:123], a[52:55], v[92:95]
ds_read_b128 v[112:115], v3 offset:6144
v_mfma_f32_16x16x32_bf16 v[100:103], v[124:127], a[52:55], v[100:103]
ds_read_b128 v[40:43], v9 offset:25600
s_waitcnt vmcnt(2)
v_cmp_gt_u32 s[58:59], 12, v15
v_mfma_f32_16x16x32_bf16 v[96:99], v[124:127], a[48:51], v[96:99]
s_waitcnt lgkmcnt(5)
ds_read_b128 v[116:119], v3 offset:7168
v_mfma_f32_16x16x32_bf16 v[88:91], v[128:131], a[56:59], v[88:91]
ds_read_b128 v[44:47], v9 offset:27776
v_mfma_f32_16x16x32_bf16 v[92:95], v[128:131], a[60:63], v[92:95]
ds_read_b128 v[120:123], v3 offset:8192
v_mfma_f32_16x16x32_bf16 v[100:103], v[132:135], a[60:63], v[100:103]
s_and_b32 s58, s58, s26
s_cbranch_scc1 Lq55
Lr56:
v_mfma_f32_16x16x32_bf16 v[96:99], v[132:135], a[56:59], v[96:99]
s_waitcnt lgkmcnt(6)
ds_read_b128 v[124:127], v3 offset:9216
s_mul_i32 s51, s18, 3200
v_mfma_f32_16x16x32_bf16 v[88:91], v[104:107], a[64:67], v[88:91]
s_add_u32 m0, s51, 12800
ds_read_b128 v[48:51], v239 offset:25600
v_mfma_f32_16x16x32_bf16 v[92:95], v[104:107], a[68:71], v[92:95]
ds_read_b128 v[128:131], v3 offset:10240
v_mfma_f32_16x16x32_bf16 v[100:103], v[108:111], a[68:71], v[100:103]
buffer_load_dwordx4 v1, s[4:7], s37 offen offset:0 sc1 lds
v_mfma_f32_16x16x32_bf16 v[96:99], v[108:111], a[64:67], v[96:99]
s_waitcnt lgkmcnt(5)
ds_read_b128 v[132:135], v3 offset:11264
v_mfma_f32_16x16x32_bf16 v[88:91], v[112:115], a[72:75], v[88:91]
ds_read_b128 v[52:55], v239 offset:27776
v_mfma_f32_16x16x32_bf16 v[92:95], v[112:115], a[76:79], v[92:95]
ds_read_b128 v[104:107], v3 offset:12288
v_mfma_f32_16x16x32_bf16 v[100:103], v[116:119], a[76:79], v[100:103]
buffer_load_dwordx4 v1, s[4:7], s37 offen offset:2176 sc1 lds
v_mfma_f32_16x16x32_bf16 v[96:99], v[116:119], a[72:75], v[96:99]
s_waitcnt lgkmcnt(5)
ds_read_b128 v[108:111], v3 offset:13312
v_mfma_f32_16x16x32_bf16 v[88:91], v[120:123], a[80:83], v[88:91]
v_mfma_f32_16x16x32_bf16 v[92:95], v[120:123], a[84:87], v[92:95]
ds_read_b128 v[112:115], v3 offset:14336
v_mfma_f32_16x16x32_bf16 v[100:103], v[124:127], a[84:87], v[100:103]
buffer_load_dwordx4 v1, s[4:7], s37 offen offset:1024 sc1 lds
v_mfma_f32_16x16x32_bf16 v[96:99], v[124:127], a[80:83], v[96:99]
s_waitcnt lgkmcnt(4)
ds_read_b128 v[116:119], v3 offset:15360
s_sub_u32 m0, m0, 12800
v_mfma_f32_16x16x32_bf16 v[88:91], v[128:131], a[88:91], v[88:91]
v_mfma_f32_16x16x32_bf16 v[92:95], v[128:131], a[92:95], v[92:95]
ds_read_b128 v[120:123], v3 offset:16384
v_mfma_f32_16x16x32_bf16 v[100:103], v[132:135], a[92:95], v[100:103]
buffer_load_dwordx4 v1, s[4:7], s79 offen offset:0 sc1 lds
v_mfma_f32_16x16x32_bf16 v[96:99], v[132:135], a[88:91], v[96:99]
s_waitcnt lgkmcnt(3)
ds_read_b128 v[124:127], v3 offset:17408
v_mfma_f32_16x16x32_bf16 v[88:91], v[104:107], a[96:99], v[88:91]
s_barrier
v_mfma_f32_16x16x32_bf16 v[92:95], v[104:107], a[100:103], v[92:95]
ds_read_b128 v[128:131], v3 offset:18432
v_mfma_f32_16x16x32_bf16 v[100:103], v[108:111], a[100:103], v[100:103]
buffer_load_dwordx4 v1, s[4:7], s79 offen offset:2176 sc1 lds
v_mfma_f32_16x16x32_bf16 v[96:99], v[108:111], a[96:99], v[96:99]
s_waitcnt lgkmcnt(3)
ds_read_b128 v[132:135], v3 offset:19456
v_mfma_f32_16x16x32_bf16 v[88:91], v[112:115], a[104:107], v[88:91]
v_mfma_f32_16x16x32_bf16 v[92:95], v[112:115], a[108:111], v[92:95]
ds_read_b128 v[104:107], v3 offset:20480
v_mfma_f32_16x16x32_bf16 v[100:103], v[116:119], a[108:111], v[100:103]
buffer_load_dwordx4 v1, s[4:7], s79 offen offset:1024 sc1 lds
v_mfma_f32_16x16x32_bf16 v[96:99], v[116:119], a[104:107], v[96:99]
s_waitcnt lgkmcnt(3)
ds_read_b128 v[108:111], v3 offset:21504
s_mul_i32 s51, s42, 3200
v_mfma_f32_16x16x32_bf16 v[88:91], v[120:123], a[112:115], v[88:91]
s_add_u32 s37, s37, s51
s_add_u32 s54, s30, 0
s_mul_i32 s51, s43, 3200
v_mfma_f32_16x16x32_bf16 v[92:95], v[120:123], a[116:119], v[92:95]
s_add_u32 s79, s79, s51
ds_read_b128 v[112:115], v3 offset:22528
v_mfma_f32_16x16x32_bf16 v[100:103], v[124:127], a[116:119], v[100:103]
s_waitcnt vmcnt(6)
s_mov_b64 exec, 1
buffer_atomic_add v13, v12, s[4:7], s25 offen sc1
s_mov_b64 exec, -1
v_mfma_f32_16x16x32_bf16 v[96:99], v[124:127], a[112:115], v[96:99]
s_waitcnt lgkmcnt(3)
ds_read_b128 v[116:119], v3 offset:23552
v_mfma_f32_16x16x32_bf16 v[88:91], v[128:131], a[120:123], v[88:91]
buffer_load_dwordx4 a[0:3], v1, s[4:7], s54 offen offset:0 sc1
v_mfma_f32_16x16x32_bf16 v[92:95], v[128:131], a[124:127], v[92:95]
ds_read_b128 v[120:123], v3 offset:24576
v_mfma_f32_16x16x32_bf16 v[100:103], v[132:135], a[124:127], v[100:103]
v_mfma_f32_16x16x32_bf16 v[96:99], v[132:135], a[120:123], v[96:99]
s_waitcnt lgkmcnt(3)
ds_read_b128 v[124:127], v3 offset:25600
v_mfma_f32_16x16x32_bf16 v[88:91], v[104:107], a[128:131], v[88:91]
buffer_load_dwordx4 a[4:7], v1, s[4:7], s54 offen offset:1024 sc1
v_mfma_f32_16x16x32_bf16 v[92:95], v[104:107], a[132:135], v[92:95]
ds_read_b128 v[128:131], v3 offset:26624
v_mfma_f32_16x16x32_bf16 v[100:103], v[108:111], a[132:135], v[100:103]
v_mfma_f32_16x16x32_bf16 v[96:99], v[108:111], a[128:131], v[96:99]
s_waitcnt lgkmcnt(3)
ds_read_b128 v[132:135], v3 offset:27648
v_mfma_f32_16x16x32_bf16 v[88:91], v[112:115], a[136:139], v[88:91]
buffer_load_dwordx4 a[8:11], v1, s[4:7], s54 offen offset:2048 sc1
v_mfma_f32_16x16x32_bf16 v[92:95], v[112:115], a[140:143], v[92:95]
v_mfma_f32_16x16x32_bf16 v[100:103], v[116:119], a[140:143], v[100:103]
v_mfma_f32_16x16x32_bf16 v[96:99], v[116:119], a[136:139], v[96:99]
s_waitcnt lgkmcnt(2)
v_mfma_f32_16x16x32_bf16 v[88:91], v[120:123], a[144:147], v[88:91]
buffer_load_dwordx4 a[12:15], v1, s[4:7], s54 offen offset:3072 sc1
v_mfma_f32_16x16x32_bf16 v[92:95], v[120:123], a[148:151], v[92:95]
v_mfma_f32_16x16x32_bf16 v[100:103], v[124:127], a[148:151], v[100:103]
v_mfma_f32_16x16x32_bf16 v[96:99], v[124:127], a[144:147], v[96:99]
s_waitcnt lgkmcnt(0)
v_mfma_f32_16x16x32_bf16 v[88:91], v[128:131], a[152:155], v[88:91]
v_mfma_f32_16x16x32_bf16 v[92:95], v[128:131], a[156:159], v[92:95]
v_mfma_f32_16x16x32_bf16 v[100:103], v[132:135], a[156:159], v[100:103]
v_mfma_f32_16x16x32_bf16 v[96:99], v[132:135], a[152:155], v[96:99]
v_mov_b32 v224, 0
v_mov_b32 v225, 0
s_nop 2
v_pk_mul_f32 v[88:89], v[88:89], v[230:231] op_sel:[0,0] op_sel_hi:[1,0]
v_pk_mul_f32 v[90:91], v[90:91], v[230:231] op_sel:[0,0] op_sel_hi:[1,0]
v_cvt_pk_bf16_f32 v240, v88, v89
v_cvt_pk_bf16_f32 v241, v90, v91
v_pk_mul_f32 v[92:93], v[92:93], v[230:231] op_sel:[0,1] op_sel_hi:[1,1]
v_pk_mul_f32 v[94:95], v[94:95], v[230:231] op_sel:[0,1] op_sel_hi:[1,1]
v_cvt_pk_bf16_f32 v248, v92, v93
v_cvt_pk_bf16_f32 v249, v94, v95
v_pk_mul_f32 v[96:97], v[96:97], v[230:231] op_sel:[0,0] op_sel_hi:[1,0]
v_pk_mul_f32 v[98:99], v[98:99], v[230:231] op_sel:[0,0] op_sel_hi:[1,0]
v_cvt_pk_bf16_f32 v242, v96, v97
v_cvt_pk_bf16_f32 v243, v98, v99
v_pk_mul_f32 v[100:101], v[100:101], v[230:231] op_sel:[0,1] op_sel_hi:[1,1]
v_pk_mul_f32 v[102:103], v[102:103], v[230:231] op_sel:[0,1] op_sel_hi:[1,1]
v_cvt_pk_bf16_f32 v250, v100, v101
v_cvt_pk_bf16_f32 v251, v102, v103
v_dot2c_f32_bf16 v224, v44, v244
v_dot2c_f32_bf16 v225, v52, v252
v_dot2c_f32_bf16 v224, v45, v245
v_dot2c_f32_bf16 v225, v53, v253
v_permlane16_swap_b32 v240, v248
v_permlane16_swap_b32 v241, v249
v_permlane16_swap_b32 v242, v250
v_permlane16_swap_b32 v243, v251
v_dot2c_f32_bf16 v224, v40, v240
v_dot2c_f32_bf16 v225, v48, v248
v_dot2c_f32_bf16 v224, v41, v241
v_dot2c_f32_bf16 v225, v49, v249
v_dot2c_f32_bf16 v224, v42, v242
v_dot2c_f32_bf16 v225, v50, v250
v_dot2c_f32_bf16 v224, v43, v243
v_dot2c_f32_bf16 v225, v51, v251
v_mfma_f32_32x32x16_bf16 v[64:79], v[40:43], v[240:243], v[152:167]
ds_read_b64_tr_b16 v[200:201], v10 offset:25600
ds_read_b64_tr_b16 v[202:203], v10 offset:25728
v_permlane32_swap_b32 v224, v225
v_add_f32 v224, v224, v225
v_cvt_pk_bf16_f32 v224, -v224, 0
v_cndmask_b32 v246, v224, 0, s[44:45]
v_cndmask_b32 v254, 0, v224, s[44:45]
s_nop 0
v_mfma_f32_32x32x16_bf16 v[64:79], v[44:47], v[244:247], v[64:79]
v_mfma_f32_32x32x16_bf16 v[80:95], v[48:51], v[248:251], v[152:167]
v_mfma_f32_32x32x16_bf16 v[80:95], v[52:55], v[252:255], v[80:95]
s_nop 9
v_exp_f32 v64, v64
v_exp_f32 v65, v65
v_exp_f32 v66, v66
v_exp_f32 v67, v67
v_cvt_pk_bf16_f32 v128, v64, v65
v_cvt_pk_bf16_f32 v129, v66, v67
s_waitcnt lgkmcnt(0)
v_exp_f32 v68, v68
v_exp_f32 v69, v69
v_exp_f32 v70, v70
v_exp_f32 v71, v71
v_cvt_pk_bf16_f32 v130, v68, v69
v_cvt_pk_bf16_f32 v131, v70, v71
s_waitcnt vmcnt(8)
s_barrier
ds_read_b128 v[56:59], v9 offset:22400
ds_read_b128 v[60:63], v9 offset:24576
ds_read_b64_tr_b16 v[204:205], v10 offset:25856
ds_read_b64_tr_b16 v[206:207], v10 offset:25984
v_exp_f32 v72, v72
v_exp_f32 v73, v73
v_exp_f32 v74, v74
v_exp_f32 v75, v75
v_cvt_pk_bf16_f32 v132, v72, v73
v_cvt_pk_bf16_f32 v133, v74, v75
v_mfma_f32_32x32x16_bf16 v[96:111], v[200:203], v[128:131], 0
ds_read_b64_tr_b16 v[200:201], v38 offset:25600
ds_read_b64_tr_b16 v[202:203], v38 offset:25728
s_mov_b64 exec, 24
buffer_load_dword v15, v37, s[4:7], 0 offen sc1
s_mov_b64 exec, -1
v_exp_f32 v76, v76
v_exp_f32 v77, v77
v_exp_f32 v78, v78
v_exp_f32 v79, v79
v_cvt_pk_bf16_f32 v134, v76, v77
v_cvt_pk_bf16_f32 v135, v78, v79
s_waitcnt lgkmcnt(5)
v_mfma_f32_32x32x16_bf16 v[64:79], v[56:59], v[240:243], 0
ds_read_b128 v[40:43], v9 offset:19200
ds_read_b128 v[44:47], v9 offset:21376
v_exp_f32 v80, v80
v_exp_f32 v81, v81
v_exp_f32 v82, v82
v_exp_f32 v83, v83
v_cvt_pk_bf16_f32 v128, v80, v81
v_cvt_pk_bf16_f32 v129, v82, v83
s_waitcnt lgkmcnt(6)
v_mfma_f32_32x32x16_bf16 v[64:79], v[60:63], v[244:247], v[64:79]
s_waitcnt lgkmcnt(2)
v_exp_f32 v84, v84
v_exp_f32 v85, v85
v_exp_f32 v86, v86
v_exp_f32 v87, v87
v_cvt_pk_bf16_f32 v130, v84, v85
v_cvt_pk_bf16_f32 v131, v86, v87
v_mfma_f32_32x32x16_bf16 v[96:111], v[204:207], v[132:135], v[96:111]
ds_read_b64_tr_b16 v[204:205], v38 offset:25856
ds_read_b64_tr_b16 v[206:207], v38 offset:25984
v_exp_f32 v88, v88
v_exp_f32 v89, v89
v_exp_f32 v90, v90
v_exp_f32 v91, v91
v_cvt_pk_bf16_f32 v132, v88, v89
v_cvt_pk_bf16_f32 v133, v90, v91
v_mfma_f32_32x32x16_bf16 v[112:127], v[200:203], v[128:131], 0
s_waitcnt lgkmcnt(2)
ds_read_b64_tr_b16 v[200:201], v10 offset:22400
ds_read_b64_tr_b16 v[202:203], v10 offset:22528
v_exp_f32 v92, v92
v_exp_f32 v93, v93
v_exp_f32 v94, v94
v_exp_f32 v95, v95
v_cvt_pk_bf16_f32 v134, v92, v93
v_cvt_pk_bf16_f32 v135, v94, v95
v_mfma_f32_32x32x16_bf16 v[80:95], v[40:43], v[240:243], 0
ds_read_b128 v[48:51], v9 offset:16000
ds_read_b128 v[52:55], v9 offset:18176
v_exp_f32 v64, v64
v_exp_f32 v65, v65
v_exp_f32 v66, v66
v_exp_f32 v67, v67
v_cvt_pk_bf16_f32 v128, v64, v65
v_cvt_pk_bf16_f32 v129, v66, v67
v_mfma_f32_32x32x16_bf16 v[80:95], v[44:47], v[244:247], v[80:95]
s_waitcnt lgkmcnt(2)
s_waitcnt vmcnt(0)
v_cmp_gt_u32 s[58:59], 16, v15
v_exp_f32 v68, v68
v_exp_f32 v69, v69
v_exp_f32 v70, v70
v_exp_f32 v71, v71
v_cvt_pk_bf16_f32 v130, v68, v69
v_cvt_pk_bf16_f32 v131, v70, v71
v_mfma_f32_32x32x16_bf16 v[112:127], v[204:207], v[132:135], v[112:127]
ds_read_b64_tr_b16 v[204:205], v10 offset:22656
ds_read_b64_tr_b16 v[206:207], v10 offset:22784
s_and_b32 s58, s58, s26
s_cbranch_scc1 Lq60
Lr61:
s_mul_i32 s51, s18, 3200
s_add_u32 m0, s51, 51200
v_exp_f32 v72, v72
v_exp_f32 v73, v73
v_exp_f32 v74, v74
v_exp_f32 v75, v75
v_cvt_pk_bf16_f32 v132, v72, v73
v_cvt_pk_bf16_f32 v133, v74, v75
v_mfma_f32_32x32x16_bf16 v[96:111], v[200:203], v[128:131], v[96:111]
s_waitcnt lgkmcnt(2)
ds_read_b64_tr_b16 v[200:201], v10 offset:19200
ds_read_b64_tr_b16 v[202:203], v10 offset:19328
buffer_load_dwordx4 v1, s[4:7], s37 offen offset:0 sc1 lds
buffer_load_dwordx4 v1, s[4:7], s37 offen offset:2176 sc1 lds
v_exp_f32 v76, v76
v_exp_f32 v77, v77
v_exp_f32 v78, v78
v_exp_f32 v79, v79
v_cvt_pk_bf16_f32 v134, v76, v77
v_cvt_pk_bf16_f32 v135, v78, v79
v_mfma_f32_32x32x16_bf16 v[64:79], v[48:51], v[240:243], 0
ds_read_b128 v[56:59], v9 offset:12800
ds_read_b128 v[60:63], v9 offset:14976
v_exp_f32 v80, v80
v_exp_f32 v81, v81
v_exp_f32 v82, v82
v_exp_f32 v83, v83
v_cvt_pk_bf16_f32 v128, v80, v81
v_cvt_pk_bf16_f32 v129, v82, v83
v_mfma_f32_32x32x16_bf16 v[64:79], v[52:55], v[244:247], v[64:79]
s_waitcnt lgkmcnt(2)
buffer_load_dwordx4 v1, s[4:7], s37 offen offset:1024 sc1 lds
v_exp_f32 v84, v84
v_exp_f32 v85, v85
v_exp_f32 v86, v86
v_exp_f32 v87, v87
v_cvt_pk_bf16_f32 v130, v84, v85
v_cvt_pk_bf16_f32 v131, v86, v87
v_mfma_f32_32x32x16_bf16 v[96:111], v[204:207], v[132:135], v[96:111]
s_sub_u32 m0, m0, 12800
ds_read_b64_tr_b16 v[204:205], v10 offset:19456
ds_read_b64_tr_b16 v[206:207], v10 offset:19584
v_exp_f32 v88, v88
v_exp_f32 v89, v89
v_exp_f32 v90, v90
v_exp_f32 v91, v91
v_cvt_pk_bf16_f32 v132, v88, v89
v_cvt_pk_bf16_f32 v133, v90, v91
v_mfma_f32_32x32x16_bf16 v[96:111], v[200:203], v[128:131], v[96:111]
s_waitcnt lgkmcnt(2)
ds_read_b64_tr_b16 v[200:201], v10 offset:16000
ds_read_b64_tr_b16 v[202:203], v10 offset:16128
buffer_load_dwordx4 v1, s[4:7], s79 offen offset:0 sc1 lds
buffer_load_dwordx4 v1, s[4:7], s79 offen offset:2176 sc1 lds
v_exp_f32 v92, v92
v_exp_f32 v93, v93
v_exp_f32 v94, v94
v_exp_f32 v95, v95
v_cvt_pk_bf16_f32 v134, v92, v93
v_cvt_pk_bf16_f32 v135, v94, v95
v_mfma_f32_32x32x16_bf16 v[80:95], v[56:59], v[240:243], 0
buffer_load_dwordx4 v1, s[4:7], s79 offen offset:1024 sc1 lds
s_add_u32 s54, s30, 4096
v_exp_f32 v64, v64
v_exp_f32 v65, v65
v_exp_f32 v66, v66
v_exp_f32 v67, v67
v_cvt_pk_bf16_f32 v128, v64, v65
v_cvt_pk_bf16_f32 v129, v66, v67
v_mfma_f32_32x32x16_bf16 v[80:95], v[60:63], v[244:247], v[80:95]
s_waitcnt lgkmcnt(0)
buffer_load_dwordx4 a[16:19], v1, s[4:7], s54 offen offset:0 sc1
buffer_load_dwordx4 a[20:23], v1, s[4:7], s54 offen offset:1024 sc1
v_exp_f32 v68, v68
v_exp_f32 v69, v69
v_exp_f32 v70, v70
v_exp_f32 v71, v71
v_cvt_pk_bf16_f32 v130, v68, v69
v_cvt_pk_bf16_f32 v131, v70, v71
v_mfma_f32_32x32x16_bf16 v[96:111], v[204:207], v[132:135], v[96:111]
s_barrier
ds_read_b128 v[40:43], v9 offset:9600
ds_read_b128 v[44:47], v9 offset:11776
ds_read_b64_tr_b16 v[204:205], v10 offset:16256
ds_read_b64_tr_b16 v[206:207], v10 offset:16384
v_exp_f32 v72, v72
v_exp_f32 v73, v73
v_exp_f32 v74, v74
v_exp_f32 v75, v75
v_cvt_pk_bf16_f32 v132, v72, v73
v_cvt_pk_bf16_f32 v133, v74, v75
v_mfma_f32_32x32x16_bf16 v[96:111], v[200:203], v[128:131], v[96:111]
ds_read_b64_tr_b16 v[200:201], v10 offset:12800
ds_read_b64_tr_b16 v[202:203], v10 offset:12928
buffer_load_dwordx4 a[24:27], v1, s[4:7], s54 offen offset:2048 sc1
v_exp_f32 v76, v76
v_exp_f32 v77, v77
v_exp_f32 v78, v78
v_exp_f32 v79, v79
v_cvt_pk_bf16_f32 v134, v76, v77
v_cvt_pk_bf16_f32 v135, v78, v79
s_waitcnt lgkmcnt(5)
v_mfma_f32_32x32x16_bf16 v[64:79], v[40:43], v[240:243], 0
ds_read_b128 v[48:51], v9 offset:6400
ds_read_b128 v[52:55], v9 offset:8576
v_exp_f32 v80, v80
v_exp_f32 v81, v81
v_exp_f32 v82, v82
v_exp_f32 v83, v83
v_cvt_pk_bf16_f32 v128, v80, v81
v_cvt_pk_bf16_f32 v129, v82, v83
s_waitcnt lgkmcnt(6)
v_mfma_f32_32x32x16_bf16 v[64:79], v[44:47], v[244:247], v[64:79]
s_waitcnt lgkmcnt(2)
buffer_load_dwordx4 a[28:31], v1, s[4:7], s54 offen offset:3072 sc1
v_exp_f32 v84, v84
v_exp_f32 v85, v85
v_exp_f32 v86, v86
v_exp_f32 v87, v87
v_cvt_pk_bf16_f32 v130, v84, v85
v_cvt_pk_bf16_f32 v131, v86, v87
v_mfma_f32_32x32x16_bf16 v[96:111], v[204:207], v[132:135], v[96:111]
s_add_u32 s54, s54, 4096
ds_read_b64_tr_b16 v[204:205], v10 offset:13056
ds_read_b64_tr_b16 v[206:207], v10 offset:13184
v_exp_f32 v88, v88
v_exp_f32 v89, v89
v_exp_f32 v90, v90
v_exp_f32 v91, v91
v_cvt_pk_bf16_f32 v132, v88, v89
v_cvt_pk_bf16_f32 v133, v90, v91
v_mfma_f32_32x32x16_bf16 v[96:111], v[200:203], v[128:131], v[96:111]
s_waitcnt lgkmcnt(2)
ds_read_b64_tr_b16 v[200:201], v10 offset:9600
ds_read_b64_tr_b16 v[202:203], v10 offset:9728
buffer_load_dwordx4 a[32:35], v1, s[4:7], s54 offen offset:0 sc1
v_exp_f32 v92, v92
v_exp_f32 v93, v93
v_exp_f32 v94, v94
v_exp_f32 v95, v95
v_cvt_pk_bf16_f32 v134, v92, v93
v_cvt_pk_bf16_f32 v135, v94, v95
v_mfma_f32_32x32x16_bf16 v[80:95], v[48:51], v[240:243], 0
ds_read_b128 v[56:59], v9 offset:3200
ds_read_b128 v[60:63], v9 offset:5376
v_exp_f32 v64, v64
v_exp_f32 v65, v65
v_exp_f32 v66, v66
v_exp_f32 v67, v67
v_cvt_pk_bf16_f32 v128, v64, v65
v_cvt_pk_bf16_f32 v129, v66, v67
v_mfma_f32_32x32x16_bf16 v[80:95], v[52:55], v[244:247], v[80:95]
s_waitcnt lgkmcnt(2)
v_exp_f32 v68, v68
v_exp_f32 v69, v69
v_exp_f32 v70, v70
v_exp_f32 v71, v71
v_cvt_pk_bf16_f32 v130, v68, v69
v_cvt_pk_bf16_f32 v131, v70, v71
v_mfma_f32_32x32x16_bf16 v[96:111], v[204:207], v[132:135], v[96:111]
ds_read_b64_tr_b16 v[204:205], v10 offset:9856
ds_read_b64_tr_b16 v[206:207], v10 offset:9984
buffer_load_dwordx4 a[36:39], v1, s[4:7], s54 offen offset:1024 sc1
v_exp_f32 v72, v72
v_exp_f32 v73, v73
v_exp_f32 v74, v74
v_exp_f32 v75, v75
v_cvt_pk_bf16_f32 v132, v72, v73
v_cvt_pk_bf16_f32 v133, v74, v75
v_mfma_f32_32x32x16_bf16 v[96:111], v[200:203], v[128:131], v[96:111]
s_waitcnt lgkmcnt(2)
ds_read_b64_tr_b16 v[200:201], v10 offset:6400
ds_read_b64_tr_b16 v[202:203], v10 offset:6528
v_exp_f32 v76, v76
v_exp_f32 v77, v77
v_exp_f32 v78, v78
v_exp_f32 v79, v79
v_cvt_pk_bf16_f32 v134, v76, v77
v_cvt_pk_bf16_f32 v135, v78, v79
v_mfma_f32_32x32x16_bf16 v[64:79], v[56:59], v[240:243], 0
ds_read_b128 v[40:43], v9 offset:0
ds_read_b128 v[44:47], v9 offset:2176
v_exp_f32 v80, v80
v_exp_f32 v81, v81
v_exp_f32 v82, v82
v_exp_f32 v83, v83
v_cvt_pk_bf16_f32 v128, v80, v81
v_cvt_pk_bf16_f32 v129, v82, v83
v_mfma_f32_32x32x16_bf16 v[64:79], v[60:63], v[244:247], v[64:79]
s_waitcnt lgkmcnt(2)
buffer_load_dwordx4 a[40:43], v1, s[4:7], s54 offen offset:2048 sc1
v_exp_f32 v84, v84
v_exp_f32 v85, v85
v_exp_f32 v86, v86
v_exp_f32 v87, v87
v_cvt_pk_bf16_f32 v130, v84, v85
v_cvt_pk_bf16_f32 v131, v86, v87
v_mfma_f32_32x32x16_bf16 v[96:111], v[204:207], v[132:135], v[96:111]
ds_read_b64_tr_b16 v[204:205], v10 offset:6656
ds_read_b64_tr_b16 v[206:207], v10 offset:6784
v_exp_f32 v88, v88
v_exp_f32 v89, v89
v_exp_f32 v90, v90
v_exp_f32 v91, v91
v_cvt_pk_bf16_f32 v132, v88, v89
v_cvt_pk_bf16_f32 v133, v90, v91
v_mfma_f32_32x32x16_bf16 v[96:111], v[200:203], v[128:131], v[96:111]
s_waitcnt lgkmcnt(2)
ds_read_b64_tr_b16 v[200:201], v10 offset:3200
ds_read_b64_tr_b16 v[202:203], v10 offset:3328
buffer_load_dwordx4 a[44:47], v1, s[4:7], s54 offen offset:3072 sc1
v_exp_f32 v92, v92
v_exp_f32 v93, v93
v_exp_f32 v94, v94
v_exp_f32 v95, v95
v_cvt_pk_bf16_f32 v134, v92, v93
v_cvt_pk_bf16_f32 v135, v94, v95
v_mfma_f32_32x32x16_bf16 v[80:95], v[40:43], v[240:243], v[136:151]
v_exp_f32 v64, v64
v_exp_f32 v65, v65
v_exp_f32 v66, v66
v_exp_f32 v67, v67
v_cvt_pk_bf16_f32 v128, v64, v65
v_cvt_pk_bf16_f32 v129, v66, v67
v_mfma_f32_32x32x16_bf16 v[80:95], v[44:47], v[244:247], v[80:95]
s_waitcnt lgkmcnt(0)
v_and_b32 v236, 0xffffff00, v0
v_add_u32 v236, v236, v0
v_exp_f32 v68, v68
v_exp_f32 v69, v69
v_exp_f32 v70, v70
v_exp_f32 v71, v71
v_cvt_pk_bf16_f32 v130, v68, v69
v_cvt_pk_bf16_f32 v131, v70, v71
v_mfma_f32_32x32x16_bf16 v[96:111], v[204:207], v[132:135], v[96:111]
s_waitcnt vmcnt(11)
s_barrier
ds_read_b128 v[48:51], v239 offset:22400
ds_read_b128 v[52:55], v239 offset:24576
ds_read_b64_tr_b16 v[204:205], v10 offset:3456
ds_read_b64_tr_b16 v[206:207], v10 offset:3584
s_add_u32 s54, s54, 4096
v_exp_f32 v72, v72
v_exp_f32 v73, v73
v_exp_f32 v74, v74
v_exp_f32 v75, v75
v_cvt_pk_bf16_f32 v132, v72, v73
v_cvt_pk_bf16_f32 v133, v74, v75
v_mfma_f32_32x32x16_bf16 v[96:111], v[200:203], v[128:131], v[96:111]
ds_read_b64_tr_b16 v[200:201], v10 offset:0
ds_read_b64_tr_b16 v[202:203], v10 offset:128
buffer_load_dwordx4 a[48:51], v1, s[4:7], s54 offen offset:0 sc1
s_mov_b64 exec, 0xfffff
buffer_load_dword v235, v236, s[12:15], s34 offen sc1
s_mov_b64 exec, 1
buffer_load_dword v235, v12, s[4:7], s35 offen sc1
s_mov_b64 exec, -1
v_exp_f32 v76, v76
v_exp_f32 v77, v77
v_exp_f32 v78, v78
v_exp_f32 v79, v79
v_cvt_pk_bf16_f32 v134, v76, v77
v_cvt_pk_bf16_f32 v135, v78, v79
s_waitcnt lgkmcnt(5)
v_mfma_f32_32x32x16_bf16 v[64:79], v[48:51], v[248:251], 0
ds_read_b128 v[56:59], v239 offset:19200
ds_read_b128 v[60:63], v239 offset:21376
v_exp_f32 v80, v80
v_exp_f32 v81, v81
v_exp_f32 v82, v82
v_exp_f32 v83, v83
v_cvt_pk_bf16_f32 v128, v80, v81
v_cvt_pk_bf16_f32 v129, v82, v83
s_waitcnt lgkmcnt(6)
v_mfma_f32_32x32x16_bf16 v[64:79], v[52:55], v[252:255], v[64:79]
s_waitcnt lgkmcnt(2)
buffer_load_dwordx4 a[52:55], v1, s[4:7], s54 offen offset:1024 sc1
v_exp_f32 v84, v84
v_exp_f32 v85, v85
v_exp_f32 v86, v86
v_exp_f32 v87, v87
v_cvt_pk_bf16_f32 v130, v84, v85
v_cvt_pk_bf16_f32 v131, v86, v87
v_mfma_f32_32x32x16_bf16 v[96:111], v[204:207], v[132:135], v[96:111]
ds_read_b64_tr_b16 v[204:205], v10 offset:256
ds_read_b64_tr_b16 v[206:207], v10 offset:384
buffer_load_dwordx4 a[56:59], v1, s[4:7], s54 offen offset:2048 sc1
v_exp_f32 v88, v88
v_exp_f32 v89, v89
v_exp_f32 v90, v90
v_exp_f32 v91, v91
v_cvt_pk_bf16_f32 v132, v88, v89
v_cvt_pk_bf16_f32 v133, v90, v91
v_mfma_f32_32x32x16_bf16 v[96:111], v[200:203], v[128:131], v[96:111]
s_waitcnt lgkmcnt(2)
ds_read_b64_tr_b16 v[200:201], v38 offset:22400
ds_read_b64_tr_b16 v[202:203], v38 offset:22528
v_exp_f32 v92, v92
v_exp_f32 v93, v93
v_exp_f32 v94, v94
v_exp_f32 v95, v95
v_cvt_pk_bf16_f32 v134, v92, v93
v_cvt_pk_bf16_f32 v135, v94, v95
v_mfma_f32_32x32x16_bf16 v[80:95], v[56:59], v[248:251], 0
ds_read_b128 v[40:43], v239 offset:16000
ds_read_b128 v[44:47], v239 offset:18176
v_exp_f32 v64, v64
v_exp_f32 v65, v65
v_exp_f32 v66, v66
v_exp_f32 v67, v67
v_cvt_pk_bf16_f32 v128, v64, v65
v_cvt_pk_bf16_f32 v129, v66, v67
v_mfma_f32_32x32x16_bf16 v[80:95], v[60:63], v[252:255], v[80:95]
s_waitcnt lgkmcnt(2)
buffer_load_dwordx4 a[60:63], v1, s[4:7], s54 offen offset:3072 sc1
v_exp_f32 v68, v68
v_exp_f32 v69, v69
v_exp_f32 v70, v70
v_exp_f32 v71, v71
v_cvt_pk_bf16_f32 v130, v68, v69
v_cvt_pk_bf16_f32 v131, v70, v71
v_mfma_f32_32x32x16_bf16 v[96:111], v[204:207], v[132:135], v[96:111]
s_mul_i32 s53, s18, 1024
ds_read_b64_tr_b16 v[204:205], v38 offset:22656
ds_read_b64_tr_b16 v[206:207], v38 offset:22784
s_add_u32 m0, s53, 77824
s_add_u32 s52, s29, s53
v_exp_f32 v72, v72
v_exp_f32 v73, v73
v_exp_f32 v74, v74
v_exp_f32 v75, v75
v_cvt_pk_bf16_f32 v132, v72, v73
v_cvt_pk_bf16_f32 v133, v74, v75
v_mfma_f32_32x32x16_bf16 v[112:127], v[200:203], v[128:131], v[112:127]
s_waitcnt lgkmcnt(2)
ds_read_b64_tr_b16 v[200:201], v38 offset:19200
ds_read_b64_tr_b16 v[202:203], v38 offset:19328
buffer_load_dwordx4 v1, s[4:7], s52 offen offset:0 sc1 lds
v_exp_f32 v76, v76
v_exp_f32 v77, v77
v_exp_f32 v78, v78
v_exp_f32 v79, v79
v_cvt_pk_bf16_f32 v134, v76, v77
v_cvt_pk_bf16_f32 v135, v78, v79
v_rcp_f32 v210, v108
v_cmp_nlt_f32 s[58:59], s72, v108
v_cmp_ngt_f32 s[60:61], s73, v108
v_mul_f32 v96, v96, v210
v_mul_f32 v97, v97, v210
v_mul_f32 v98, v98, v210
v_mul_f32 v99, v99, v210
v_mul_f32 v100, v100, v210
v_mul_f32 v101, v101, v210
v_mul_f32 v102, v102, v210
v_mul_f32 v103, v103, v210
v_mul_f32 v104, v104, v210
v_mul_f32 v105, v105, v210
v_mul_f32 v106, v106, v210
v_mul_f32 v107, v107, v210
v_cvt_pk_bf16_f32 v216, v96, v97
v_cvt_pk_bf16_f32 v217, v98, v99
v_cvt_pk_bf16_f32 v218, v100, v101
v_cvt_pk_bf16_f32 v219, v102, v103
v_cvt_pk_bf16_f32 v220, v104, v105
v_cvt_pk_bf16_f32 v221, v106, v107
s_or_b64 s[58:59], s[58:59], s[60:61]
s_cbranch_scc1 Lfb64
Lfr65:
s_barrier
v_mfma_f32_32x32x16_bf16 v[64:79], v[40:43], v[248:251], 0
s_add_u32 s54, s30, 16384
ds_read_b128 v[48:51], v239 offset:12800
ds_read_b128 v[52:55], v239 offset:14976
v_exp_f32 v80, v80
v_exp_f32 v81, v81
v_exp_f32 v82, v82
v_exp_f32 v83, v83
v_cvt_pk_bf16_f32 v128, v80, v81
v_cvt_pk_bf16_f32 v129, v82, v83
v_mfma_f32_32x32x16_bf16 v[64:79], v[44:47], v[252:255], v[64:79]
s_waitcnt lgkmcnt(2)
buffer_store_dwordx4 v[216:219], v1, s[4:7], s38 offen offset:0 sc1
v_exp_f32 v84, v84
v_exp_f32 v85, v85
v_exp_f32 v86, v86
v_exp_f32 v87, v87
v_cvt_pk_bf16_f32 v130, v84, v85
v_cvt_pk_bf16_f32 v131, v86, v87
v_mfma_f32_32x32x16_bf16 v[112:127], v[204:207], v[132:135], v[112:127]
ds_read_b64_tr_b16 v[204:205], v38 offset:19456
ds_read_b64_tr_b16 v[206:207], v38 offset:19584
buffer_load_dwordx4 a[64:67], v1, s[4:7], s54 offen offset:0 sc1
v_exp_f32 v88, v88
v_exp_f32 v89, v89
v_exp_f32 v90, v90
v_exp_f32 v91, v91
v_cvt_pk_bf16_f32 v132, v88, v89
v_cvt_pk_bf16_f32 v133, v90, v91
v_mfma_f32_32x32x16_bf16 v[112:127], v[200:203], v[128:131], v[112:127]
s_waitcnt lgkmcnt(2)
ds_read_b64_tr_b16 v[200:201], v38 offset:16000
ds_read_b64_tr_b16 v[202:203], v38 offset:16128
buffer_load_dwordx4 a[68:71], v1, s[4:7], s54 offen offset:1024 sc1
v_exp_f32 v92, v92
v_exp_f32 v93, v93
v_exp_f32 v94, v94
v_exp_f32 v95, v95
v_cvt_pk_bf16_f32 v134, v92, v93
v_cvt_pk_bf16_f32 v135, v94, v95
v_mfma_f32_32x32x16_bf16 v[80:95], v[48:51], v[248:251], 0
buffer_load_dwordx4 a[72:75], v1, s[4:7], s54 offen offset:2048 sc1
v_exp_f32 v64, v64
v_exp_f32 v65, v65
v_exp_f32 v66, v66
v_exp_f32 v67, v67
v_cvt_pk_bf16_f32 v128, v64, v65
v_cvt_pk_bf16_f32 v129, v66, v67
v_mfma_f32_32x32x16_bf16 v[80:95], v[52:55], v[252:255], v[80:95]
s_waitcnt lgkmcnt(0)
buffer_load_dwordx4 a[76:79], v1, s[4:7], s54 offen offset:3072 sc1
v_exp_f32 v68, v68
v_exp_f32 v69, v69
v_exp_f32 v70, v70
v_exp_f32 v71, v71
v_cvt_pk_bf16_f32 v130, v68, v69
v_cvt_pk_bf16_f32 v131, v70, v71
v_mfma_f32_32x32x16_bf16 v[112:127], v[204:207], v[132:135], v[112:127]
s_waitcnt vmcnt(20)
s_barrier
ds_read_b128 v[56:59], v239 offset:9600
ds_read_b128 v[60:63], v239 offset:11776
ds_read_b64_tr_b16 v[204:205], v38 offset:16256
ds_read_b64_tr_b16 v[206:207], v38 offset:16384
s_add_u32 s54, s54, 4096
v_exp_f32 v72, v72
v_exp_f32 v73, v73
v_exp_f32 v74, v74
v_exp_f32 v75, v75
v_cvt_pk_bf16_f32 v132, v72, v73
v_cvt_pk_bf16_f32 v133, v74, v75
v_mfma_f32_32x32x16_bf16 v[112:127], v[200:203], v[128:131], v[112:127]
ds_read_b64_tr_b16 v[200:201], v38 offset:12800
ds_read_b64_tr_b16 v[202:203], v38 offset:12928
buffer_load_dwordx4 a[80:83], v1, s[4:7], s54 offen offset:0 sc1
buffer_load_dwordx4 a[84:87], v1, s[4:7], s54 offen offset:1024 sc1
v_exp_f32 v76, v76
v_exp_f32 v77, v77
v_exp_f32 v78, v78
v_exp_f32 v79, v79
v_cvt_pk_bf16_f32 v134, v76, v77
v_cvt_pk_bf16_f32 v135, v78, v79
s_waitcnt lgkmcnt(5)
v_mfma_f32_32x32x16_bf16 v[64:79], v[56:59], v[248:251], 0
ds_read_b128 v[40:43], v239 offset:6400
ds_read_b128 v[44:47], v239 offset:8576
v_exp_f32 v80, v80
v_exp_f32 v81, v81
v_exp_f32 v82, v82
v_exp_f32 v83, v83
v_cvt_pk_bf16_f32 v128, v80, v81
v_cvt_pk_bf16_f32 v129, v82, v83
s_waitcnt lgkmcnt(6)
v_mfma_f32_32x32x16_bf16 v[64:79], v[60:63], v[252:255], v[64:79]
s_waitcnt lgkmcnt(2)
buffer_load_dwordx4 a[88:91], v1, s[4:7], s54 offen offset:2048 sc1
v_exp_f32 v84, v84
v_exp_f32 v85, v85
v_exp_f32 v86, v86
v_exp_f32 v87, v87
v_cvt_pk_bf16_f32 v130, v84, v85
v_cvt_pk_bf16_f32 v131, v86, v87
v_mfma_f32_32x32x16_bf16 v[112:127], v[204:207], v[132:135], v[112:127]
ds_read_b64_tr_b16 v[204:205], v38 offset:13056
ds_read_b64_tr_b16 v[206:207], v38 offset:13184
buffer_load_dwordx4 a[92:95], v1, s[4:7], s54 offen offset:3072 sc1
s_add_u32 s54, s54, 4096
v_exp_f32 v88, v88
v_exp_f32 v89, v89
v_exp_f32 v90, v90
v_exp_f32 v91, v91
v_cvt_pk_bf16_f32 v132, v88, v89
v_cvt_pk_bf16_f32 v133, v90, v91
v_mfma_f32_32x32x16_bf16 v[112:127], v[200:203], v[128:131], v[112:127]
s_waitcnt lgkmcnt(2)
ds_read_b64_tr_b16 v[200:201], v38 offset:9600
ds_read_b64_tr_b16 v[202:203], v38 offset:9728
buffer_load_dwordx4 a[96:99], v1, s[4:7], s54 offen offset:0 sc1
s_mul_i32 s53, s18, 11264
s_add_u32 m0, s53, 81920
s_add_u32 s52, s29, s53
v_exp_f32 v92, v92
v_exp_f32 v93, v93
v_exp_f32 v94, v94
v_exp_f32 v95, v95
v_cvt_pk_bf16_f32 v134, v92, v93
v_cvt_pk_bf16_f32 v135, v94, v95
v_mfma_f32_32x32x16_bf16 v[80:95], v[40:43], v[248:251], 0
s_add_u32 s52, s52, 4096
ds_read_b128 v[48:51], v239 offset:3200
ds_read_b128 v[52:55], v239 offset:5376
v_exp_f32 v64, v64
v_exp_f32 v65, v65
v_exp_f32 v66, v66
v_exp_f32 v67, v67
v_cvt_pk_bf16_f32 v128, v64, v65
v_cvt_pk_bf16_f32 v129, v66, v67
v_mfma_f32_32x32x16_bf16 v[80:95], v[44:47], v[252:255], v[80:95]
s_waitcnt lgkmcnt(2)
buffer_load_dwordx4 v1, s[4:7], s52 offen offset:0 sc1 lds
buffer_load_dwordx4 v1, s[4:7], s52 offen offset:1024 sc1 lds
v_exp_f32 v68, v68
v_exp_f32 v69, v69
v_exp_f32 v70, v70
v_exp_f32 v71, v71
v_cvt_pk_bf16_f32 v130, v68, v69
v_cvt_pk_bf16_f32 v131, v70, v71
v_mfma_f32_32x32x16_bf16 v[112:127], v[204:207], v[132:135], v[112:127]
ds_read_b64_tr_b16 v[204:205], v38 offset:9856
ds_read_b64_tr_b16 v[206:207], v38 offset:9984
buffer_load_dwordx4 v1, s[4:7], s52 offen offset:2048 sc1 lds
v_exp_f32 v72, v72
v_exp_f32 v73, v73
v_exp_f32 v74, v74
v_exp_f32 v75, v75
v_cvt_pk_bf16_f32 v132, v72, v73
v_cvt_pk_bf16_f32 v133, v74, v75
v_mfma_f32_32x32x16_bf16 v[112:127], v[200:203], v[128:131], v[112:127]
s_waitcnt lgkmcnt(2)
ds_read_b64_tr_b16 v[200:201], v38 offset:6400
ds_read_b64_tr_b16 v[202:203], v38 offset:6528
buffer_load_dwordx4 v1, s[4:7], s52 offen offset:3072 sc1 lds
s_add_u32 m0, m0, 4096
v_exp_f32 v76, v76
v_exp_f32 v77, v77
v_exp_f32 v78, v78
v_exp_f32 v79, v79
v_cvt_pk_bf16_f32 v134, v76, v77
v_cvt_pk_bf16_f32 v135, v78, v79
v_mfma_f32_32x32x16_bf16 v[64:79], v[48:51], v[248:251], 0
s_add_u32 s52, s52, 4096
ds_read_b128 v[56:59], v239 offset:0
ds_read_b128 v[60:63], v239 offset:2176
v_exp_f32 v80, v80
v_exp_f32 v81, v81
v_exp_f32 v82, v82
v_exp_f32 v83, v83
v_cvt_pk_bf16_f32 v128, v80, v81
v_cvt_pk_bf16_f32 v129, v82, v83
v_mfma_f32_32x32x16_bf16 v[64:79], v[52:55], v[252:255], v[64:79]
s_waitcnt lgkmcnt(2)
buffer_load_dwordx4 v1, s[4:7], s52 offen offset:0 sc1 lds
v_exp_f32 v84, v84
v_exp_f32 v85, v85
v_exp_f32 v86, v86
v_exp_f32 v87, v87
v_cvt_pk_bf16_f32 v130, v84, v85
v_cvt_pk_bf16_f32 v131, v86, v87
v_mfma_f32_32x32x16_bf16 v[112:127], v[204:207], v[132:135], v[112:127]
ds_read_b64_tr_b16 v[204:205], v38 offset:6656
ds_read_b64_tr_b16 v[206:207], v38 offset:6784
buffer_load_dwordx4 v1, s[4:7], s52 offen offset:1024 sc1 lds
v_exp_f32 v88, v88
v_exp_f32 v89, v89
v_exp_f32 v90, v90
v_exp_f32 v91, v91
v_cvt_pk_bf16_f32 v132, v88, v89
v_cvt_pk_bf16_f32 v133, v90, v91
v_mfma_f32_32x32x16_bf16 v[112:127], v[200:203], v[128:131], v[112:127]
s_waitcnt lgkmcnt(2)
ds_read_b64_tr_b16 v[200:201], v38 offset:3200
ds_read_b64_tr_b16 v[202:203], v38 offset:3328
buffer_load_dwordx4 v1, s[4:7], s52 offen offset:2048 sc1 lds
v_exp_f32 v92, v92
v_exp_f32 v93, v93
v_exp_f32 v94, v94
v_exp_f32 v95, v95
v_cvt_pk_bf16_f32 v134, v92, v93
v_cvt_pk_bf16_f32 v135, v94, v95
v_mfma_f32_32x32x16_bf16 v[80:95], v[56:59], v[248:251], v[136:151]
buffer_load_dwordx4 v1, s[4:7], s52 offen offset:3072 sc1 lds
s_add_u32 m0, m0, 4096
s_add_u32 s52, s52, 4096
v_exp_f32 v64, v64
v_exp_f32 v65, v65
v_exp_f32 v66, v66
v_exp_f32 v67, v67
v_cvt_pk_bf16_f32 v128, v64, v65
v_cvt_pk_bf16_f32 v129, v66, v67
v_mfma_f32_32x32x16_bf16 v[80:95], v[60:63], v[252:255], v[80:95]
s_waitcnt lgkmcnt(0)
buffer_load_dwordx4 v1, s[4:7], s52 offen offset:0 sc1 lds
v_exp_f32 v68, v68
v_exp_f32 v69, v69
v_exp_f32 v70, v70
v_exp_f32 v71, v71
v_cvt_pk_bf16_f32 v130, v68, v69
v_cvt_pk_bf16_f32 v131, v70, v71
v_mfma_f32_32x32x16_bf16 v[112:127], v[204:207], v[132:135], v[112:127]
ds_read_b64_tr_b16 v[204:205], v38 offset:3456
ds_read_b64_tr_b16 v[206:207], v38 offset:3584
buffer_load_dwordx4 v1, s[4:7], s52 offen offset:1024 sc1 lds
v_exp_f32 v72, v72
v_exp_f32 v73, v73
v_exp_f32 v74, v74
v_exp_f32 v75, v75
v_cvt_pk_bf16_f32 v132, v72, v73
v_cvt_pk_bf16_f32 v133, v74, v75
v_mfma_f32_32x32x16_bf16 v[112:127], v[200:203], v[128:131], v[112:127]
ds_read_b64_tr_b16 v[200:201], v38 offset:0
ds_read_b64_tr_b16 v[202:203], v38 offset:128
buffer_load_dwordx4 v1, s[4:7], s52 offen offset:2048 sc1 lds
v_exp_f32 v76, v76
v_exp_f32 v77, v77
v_exp_f32 v78, v78
v_exp_f32 v79, v79
v_cvt_pk_bf16_f32 v134, v76, v77
v_cvt_pk_bf16_f32 v135, v78, v79
v_exp_f32 v80, v80
v_exp_f32 v81, v81
v_exp_f32 v82, v82
v_exp_f32 v83, v83
v_cvt_pk_bf16_f32 v128, v80, v81
v_cvt_pk_bf16_f32 v129, v82, v83
s_waitcnt lgkmcnt(0)
v_exp_f32 v84, v84
v_exp_f32 v85, v85
v_exp_f32 v86, v86
v_exp_f32 v87, v87
v_cvt_pk_bf16_f32 v130, v84, v85
v_cvt_pk_bf16_f32 v131, v86, v87
v_mfma_f32_32x32x16_bf16 v[112:127], v[204:207], v[132:135], v[112:127]
ds_read_b64_tr_b16 v[204:205], v38 offset:256
ds_read_b64_tr_b16 v[206:207], v38 offset:384
v_exp_f32 v88, v88
v_exp_f32 v89, v89
v_exp_f32 v90, v90
v_exp_f32 v91, v91
v_cvt_pk_bf16_f32 v132, v88, v89
v_cvt_pk_bf16_f32 v133, v90, v91
v_mfma_f32_32x32x16_bf16 v[112:127], v[200:203], v[128:131], v[112:127]
v_exp_f32 v92, v92
v_exp_f32 v93, v93
v_exp_f32 v94, v94
v_exp_f32 v95, v95
v_cvt_pk_bf16_f32 v134, v92, v93
v_cvt_pk_bf16_f32 v135, v94, v95
s_waitcnt lgkmcnt(0)
s_nop 0
v_mfma_f32_32x32x16_bf16 v[112:127], v[204:207], v[132:135], v[112:127]
s_nop 11
v_rcp_f32 v210, v124
v_cmp_nlt_f32 s[58:59], s72, v124
v_cmp_ngt_f32 s[60:61], s73, v124
v_pk_mul_f32 v[112:113], v[112:113], v[210:211] op_sel_hi:[1,0]
v_pk_mul_f32 v[114:115], v[114:115], v[210:211] op_sel_hi:[1,0]
v_pk_mul_f32 v[116:117], v[116:117], v[210:211] op_sel_hi:[1,0]
v_pk_mul_f32 v[118:119], v[118:119], v[210:211] op_sel_hi:[1,0]
v_pk_mul_f32 v[120:121], v[120:121], v[210:211] op_sel_hi:[1,0]
v_pk_mul_f32 v[122:123], v[122:123], v[210:211] op_sel_hi:[1,0]
v_cvt_pk_bf16_f32 v224, v112, v113
v_cvt_pk_bf16_f32 v225, v114, v115
v_cvt_pk_bf16_f32 v226, v116, v117
v_cvt_pk_bf16_f32 v227, v118, v119
v_cvt_pk_bf16_f32 v222, v120, v121
v_cvt_pk_bf16_f32 v223, v122, v123
s_or_b64 s[58:59], s[58:59], s[60:61]
s_or_b64 s[60:61], s[58:59], vcc
s_cbranch_scc1 Lfb66
buffer_store_dwordx4 v[224:227], v1, s[4:7], s38 offen offset:1024
s_mov_b32 exec_hi, 0
buffer_store_dwordx4 v[220:223], v1, s[4:7], s38 offen offset:2048
s_mov_b64 exec, -1
Lfr67:
s_add_u32 s66, s18, 1
s_and_b32 s66, s66, 3
s_lshr_b32 s67, s66, 1
s_mul_i32 s67, s67, 40448
s_lshl_b32 s62, s66, 8
s_add_u32 s62, s62, s67
s_add_u32 s62, s62, s39
s_mul_i32 s66, s66, 5120
s_add_u32 s66, s66, 36864
v_add_u32 v246, s66, v1
s_add_u32 s66, s18, 2
s_and_b32 s66, s66, 3
s_lshr_b32 s67, s66, 1
s_mul_i32 s67, s67, 40448
s_lshl_b32 s63, s66, 8
s_add_u32 s63, s63, s67
s_add_u32 s63, s63, s39
s_mul_i32 s66, s66, 5120
s_add_u32 s66, s66, 57344
v_add_u32 v247, s66, v1
s_add_u32 s66, s18, 3
s_and_b32 s66, s66, 3
s_lshr_b32 s67, s66, 1
s_mul_i32 s67, s67, 40448
s_lshl_b32 s64, s66, 8
s_add_u32 s64, s64, s67
s_add_u32 s64, s64, s39
s_mul_i32 s66, s66, 5120
s_add_u32 s66, s66, 36864
v_add_u32 v248, s66, v1
s_add_u32 s66, s18, 4
s_and_b32 s66, s66, 3
s_lshr_b32 s67, s66, 1
s_mul_i32 s67, s67, 40448
s_lshl_b32 s65, s66, 8
s_add_u32 s65, s65, s67
s_add_u32 s65, s65, s39
s_mul_i32 s66, s66, 5120
s_add_u32 s66, s66, 36864
v_add_u32 v249, s66, v1
v_mov_b32 v15, 5
s_cmp_eq_u32 s18, 0
s_cbranch_scc1 Lo68
s_waitcnt vmcnt(0) lgkmcnt(0)
s_barrier
s_sub_u32 s60, s18, 1
s_mul_i32 s53, s60, 11264
s_add_u32 m0, s53, 125952
s_add_u32 s52, s29, s53
s_add_u32 s52, s52, 48128
buffer_load_dwordx4 v1, s[4:7], s52 offen offset:0 sc1 lds
buffer_load_dwordx4 v1, s[4:7], s52 offen offset:1024 sc1 lds
buffer_load_dwordx4 v1, s[4:7], s52 offen offset:2048 sc1 lds
buffer_load_dwordx4 v1, s[4:7], s52 offen offset:3072 sc1 lds
s_add_u32 m0, m0, 4096
s_add_u32 s52, s52, 4096
buffer_load_dwordx4 v1, s[4:7], s52 offen offset:0 sc1 lds
buffer_load_dwordx4 v1, s[4:7], s52 offen offset:1024 sc1 lds
buffer_load_dwordx4 v1, s[4:7], s52 offen offset:2048 sc1 lds
buffer_load_dwordx4 v1, s[4:7], s52 offen offset:3072 sc1 lds
s_add_u32 m0, m0, 4096
s_add_u32 s52, s52, 4096
buffer_load_dwordx4 v1, s[4:7], s52 offen offset:0 sc1 lds
buffer_load_dwordx4 v1, s[4:7], s52 offen offset:1024 sc1 lds
buffer_load_dwordx4 v1, s[4:7], s52 offen offset:2048 sc1 lds
s_branch Lj69
Lr71_x:
s_add_u32 s57, s57, 1
s_cmp_lt_u32 s57, 1048576
s_cbranch_scc1 Lr71_0
s_mov_b64 vcc, 0
s_branch Lr71_d
Lo68:
s_cbranch_vccnz Lw70
s_mov_b32 s57, 0
s_mov_b64 exec, 1
s_waitcnt vmcnt(0) lgkmcnt(0)
s_barrier
buffer_store_dword v15, v12, s[4:7], s49 offen
s_mov_b64 exec, 0xffff
Lr71_0:
buffer_load_dword v15, v7, s[4:7], s23 offen sc1
Lr71_w:
s_waitcnt vmcnt(0)
v_cmp_gt_u32 vcc, 5, v15
s_nop 0
s_cbranch_vccnz Lr71_x
Lr71_d:
s_mov_b64 exec, -1
Lj69:
s_barrier
buffer_load_dwordx4 v[40:43], v4, s[4:7], s62 offen offset:0 sc1
buffer_load_dwordx4 v[44:47], v4, s[4:7], s62 offen offset:2048 sc1
s_add_u32 s66, s62, 4096
buffer_load_dwordx4 v[48:51], v4, s[4:7], s66 offen offset:0 sc1
s_add_u32 s66, s62, 6144
buffer_load_dwordx4 v[52:55], v4, s[4:7], s66 offen offset:0 sc1
s_add_u32 s66, s62, 8192
buffer_load_dwordx4 v[56:59], v4, s[4:7], s66 offen offset:0 sc1
buffer_load_dwordx4 v[60:63], v4, s[4:7], s63 offen offset:0 sc1
buffer_load_dwordx4 v[64:67], v4, s[4:7], s63 offen offset:2048 sc1
s_waitcnt vmcnt(6)
v_mfma_f32_16x16x32_bf16 v[88:91], a[0:3], v[40:43], 0
s_add_u32 s66, s63, 4096
v_mfma_f32_16x16x32_bf16 v[92:95], a[4:7], v[40:43], 0
buffer_load_dwordx4 v[68:71], v4, s[4:7], s66 offen offset:0 sc1
v_mfma_f32_16x16x32_bf16 v[96:99], a[8:11], v[40:43], 0
s_add_u32 s66, s63, 6144
v_mfma_f32_16x16x32_bf16 v[100:103], a[12:15], v[40:43], 0
v_mfma_f32_16x16x32_bf16 v[104:107], a[16:19], v[40:43], 0
s_waitcnt vmcnt(6)
v_mfma_f32_16x16x32_bf16 v[88:91], a[20:23], v[44:47], v[88:91]
buffer_load_dwordx4 v[72:75], v4, s[4:7], s66 offen offset:0 sc1
v_mfma_f32_16x16x32_bf16 v[92:95], a[24:27], v[44:47], v[92:95]
s_add_u32 s66, s63, 8192
v_mfma_f32_16x16x32_bf16 v[96:99], a[28:31], v[44:47], v[96:99]
v_mfma_f32_16x16x32_bf16 v[100:103], a[32:35], v[44:47], v[100:103]
v_mfma_f32_16x16x32_bf16 v[104:107], a[36:39], v[44:47], v[104:107]
s_waitcnt vmcnt(6)
buffer_load_dwordx4 v[76:79], v4, s[4:7], s66 offen offset:0 sc1
v_mfma_f32_16x16x32_bf16 v[88:91], a[40:43], v[48:51], v[88:91]
v_mfma_f32_16x16x32_bf16 v[92:95], a[44:47], v[48:51], v[92:95]
s_mov_b32 s70, Lc74-C_pc+2048
s_min_u32 s70, s70, M_text_end-C_pc-16384
v_mfma_f32_16x16x32_bf16 v[96:99], a[48:51], v[48:51], v[96:99]
s_add_u32 s70, s70, s74
s_addc_u32 s71, s75, 0
v_mfma_f32_16x16x32_bf16 v[100:103], a[52:55], v[48:51], v[100:103]
buffer_load_dwordx4 v[80:83], v4, s[4:7], s64 offen offset:0 sc1
v_mfma_f32_16x16x32_bf16 v[104:107], a[56:59], v[48:51], v[104:107]
s_waitcnt vmcnt(7)
s_mov_b64 exec, 1
Lc74:
global_load_dword v250, v0, s[70:71]
s_mov_b64 exec, -1
v_mfma_f32_16x16x32_bf16 v[88:91], a[60:63], v[52:55], v[88:91]
v_mfma_f32_16x16x32_bf16 v[92:95], a[64:67], v[52:55], v[92:95]
v_mfma_f32_16x16x32_bf16 v[96:99], a[68:71], v[52:55], v[96:99]
buffer_load_dwordx4 v[84:87], v4, s[4:7], s64 offen offset:2048 sc1
v_mfma_f32_16x16x32_bf16 v[100:103], a[72:75], v[52:55], v[100:103]
s_add_u32 s66, s64, 4096
v_mfma_f32_16x16x32_bf16 v[104:107], a[76:79], v[52:55], v[104:107]
s_waitcnt vmcnt(8)
v_mfma_f32_16x16x32_bf16 v[88:91], a[80:83], v[56:59], v[88:91]
v_mfma_f32_16x16x32_bf16 v[92:95], a[84:87], v[56:59], v[92:95]
buffer_load_dwordx4 v[40:43], v4, s[4:7], s66 offen offset:0 sc1
v_mfma_f32_16x16x32_bf16 v[96:99], a[88:91], v[56:59], v[96:99]
s_add_u32 s66, s64, 6144
v_mfma_f32_16x16x32_bf16 v[100:103], a[92:95], v[56:59], v[100:103]
v_mfma_f32_16x16x32_bf16 v[104:107], a[96:99], v[56:59], v[104:107]
s_waitcnt vmcnt(8)
v_mfma_f32_16x16x32_bf16 v[108:111], a[0:3], v[60:63], 0
buffer_load_dwordx4 v[44:47], v4, s[4:7], s66 offen offset:0 sc1
v_mfma_f32_16x16x32_bf16 v[112:115], a[4:7], v[60:63], 0
s_add_u32 s66, s64, 8192
v_mfma_f32_16x16x32_bf16 v[116:119], a[8:11], v[60:63], 0
v_mfma_f32_16x16x32_bf16 v[120:123], a[12:15], v[60:63], 0
ds_write_b128 v246, v[88:91] offset:0
v_mfma_f32_16x16x32_bf16 v[124:127], a[16:19], v[60:63], 0
s_waitcnt vmcnt(8)
buffer_load_dwordx4 v[48:51], v4, s[4:7], s66 offen offset:0 sc1
v_mfma_f32_16x16x32_bf16 v[108:111], a[20:23], v[64:67], v[108:111]
ds_write_b128 v246, v[92:95] offset:1024
v_mfma_f32_16x16x32_bf16 v[112:115], a[24:27], v[64:67], v[112:115]
v_mfma_f32_16x16x32_bf16 v[116:119], a[28:31], v[64:67], v[116:119]
ds_write_b128 v246, v[96:99] offset:2048
v_mfma_f32_16x16x32_bf16 v[120:123], a[32:35], v[64:67], v[120:123]
buffer_load_dwordx4 v[52:55], v4, s[4:7], s65 offen offset:0 sc1
v_mfma_f32_16x16x32_bf16 v[124:127], a[36:39], v[64:67], v[124:127]
s_waitcnt vmcnt(9)
ds_write_b128 v246, v[100:103] offset:3072
v_mfma_f32_16x16x32_bf16 v[108:111], a[40:43], v[68:71], v[108:111]
v_mfma_f32_16x16x32_bf16 v[112:115], a[44:47], v[68:71], v[112:115]
ds_write_b128 v246, v[104:107] offset:4096
v_mfma_f32_16x16x32_bf16 v[116:119], a[48:51], v[68:71], v[116:119]
buffer_load_dwordx4 v[56:59], v4, s[4:7], s65 offen offset:2048 sc1
v_mfma_f32_16x16x32_bf16 v[120:123], a[52:55], v[68:71], v[120:123]
s_add_u32 s66, s65, 4096
v_mfma_f32_16x16x32_bf16 v[124:127], a[56:59], v[68:71], v[124:127]
s_waitcnt vmcnt(9)
v_mfma_f32_16x16x32_bf16 v[108:111], a[60:63], v[72:75], v[108:111]
s_waitcnt lgkmcnt(0)
s_barrier
ds_read_b128 v[200:203], v249 offset:0
v_mfma_f32_16x16x32_bf16 v[112:115], a[64:67], v[72:75], v[112:115]
buffer_load_dwordx4 v[60:63], v4, s[4:7], s66 offen offset:0 sc1
v_mfma_f32_16x16x32_bf16 v[116:119], a[68:71], v[72:75], v[116:119]
s_add_u32 s66, s65, 6144
ds_read_b128 v[204:207], v249 offset:1024
v_mfma_f32_16x16x32_bf16 v[120:123], a[72:75], v[72:75], v[120:123]
ds_read_b128 v[208:211], v249 offset:2048
v_mfma_f32_16x16x32_bf16 v[124:127], a[76:79], v[72:75], v[124:127]
s_waitcnt vmcnt(9)
ds_read_b128 v[212:215], v249 offset:3072
v_mfma_f32_16x16x32_bf16 v[108:111], a[80:83], v[76:79], v[108:111]
buffer_load_dwordx4 v[64:67], v4, s[4:7], s66 offen offset:0 sc1
v_mfma_f32_16x16x32_bf16 v[112:115], a[84:87], v[76:79], v[112:115]
s_add_u32 s66, s65, 8192
ds_read_b128 v[216:219], v249 offset:4096
v_mfma_f32_16x16x32_bf16 v[116:119], a[88:91], v[76:79], v[116:119]
v_mfma_f32_16x16x32_bf16 v[120:123], a[92:95], v[76:79], v[120:123]
v_mfma_f32_16x16x32_bf16 v[124:127], a[96:99], v[76:79], v[124:127]
s_waitcnt vmcnt(9)
buffer_load_dwordx4 v[68:71], v4, s[4:7], s66 offen offset:0 sc1
v_mfma_f32_16x16x32_bf16 v[128:131], a[0:3], v[80:83], 0
s_mul_i32 s53, s18, 9216
s_waitcnt lgkmcnt(0)
v_add_f32 v16, v16, v200
v_mfma_f32_16x16x32_bf16 v[132:135], a[4:7], v[80:83], 0
s_add_u32 m0, s53, 0
v_add_f32 v17, v17, v201
s_add_u32 s52, s29, s53
v_mfma_f32_16x16x32_bf16 v[136:139], a[8:11], v[80:83], 0
s_add_u32 s52, s52, 81920
v_add_f32 v18, v18, v202
v_add_f32 v19, v19, v203
v_mfma_f32_16x16x32_bf16 v[140:143], a[12:15], v[80:83], 0
buffer_load_dwordx4 v1, s[4:7], s52 offen offset:0 sc1 lds
v_mfma_f32_16x16x32_bf16 v[144:147], a[16:19], v[80:83], 0
s_waitcnt vmcnt(9)
ds_write_b128 v247, v[108:111] offset:0
v_mfma_f32_16x16x32_bf16 v[128:131], a[20:23], v[84:87], v[128:131]
ds_write_b128 v247, v[112:115] offset:1024
v_mfma_f32_16x16x32_bf16 v[132:135], a[24:27], v[84:87], v[132:135]
v_add_f32 v20, v20, v204
v_add_f32 v21, v21, v205
v_mfma_f32_16x16x32_bf16 v[136:139], a[28:31], v[84:87], v[136:139]
buffer_load_dwordx4 v1, s[4:7], s52 offen offset:1024 sc1 lds
v_mfma_f32_16x16x32_bf16 v[140:143], a[32:35], v[84:87], v[140:143]
ds_write_b128 v247, v[116:119] offset:2048
v_mfma_f32_16x16x32_bf16 v[144:147], a[36:39], v[84:87], v[144:147]
s_waitcnt vmcnt(9)
ds_write_b128 v247, v[120:123] offset:3072
v_mfma_f32_16x16x32_bf16 v[128:131], a[40:43], v[40:43], v[128:131]
v_add_f32 v22, v22, v206
v_add_f32 v23, v23, v207
v_mfma_f32_16x16x32_bf16 v[132:135], a[44:47], v[40:43], v[132:135]
buffer_load_dwordx4 v1, s[4:7], s52 offen offset:2048 sc1 lds
v_mfma_f32_16x16x32_bf16 v[136:139], a[48:51], v[40:43], v[136:139]
ds_write_b128 v247, v[124:127] offset:4096
v_mfma_f32_16x16x32_bf16 v[140:143], a[52:55], v[40:43], v[140:143]
v_add_f32 v24, v24, v208
v_add_f32 v25, v25, v209
v_mfma_f32_16x16x32_bf16 v[144:147], a[56:59], v[40:43], v[144:147]
s_waitcnt vmcnt(9)
v_add_f32 v26, v26, v210
v_add_f32 v27, v27, v211
v_mfma_f32_16x16x32_bf16 v[128:131], a[60:63], v[44:47], v[128:131]
buffer_load_dwordx4 v1, s[4:7], s52 offen offset:3072 sc1 lds
v_mfma_f32_16x16x32_bf16 v[132:135], a[64:67], v[44:47], v[132:135]
s_add_u32 m0, m0, 4096
s_waitcnt lgkmcnt(0)
s_barrier
ds_read_b128 v[220:223], v249 offset:20480
v_mfma_f32_16x16x32_bf16 v[136:139], a[68:71], v[44:47], v[136:139]
s_add_u32 s52, s52, 4096
ds_read_b128 v[224:227], v249 offset:21504
v_add_f32 v28, v28, v212
v_mfma_f32_16x16x32_bf16 v[140:143], a[72:75], v[44:47], v[140:143]
ds_read_b128 v[228:231], v249 offset:22528
v_add_f32 v29, v29, v213
v_mfma_f32_16x16x32_bf16 v[144:147], a[76:79], v[44:47], v[144:147]
s_waitcnt vmcnt(9)
buffer_load_dwordx4 v1, s[4:7], s52 offen offset:0 sc1 lds
v_mfma_f32_16x16x32_bf16 v[128:131], a[80:83], v[48:51], v[128:131]
ds_read_b128 v[232:235], v249 offset:23552
v_add_f32 v30, v30, v214
v_mfma_f32_16x16x32_bf16 v[132:135], a[84:87], v[48:51], v[132:135]
ds_read_b128 v[236:239], v249 offset:24576
v_add_f32 v31, v31, v215
v_mfma_f32_16x16x32_bf16 v[136:139], a[88:91], v[48:51], v[136:139]
v_add_f32 v32, v32, v216
v_add_f32 v33, v33, v217
v_mfma_f32_16x16x32_bf16 v[140:143], a[92:95], v[48:51], v[140:143]
buffer_load_dwordx4 v1, s[4:7], s52 offen offset:1024 sc1 lds
v_mfma_f32_16x16x32_bf16 v[144:147], a[96:99], v[48:51], v[144:147]
s_waitcnt vmcnt(10)
v_add_f32 v34, v34, v218
v_add_f32 v35, v35, v219
v_mfma_f32_16x16x32_bf16 v[148:151], a[0:3], v[52:55], 0
s_waitcnt lgkmcnt(0)
v_add_f32 v16, v16, v220
v_mfma_f32_16x16x32_bf16 v[152:155], a[4:7], v[52:55], 0
v_add_f32 v17, v17, v221
v_add_f32 v18, v18, v222
v_mfma_f32_16x16x32_bf16 v[156:159], a[8:11], v[52:55], 0
buffer_load_dwordx4 v1, s[4:7], s52 offen offset:2048 sc1 lds
v_mfma_f32_16x16x32_bf16 v[160:163], a[12:15], v[52:55], 0
ds_write_b128 v248, v[128:131] offset:0
v_mfma_f32_16x16x32_bf16 v[164:167], a[16:19], v[52:55], 0
s_waitcnt vmcnt(10)
v_add_f32 v19, v19, v223
v_add_f32 v20, v20, v224
v_mfma_f32_16x16x32_bf16 v[148:151], a[20:23], v[56:59], v[148:151]
ds_write_b128 v248, v[132:135] offset:1024
v_mfma_f32_16x16x32_bf16 v[152:155], a[24:27], v[56:59], v[152:155]
buffer_load_dwordx4 v1, s[4:7], s52 offen offset:3072 sc1 lds
v_mfma_f32_16x16x32_bf16 v[156:159], a[28:31], v[56:59], v[156:159]
s_add_u32 m0, m0, 4096
ds_write_b128 v248, v[136:139] offset:2048
v_mfma_f32_16x16x32_bf16 v[160:163], a[32:35], v[56:59], v[160:163]
s_add_u32 s52, s52, 4096
v_add_f32 v21, v21, v225
v_add_f32 v22, v22, v226
v_mfma_f32_16x16x32_bf16 v[164:167], a[36:39], v[56:59], v[164:167]
s_waitcnt vmcnt(10)
ds_write_b128 v248, v[140:143] offset:3072
v_mfma_f32_16x16x32_bf16 v[148:151], a[40:43], v[60:63], v[148:151]
buffer_load_dwordx4 v1, s[4:7], s52 offen offset:0 sc1 lds
v_mfma_f32_16x16x32_bf16 v[152:155], a[44:47], v[60:63], v[152:155]
ds_write_b128 v248, v[144:147] offset:4096
v_mfma_f32_16x16x32_bf16 v[156:159], a[48:51], v[60:63], v[156:159]
v_add_f32 v23, v23, v227
v_add_f32 v24, v24, v228
v_mfma_f32_16x16x32_bf16 v[160:163], a[52:55], v[60:63], v[160:163]
v_add_f32 v25, v25, v229
v_add_f32 v26, v26, v230
v_mfma_f32_16x16x32_bf16 v[164:167], a[56:59], v[60:63], v[164:167]
s_waitcnt vmcnt(10)
v_add_f32 v27, v27, v231
v_add_f32 v28, v28, v232
v_mfma_f32_16x16x32_bf16 v[148:151], a[60:63], v[64:67], v[148:151]
s_waitcnt lgkmcnt(0)
s_barrier
ds_read_b128 v[200:203], v249 offset:0
v_mfma_f32_16x16x32_bf16 v[152:155], a[64:67], v[64:67], v[152:155]
ds_read_b128 v[204:207], v249 offset:1024
v_add_f32 v29, v29, v233
v_mfma_f32_16x16x32_bf16 v[156:159], a[68:71], v[64:67], v[156:159]
ds_read_b128 v[208:211], v249 offset:2048
v_add_f32 v30, v30, v234
v_mfma_f32_16x16x32_bf16 v[160:163], a[72:75], v[64:67], v[160:163]
ds_read_b128 v[212:215], v249 offset:3072
v_add_f32 v31, v31, v235
v_mfma_f32_16x16x32_bf16 v[164:167], a[76:79], v[64:67], v[164:167]
s_waitcnt vmcnt(9)
ds_read_b128 v[216:219], v249 offset:4096
v_add_f32 v32, v32, v236
v_mfma_f32_16x16x32_bf16 v[148:151], a[80:83], v[68:71], v[148:151]
v_add_f32 v33, v33, v237
v_add_f32 v34, v34, v238
v_mfma_f32_16x16x32_bf16 v[152:155], a[84:87], v[68:71], v[152:155]
v_add_f32 v35, v35, v239
v_mfma_f32_16x16x32_bf16 v[156:159], a[88:91], v[68:71], v[156:159]
v_mfma_f32_16x16x32_bf16 v[160:163], a[92:95], v[68:71], v[160:163]
v_mfma_f32_16x16x32_bf16 v[164:167], a[96:99], v[68:71], v[164:167]
s_mov_b32 s64, 0xffff
s_mov_b32 s65, 0xffff
s_cbranch_vccnz Ls75
v_pk_add_f32 v[16:17], v[16:17], v[148:149]
v_pk_add_f32 v[18:19], v[18:19], v[150:151]
v_pk_add_f32 v[20:21], v[20:21], v[152:153]
v_pk_add_f32 v[22:23], v[22:23], v[154:155]
v_pk_add_f32 v[24:25], v[24:25], v[156:157]
v_pk_add_f32 v[26:27], v[26:27], v[158:159]
v_pk_add_f32 v[28:29], v[28:29], v[160:161]
v_pk_add_f32 v[30:31], v[30:31], v[162:163]
v_pk_add_f32 v[32:33], v[32:33], v[164:165]
v_pk_add_f32 v[34:35], v[34:35], v[166:167]
s_waitcnt lgkmcnt(0)
v_pk_add_f32 v[16:17], v[16:17], v[200:201]
v_pk_add_f32 v[18:19], v[18:19], v[202:203]
v_pk_add_f32 v[20:21], v[20:21], v[204:205]
v_pk_add_f32 v[22:23], v[22:23], v[206:207]
v_pk_add_f32 v[24:25], v[24:25], v[208:209]
v_pk_add_f32 v[26:27], v[26:27], v[210:211]
v_pk_add_f32 v[28:29], v[28:29], v[212:213]
v_pk_add_f32 v[30:31], v[30:31], v[214:215]
v_pk_add_f32 v[32:33], v[32:33], v[216:217]
v_pk_add_f32 v[34:35], v[34:35], v[218:219]
v_cvt_pk_bf16_f32 v40, v16, v17
v_cvt_pk_bf16_f32 v41, v18, v19
v_cvt_pk_bf16_f32 v42, v20, v21
v_cvt_pk_bf16_f32 v43, v22, v23
v_cvt_pk_bf16_f32 v44, v24, v25
v_cvt_pk_bf16_f32 v45, v26, v27
v_cvt_pk_bf16_f32 v46, v28, v29
v_cvt_pk_bf16_f32 v47, v30, v31
v_cvt_pk_bf16_f32 v48, v32, v33
v_cvt_pk_bf16_f32 v49, v34, v35
v_cvt_pk_bf16_f32 v50, v32, v33
v_cvt_pk_bf16_f32 v51, v34, v35
buffer_store_dwordx4 v[40:43], v4, s[12:15], s34 offen
buffer_store_dwordx4 v[44:47], v4, s[12:15], s34 offen offset:2048
v_permlane16_swap_b32 v48, v50
v_permlane16_swap_b32 v49, v51
v_pk_add_f32 v[52:53], v[16:17], v[18:19]
v_pk_mul_f32 v[54:55], v[16:17], v[16:17]
v_pk_fma_f32 v[54:55], v[18:19], v[18:19], v[54:55]
v_pk_add_f32 v[52:53], v[52:53], v[20:21]
v_pk_fma_f32 v[54:55], v[20:21], v[20:21], v[54:55]
v_pk_add_f32 v[52:53], v[52:53], v[22:23]
v_pk_fma_f32 v[54:55], v[22:23], v[22:23], v[54:55]
v_pk_add_f32 v[52:53], v[52:53], v[24:25]
v_pk_fma_f32 v[54:55], v[24:25], v[24:25], v[54:55]
v_pk_add_f32 v[52:53], v[52:53], v[26:27]
v_pk_fma_f32 v[54:55], v[26:27], v[26:27], v[54:55]
v_pk_add_f32 v[52:53], v[52:53], v[28:29]
v_pk_fma_f32 v[54:55], v[28:29], v[28:29], v[54:55]
v_pk_add_f32 v[52:53], v[52:53], v[30:31]
v_pk_fma_f32 v[54:55], v[30:31], v[30:31], v[54:55]
v_pk_add_f32 v[52:53], v[52:53], v[32:33]
v_pk_fma_f32 v[54:55], v[32:33], v[32:33], v[54:55]
v_pk_add_f32 v[52:53], v[52:53], v[34:35]
v_pk_fma_f32 v[54:55], v[34:35], v[34:35], v[54:55]
v_add_f32 v52, v52, v53
v_add_f32 v54, v54, v55
s_mov_b64 exec, s[64:65]
buffer_store_dwordx4 v[48:51], v5, s[12:15], s34 offen
s_mov_b64 exec, -1
v_permlane32_swap_b32 v52, v54
v_add_f32 v53, v52, v54
v_add_f32 v52, v52, v54
s_nop 1
v_permlane16_swap_b32 v52, v53
v_add_f32 v52, v52, v53
s_mov_b64 exec, s[64:65]
buffer_store_dword v52, v7, s[4:7], s35 offen
s_mov_b64 exec, -1
Lt76:
s_mov_b32 s50, s32
s_add_u32 s78, s40, 4096
v_mov_b32 v15, 6
s_cmp_eq_u32 s18, 0
s_cbranch_scc1 Lo77
s_waitcnt vmcnt(0) lgkmcnt(0)
s_barrier
s_sub_u32 s60, s18, 1
s_mul_i32 s53, s60, 2048
s_add_u32 m0, s53, 34816
s_add_u32 s52, s29, s53
s_add_u32 s52, s52, 116736
buffer_load_dwordx4 v1, s[4:7], s52 offen offset:0 sc1 lds
buffer_load_dwordx4 v1, s[4:7], s52 offen offset:1024 sc1 lds
s_branch Lj78
Lr80_x:
s_add_u32 s57, s57, 1
s_cmp_lt_u32 s57, 1048576
s_cbranch_scc1 Lr80_0
s_mov_b64 vcc, 0
s_branch Lr80_d
Lo77:
s_cbranch_vccnz Lw79
s_mov_b32 s57, 0
s_mov_b64 exec, 1
s_waitcnt vmcnt(0) lgkmcnt(0)
s_barrier
buffer_store_dword v15, v12, s[4:7], s49 offen
s_mov_b64 exec, 0xffff
Lr80_0:
buffer_load_dword v15, v7, s[4:7], s23 offen sc1
Lr80_w:
s_waitcnt vmcnt(0)
v_cmp_gt_u32 vcc, 6, v15
s_nop 0
s_cbranch_vccnz Lr80_x
Lr80_d:
s_mov_b64 exec, -1
Lj78:
s_barrier
buffer_load_dwordx4 a[0:3], v4, s[12:15], s50 offen offset:0 sc1
buffer_load_dwordx4 a[4:7], v4, s[12:15], s50 offen offset:256 sc1
buffer_load_dwordx4 a[8:11], v4, s[12:15], s50 offen offset:2048 sc1
buffer_load_dwordx4 a[12:15], v4, s[12:15], s50 offen offset:2304 sc1
s_add_u32 s50, s50, 4096
buffer_load_dwordx4 a[16:19], v4, s[12:15], s50 offen offset:0 sc1
buffer_load_dwordx4 a[20:23], v4, s[12:15], s50 offen offset:256 sc1
buffer_load_dword v216, v6, s[4:7], s33 offen offset:0 sc1
buffer_load_dword v217, v6, s[4:7], s33 offen offset:128 sc1
buffer_load_dword v218, v6, s[4:7], s33 offen offset:256 sc1
buffer_load_dword v219, v6, s[4:7], s33 offen offset:384 sc1
buffer_load_dword v220, v6, s[4:7], s33 offen offset:512 sc1
buffer_load_dword v221, v6, s[4:7], s33 offen offset:640 sc1
buffer_load_dword v222, v6, s[4:7], s33 offen offset:768 sc1
buffer_load_dword v223, v6, s[4:7], s33 offen offset:896 sc1
buffer_load_dwordx4 a[24:27], v4, s[12:15], s50 offen offset:2048 sc1
buffer_load_dwordx4 a[28:31], v4, s[12:15], s50 offen offset:2304 sc1
s_add_u32 s50, s50, 4096
buffer_load_dwordx4 a[32:35], v4, s[12:15], s50 offen offset:0 sc1
buffer_load_dwordx4 a[36:39], v4, s[12:15], s50 offen offset:256 sc1
buffer_load_dwordx4 a[40:43], v4, s[12:15], s50 offen offset:2048 sc1
buffer_load_dwordx4 a[44:47], v4, s[12:15], s50 offen offset:2304 sc1
s_add_u32 s50, s50, 4096
buffer_load_dwordx4 a[48:51], v4, s[12:15], s50 offen offset:0 sc1
s_waitcnt vmcnt(19)
s_barrier
ds_read_b128 v[136:139], v2 offset:12288
ds_read_b128 v[140:143], v2 offset:13312
ds_read_b128 v[144:147], v2 offset:14336
ds_read_b128 v[148:151], v2 offset:15360
ds_read_b128 v[152:155], v2 offset:16384
ds_read_b128 v[156:159], v2 offset:17408
s_waitcnt lgkmcnt(5)
v_mfma_f32_16x16x32_bf16 v[40:43], v[136:139], a[0:3], 0
buffer_load_dwordx4 a[52:55], v4, s[12:15], s50 offen offset:256 sc1
v_mfma_f32_16x16x32_bf16 v[48:51], v[136:139], a[4:7], 0
ds_read_b128 v[160:163], v2 offset:18432
s_waitcnt lgkmcnt(5)
v_mfma_f32_16x16x32_bf16 v[52:55], v[140:143], a[4:7], 0
v_mfma_f32_16x16x32_bf16 v[44:47], v[140:143], a[0:3], 0
s_waitcnt lgkmcnt(3)
ds_read_b128 v[164:167], v2 offset:19456
v_mfma_f32_16x16x32_bf16 v[56:59], v[144:147], a[0:3], 0
buffer_load_dwordx4 a[56:59], v4, s[12:15], s50 offen offset:2048 sc1
v_mfma_f32_16x16x32_bf16 v[64:67], v[144:147], a[4:7], 0
ds_read_b128 v[136:139], v2 offset:20480
v_mfma_f32_16x16x32_bf16 v[68:71], v[148:151], a[4:7], 0
ds_read_b128 v[200:203], v8 offset:512
v_mfma_f32_16x16x32_bf16 v[60:63], v[148:151], a[0:3], 0
s_waitcnt vmcnt(19) lgkmcnt(4)
ds_read_b128 v[140:143], v2 offset:21504
v_mfma_f32_16x16x32_bf16 v[40:43], v[152:155], a[8:11], v[40:43]
buffer_load_dwordx4 a[60:63], v4, s[12:15], s50 offen offset:2304 sc1
v_mfma_f32_16x16x32_bf16 v[48:51], v[152:155], a[12:15], v[48:51]
s_add_u32 s50, s50, 4096
ds_read_b128 v[144:147], v2 offset:22528
v_mfma_f32_16x16x32_bf16 v[52:55], v[156:159], a[12:15], v[52:55]
ds_read_b128 v[204:207], v8 offset:576
v_mfma_f32_16x16x32_bf16 v[44:47], v[156:159], a[8:11], v[44:47]
s_waitcnt lgkmcnt(5)
ds_read_b128 v[148:151], v2 offset:23552
v_mfma_f32_16x16x32_bf16 v[56:59], v[160:163], a[8:11], v[56:59]
buffer_load_dwordx4 a[64:67], v4, s[12:15], s50 offen offset:0 sc1
v_mfma_f32_16x16x32_bf16 v[64:67], v[160:163], a[12:15], v[64:67]
ds_read_b128 v[152:155], v2 offset:24576
v_mfma_f32_16x16x32_bf16 v[68:71], v[164:167], a[12:15], v[68:71]
ds_read_b128 v[208:211], v8 offset:640
v_mfma_f32_16x16x32_bf16 v[60:63], v[164:167], a[8:11], v[60:63]
s_waitcnt vmcnt(19) lgkmcnt(5)
ds_read_b128 v[156:159], v2 offset:25600
v_mfma_f32_16x16x32_bf16 v[40:43], v[136:139], a[16:19], v[40:43]
buffer_load_dwordx4 a[68:71], v4, s[12:15], s50 offen offset:256 sc1
v_mfma_f32_16x16x32_bf16 v[48:51], v[136:139], a[20:23], v[48:51]
ds_read_b128 v[160:163], v2 offset:26624
v_mfma_f32_16x16x32_bf16 v[52:55], v[140:143], a[20:23], v[52:55]
ds_read_b128 v[212:215], v8 offset:704
v_mfma_f32_16x16x32_bf16 v[44:47], v[140:143], a[16:19], v[44:47]
s_waitcnt lgkmcnt(5)
ds_read_b128 v[164:167], v2 offset:27648
v_mfma_f32_16x16x32_bf16 v[56:59], v[144:147], a[16:19], v[56:59]
buffer_load_dwordx4 a[72:75], v4, s[12:15], s50 offen offset:2048 sc1
v_mfma_f32_16x16x32_bf16 v[64:67], v[144:147], a[20:23], v[64:67]
ds_read_b128 v[136:139], v2 offset:28672
v_mfma_f32_16x16x32_bf16 v[68:71], v[148:151], a[20:23], v[68:71]
ds_read_b128 v[72:75], v8 offset:768
v_mfma_f32_16x16x32_bf16 v[60:63], v[148:151], a[16:19], v[60:63]
s_waitcnt vmcnt(11) lgkmcnt(5)
ds_read_b128 v[140:143], v2 offset:29696
v_mfma_f32_16x16x32_bf16 v[40:43], v[152:155], a[24:27], v[40:43]
buffer_load_dwordx4 a[76:79], v4, s[12:15], s50 offen offset:2304 sc1
v_mfma_f32_16x16x32_bf16 v[48:51], v[152:155], a[28:31], v[48:51]
s_add_u32 s50, s50, 4096
ds_read_b128 v[144:147], v2 offset:30720
v_mfma_f32_16x16x32_bf16 v[52:55], v[156:159], a[28:31], v[52:55]
ds_read_b128 v[76:79], v8 offset:832
v_mfma_f32_16x16x32_bf16 v[44:47], v[156:159], a[24:27], v[44:47]
s_waitcnt lgkmcnt(5)
ds_read_b128 v[148:151], v2 offset:31744
v_mfma_f32_16x16x32_bf16 v[56:59], v[160:163], a[24:27], v[56:59]
buffer_load_dwordx4 a[80:83], v4, s[12:15], s50 offen offset:0 sc1
v_mfma_f32_16x16x32_bf16 v[64:67], v[160:163], a[28:31], v[64:67]
ds_read_b128 v[152:155], v2 offset:32768
v_add_f32 v216, v216, v217
v_mfma_f32_16x16x32_bf16 v[68:71], v[164:167], a[28:31], v[68:71]
ds_read_b128 v[88:91], v8 offset:896
v_add_f32 v218, v218, v219
v_mfma_f32_16x16x32_bf16 v[60:63], v[164:167], a[24:27], v[60:63]
s_waitcnt vmcnt(11) lgkmcnt(5)
ds_read_b128 v[156:159], v2 offset:33792
v_add_f32 v220, v220, v221
v_mfma_f32_16x16x32_bf16 v[40:43], v[136:139], a[32:35], v[40:43]
buffer_load_dwordx4 a[84:87], v4, s[12:15], s50 offen offset:256 sc1
v_mfma_f32_16x16x32_bf16 v[48:51], v[136:139], a[36:39], v[48:51]
ds_read_b128 v[160:163], v2 offset:34816
v_add_f32 v222, v222, v223
v_mfma_f32_16x16x32_bf16 v[52:55], v[140:143], a[36:39], v[52:55]
ds_read_b128 v[92:95], v8 offset:960
v_add_f32 v216, v216, v218
v_mfma_f32_16x16x32_bf16 v[44:47], v[140:143], a[32:35], v[44:47]
s_waitcnt lgkmcnt(5)
ds_read_b128 v[164:167], v2 offset:35840
v_add_f32 v220, v220, v222
v_mfma_f32_16x16x32_bf16 v[56:59], v[144:147], a[32:35], v[56:59]
buffer_load_dwordx4 a[88:91], v4, s[12:15], s50 offen offset:2048 sc1
v_mfma_f32_16x16x32_bf16 v[64:67], v[144:147], a[36:39], v[64:67]
ds_read_b128 v[136:139], v2 offset:36864
v_add_f32 v216, v216, v220
v_mfma_f32_16x16x32_bf16 v[68:71], v[148:151], a[36:39], v[68:71]
ds_read_b128 v[104:107], v8 offset:1024
v_mul_f32 v216, 986500301, v216
v_mfma_f32_16x16x32_bf16 v[60:63], v[148:151], a[32:35], v[60:63]
s_waitcnt vmcnt(11) lgkmcnt(5)
ds_read_b128 v[140:143], v2 offset:37888
v_mov_b32 v217, v216
v_mfma_f32_16x16x32_bf16 v[40:43], v[152:155], a[40:43], v[40:43]
buffer_load_dwordx4 a[92:95], v4, s[12:15], s50 offen offset:2304 sc1
v_mfma_f32_16x16x32_bf16 v[48:51], v[152:155], a[44:47], v[48:51]
s_add_u32 s50, s50, 4096
ds_read_b128 v[144:147], v2 offset:38912
v_mfma_f32_16x16x32_bf16 v[52:55], v[156:159], a[44:47], v[52:55]
ds_read_b128 v[108:111], v8 offset:1088
v_mfma_f32_16x16x32_bf16 v[44:47], v[156:159], a[40:43], v[44:47]
s_waitcnt lgkmcnt(5)
ds_read_b128 v[148:151], v2 offset:39936
v_mfma_f32_16x16x32_bf16 v[56:59], v[160:163], a[40:43], v[56:59]
buffer_load_dwordx4 a[96:99], v4, s[12:15], s50 offen offset:0 sc1
v_mfma_f32_16x16x32_bf16 v[64:67], v[160:163], a[44:47], v[64:67]
ds_read_b128 v[152:155], v2 offset:40960
v_mfma_f32_16x16x32_bf16 v[68:71], v[164:167], a[44:47], v[68:71]
ds_read_b128 v[120:123], v8 offset:1152
v_mfma_f32_16x16x32_bf16 v[60:63], v[164:167], a[40:43], v[60:63]
s_waitcnt vmcnt(11) lgkmcnt(5)
ds_read_b128 v[156:159], v2 offset:41984
v_mfma_f32_16x16x32_bf16 v[40:43], v[136:139], a[48:51], v[40:43]
buffer_load_dwordx4 a[100:103], v4, s[12:15], s50 offen offset:256 sc1
v_mfma_f32_16x16x32_bf16 v[48:51], v[136:139], a[52:55], v[48:51]
ds_read_b128 v[160:163], v2 offset:43008
v_mfma_f32_16x16x32_bf16 v[52:55], v[140:143], a[52:55], v[52:55]
ds_read_b128 v[124:127], v8 offset:1216
v_mfma_f32_16x16x32_bf16 v[44:47], v[140:143], a[48:51], v[44:47]
s_waitcnt lgkmcnt(5)
ds_read_b128 v[164:167], v2 offset:44032
v_mfma_f32_16x16x32_bf16 v[56:59], v[144:147], a[48:51], v[56:59]
buffer_load_dwordx4 a[104:107], v4, s[12:15], s50 offen offset:2048 sc1
v_mfma_f32_16x16x32_bf16 v[64:67], v[144:147], a[52:55], v[64:67]
ds_read_b128 v[136:139], v2 offset:45056
v_mfma_f32_16x16x32_bf16 v[68:71], v[148:151], a[52:55], v[68:71]
v_permlane32_swap_b32 v216, v217
v_mfma_f32_16x16x32_bf16 v[60:63], v[148:151], a[48:51], v[60:63]
s_waitcnt vmcnt(11) lgkmcnt(4)
ds_read_b128 v[140:143], v2 offset:46080
v_fma_f32 v217, -v216, v216, v217
v_mfma_f32_16x16x32_bf16 v[40:43], v[152:155], a[56:59], v[40:43]
buffer_load_dwordx4 a[108:111], v4, s[12:15], s50 offen offset:2304 sc1
v_mfma_f32_16x16x32_bf16 v[48:51], v[152:155], a[60:63], v[48:51]
s_add_u32 s50, s50, 4096
ds_read_b128 v[144:147], v2 offset:47104
v_max_f32 v217, 0, v217
v_mfma_f32_16x16x32_bf16 v[52:55], v[156:159], a[60:63], v[52:55]
v_add_f32 v217, 925353388, v217
v_mfma_f32_16x16x32_bf16 v[44:47], v[156:159], a[56:59], v[44:47]
s_waitcnt lgkmcnt(3)
ds_read_b128 v[148:151], v2 offset:48128
v_mfma_f32_16x16x32_bf16 v[56:59], v[160:163], a[56:59], v[56:59]
buffer_load_dwordx4 a[112:115], v4, s[12:15], s50 offen offset:0 sc1
v_mfma_f32_16x16x32_bf16 v[64:67], v[160:163], a[60:63], v[64:67]
ds_read_b128 v[152:155], v2 offset:49152
v_mfma_f32_16x16x32_bf16 v[68:71], v[164:167], a[60:63], v[68:71]
v_rsq_f32 v36, v217
v_mfma_f32_16x16x32_bf16 v[60:63], v[164:167], a[56:59], v[60:63]
s_waitcnt vmcnt(11) lgkmcnt(3)
ds_read_b128 v[156:159], v2 offset:50176
v_sub_f32 v242, 0, v216
v_mfma_f32_16x16x32_bf16 v[40:43], v[136:139], a[64:67], v[40:43]
buffer_load_dwordx4 a[116:119], v4, s[12:15], s50 offen offset:256 sc1
v_mfma_f32_16x16x32_bf16 v[48:51], v[136:139], a[68:71], v[48:51]
ds_read_b128 v[160:163], v2 offset:51200
v_mul_f32 v236, 3222493025, v36
v_mfma_f32_16x16x32_bf16 v[52:55], v[140:143], a[68:71], v[52:55]
v_mul_f32 v238, v36, v36
v_mov_b32 v240, v217
v_mfma_f32_16x16x32_bf16 v[44:47], v[140:143], a[64:67], v[44:47]
s_waitcnt lgkmcnt(3)
ds_read_b128 v[164:167], v2 offset:52224
v_mul_f32 v238, v238, v36
v_mfma_f32_16x16x32_bf16 v[56:59], v[144:147], a[64:67], v[56:59]
buffer_load_dwordx4 a[120:123], v4, s[12:15], s50 offen offset:2048 sc1
v_mfma_f32_16x16x32_bf16 v[64:67], v[144:147], a[68:71], v[64:67]
ds_read_b128 v[136:139], v2 offset:53248
v_mul_f32 v238, 3184710632, v238
v_mfma_f32_16x16x32_bf16 v[68:71], v[148:151], a[68:71], v[68:71]
v_mov_b32 v237, v236
v_mov_b32 v239, v238
v_mfma_f32_16x16x32_bf16 v[60:63], v[148:151], a[64:67], v[60:63]
s_waitcnt vmcnt(11) lgkmcnt(3)
ds_read_b128 v[140:143], v2 offset:54272
v_mov_b32 v241, v240
v_mfma_f32_16x16x32_bf16 v[40:43], v[152:155], a[72:75], v[40:43]
buffer_load_dwordx4 a[124:127], v4, s[12:15], s50 offen offset:2304 sc1
v_mfma_f32_16x16x32_bf16 v[48:51], v[152:155], a[76:79], v[48:51]
s_add_u32 s50, s50, 4096
ds_read_b128 v[144:147], v2 offset:55296
v_mov_b32 v243, v242
v_mfma_f32_16x16x32_bf16 v[52:55], v[156:159], a[76:79], v[52:55]
v_permlane16_swap_b32 v236, v237
v_mfma_f32_16x16x32_bf16 v[44:47], v[156:159], a[72:75], v[44:47]
s_waitcnt lgkmcnt(3)
ds_read_b128 v[148:151], v2 offset:56320
v_mfma_f32_16x16x32_bf16 v[56:59], v[160:163], a[72:75], v[56:59]
buffer_load_dwordx4 a[128:131], v4, s[12:15], s50 offen offset:0 sc1
v_mfma_f32_16x16x32_bf16 v[64:67], v[160:163], a[76:79], v[64:67]
ds_read_b128 v[152:155], v2 offset:57344
v_mfma_f32_16x16x32_bf16 v[68:71], v[164:167], a[76:79], v[68:71]
v_permlane16_swap_b32 v238, v239
v_mfma_f32_16x16x32_bf16 v[60:63], v[164:167], a[72:75], v[60:63]
s_waitcnt vmcnt(11) lgkmcnt(3)
ds_read_b128 v[156:159], v2 offset:58368
v_mfma_f32_16x16x32_bf16 v[40:43], v[136:139], a[80:83], v[40:43]
buffer_load_dwordx4 a[132:135], v4, s[12:15], s50 offen offset:256 sc1
v_mfma_f32_16x16x32_bf16 v[48:51], v[136:139], a[84:87], v[48:51]
ds_read_b128 v[160:163], v2 offset:59392
v_mfma_f32_16x16x32_bf16 v[52:55], v[140:143], a[84:87], v[52:55]
v_permlane16_swap_b32 v240, v241
v_mfma_f32_16x16x32_bf16 v[44:47], v[140:143], a[80:83], v[44:47]
s_waitcnt lgkmcnt(3)
ds_read_b128 v[164:167], v2 offset:60416
v_mfma_f32_16x16x32_bf16 v[56:59], v[144:147], a[80:83], v[56:59]
buffer_load_dwordx4 a[136:139], v4, s[12:15], s50 offen offset:2048 sc1
v_mfma_f32_16x16x32_bf16 v[64:67], v[144:147], a[84:87], v[64:67]
ds_read_b128 v[136:139], v2 offset:61440
v_mfma_f32_16x16x32_bf16 v[68:71], v[148:151], a[84:87], v[68:71]
v_permlane16_swap_b32 v242, v243
v_mfma_f32_16x16x32_bf16 v[60:63], v[148:151], a[80:83], v[60:63]
s_waitcnt vmcnt(11) lgkmcnt(3)
ds_read_b128 v[140:143], v2 offset:62464
v_mul_f32 v80, v72, v243
v_mfma_f32_16x16x32_bf16 v[40:43], v[152:155], a[88:91], v[40:43]
s_add_u32 s66, s18, 1
buffer_load_dwordx4 a[140:143], v4, s[12:15], s50 offen offset:2304 sc1
v_mfma_f32_16x16x32_bf16 v[48:51], v[152:155], a[92:95], v[48:51]
s_add_u32 s50, s50, 4096
ds_read_b128 v[144:147], v2 offset:63488
v_mul_f32 v81, v73, v243
v_mfma_f32_16x16x32_bf16 v[52:55], v[156:159], a[92:95], v[52:55]
s_and_b32 s66, s66, 3
v_mul_f32 v82, v74, v243
v_mul_f32 v83, v75, v243
v_mfma_f32_16x16x32_bf16 v[44:47], v[156:159], a[88:91], v[44:47]
s_waitcnt lgkmcnt(3)
ds_read_b128 v[148:151], v2 offset:64512
v_mul_f32 v72, v72, v242
v_mfma_f32_16x16x32_bf16 v[56:59], v[160:163], a[88:91], v[56:59]
s_lshr_b32 s67, s66, 1
buffer_load_dwordx4 a[144:147], v4, s[12:15], s50 offen offset:0 sc1
v_mfma_f32_16x16x32_bf16 v[64:67], v[160:163], a[92:95], v[64:67]
s_mul_i32 s67, s67, 101888
ds_read_b128 v[152:155], v3 offset:0
v_mul_f32 v73, v73, v242
v_mfma_f32_16x16x32_bf16 v[68:71], v[164:167], a[92:95], v[68:71]
s_lshl_b32 s62, s66, 8
v_mul_f32 v74, v74, v242
v_mul_f32 v75, v75, v242
v_mfma_f32_16x16x32_bf16 v[60:63], v[164:167], a[88:91], v[60:63]
s_waitcnt vmcnt(11) lgkmcnt(3)
ds_read_b128 v[156:159], v3 offset:1024
v_mul_f32 v84, v76, v243
v_mfma_f32_16x16x32_bf16 v[40:43], v[136:139], a[96:99], v[40:43]
s_add_u32 s62, s62, s67
buffer_load_dwordx4 a[148:151], v4, s[12:15], s50 offen offset:256 sc1
v_mfma_f32_16x16x32_bf16 v[48:51], v[136:139], a[100:103], v[48:51]
s_add_u32 s62, s62, s41
ds_read_b128 v[160:163], v3 offset:2048
v_mul_f32 v85, v77, v243
v_mfma_f32_16x16x32_bf16 v[52:55], v[140:143], a[100:103], v[52:55]
s_mul_i32 s66, s66, 5120
v_mul_f32 v86, v78, v243
v_mul_f32 v87, v79, v243
v_mfma_f32_16x16x32_bf16 v[44:47], v[140:143], a[96:99], v[44:47]
s_waitcnt lgkmcnt(3)
ds_read_b128 v[164:167], v3 offset:3072
v_mul_f32 v76, v76, v242
v_mfma_f32_16x16x32_bf16 v[56:59], v[144:147], a[96:99], v[56:59]
s_add_u32 s66, s66, 118784
buffer_load_dwordx4 a[152:155], v4, s[12:15], s50 offen offset:2048 sc1
v_mfma_f32_16x16x32_bf16 v[64:67], v[144:147], a[100:103], v[64:67]
ds_read_b128 v[136:139], v3 offset:4096
v_mul_f32 v77, v77, v242
v_mfma_f32_16x16x32_bf16 v[68:71], v[148:151], a[100:103], v[68:71]
v_mul_f32 v78, v78, v242
v_add_u32 v246, s66, v1
v_mfma_f32_16x16x32_bf16 v[60:63], v[148:151], a[96:99], v[60:63]
s_waitcnt vmcnt(11) lgkmcnt(3)
ds_read_b128 v[140:143], v3 offset:5120
v_mul_f32 v79, v79, v242
v_mfma_f32_16x16x32_bf16 v[40:43], v[152:155], a[104:107], v[40:43]
s_add_u32 s66, s18, 2
buffer_load_dwordx4 a[156:159], v4, s[12:15], s50 offen offset:2304 sc1
v_mfma_f32_16x16x32_bf16 v[48:51], v[152:155], a[108:111], v[48:51]
s_mul_i32 s53, s18, 5120
ds_read_b128 v[144:147], v3 offset:6144
v_mul_f32 v96, v88, v243
v_mfma_f32_16x16x32_bf16 v[52:55], v[156:159], a[108:111], v[52:55]
s_add_u32 m0, s53, 40960
v_mul_f32 v97, v89, v243
s_and_b32 s66, s66, 3
v_mfma_f32_16x16x32_bf16 v[44:47], v[156:159], a[104:107], v[44:47]
s_waitcnt lgkmcnt(3)
ds_read_b128 v[148:151], v3 offset:7168
s_add_u32 s52, s29, s53
v_mfma_f32_16x16x32_bf16 v[56:59], v[160:163], a[104:107], v[56:59]
s_add_u32 s52, s52, 122880
v_mul_f32 v98, v90, v243
s_lshr_b32 s67, s66, 1
v_mfma_f32_16x16x32_bf16 v[64:67], v[160:163], a[108:111], v[64:67]
s_mul_i32 s67, s67, 101888
ds_read_b128 v[152:155], v3 offset:8192
v_mul_f32 v99, v91, v243
v_mfma_f32_16x16x32_bf16 v[68:71], v[164:167], a[108:111], v[68:71]
s_lshl_b32 s63, s66, 8
buffer_load_dwordx4 v1, s[4:7], s52 offen offset:0 sc1 lds
v_mfma_f32_16x16x32_bf16 v[60:63], v[164:167], a[104:107], v[60:63]
s_waitcnt vmcnt(11) lgkmcnt(3)
ds_read_b128 v[156:159], v3 offset:9216
v_mul_f32 v88, v88, v242
v_mfma_f32_16x16x32_bf16 v[40:43], v[136:139], a[112:115], v[40:43]
s_add_u32 s63, s63, s67
v_mul_f32 v89, v89, v242
v_mul_f32 v90, v90, v242
v_mfma_f32_16x16x32_bf16 v[48:51], v[136:139], a[116:119], v[48:51]
s_add_u32 s63, s63, s41
ds_read_b128 v[160:163], v3 offset:10240
v_mul_f32 v91, v91, v242
v_mfma_f32_16x16x32_bf16 v[52:55], v[140:143], a[116:119], v[52:55]
s_mul_i32 s66, s66, 5120
buffer_load_dwordx4 v1, s[4:7], s52 offen offset:1024 sc1 lds
v_mfma_f32_16x16x32_bf16 v[44:47], v[140:143], a[112:115], v[44:47]
s_waitcnt lgkmcnt(3)
ds_read_b128 v[164:167], v3 offset:11264
v_mul_f32 v100, v92, v243
v_mfma_f32_16x16x32_bf16 v[56:59], v[144:147], a[112:115], v[56:59]
s_add_u32 s66, s66, 139264
v_mul_f32 v101, v93, v243
v_mul_f32 v102, v94, v243
v_mfma_f32_16x16x32_bf16 v[64:67], v[144:147], a[116:119], v[64:67]
ds_read_b128 v[136:139], v3 offset:12288
v_mul_f32 v103, v95, v243
v_mfma_f32_16x16x32_bf16 v[68:71], v[148:151], a[116:119], v[68:71]
buffer_load_dwordx4 v1, s[4:7], s52 offen offset:2048 sc1 lds
v_mfma_f32_16x16x32_bf16 v[60:63], v[148:151], a[112:115], v[60:63]
s_waitcnt vmcnt(11) lgkmcnt(3)
ds_read_b128 v[140:143], v3 offset:13312
v_mul_f32 v92, v92, v242
v_mfma_f32_16x16x32_bf16 v[40:43], v[152:155], a[120:123], v[40:43]
s_barrier
v_mfma_f32_16x16x32_bf16 v[48:51], v[152:155], a[124:127], v[48:51]
ds_read_b128 v[144:147], v3 offset:14336
v_mul_f32 v93, v93, v242
v_mfma_f32_16x16x32_bf16 v[52:55], v[156:159], a[124:127], v[52:55]
buffer_load_dwordx4 v1, s[4:7], s52 offen offset:3072 sc1 lds
v_mfma_f32_16x16x32_bf16 v[44:47], v[156:159], a[120:123], v[44:47]
s_waitcnt lgkmcnt(3)
ds_read_b128 v[148:151], v3 offset:15360
v_mul_f32 v94, v94, v242
v_mfma_f32_16x16x32_bf16 v[56:59], v[160:163], a[120:123], v[56:59]
s_add_u32 m0, m0, 4096
v_mul_f32 v95, v95, v242
v_add_u32 v247, s66, v1
v_mfma_f32_16x16x32_bf16 v[64:67], v[160:163], a[124:127], v[64:67]
s_add_u32 s52, s52, 4096
ds_read_b128 v[152:155], v3 offset:16384
v_mul_f32 v112, v104, v243
v_mfma_f32_16x16x32_bf16 v[68:71], v[164:167], a[124:127], v[68:71]
s_add_u32 s66, s18, 3
v_mul_f32 v113, v105, v243
v_mul_f32 v114, v106, v243
v_mfma_f32_16x16x32_bf16 v[60:63], v[164:167], a[120:123], v[60:63]
s_waitcnt vmcnt(10) lgkmcnt(3)
ds_read_b128 v[156:159], v3 offset:17408
v_mul_f32 v115, v107, v243
v_mfma_f32_16x16x32_bf16 v[40:43], v[136:139], a[128:131], v[40:43]
s_and_b32 s66, s66, 3
buffer_load_dwordx4 v1, s[4:7], s52 offen offset:0 sc1 lds
v_mfma_f32_16x16x32_bf16 v[48:51], v[136:139], a[132:135], v[48:51]
s_lshr_b32 s67, s66, 1
ds_read_b128 v[160:163], v3 offset:18432
v_mul_f32 v104, v104, v242
v_mfma_f32_16x16x32_bf16 v[52:55], v[140:143], a[132:135], v[52:55]
s_mul_i32 s53, s18, 5120
v_mul_f32 v105, v105, v242
s_mul_i32 s67, s67, 101888
v_mfma_f32_16x16x32_bf16 v[44:47], v[140:143], a[128:131], v[44:47]
s_waitcnt lgkmcnt(3)
ds_read_b128 v[164:167], v3 offset:19456
s_add_u32 m0, s53, 77824
v_mfma_f32_16x16x32_bf16 v[56:59], v[144:147], a[128:131], v[56:59]
s_add_u32 s52, s29, s53
v_mul_f32 v106, v106, v242
s_lshl_b32 s64, s66, 8
v_mfma_f32_16x16x32_bf16 v[64:67], v[144:147], a[132:135], v[64:67]
s_add_u32 s52, s52, 143360
ds_read_b128 v[136:139], v3 offset:20480
v_mul_f32 v107, v107, v242
v_mfma_f32_16x16x32_bf16 v[68:71], v[148:151], a[132:135], v[68:71]
s_add_u32 s64, s64, s67
buffer_load_dwordx4 v1, s[4:7], s52 offen offset:0 sc1 lds
v_mfma_f32_16x16x32_bf16 v[60:63], v[148:151], a[128:131], v[60:63]
s_waitcnt vmcnt(10) lgkmcnt(3)
ds_read_b128 v[140:143], v3 offset:21504
v_mul_f32 v116, v108, v243
v_mfma_f32_16x16x32_bf16 v[40:43], v[152:155], a[136:139], v[40:43]
s_add_u32 s64, s64, s41
v_mul_f32 v117, v109, v243
v_mul_f32 v118, v110, v243
v_mfma_f32_16x16x32_bf16 v[48:51], v[152:155], a[140:143], v[48:51]
s_mul_i32 s66, s66, 5120
ds_read_b128 v[144:147], v3 offset:22528
v_mul_f32 v119, v111, v243
v_mfma_f32_16x16x32_bf16 v[52:55], v[156:159], a[140:143], v[52:55]
s_add_u32 s66, s66, 118784
v_mul_f32 v108, v108, v242
v_mul_f32 v109, v109, v242
v_mfma_f32_16x16x32_bf16 v[44:47], v[156:159], a[136:139], v[44:47]
s_waitcnt lgkmcnt(3)
ds_read_b128 v[148:151], v3 offset:23552
v_mul_f32 v110, v110, v242
v_mfma_f32_16x16x32_bf16 v[56:59], v[160:163], a[136:139], v[56:59]
buffer_load_dwordx4 v1, s[4:7], s52 offen offset:1024 sc1 lds
v_mfma_f32_16x16x32_bf16 v[64:67], v[160:163], a[140:143], v[64:67]
ds_read_b128 v[152:155], v3 offset:24576
v_mul_f32 v111, v111, v242
v_mfma_f32_16x16x32_bf16 v[68:71], v[164:167], a[140:143], v[68:71]
v_mul_f32 v128, v120, v243
v_add_u32 v248, s66, v1
v_mfma_f32_16x16x32_bf16 v[60:63], v[164:167], a[136:139], v[60:63]
s_waitcnt vmcnt(9) lgkmcnt(3)
ds_read_b128 v[156:159], v3 offset:25600
v_mul_f32 v129, v121, v243
v_mfma_f32_16x16x32_bf16 v[40:43], v[136:139], a[144:147], v[40:43]
s_add_u32 s66, s18, 4
v_mul_f32 v130, v122, v243
v_mul_f32 v131, v123, v243
v_mfma_f32_16x16x32_bf16 v[48:51], v[136:139], a[148:151], v[48:51]
s_and_b32 s66, s66, 3
ds_read_b128 v[160:163], v3 offset:26624
v_mul_f32 v120, v120, v242
v_mfma_f32_16x16x32_bf16 v[52:55], v[140:143], a[148:151], v[52:55]
s_lshr_b32 s67, s66, 1
buffer_load_dwordx4 v1, s[4:7], s52 offen offset:2048 sc1 lds
v_mfma_f32_16x16x32_bf16 v[44:47], v[140:143], a[144:147], v[44:47]
s_waitcnt lgkmcnt(3)
ds_read_b128 v[164:167], v3 offset:27648
v_mul_f32 v121, v121, v242
v_mfma_f32_16x16x32_bf16 v[56:59], v[144:147], a[144:147], v[56:59]
s_mul_i32 s67, s67, 101888
v_mul_f32 v122, v122, v242
v_mul_f32 v123, v123, v242
v_mfma_f32_16x16x32_bf16 v[64:67], v[144:147], a[148:151], v[64:67]
s_lshl_b32 s65, s66, 8
ds_read_b128 v[136:139], v1 offset:0
v_mul_f32 v132, v124, v243
v_mfma_f32_16x16x32_bf16 v[68:71], v[148:151], a[148:151], v[68:71]
s_add_u32 s65, s65, s67
v_mul_f32 v133, v125, v243
v_mul_f32 v134, v126, v243
v_mfma_f32_16x16x32_bf16 v[60:63], v[148:151], a[144:147], v[60:63]
s_waitcnt vmcnt(8) lgkmcnt(3)
ds_read_b128 v[140:143], v1 offset:1024
v_mul_f32 v135, v127, v243
v_mfma_f32_16x16x32_bf16 v[40:43], v[152:155], a[152:155], v[40:43]
s_add_u32 s65, s65, s41
buffer_load_dwordx4 v1, s[4:7], s52 offen offset:3072 sc1 lds
v_mfma_f32_16x16x32_bf16 v[48:51], v[152:155], a[156:159], v[48:51]
s_mul_i32 s66, s66, 5120
ds_read_b128 v[144:147], v1 offset:2048
v_mul_f32 v124, v124, v242
v_mfma_f32_16x16x32_bf16 v[52:55], v[156:159], a[156:159], v[52:55]
s_add_u32 m0, m0, 4096
v_mul_f32 v125, v125, v242
s_add_u32 s66, s66, 118784
v_mfma_f32_16x16x32_bf16 v[44:47], v[156:159], a[152:155], v[44:47]
s_waitcnt lgkmcnt(3)
ds_read_b128 v[148:151], v1 offset:3072
s_add_u32 s52, s52, 4096
v_mfma_f32_16x16x32_bf16 v[56:59], v[160:163], a[152:155], v[56:59]
v_mul_f32 v126, v126, v242
v_add_u32 v249, s66, v1
v_mfma_f32_16x16x32_bf16 v[64:67], v[160:163], a[156:159], v[64:67]
ds_read_b128 v[152:155], v1 offset:4096
v_mul_f32 v127, v127, v242
v_mfma_f32_16x16x32_bf16 v[68:71], v[164:167], a[156:159], v[68:71]
buffer_load_dwordx4 v1, s[4:7], s52 offen offset:0 sc1 lds
v_mfma_f32_16x16x32_bf16 v[60:63], v[164:167], a[152:155], v[60:63]
s_waitcnt lgkmcnt(3)
ds_read_b128 v[156:159], v1 offset:5120
v_bfe_u32 v254, v1, 4, 4
v_mfma_f32_16x16x32_bf16 v[72:75], v[136:139], a[0:3], v[72:75]
s_mul_i32 s53, s18, 5120
v_mul_u32_u24 v254, 1280, v254
s_add_u32 m0, s53, 98304
v_mfma_f32_16x16x32_bf16 v[80:83], v[136:139], a[4:7], v[80:83]
s_add_u32 s52, s29, s53
ds_read_b128 v[160:163], v1 offset:6144
v_lshrrev_b32 v253, 8, v1
v_mfma_f32_16x16x32_bf16 v[84:87], v[140:143], a[4:7], v[84:87]
s_add_u32 s52, s52, 163840
v_lshl_add_u32 v255, v253, 3, v254
v_lshl_add_u32 v254, v253, 4, v254
v_mfma_f32_16x16x32_bf16 v[76:79], v[140:143], a[0:3], v[76:79]
s_waitcnt lgkmcnt(3)
ds_read_b128 v[164:167], v1 offset:7168
v_mfma_f32_16x16x32_bf16 v[88:91], v[144:147], a[0:3], v[88:91]
buffer_load_dwordx4 v1, s[4:7], s52 offen offset:0 sc1 lds
v_mfma_f32_16x16x32_bf16 v[96:99], v[144:147], a[4:7], v[96:99]
ds_read_b128 v[136:139], v1 offset:8192
v_mfma_f32_16x16x32_bf16 v[100:103], v[148:151], a[4:7], v[100:103]
v_mfma_f32_16x16x32_bf16 v[92:95], v[148:151], a[0:3], v[92:95]
s_waitcnt lgkmcnt(3)
ds_read_b128 v[140:143], v1 offset:9216
v_mfma_f32_16x16x32_bf16 v[72:75], v[152:155], a[8:11], v[72:75]
v_fma_f32 v40, v200, v242, v40
v_fma_f32 v42, v202, v242, v42
v_mfma_f32_16x16x32_bf16 v[80:83], v[152:155], a[12:15], v[80:83]
ds_read_b128 v[144:147], v1 offset:10240
v_fma_f32 v41, v201, v242, v41
v_mfma_f32_16x16x32_bf16 v[84:87], v[156:159], a[12:15], v[84:87]
buffer_load_dwordx4 v1, s[4:7], s52 offen offset:1024 sc1 lds
v_mfma_f32_16x16x32_bf16 v[76:79], v[156:159], a[8:11], v[76:79]
s_waitcnt lgkmcnt(3)
ds_read_b128 v[148:151], v1 offset:11264
v_mul_f32 v216, v40, v40
v_mfma_f32_16x16x32_bf16 v[88:91], v[160:163], a[8:11], v[88:91]
v_mul_f32 v217, v41, v41
v_fma_f32 v43, v203, v242, v43
v_mfma_f32_16x16x32_bf16 v[96:99], v[160:163], a[12:15], v[96:99]
ds_read_b128 v[152:155], v1 offset:12288
v_fma_f32 v216, v216, v238, v236
v_mfma_f32_16x16x32_bf16 v[100:103], v[164:167], a[12:15], v[100:103]
v_fma_f32 v217, v217, v238, v236
v_mul_f32 v218, v42, v42
v_mfma_f32_16x16x32_bf16 v[92:95], v[164:167], a[8:11], v[92:95]
s_waitcnt lgkmcnt(3)
ds_read_b128 v[156:159], v1 offset:13312
v_mul_f32 v216, v216, v40
v_mfma_f32_16x16x32_bf16 v[72:75], v[136:139], a[16:19], v[72:75]
buffer_load_dwordx4 v1, s[4:7], s52 offen offset:2048 sc1 lds
v_mfma_f32_16x16x32_bf16 v[80:83], v[136:139], a[20:23], v[80:83]
ds_read_b128 v[160:163], v1 offset:14336
v_mul_f32 v217, v217, v41
v_mfma_f32_16x16x32_bf16 v[84:87], v[140:143], a[20:23], v[84:87]
v_exp_f32 v216, v216
v_mfma_f32_16x16x32_bf16 v[76:79], v[140:143], a[16:19], v[76:79]
s_waitcnt lgkmcnt(3)
ds_read_b128 v[164:167], v1 offset:15360
v_fma_f32 v56, v208, v242, v56
v_mfma_f32_16x16x32_bf16 v[88:91], v[144:147], a[16:19], v[88:91]
v_fma_f32 v57, v209, v242, v57
v_mul_f32 v219, v43, v43
v_mfma_f32_16x16x32_bf16 v[96:99], v[144:147], a[20:23], v[96:99]
ds_read_b128 v[136:139], v1 offset:16384
v_mul_f32 v56, v56, v40
v_mfma_f32_16x16x32_bf16 v[100:103], v[148:151], a[20:23], v[100:103]
buffer_load_dwordx4 v1, s[4:7], s52 offen offset:3072 sc1 lds
v_mfma_f32_16x16x32_bf16 v[92:95], v[148:151], a[16:19], v[92:95]
s_waitcnt lgkmcnt(3)
ds_read_b128 v[140:143], v1 offset:17408
v_fma_f32 v218, v218, v238, v236
v_mfma_f32_16x16x32_bf16 v[72:75], v[152:155], a[24:27], v[72:75]
s_add_u32 m0, m0, 4096
v_exp_f32 v217, v217
v_mfma_f32_16x16x32_bf16 v[80:83], v[152:155], a[28:31], v[80:83]
s_add_u32 s52, s52, 4096
ds_read_b128 v[144:147], v1 offset:18432
v_fma_f32 v216, v216, v240, v240
v_mfma_f32_16x16x32_bf16 v[84:87], v[156:159], a[28:31], v[84:87]
v_rcp_f32 v216, v216
v_mfma_f32_16x16x32_bf16 v[76:79], v[156:159], a[24:27], v[76:79]
s_waitcnt lgkmcnt(3)
ds_read_b128 v[148:151], v1 offset:19456
v_fma_f32 v217, v217, v240, v240
v_mfma_f32_16x16x32_bf16 v[88:91], v[160:163], a[24:27], v[88:91]
buffer_load_dwordx4 v1, s[4:7], s52 offen offset:0 sc1 lds
v_mfma_f32_16x16x32_bf16 v[96:99], v[160:163], a[28:31], v[96:99]
ds_read_b128 v[152:155], v1 offset:20480
v_mul_f32 v57, v57, v41
v_mfma_f32_16x16x32_bf16 v[100:103], v[164:167], a[28:31], v[100:103]
s_mul_i32 s53, s18, 5120
v_rcp_f32 v217, v217
v_mfma_f32_16x16x32_bf16 v[92:95], v[164:167], a[24:27], v[92:95]
s_waitcnt lgkmcnt(3)
ds_read_b128 v[156:159], v1 offset:21504
s_add_u32 m0, s53, 118784
v_mfma_f32_16x16x32_bf16 v[72:75], v[136:139], a[32:35], v[72:75]
s_add_u32 s52, s29, s53
v_mul_f32 v56, v56, v216
v_fma_f32 v219, v219, v238, v236
v_mfma_f32_16x16x32_bf16 v[80:83], v[136:139], a[36:39], v[80:83]
s_add_u32 s52, s52, 184320
ds_read_b128 v[160:163], v1 offset:22528
v_mul_f32 v57, v57, v217
v_mfma_f32_16x16x32_bf16 v[84:87], v[140:143], a[36:39], v[84:87]
buffer_load_dwordx4 v1, s[4:7], s52 offen offset:0 sc1 lds
v_mfma_f32_16x16x32_bf16 v[76:79], v[140:143], a[32:35], v[76:79]
s_waitcnt lgkmcnt(3)
ds_read_b128 v[164:167], v1 offset:23552
v_cvt_pk_bf16_f32 v228, v56, v57
v_mfma_f32_16x16x32_bf16 v[88:91], v[144:147], a[32:35], v[88:91]
v_fma_f32 v52, v204, v243, v52
v_mul_f32 v218, v218, v42
v_mfma_f32_16x16x32_bf16 v[96:99], v[144:147], a[36:39], v[96:99]
ds_read_b128 v[136:139], v1 offset:24576
v_fma_f32 v53, v205, v243, v53
v_mfma_f32_16x16x32_bf16 v[100:103], v[148:151], a[36:39], v[100:103]
v_mul_f32 v216, v52, v52
v_mul_f32 v219, v219, v43
v_mfma_f32_16x16x32_bf16 v[92:95], v[148:151], a[32:35], v[92:95]
s_waitcnt lgkmcnt(3)
ds_read_b128 v[140:143], v1 offset:25600
v_mul_f32 v217, v53, v53
v_mfma_f32_16x16x32_bf16 v[72:75], v[152:155], a[40:43], v[72:75]
s_barrier
v_mfma_f32_16x16x32_bf16 v[80:83], v[152:155], a[44:47], v[80:83]
ds_read_b128 v[144:147], v1 offset:26624
v_fma_f32 v216, v216, v239, v237
v_mfma_f32_16x16x32_bf16 v[84:87], v[156:159], a[44:47], v[84:87]
buffer_load_dwordx4 v1, s[4:7], s52 offen offset:1024 sc1 lds
v_mfma_f32_16x16x32_bf16 v[76:79], v[156:159], a[40:43], v[76:79]
s_waitcnt lgkmcnt(3)
ds_read_b128 v[148:151], v1 offset:27648
v_fma_f32 v217, v217, v239, v237
v_mfma_f32_16x16x32_bf16 v[88:91], v[160:163], a[40:43], v[88:91]
v_mul_f32 v216, v216, v52
v_fma_f32 v44, v204, v242, v44
v_mfma_f32_16x16x32_bf16 v[96:99], v[160:163], a[44:47], v[96:99]
ds_read_b128 v[152:155], v1 offset:28672
v_mul_f32 v217, v217, v53
v_mfma_f32_16x16x32_bf16 v[100:103], v[164:167], a[44:47], v[100:103]
buffer_load_dwordx4 v1, s[4:7], s52 offen offset:2048 sc1 lds
v_mfma_f32_16x16x32_bf16 v[92:95], v[164:167], a[40:43], v[92:95]
s_waitcnt lgkmcnt(3)
ds_read_b128 v[156:159], v1 offset:29696
v_fma_f32 v45, v205, v242, v45
v_mfma_f32_16x16x32_bf16 v[72:75], v[136:139], a[48:51], v[72:75]
v_exp_f32 v216, v216
v_mfma_f32_16x16x32_bf16 v[80:83], v[136:139], a[52:55], v[80:83]
ds_read_b128 v[160:163], v1 offset:30720
v_fma_f32 v68, v212, v243, v68
v_mfma_f32_16x16x32_bf16 v[84:87], v[140:143], a[52:55], v[84:87]
v_fma_f32 v69, v213, v243, v69
v_mul_f32 v220, v44, v44
v_mfma_f32_16x16x32_bf16 v[76:79], v[140:143], a[48:51], v[76:79]
s_waitcnt lgkmcnt(3)
ds_read_b128 v[164:167], v1 offset:31744
v_mul_f32 v68, v68, v52
v_mfma_f32_16x16x32_bf16 v[88:91], v[144:147], a[48:51], v[88:91]
buffer_load_dwordx4 v1, s[4:7], s52 offen offset:3072 sc1 lds
v_mfma_f32_16x16x32_bf16 v[96:99], v[144:147], a[52:55], v[96:99]
ds_read_b128 v[136:139], v1 offset:32768
v_mul_f32 v221, v45, v45
v_mfma_f32_16x16x32_bf16 v[100:103], v[148:151], a[52:55], v[100:103]
s_add_u32 m0, m0, 4096
v_exp_f32 v217, v217
v_mfma_f32_16x16x32_bf16 v[92:95], v[148:151], a[48:51], v[92:95]
s_waitcnt lgkmcnt(3)
ds_read_b128 v[140:143], v1 offset:33792
s_add_u32 s52, s52, 4096
v_mfma_f32_16x16x32_bf16 v[72:75], v[152:155], a[56:59], v[72:75]
v_fma_f32 v216, v216, v241, v241
v_fma_f32 v220, v220, v238, v236
v_mfma_f32_16x16x32_bf16 v[80:83], v[152:155], a[60:63], v[80:83]
ds_read_b128 v[144:147], v1 offset:34816
v_fma_f32 v221, v221, v238, v236
v_mfma_f32_16x16x32_bf16 v[84:87], v[156:159], a[60:63], v[84:87]
buffer_load_dwordx4 v1, s[4:7], s52 offen offset:0 sc1 lds
v_mfma_f32_16x16x32_bf16 v[76:79], v[156:159], a[56:59], v[76:79]
s_waitcnt lgkmcnt(3)
ds_read_b128 v[148:151], v1 offset:35840
s_mov_b32 s70, Lc83-C_pc+2048
v_mfma_f32_16x16x32_bf16 v[88:91], v[160:163], a[56:59], v[88:91]
s_mul_i32 s53, s18, 5120
s_min_u32 s70, s70, M_text_end-C_pc-16384
v_mul_f32 v220, v220, v44
v_mfma_f32_16x16x32_bf16 v[96:99], v[160:163], a[60:63], v[96:99]
s_add_u32 m0, s53, 139264
ds_read_b128 v[152:155], v1 offset:36864
v_mul_f32 v221, v221, v45
v_mfma_f32_16x16x32_bf16 v[100:103], v[164:167], a[60:63], v[100:103]
s_add_u32 s52, s29, s53
s_add_u32 s70, s70, s74
s_addc_u32 s71, s75, 0
v_mfma_f32_16x16x32_bf16 v[92:95], v[164:167], a[56:59], v[92:95]
s_waitcnt lgkmcnt(3)
ds_read_b128 v[156:159], v1 offset:37888
s_add_u32 s52, s52, 204800
v_mfma_f32_16x16x32_bf16 v[72:75], v[136:139], a[64:67], v[72:75]
s_waitcnt vmcnt(15)
s_barrier
s_mov_b64 exec, 1
Lc83:
global_load_dword v250, v0, s[70:71]
s_mov_b64 exec, -1
v_mfma_f32_16x16x32_bf16 v[80:83], v[136:139], a[68:71], v[80:83]
ds_read_b128 v[160:163], v1 offset:38912
v_fma_f32 v46, v206, v242, v46
v_mfma_f32_16x16x32_bf16 v[84:87], v[140:143], a[68:71], v[84:87]
buffer_load_dwordx4 v1, s[4:7], s52 offen offset:0 sc1 lds
v_mfma_f32_16x16x32_bf16 v[76:79], v[140:143], a[64:67], v[76:79]
s_waitcnt lgkmcnt(3)
ds_read_b128 v[164:167], v1 offset:39936
v_fma_f32 v47, v207, v242, v47
v_mfma_f32_16x16x32_bf16 v[88:91], v[144:147], a[64:67], v[88:91]
v_rcp_f32 v216, v216
v_mfma_f32_16x16x32_bf16 v[96:99], v[144:147], a[68:71], v[96:99]
ds_read_b128 v[136:139], v1 offset:40960
v_fma_f32 v217, v217, v241, v241
v_mfma_f32_16x16x32_bf16 v[100:103], v[148:151], a[68:71], v[100:103]
buffer_load_dwordx4 v1, s[4:7], s52 offen offset:1024 sc1 lds
v_mfma_f32_16x16x32_bf16 v[92:95], v[148:151], a[64:67], v[92:95]
s_waitcnt lgkmcnt(3)
ds_read_b128 v[140:143], v1 offset:41984
v_mul_f32 v69, v69, v53
v_mfma_f32_16x16x32_bf16 v[72:75], v[152:155], a[72:75], v[72:75]
v_rcp_f32 v217, v217
v_mfma_f32_16x16x32_bf16 v[80:83], v[152:155], a[76:79], v[80:83]
ds_read_b128 v[144:147], v1 offset:43008
v_mul_f32 v68, v68, v216
v_mfma_f32_16x16x32_bf16 v[84:87], v[156:159], a[76:79], v[84:87]
v_mul_f32 v69, v69, v217
v_mul_f32 v222, v46, v46
v_mfma_f32_16x16x32_bf16 v[76:79], v[156:159], a[72:75], v[76:79]
s_waitcnt lgkmcnt(3)
ds_read_b128 v[148:151], v1 offset:44032
v_cvt_pk_bf16_f32 v234, v68, v69
v_mfma_f32_16x16x32_bf16 v[88:91], v[160:163], a[72:75], v[88:91]
buffer_load_dwordx4 v1, s[4:7], s52 offen offset:2048 sc1 lds
v_mfma_f32_16x16x32_bf16 v[96:99], v[160:163], a[76:79], v[96:99]
ds_read_b128 v[152:155], v1 offset:45056
v_mul_f32 v223, v47, v47
v_mfma_f32_16x16x32_bf16 v[100:103], v[164:167], a[76:79], v[100:103]
v_exp_f32 v218, v218
v_mfma_f32_16x16x32_bf16 v[92:95], v[164:167], a[72:75], v[92:95]
s_waitcnt lgkmcnt(3)
ds_read_b128 v[156:159], v1 offset:46080
v_fma_f32 v58, v210, v242, v58
v_mfma_f32_16x16x32_bf16 v[72:75], v[136:139], a[80:83], v[72:75]
v_fma_f32 v59, v211, v242, v59
v_fma_f32 v222, v222, v238, v236
v_mfma_f32_16x16x32_bf16 v[80:83], v[136:139], a[84:87], v[80:83]
ds_read_b128 v[160:163], v1 offset:47104
v_mul_f32 v58, v58, v42
v_mfma_f32_16x16x32_bf16 v[84:87], v[140:143], a[84:87], v[84:87]
buffer_load_dwordx4 v1, s[4:7], s52 offen offset:3072 sc1 lds
v_mfma_f32_16x16x32_bf16 v[76:79], v[140:143], a[80:83], v[76:79]
s_waitcnt lgkmcnt(3)
ds_read_b128 v[164:167], v1 offset:48128
v_fma_f32 v223, v223, v238, v236
v_mfma_f32_16x16x32_bf16 v[88:91], v[144:147], a[80:83], v[88:91]
s_add_u32 m0, m0, 4096
v_exp_f32 v219, v219
v_mfma_f32_16x16x32_bf16 v[96:99], v[144:147], a[84:87], v[96:99]
s_add_u32 s52, s52, 4096
ds_read_b128 v[136:139], v1 offset:49152
v_fma_f32 v218, v218, v240, v240
v_mfma_f32_16x16x32_bf16 v[100:103], v[148:151], a[84:87], v[100:103]
v_rcp_f32 v218, v218
v_mfma_f32_16x16x32_bf16 v[92:95], v[148:151], a[80:83], v[92:95]
s_waitcnt lgkmcnt(3)
ds_read_b128 v[140:143], v1 offset:50176
v_fma_f32 v219, v219, v240, v240
v_mfma_f32_16x16x32_bf16 v[72:75], v[152:155], a[88:91], v[72:75]
buffer_load_dwordx4 v1, s[4:7], s52 offen offset:0 sc1 lds
v_mfma_f32_16x16x32_bf16 v[80:83], v[152:155], a[92:95], v[80:83]
ds_read_b128 v[144:147], v1 offset:51200
v_mul_f32 v59, v59, v43
v_mfma_f32_16x16x32_bf16 v[84:87], v[156:159], a[92:95], v[84:87]
s_mul_i32 s53, s18, 5120
v_rcp_f32 v219, v219
v_mfma_f32_16x16x32_bf16 v[76:79], v[156:159], a[88:91], v[76:79]
s_waitcnt lgkmcnt(3)
ds_read_b128 v[148:151], v1 offset:52224
s_add_u32 m0, s53, 0
v_mfma_f32_16x16x32_bf16 v[88:91], v[160:163], a[88:91], v[88:91]
s_add_u32 s52, s29, s53
v_mul_f32 v58, v58, v218
v_mul_f32 v222, v222, v46
v_mfma_f32_16x16x32_bf16 v[96:99], v[160:163], a[92:95], v[96:99]
s_add_u32 s52, s52, 225280
ds_read_b128 v[152:155], v1 offset:53248
v_mul_f32 v59, v59, v219
v_mfma_f32_16x16x32_bf16 v[100:103], v[164:167], a[92:95], v[100:103]
buffer_load_dwordx4 v1, s[4:7], s52 offen offset:0 sc1 lds
v_mfma_f32_16x16x32_bf16 v[92:95], v[164:167], a[88:91], v[92:95]
s_waitcnt lgkmcnt(3)
ds_read_b128 v[156:159], v1 offset:54272
v_cvt_pk_bf16_f32 v229, v58, v59
v_mfma_f32_16x16x32_bf16 v[72:75], v[136:139], a[96:99], v[72:75]
v_fma_f32 v54, v206, v243, v54
v_mul_f32 v223, v223, v47
v_mfma_f32_16x16x32_bf16 v[80:83], v[136:139], a[100:103], v[80:83]
ds_read_b128 v[160:163], v1 offset:55296
v_fma_f32 v55, v207, v243, v55
v_mfma_f32_16x16x32_bf16 v[84:87], v[140:143], a[100:103], v[84:87]
v_mul_f32 v218, v54, v54
v_fma_f32 v48, v200, v243, v48
v_mfma_f32_16x16x32_bf16 v[76:79], v[140:143], a[96:99], v[76:79]
s_waitcnt lgkmcnt(3)
ds_read_b128 v[164:167], v1 offset:56320
v_mul_f32 v219, v55, v55
v_mfma_f32_16x16x32_bf16 v[88:91], v[144:147], a[96:99], v[88:91]
buffer_load_dwordx4 v1, s[4:7], s52 offen offset:1024 sc1 lds
v_mfma_f32_16x16x32_bf16 v[96:99], v[144:147], a[100:103], v[96:99]
ds_read_b128 v[136:139], v1 offset:57344
v_fma_f32 v218, v218, v239, v237
v_mfma_f32_16x16x32_bf16 v[100:103], v[148:151], a[100:103], v[100:103]
v_fma_f32 v219, v219, v239, v237
v_fma_f32 v49, v201, v243, v49
v_mfma_f32_16x16x32_bf16 v[92:95], v[148:151], a[96:99], v[92:95]
s_waitcnt lgkmcnt(3)
ds_read_b128 v[140:143], v1 offset:58368
v_mul_f32 v218, v218, v54
v_mfma_f32_16x16x32_bf16 v[72:75], v[152:155], a[104:107], v[72:75]
s_waitcnt vmcnt(13)
s_barrier
v_mfma_f32_16x16x32_bf16 v[80:83], v[152:155], a[108:111], v[80:83]
ds_read_b128 v[144:147], v1 offset:59392
v_mul_f32 v219, v219, v55
v_mfma_f32_16x16x32_bf16 v[84:87], v[156:159], a[108:111], v[84:87]
buffer_load_dwordx4 v1, s[4:7], s52 offen offset:2048 sc1 lds
v_mfma_f32_16x16x32_bf16 v[76:79], v[156:159], a[104:107], v[76:79]
s_waitcnt lgkmcnt(3)
ds_read_b128 v[148:151], v1 offset:60416
v_mul_f32 v224, v48, v48
v_mfma_f32_16x16x32_bf16 v[88:91], v[160:163], a[104:107], v[88:91]
v_exp_f32 v218, v218
v_mfma_f32_16x16x32_bf16 v[96:99], v[160:163], a[108:111], v[96:99]
ds_read_b128 v[152:155], v2 offset:12288
v_fma_f32 v70, v214, v243, v70
v_mfma_f32_16x16x32_bf16 v[100:103], v[164:167], a[108:111], v[100:103]
v_fma_f32 v71, v215, v243, v71
v_mul_f32 v225, v49, v49
v_mfma_f32_16x16x32_bf16 v[92:95], v[164:167], a[104:107], v[92:95]
s_waitcnt lgkmcnt(3)
ds_read_b128 v[156:159], v2 offset:13312
v_mul_f32 v70, v70, v54
v_mfma_f32_16x16x32_bf16 v[72:75], v[136:139], a[112:115], v[72:75]
buffer_load_dwordx4 v1, s[4:7], s52 offen offset:3072 sc1 lds
v_mfma_f32_16x16x32_bf16 v[80:83], v[136:139], a[116:119], v[80:83]
ds_read_b128 v[160:163], v2 offset:14336
v_fma_f32 v224, v224, v239, v237
v_mfma_f32_16x16x32_bf16 v[84:87], v[140:143], a[116:119], v[84:87]
s_add_u32 m0, m0, 4096
v_exp_f32 v219, v219
v_mfma_f32_16x16x32_bf16 v[76:79], v[140:143], a[112:115], v[76:79]
s_waitcnt lgkmcnt(3)
ds_read_b128 v[164:167], v2 offset:15360
s_add_u32 s52, s52, 4096
v_mfma_f32_16x16x32_bf16 v[88:91], v[144:147], a[112:115], v[88:91]
v_fma_f32 v218, v218, v241, v241
v_fma_f32 v225, v225, v239, v237
v_mfma_f32_16x16x32_bf16 v[96:99], v[144:147], a[116:119], v[96:99]
ds_read_b128 v[136:139], v2 offset:16384
v_exp_f32 v220, v220
v_fma_f32 v60, v212, v242, v60
v_mfma_f32_16x16x32_bf16 v[100:103], v[148:151], a[116:119], v[100:103]
buffer_load_dwordx4 v1, s[4:7], s52 offen offset:0 sc1 lds
v_mfma_f32_16x16x32_bf16 v[92:95], v[148:151], a[112:115], v[92:95]
s_waitcnt lgkmcnt(3)
ds_read_b128 v[140:143], v2 offset:17408
v_fma_f32 v61, v213, v242, v61
v_mul_f32 v60, v60, v44
v_mfma_f32_16x16x32_bf16 v[72:75], v[152:155], a[120:123], v[72:75]
v_rcp_f32 v218, v218
v_mfma_f32_16x16x32_bf16 v[80:83], v[152:155], a[124:127], v[80:83]
ds_read_b128 v[144:147], v2 offset:18432
v_fma_f32 v219, v219, v241, v241
v_exp_f32 v221, v221
v_exp_f32 v222, v222
v_fma_f32 v50, v202, v243, v50
v_fma_f32 v220, v220, v240, v240
v_fma_f32 v62, v214, v242, v62
v_fma_f32 v51, v203, v243, v51
v_mfma_f32_16x16x32_bf16 v[84:87], v[156:159], a[124:127], v[84:87]
v_mul_f32 v71, v71, v55
v_fma_f32 v63, v215, v242, v63
v_mfma_f32_16x16x32_bf16 v[76:79], v[156:159], a[120:123], v[76:79]
s_waitcnt lgkmcnt(3)
ds_read_b128 v[148:151], v2 offset:19456
v_rcp_f32 v220, v220
v_mul_f32 v62, v62, v46
v_mul_f32 v224, v224, v48
v_mul_f32 v226, v50, v50
v_fma_f32 v221, v221, v240, v240
v_mul_f32 v225, v225, v49
v_mul_f32 v227, v51, v51
v_mfma_f32_16x16x32_bf16 v[88:91], v[160:163], a[120:123], v[88:91]
v_rcp_f32 v219, v219
v_mfma_f32_16x16x32_bf16 v[96:99], v[160:163], a[124:127], v[96:99]
ds_read_b128 v[152:155], v2 offset:20480
v_mul_f32 v70, v70, v218
v_mul_f32 v61, v61, v45
v_exp_f32 v223, v223
v_exp_f32 v224, v224
v_fma_f32 v226, v226, v239, v237
v_rcp_f32 v221, v221
v_fma_f32 v222, v222, v240, v240
v_fma_f32 v64, v208, v243, v64
v_fma_f32 v227, v227, v239, v237
v_mfma_f32_16x16x32_bf16 v[100:103], v[164:167], a[124:127], v[100:103]
v_mul_f32 v71, v71, v219
v_mul_f32 v60, v60, v220
v_mfma_f32_16x16x32_bf16 v[92:95], v[164:167], a[120:123], v[92:95]
s_waitcnt lgkmcnt(3)
ds_read_b128 v[156:159], v2 offset:21504
v_cvt_pk_bf16_f32 v235, v70, v71
v_mul_f32 v61, v61, v221
v_rcp_f32 v222, v222
v_fma_f32 v65, v209, v243, v65
v_mul_f32 v226, v226, v50
v_fma_f32 v223, v223, v240, v240
v_mul_f32 v64, v64, v48
v_mul_f32 v227, v227, v51
v_mfma_f32_16x16x32_bf16 v[72:75], v[136:139], a[128:131], v[72:75]
v_cvt_pk_bf16_f32 v230, v60, v61
v_mul_f32 v63, v63, v47
v_mfma_f32_16x16x32_bf16 v[80:83], v[136:139], a[132:135], v[80:83]
ds_read_b128 v[160:163], v2 offset:22528
v_rcp_f32 v223, v223
v_exp_f32 v225, v225
v_exp_f32 v226, v226
v_fma_f32 v224, v224, v241, v241
v_fma_f32 v66, v210, v243, v66
v_mfma_f32_16x16x32_bf16 v[84:87], v[140:143], a[132:135], v[84:87]
v_mul_f32 v62, v62, v222
v_fma_f32 v67, v211, v243, v67
v_mfma_f32_16x16x32_bf16 v[76:79], v[140:143], a[128:131], v[76:79]
s_waitcnt lgkmcnt(3)
ds_read_b128 v[164:167], v2 offset:23552
v_mul_f32 v63, v63, v223
v_rcp_f32 v224, v224
v_mul_f32 v66, v66, v50
v_fma_f32 v225, v225, v241, v241
v_mfma_f32_16x16x32_bf16 v[88:91], v[144:147], a[128:131], v[88:91]
v_cvt_pk_bf16_f32 v231, v62, v63
v_mul_f32 v65, v65, v49
v_mfma_f32_16x16x32_bf16 v[96:99], v[144:147], a[132:135], v[96:99]
ds_read_b128 v[136:139], v2 offset:24576
v_rcp_f32 v225, v225
v_exp_f32 v227, v227
v_fma_f32 v226, v226, v241, v241
v_mfma_f32_16x16x32_bf16 v[100:103], v[148:151], a[132:135], v[100:103]
buffer_store_dwordx4 v[228:231], v4, s[4:7], s40 offen offset:0 sc1
v_mfma_f32_16x16x32_bf16 v[92:95], v[148:151], a[128:131], v[92:95]
s_waitcnt lgkmcnt(3)
ds_read_b128 v[140:143], v2 offset:25600
v_mul_f32 v64, v64, v224
v_rcp_f32 v226, v226
v_mul_f32 v65, v65, v225
v_fma_f32 v227, v227, v241, v241
v_mfma_f32_16x16x32_bf16 v[72:75], v[152:155], a[136:139], v[72:75]
v_cvt_pk_bf16_f32 v232, v64, v65
v_mul_f32 v67, v67, v51
v_mfma_f32_16x16x32_bf16 v[80:83], v[152:155], a[140:143], v[80:83]
ds_read_b128 v[144:147], v2 offset:26624
v_rcp_f32 v227, v227
v_mfma_f32_16x16x32_bf16 v[84:87], v[156:159], a[140:143], v[84:87]
v_mul_f32 v66, v66, v226
v_mul_f32 v67, v67, v227
v_mfma_f32_16x16x32_bf16 v[76:79], v[156:159], a[136:139], v[76:79]
s_waitcnt lgkmcnt(3)
ds_read_b128 v[148:151], v2 offset:27648
v_cvt_pk_bf16_f32 v233, v66, v67
v_mfma_f32_16x16x32_bf16 v[88:91], v[160:163], a[136:139], v[88:91]
buffer_store_dwordx4 v[232:235], v4, s[4:7], s40 offen offset:256 sc1
v_mfma_f32_16x16x32_bf16 v[96:99], v[160:163], a[140:143], v[96:99]
ds_read_b128 v[152:155], v2 offset:28672
v_mfma_f32_16x16x32_bf16 v[100:103], v[164:167], a[140:143], v[100:103]
v_mfma_f32_16x16x32_bf16 v[92:95], v[164:167], a[136:139], v[92:95]
s_waitcnt lgkmcnt(3)
ds_read_b128 v[156:159], v2 offset:29696
v_mfma_f32_16x16x32_bf16 v[72:75], v[136:139], a[144:147], v[72:75]
v_mfma_f32_16x16x32_bf16 v[80:83], v[136:139], a[148:151], v[80:83]
ds_read_b128 v[160:163], v2 offset:30720
v_mfma_f32_16x16x32_bf16 v[84:87], v[140:143], a[148:151], v[84:87]
v_mfma_f32_16x16x32_bf16 v[76:79], v[140:143], a[144:147], v[76:79]
s_waitcnt lgkmcnt(3)
ds_read_b128 v[164:167], v2 offset:31744
v_mfma_f32_16x16x32_bf16 v[88:91], v[144:147], a[144:147], v[88:91]
v_mfma_f32_16x16x32_bf16 v[96:99], v[144:147], a[148:151], v[96:99]
ds_read_b128 v[136:139], v2 offset:32768
v_mfma_f32_16x16x32_bf16 v[100:103], v[148:151], a[148:151], v[100:103]
v_mfma_f32_16x16x32_bf16 v[92:95], v[148:151], a[144:147], v[92:95]
s_waitcnt lgkmcnt(3)
ds_read_b128 v[140:143], v2 offset:33792
v_mfma_f32_16x16x32_bf16 v[72:75], v[152:155], a[152:155], v[72:75]
v_mfma_f32_16x16x32_bf16 v[80:83], v[152:155], a[156:159], v[80:83]
ds_read_b128 v[144:147], v2 offset:34816
v_mfma_f32_16x16x32_bf16 v[84:87], v[156:159], a[156:159], v[84:87]
v_mfma_f32_16x16x32_bf16 v[76:79], v[156:159], a[152:155], v[76:79]
s_waitcnt lgkmcnt(3)
ds_read_b128 v[148:151], v2 offset:35840
v_mfma_f32_16x16x32_bf16 v[88:91], v[160:163], a[152:155], v[88:91]
v_mfma_f32_16x16x32_bf16 v[96:99], v[160:163], a[156:159], v[96:99]
ds_read_b128 v[152:155], v2 offset:36864
v_mfma_f32_16x16x32_bf16 v[100:103], v[164:167], a[156:159], v[100:103]
v_mfma_f32_16x16x32_bf16 v[92:95], v[164:167], a[152:155], v[92:95]
s_waitcnt lgkmcnt(3)
ds_read_b128 v[156:159], v2 offset:37888
v_mfma_f32_16x16x32_bf16 v[104:107], v[136:139], a[0:3], v[104:107]
v_mfma_f32_16x16x32_bf16 v[112:115], v[136:139], a[4:7], v[112:115]
ds_read_b128 v[160:163], v2 offset:38912
v_mfma_f32_16x16x32_bf16 v[116:119], v[140:143], a[4:7], v[116:119]
v_mfma_f32_16x16x32_bf16 v[108:111], v[140:143], a[0:3], v[108:111]
s_waitcnt lgkmcnt(3)
ds_read_b128 v[164:167], v2 offset:39936
v_mfma_f32_16x16x32_bf16 v[120:123], v[144:147], a[0:3], v[120:123]
s_add_u32 s61, s31, 37888
v_mfma_f32_16x16x32_bf16 v[128:131], v[144:147], a[4:7], v[128:131]
ds_read_b128 v[136:139], v2 offset:40960
v_mfma_f32_16x16x32_bf16 v[132:135], v[148:151], a[4:7], v[132:135]
v_mfma_f32_16x16x32_bf16 v[124:127], v[148:151], a[0:3], v[124:127]
s_waitcnt lgkmcnt(3)
ds_read_b128 v[140:143], v2 offset:41984
v_mfma_f32_16x16x32_bf16 v[104:107], v[152:155], a[8:11], v[104:107]
buffer_load_dwordx4 a[0:3], v1, s[4:7], s61 offen offset:0 sc1
v_mfma_f32_16x16x32_bf16 v[112:115], v[152:155], a[12:15], v[112:115]
ds_read_b128 v[144:147], v2 offset:43008
v_mul_f32 v216, v72, v72
v_mfma_f32_16x16x32_bf16 v[116:119], v[156:159], a[12:15], v[116:119]
v_mul_f32 v217, v73, v73
v_mul_f32 v218, v74, v74
v_mfma_f32_16x16x32_bf16 v[108:111], v[156:159], a[8:11], v[108:111]
s_waitcnt lgkmcnt(3)
ds_read_b128 v[148:151], v2 offset:44032
v_fma_f32 v216, v216, v238, v236
v_mfma_f32_16x16x32_bf16 v[120:123], v[160:163], a[8:11], v[120:123]
v_fma_f32 v217, v217, v238, v236
v_mul_f32 v219, v75, v75
v_mfma_f32_16x16x32_bf16 v[128:131], v[160:163], a[12:15], v[128:131]
ds_read_b128 v[152:155], v2 offset:45056
v_mul_f32 v216, v216, v72
v_mfma_f32_16x16x32_bf16 v[132:135], v[164:167], a[12:15], v[132:135]
buffer_load_dwordx4 a[4:7], v1, s[4:7], s61 offen offset:1024 sc1
v_mfma_f32_16x16x32_bf16 v[124:127], v[164:167], a[8:11], v[124:127]
s_waitcnt lgkmcnt(3)
ds_read_b128 v[156:159], v2 offset:46080
v_mul_f32 v217, v217, v73
v_mfma_f32_16x16x32_bf16 v[104:107], v[136:139], a[16:19], v[104:107]
v_exp_f32 v216, v216
v_mfma_f32_16x16x32_bf16 v[112:115], v[136:139], a[20:23], v[112:115]
ds_read_b128 v[160:163], v2 offset:47104
v_mul_f32 v88, v88, v72
v_mfma_f32_16x16x32_bf16 v[116:119], v[140:143], a[20:23], v[116:119]
buffer_load_dwordx4 a[8:11], v1, s[4:7], s61 offen offset:2048 sc1
v_mfma_f32_16x16x32_bf16 v[108:111], v[140:143], a[16:19], v[108:111]
s_waitcnt lgkmcnt(3)
ds_read_b128 v[164:167], v2 offset:48128
s_add_u32 s61, s31, 51200
v_mfma_f32_16x16x32_bf16 v[120:123], v[144:147], a[16:19], v[120:123]
v_exp_f32 v217, v217
v_mfma_f32_16x16x32_bf16 v[128:131], v[144:147], a[20:23], v[128:131]
ds_read_b128 v[136:139], v2 offset:49152
v_fma_f32 v216, v216, v240, v240
v_mfma_f32_16x16x32_bf16 v[132:135], v[148:151], a[20:23], v[132:135]
v_rcp_f32 v216, v216
v_mfma_f32_16x16x32_bf16 v[124:127], v[148:151], a[16:19], v[124:127]
s_waitcnt lgkmcnt(3)
ds_read_b128 v[140:143], v2 offset:50176
v_fma_f32 v217, v217, v240, v240
v_mfma_f32_16x16x32_bf16 v[104:107], v[152:155], a[24:27], v[104:107]
s_waitcnt vmcnt(10)
s_barrier
v_mfma_f32_16x16x32_bf16 v[112:115], v[152:155], a[28:31], v[112:115]
ds_read_b128 v[144:147], v2 offset:51200
v_mul_f32 v89, v89, v73
v_mfma_f32_16x16x32_bf16 v[116:119], v[156:159], a[28:31], v[116:119]
buffer_load_dwordx4 a[12:15], v1, s[4:7], s61 offen offset:0 sc1
v_mfma_f32_16x16x32_bf16 v[108:111], v[156:159], a[24:27], v[108:111]
s_waitcnt lgkmcnt(3)
ds_read_b128 v[148:151], v2 offset:52224
v_fma_f32 v218, v218, v238, v236
v_mfma_f32_16x16x32_bf16 v[120:123], v[160:163], a[24:27], v[120:123]
v_rcp_f32 v217, v217
v_mfma_f32_16x16x32_bf16 v[128:131], v[160:163], a[28:31], v[128:131]
ds_read_b128 v[152:155], v2 offset:53248
v_mul_f32 v88, v88, v216
v_mfma_f32_16x16x32_bf16 v[132:135], v[164:167], a[28:31], v[132:135]
buffer_load_dwordx4 a[16:19], v1, s[4:7], s61 offen offset:1024 sc1
v_mfma_f32_16x16x32_bf16 v[124:127], v[164:167], a[24:27], v[124:127]
s_waitcnt lgkmcnt(3)
ds_read_b128 v[156:159], v2 offset:54272
v_mul_f32 v89, v89, v217
v_mfma_f32_16x16x32_bf16 v[104:107], v[136:139], a[32:35], v[104:107]
v_cvt_pk_bf16_f32 v200, v88, v89
v_fma_f32 v219, v219, v238, v236
v_mfma_f32_16x16x32_bf16 v[112:115], v[136:139], a[36:39], v[112:115]
ds_read_b128 v[160:163], v2 offset:55296
v_mul_f32 v216, v84, v84
v_mfma_f32_16x16x32_bf16 v[116:119], v[140:143], a[36:39], v[116:119]
buffer_load_dwordx4 a[20:23], v1, s[4:7], s61 offen offset:2048 sc1
v_mfma_f32_16x16x32_bf16 v[108:111], v[140:143], a[32:35], v[108:111]
s_waitcnt lgkmcnt(3)
ds_read_b128 v[164:167], v2 offset:56320
v_mul_f32 v217, v85, v85
v_mfma_f32_16x16x32_bf16 v[120:123], v[144:147], a[32:35], v[120:123]
v_fma_f32 v216, v216, v239, v237
v_mul_f32 v218, v218, v74
v_mfma_f32_16x16x32_bf16 v[128:131], v[144:147], a[36:39], v[128:131]
ds_read_b128 v[136:139], v2 offset:57344
v_fma_f32 v217, v217, v239, v237
v_mfma_f32_16x16x32_bf16 v[132:135], v[148:151], a[36:39], v[132:135]
buffer_load_dwordx4 a[24:27], v1, s[4:7], s61 offen offset:3072 sc1
v_mfma_f32_16x16x32_bf16 v[124:127], v[148:151], a[32:35], v[124:127]
s_waitcnt lgkmcnt(3)
ds_read_b128 v[140:143], v2 offset:58368
s_add_u32 s61, s31, 55296
v_mfma_f32_16x16x32_bf16 v[104:107], v[152:155], a[40:43], v[104:107]
v_mul_f32 v216, v216, v84
v_mul_f32 v219, v219, v75
v_mfma_f32_16x16x32_bf16 v[112:115], v[152:155], a[44:47], v[112:115]
ds_read_b128 v[144:147], v2 offset:59392
v_mul_f32 v217, v217, v85
v_mfma_f32_16x16x32_bf16 v[116:119], v[156:159], a[44:47], v[116:119]
v_exp_f32 v216, v216
v_mfma_f32_16x16x32_bf16 v[108:111], v[156:159], a[40:43], v[108:111]
s_waitcnt lgkmcnt(3)
ds_read_b128 v[148:151], v2 offset:60416
v_mul_f32 v100, v100, v84
v_mfma_f32_16x16x32_bf16 v[120:123], v[160:163], a[40:43], v[120:123]
buffer_load_dwordx4 a[28:31], v1, s[4:7], s61 offen offset:0 sc1
v_mfma_f32_16x16x32_bf16 v[128:131], v[160:163], a[44:47], v[128:131]
s_add_u32 s61, s31, 10240
ds_read_b128 v[152:155], v2 offset:61440
v_mul_f32 v220, v76, v76
v_mfma_f32_16x16x32_bf16 v[132:135], v[164:167], a[44:47], v[132:135]
v_exp_f32 v217, v217
v_mfma_f32_16x16x32_bf16 v[124:127], v[164:167], a[40:43], v[124:127]
s_waitcnt lgkmcnt(3)
ds_read_b128 v[156:159], v2 offset:62464
v_fma_f32 v216, v216, v241, v241
v_mfma_f32_16x16x32_bf16 v[104:107], v[136:139], a[48:51], v[104:107]
buffer_load_dwordx4 a[32:35], v1, s[4:7], s61 offen offset:0 sc1
v_mfma_f32_16x16x32_bf16 v[112:115], v[136:139], a[52:55], v[112:115]
ds_read_b128 v[160:163], v2 offset:63488
v_mul_f32 v221, v77, v77
v_mfma_f32_16x16x32_bf16 v[116:119], v[140:143], a[52:55], v[116:119]
v_rcp_f32 v216, v216
v_mfma_f32_16x16x32_bf16 v[108:111], v[140:143], a[48:51], v[108:111]
s_waitcnt lgkmcnt(3)
ds_read_b128 v[164:167], v2 offset:64512
v_fma_f32 v217, v217, v241, v241
v_mfma_f32_16x16x32_bf16 v[120:123], v[144:147], a[48:51], v[120:123]
v_mul_f32 v101, v101, v85
v_fma_f32 v220, v220, v238, v236
v_mfma_f32_16x16x32_bf16 v[128:131], v[144:147], a[52:55], v[128:131]
ds_read_b128 v[136:139], v3 offset:0
v_fma_f32 v221, v221, v238, v236
v_mfma_f32_16x16x32_bf16 v[132:135], v[148:151], a[52:55], v[132:135]
buffer_load_dwordx4 a[36:39], v1, s[4:7], s61 offen offset:1024 sc1
v_mfma_f32_16x16x32_bf16 v[124:127], v[148:151], a[48:51], v[124:127]
s_waitcnt lgkmcnt(3)
ds_read_b128 v[140:143], v3 offset:1024
v_mul_f32 v220, v220, v76
v_mfma_f32_16x16x32_bf16 v[104:107], v[152:155], a[56:59], v[104:107]
v_rcp_f32 v217, v217
v_mfma_f32_16x16x32_bf16 v[112:115], v[152:155], a[60:63], v[112:115]
ds_read_b128 v[144:147], v3 offset:2048
v_mul_f32 v100, v100, v216
v_mfma_f32_16x16x32_bf16 v[116:119], v[156:159], a[60:63], v[116:119]
buffer_load_dwordx4 a[40:43], v1, s[4:7], s61 offen offset:2048 sc1
v_mfma_f32_16x16x32_bf16 v[108:111], v[156:159], a[56:59], v[108:111]
s_waitcnt lgkmcnt(3)
ds_read_b128 v[148:151], v3 offset:3072
v_mul_f32 v101, v101, v217
v_mfma_f32_16x16x32_bf16 v[120:123], v[160:163], a[56:59], v[120:123]
v_cvt_pk_bf16_f32 v206, v100, v101
v_mul_f32 v221, v221, v77
v_mfma_f32_16x16x32_bf16 v[128:131], v[160:163], a[60:63], v[128:131]
ds_read_b128 v[152:155], v3 offset:4096
v_mul_f32 v222, v78, v78
v_mfma_f32_16x16x32_bf16 v[132:135], v[164:167], a[60:63], v[132:135]
v_exp_f32 v218, v218
v_mfma_f32_16x16x32_bf16 v[124:127], v[164:167], a[56:59], v[124:127]
s_waitcnt lgkmcnt(3)
ds_read_b128 v[156:159], v3 offset:5120
v_mul_f32 v90, v90, v74
v_mfma_f32_16x16x32_bf16 v[104:107], v[136:139], a[64:67], v[104:107]
buffer_load_dwordx4 a[44:47], v1, s[4:7], s61 offen offset:3072 sc1
v_mfma_f32_16x16x32_bf16 v[112:115], v[136:139], a[68:71], v[112:115]
s_add_u32 s61, s31, 14336
ds_read_b128 v[160:163], v3 offset:6144
v_mul_f32 v223, v79, v79
v_mfma_f32_16x16x32_bf16 v[116:119], v[140:143], a[68:71], v[116:119]
v_exp_f32 v219, v219
v_mfma_f32_16x16x32_bf16 v[108:111], v[140:143], a[64:67], v[108:111]
s_waitcnt lgkmcnt(3)
ds_read_b128 v[164:167], v3 offset:7168
v_fma_f32 v218, v218, v240, v240
v_mfma_f32_16x16x32_bf16 v[120:123], v[144:147], a[64:67], v[120:123]
buffer_load_dwordx4 a[48:51], v1, s[4:7], s61 offen offset:0 sc1
v_mfma_f32_16x16x32_bf16 v[128:131], v[144:147], a[68:71], v[128:131]
s_add_u32 s61, s31, 25600
ds_read_b128 v[136:139], v3 offset:8192
v_fma_f32 v222, v222, v238, v236
v_mfma_f32_16x16x32_bf16 v[132:135], v[148:151], a[68:71], v[132:135]
v_rcp_f32 v218, v218
v_mfma_f32_16x16x32_bf16 v[124:127], v[148:151], a[64:67], v[124:127]
s_waitcnt lgkmcnt(3)
ds_read_b128 v[140:143], v3 offset:9216
v_fma_f32 v219, v219, v240, v240
v_mfma_f32_16x16x32_bf16 v[104:107], v[152:155], a[72:75], v[104:107]
v_mul_f32 v91, v91, v75
v_fma_f32 v223, v223, v238, v236
v_mfma_f32_16x16x32_bf16 v[112:115], v[152:155], a[76:79], v[112:115]
ds_read_b128 v[144:147], v3 offset:10240
v_mul_f32 v222, v222, v78
v_mfma_f32_16x16x32_bf16 v[116:119], v[156:159], a[76:79], v[116:119]
buffer_load_dwordx4 a[52:55], v1, s[4:7], s61 offen offset:0 sc1
v_mfma_f32_16x16x32_bf16 v[108:111], v[156:159], a[72:75], v[108:111]
s_waitcnt lgkmcnt(3)
ds_read_b128 v[148:151], v3 offset:11264
v_mul_f32 v223, v223, v79
v_mfma_f32_16x16x32_bf16 v[120:123], v[160:163], a[72:75], v[120:123]
v_rcp_f32 v219, v219
v_mfma_f32_16x16x32_bf16 v[128:131], v[160:163], a[76:79], v[128:131]
ds_read_b128 v[152:155], v3 offset:12288
v_mul_f32 v90, v90, v218
v_mfma_f32_16x16x32_bf16 v[132:135], v[164:167], a[76:79], v[132:135]
buffer_load_dwordx4 a[56:59], v1, s[4:7], s61 offen offset:1024 sc1
v_mfma_f32_16x16x32_bf16 v[124:127], v[164:167], a[72:75], v[124:127]
s_waitcnt lgkmcnt(3)
ds_read_b128 v[156:159], v3 offset:13312
v_mul_f32 v91, v91, v219
v_mfma_f32_16x16x32_bf16 v[104:107], v[136:139], a[80:83], v[104:107]
v_cvt_pk_bf16_f32 v201, v90, v91
v_mul_f32 v224, v80, v80
v_mfma_f32_16x16x32_bf16 v[112:115], v[136:139], a[84:87], v[112:115]
ds_read_b128 v[160:163], v3 offset:14336
v_mul_f32 v218, v86, v86
v_mfma_f32_16x16x32_bf16 v[116:119], v[140:143], a[84:87], v[116:119]
v_mul_f32 v219, v87, v87
v_mul_f32 v225, v81, v81
v_mfma_f32_16x16x32_bf16 v[108:111], v[140:143], a[80:83], v[108:111]
s_waitcnt lgkmcnt(3)
ds_read_b128 v[164:167], v3 offset:15360
v_fma_f32 v218, v218, v239, v237
v_mfma_f32_16x16x32_bf16 v[120:123], v[144:147], a[80:83], v[120:123]
buffer_load_dwordx4 a[60:63], v1, s[4:7], s61 offen offset:2048 sc1
v_mfma_f32_16x16x32_bf16 v[128:131], v[144:147], a[84:87], v[128:131]
ds_read_b128 v[136:139], v3 offset:16384
v_fma_f32 v219, v219, v239, v237
v_mfma_f32_16x16x32_bf16 v[132:135], v[148:151], a[84:87], v[132:135]
v_mul_f32 v218, v218, v86
v_fma_f32 v224, v224, v239, v237
v_mfma_f32_16x16x32_bf16 v[124:127], v[148:151], a[80:83], v[124:127]
s_waitcnt lgkmcnt(3)
ds_read_b128 v[140:143], v3 offset:17408
v_mul_f32 v219, v219, v87
v_mfma_f32_16x16x32_bf16 v[104:107], v[152:155], a[88:91], v[104:107]
buffer_load_dwordx4 a[64:67], v1, s[4:7], s61 offen offset:3072 sc1
v_mfma_f32_16x16x32_bf16 v[112:115], v[152:155], a[92:95], v[112:115]
s_add_u32 s61, s31, 29696
ds_read_b128 v[144:147], v3 offset:18432
v_fma_f32 v225, v225, v239, v237
v_mfma_f32_16x16x32_bf16 v[116:119], v[156:159], a[92:95], v[116:119]
v_exp_f32 v218, v218
v_mfma_f32_16x16x32_bf16 v[108:111], v[156:159], a[88:91], v[108:111]
s_waitcnt lgkmcnt(3)
ds_read_b128 v[148:151], v3 offset:19456
v_mul_f32 v102, v102, v86
v_mfma_f32_16x16x32_bf16 v[120:123], v[160:163], a[88:91], v[120:123]
v_exp_f32 v219, v219
v_mfma_f32_16x16x32_bf16 v[128:131], v[160:163], a[92:95], v[128:131]
ds_read_b128 v[152:155], v3 offset:20480
v_fma_f32 v218, v218, v241, v241
v_mfma_f32_16x16x32_bf16 v[132:135], v[164:167], a[92:95], v[132:135]
buffer_load_dwordx4 a[68:71], v1, s[4:7], s61 offen offset:0 sc1
v_mfma_f32_16x16x32_bf16 v[124:127], v[164:167], a[88:91], v[124:127]
s_waitcnt lgkmcnt(3)
ds_read_b128 v[156:159], v3 offset:21504
s_add_u32 s61, s31, 40960
v_mfma_f32_16x16x32_bf16 v[104:107], v[136:139], a[96:99], v[104:107]
v_rcp_f32 v218, v218
v_mfma_f32_16x16x32_bf16 v[112:115], v[136:139], a[100:103], v[112:115]
ds_read_b128 v[160:163], v3 offset:22528
v_fma_f32 v219, v219, v241, v241
v_mfma_f32_16x16x32_bf16 v[116:119], v[140:143], a[100:103], v[116:119]
buffer_load_dwordx4 a[72:75], v1, s[4:7], s61 offen offset:0 sc1
v_mfma_f32_16x16x32_bf16 v[108:111], v[140:143], a[96:99], v[108:111]
s_waitcnt lgkmcnt(3)
ds_read_b128 v[164:167], v3 offset:23552
v_mul_f32 v103, v103, v87
v_mfma_f32_16x16x32_bf16 v[120:123], v[144:147], a[96:99], v[120:123]
v_rcp_f32 v219, v219
v_mfma_f32_16x16x32_bf16 v[128:131], v[144:147], a[100:103], v[128:131]
ds_read_b128 v[136:139], v3 offset:24576
v_mul_f32 v102, v102, v218
v_mfma_f32_16x16x32_bf16 v[132:135], v[148:151], a[100:103], v[132:135]
v_mul_f32 v103, v103, v219
v_mul_f32 v224, v224, v80
v_mfma_f32_16x16x32_bf16 v[124:127], v[148:151], a[96:99], v[124:127]
s_waitcnt lgkmcnt(3)
ds_read_b128 v[140:143], v3 offset:25600
v_cvt_pk_bf16_f32 v207, v102, v103
v_mfma_f32_16x16x32_bf16 v[104:107], v[152:155], a[104:107], v[104:107]
s_waitcnt vmcnt(21)
s_barrier
v_mfma_f32_16x16x32_bf16 v[112:115], v[152:155], a[108:111], v[112:115]
ds_read_b128 v[144:147], v3 offset:26624
v_mul_f32 v225, v225, v81
v_mfma_f32_16x16x32_bf16 v[116:119], v[156:159], a[108:111], v[116:119]
buffer_load_dwordx4 a[76:79], v1, s[4:7], s61 offen offset:1024 sc1
v_mfma_f32_16x16x32_bf16 v[108:111], v[156:159], a[104:107], v[108:111]
s_waitcnt lgkmcnt(3)
ds_read_b128 v[148:151], v3 offset:27648
v_exp_f32 v220, v220
v_mul_f32 v92, v92, v76
v_mfma_f32_16x16x32_bf16 v[120:123], v[160:163], a[104:107], v[120:123]
v_exp_f32 v221, v221
v_mfma_f32_16x16x32_bf16 v[128:131], v[160:163], a[108:111], v[128:131]
ds_read_b128 v[152:155], v1 offset:0
v_fma_f32 v220, v220, v240, v240
v_mfma_f32_16x16x32_bf16 v[132:135], v[164:167], a[108:111], v[132:135]
buffer_load_dwordx4 a[80:83], v1, s[4:7], s61 offen offset:2048 sc1
v_mfma_f32_16x16x32_bf16 v[124:127], v[164:167], a[104:107], v[124:127]
s_waitcnt lgkmcnt(3)
ds_read_b128 v[156:159], v1 offset:1024
v_rcp_f32 v220, v220
v_exp_f32 v222, v222
v_fma_f32 v221, v221, v240, v240
v_mul_f32 v94, v94, v78
v_mfma_f32_16x16x32_bf16 v[104:107], v[136:139], a[112:115], v[104:107]
v_mul_f32 v93, v93, v77
v_mul_f32 v226, v82, v82
v_mfma_f32_16x16x32_bf16 v[112:115], v[136:139], a[116:119], v[112:115]
ds_read_b128 v[160:163], v1 offset:2048
v_rcp_f32 v221, v221
v_exp_f32 v223, v223
v_mul_f32 v227, v83, v83
v_fma_f32 v222, v222, v240, v240
v_mfma_f32_16x16x32_bf16 v[116:119], v[140:143], a[116:119], v[116:119]
buffer_load_dwordx4 a[84:87], v1, s[4:7], s61 offen offset:3072 sc1
v_mfma_f32_16x16x32_bf16 v[108:111], v[140:143], a[112:115], v[108:111]
s_waitcnt lgkmcnt(3)
ds_read_b128 v[164:167], v1 offset:3072
s_add_u32 s61, s31, 45056
v_mul_f32 v92, v92, v220
v_rcp_f32 v222, v222
v_exp_f32 v224, v224
v_fma_f32 v226, v226, v239, v237
v_mul_f32 v93, v93, v221
v_fma_f32 v223, v223, v240, v240
v_mul_f32 v96, v96, v80
v_fma_f32 v227, v227, v239, v237
v_mfma_f32_16x16x32_bf16 v[120:123], v[144:147], a[112:115], v[120:123]
v_cvt_pk_bf16_f32 v202, v92, v93
v_mul_f32 v95, v95, v79
v_mfma_f32_16x16x32_bf16 v[128:131], v[144:147], a[116:119], v[128:131]
ds_read_b128 v[136:139], v1 offset:4096
v_rcp_f32 v223, v223
v_exp_f32 v225, v225
v_mul_f32 v226, v226, v82
v_fma_f32 v224, v224, v241, v241
v_mul_f32 v227, v227, v83
v_mfma_f32_16x16x32_bf16 v[132:135], v[148:151], a[116:119], v[132:135]
buffer_load_dwordx4 a[88:91], v1, s[4:7], s61 offen offset:0 sc1
v_mfma_f32_16x16x32_bf16 v[124:127], v[148:151], a[112:115], v[124:127]
s_waitcnt lgkmcnt(3)
ds_read_b128 v[140:143], v1 offset:5120
s_add_u32 s61, s31, 56320
v_mul_f32 v94, v94, v222
v_rcp_f32 v224, v224
v_exp_f32 v226, v226
v_mul_f32 v95, v95, v223
v_fma_f32 v225, v225, v241, v241
v_mul_f32 v98, v98, v82
v_mfma_f32_16x16x32_bf16 v[104:107], v[152:155], a[120:123], v[104:107]
v_cvt_pk_bf16_f32 v203, v94, v95
v_mul_f32 v97, v97, v81
v_mfma_f32_16x16x32_bf16 v[112:115], v[152:155], a[124:127], v[112:115]
ds_read_b128 v[144:147], v1 offset:6144
v_rcp_f32 v225, v225
v_exp_f32 v227, v227
v_fma_f32 v226, v226, v241, v241
v_mfma_f32_16x16x32_bf16 v[116:119], v[156:159], a[124:127], v[116:119]
buffer_store_dwordx4 v[200:203], v4, s[4:7], s40 offen offset:2048 sc1
v_mfma_f32_16x16x32_bf16 v[108:111], v[156:159], a[120:123], v[108:111]
s_waitcnt lgkmcnt(3)
ds_read_b128 v[148:151], v1 offset:7168
v_mul_f32 v96, v96, v224
v_rcp_f32 v226, v226
v_mul_f32 v97, v97, v225
v_fma_f32 v227, v227, v241, v241
v_mfma_f32_16x16x32_bf16 v[120:123], v[160:163], a[120:123], v[120:123]
buffer_load_dwordx4 a[92:95], v1, s[4:7], s61 offen offset:0 sc1
v_mfma_f32_16x16x32_bf16 v[128:131], v[160:163], a[124:127], v[128:131]
ds_read_b128 v[152:155], v1 offset:8192
v_cvt_pk_bf16_f32 v204, v96, v97
v_mul_f32 v99, v99, v83
v_rcp_f32 v227, v227
v_mfma_f32_16x16x32_bf16 v[132:135], v[164:167], a[124:127], v[132:135]
v_mul_f32 v98, v98, v226
v_mul_f32 v99, v99, v227
v_mfma_f32_16x16x32_bf16 v[124:127], v[164:167], a[120:123], v[124:127]
s_waitcnt lgkmcnt(3)
ds_read_b128 v[156:159], v1 offset:9216
v_cvt_pk_bf16_f32 v205, v98, v99
v_mfma_f32_16x16x32_bf16 v[104:107], v[136:139], a[128:131], v[104:107]
buffer_store_dwordx4 v[204:207], v4, s[4:7], s40 offen offset:2304 sc1
v_mfma_f32_16x16x32_bf16 v[112:115], v[136:139], a[132:135], v[112:115]
ds_read_b128 v[160:163], v1 offset:10240
v_mfma_f32_16x16x32_bf16 v[116:119], v[140:143], a[132:135], v[116:119]
buffer_load_dwordx4 a[96:99], v1, s[4:7], s61 offen offset:1024 sc1
v_mfma_f32_16x16x32_bf16 v[108:111], v[140:143], a[128:131], v[108:111]
s_waitcnt lgkmcnt(3)
ds_read_b128 v[164:167], v1 offset:11264
v_mfma_f32_16x16x32_bf16 v[120:123], v[144:147], a[128:131], v[120:123]
v_mfma_f32_16x16x32_bf16 v[128:131], v[144:147], a[132:135], v[128:131]
ds_read_b128 v[136:139], v1 offset:12288
v_mfma_f32_16x16x32_bf16 v[132:135], v[148:151], a[132:135], v[132:135]
buffer_load_dwordx4 a[100:103], v1, s[4:7], s61 offen offset:2048 sc1
v_mfma_f32_16x16x32_bf16 v[124:127], v[148:151], a[128:131], v[124:127]
s_waitcnt lgkmcnt(3)
ds_read_b128 v[140:143], v1 offset:13312
v_mfma_f32_16x16x32_bf16 v[104:107], v[152:155], a[136:139], v[104:107]
v_mfma_f32_16x16x32_bf16 v[112:115], v[152:155], a[140:143], v[112:115]
ds_read_b128 v[144:147], v1 offset:14336
v_mfma_f32_16x16x32_bf16 v[116:119], v[156:159], a[140:143], v[116:119]
buffer_load_dwordx4 a[104:107], v1, s[4:7], s61 offen offset:3072 sc1
v_mfma_f32_16x16x32_bf16 v[108:111], v[156:159], a[136:139], v[108:111]
s_waitcnt lgkmcnt(3)
ds_read_b128 v[148:151], v1 offset:15360
s_add_u32 s61, s31, 60416
v_mfma_f32_16x16x32_bf16 v[120:123], v[160:163], a[136:139], v[120:123]
v_mfma_f32_16x16x32_bf16 v[128:131], v[160:163], a[140:143], v[128:131]
ds_read_b128 v[152:155], v1 offset:16384
v_mfma_f32_16x16x32_bf16 v[132:135], v[164:167], a[140:143], v[132:135]
v_mfma_f32_16x16x32_bf16 v[124:127], v[164:167], a[136:139], v[124:127]
s_waitcnt lgkmcnt(3)
ds_read_b128 v[156:159], v1 offset:17408
v_mfma_f32_16x16x32_bf16 v[104:107], v[136:139], a[144:147], v[104:107]
buffer_load_dwordx4 a[108:111], v1, s[4:7], s61 offen offset:0 sc1
v_mfma_f32_16x16x32_bf16 v[112:115], v[136:139], a[148:151], v[112:115]
ds_read_b128 v[160:163], v1 offset:18432
v_mfma_f32_16x16x32_bf16 v[116:119], v[140:143], a[148:151], v[116:119]
v_mfma_f32_16x16x32_bf16 v[108:111], v[140:143], a[144:147], v[108:111]
s_waitcnt lgkmcnt(3)
ds_read_b128 v[164:167], v1 offset:19456
v_mfma_f32_16x16x32_bf16 v[120:123], v[144:147], a[144:147], v[120:123]
v_mfma_f32_16x16x32_bf16 v[128:131], v[144:147], a[148:151], v[128:131]
v_mfma_f32_16x16x32_bf16 v[132:135], v[148:151], a[148:151], v[132:135]
v_mfma_f32_16x16x32_bf16 v[124:127], v[148:151], a[144:147], v[124:127]
s_waitcnt lgkmcnt(2)
v_mfma_f32_16x16x32_bf16 v[104:107], v[152:155], a[152:155], v[104:107]
v_mfma_f32_16x16x32_bf16 v[112:115], v[152:155], a[156:159], v[112:115]
v_mfma_f32_16x16x32_bf16 v[116:119], v[156:159], a[156:159], v[116:119]
v_mfma_f32_16x16x32_bf16 v[108:111], v[156:159], a[152:155], v[108:111]
s_waitcnt lgkmcnt(0)
v_mfma_f32_16x16x32_bf16 v[120:123], v[160:163], a[152:155], v[120:123]
v_mfma_f32_16x16x32_bf16 v[128:131], v[160:163], a[156:159], v[128:131]
v_mfma_f32_16x16x32_bf16 v[132:135], v[164:167], a[156:159], v[132:135]
v_mfma_f32_16x16x32_bf16 v[124:127], v[164:167], a[152:155], v[124:127]
v_pk_mul_f32 v[216:217], v[104:105], v[104:105]
v_pk_mul_f32 v[218:219], v[106:107], v[106:107]
v_pk_fma_f32 v[216:217], v[216:217], v[238:239], v[236:237] op_sel:[0,0,0] op_sel_hi:[1,0,0]
v_pk_fma_f32 v[218:219], v[218:219], v[238:239], v[236:237] op_sel:[0,0,0] op_sel_hi:[1,0,0]
v_pk_mul_f32 v[216:217], v[216:217], v[104:105]
v_pk_mul_f32 v[218:219], v[218:219], v[106:107]
v_exp_f32 v216, v216
v_exp_f32 v217, v217
v_exp_f32 v218, v218
v_exp_f32 v219, v219
v_pk_mul_f32 v[120:121], v[120:121], v[104:105]
v_pk_mul_f32 v[122:123], v[122:123], v[106:107]
v_pk_fma_f32 v[216:217], v[216:217], v[240:241], v[240:241] op_sel:[0,0,0] op_sel_hi:[1,0,0]
v_pk_fma_f32 v[218:219], v[218:219], v[240:241], v[240:241] op_sel:[0,0,0] op_sel_hi:[1,0,0]
v_rcp_f32 v216, v216
v_rcp_f32 v217, v217
v_rcp_f32 v218, v218
v_rcp_f32 v219, v219
v_pk_mul_f32 v[120:121], v[120:121], v[216:217]
v_pk_mul_f32 v[122:123], v[122:123], v[218:219]
v_cvt_pk_bf16_f32 v228, v120, v121
v_cvt_pk_bf16_f32 v229, v122, v123
v_pk_mul_f32 v[216:217], v[108:109], v[108:109]
v_pk_mul_f32 v[218:219], v[110:111], v[110:111]
v_pk_fma_f32 v[216:217], v[216:217], v[238:239], v[236:237] op_sel:[0,0,0] op_sel_hi:[1,0,0]
v_pk_fma_f32 v[218:219], v[218:219], v[238:239], v[236:237] op_sel:[0,0,0] op_sel_hi:[1,0,0]
v_pk_mul_f32 v[216:217], v[216:217], v[108:109]
v_pk_mul_f32 v[218:219], v[218:219], v[110:111]
v_exp_f32 v216, v216
v_exp_f32 v217, v217
v_exp_f32 v218, v218
v_exp_f32 v219, v219
v_pk_mul_f32 v[124:125], v[124:125], v[108:109]
v_pk_mul_f32 v[126:127], v[126:127], v[110:111]
v_pk_fma_f32 v[216:217], v[216:217], v[240:241], v[240:241] op_sel:[0,0,0] op_sel_hi:[1,0,0]
v_pk_fma_f32 v[218:219], v[218:219], v[240:241], v[240:241] op_sel:[0,0,0] op_sel_hi:[1,0,0]
v_rcp_f32 v216, v216
v_rcp_f32 v217, v217
v_rcp_f32 v218, v218
v_rcp_f32 v219, v219
v_pk_mul_f32 v[124:125], v[124:125], v[216:217]
v_pk_mul_f32 v[126:127], v[126:127], v[218:219]
v_cvt_pk_bf16_f32 v230, v124, v125
v_cvt_pk_bf16_f32 v231, v126, v127
buffer_store_dwordx4 v[228:231], v4, s[4:7], s78 offen offset:0 sc1
v_pk_mul_f32 v[216:217], v[112:113], v[112:113]
v_pk_mul_f32 v[218:219], v[114:115], v[114:115]
v_pk_fma_f32 v[216:217], v[216:217], v[238:239], v[236:237] op_sel:[0,1,1] op_sel_hi:[1,1,1]
v_pk_fma_f32 v[218:219], v[218:219], v[238:239], v[236:237] op_sel:[0,1,1] op_sel_hi:[1,1,1]
v_pk_mul_f32 v[216:217], v[216:217], v[112:113]
v_pk_mul_f32 v[218:219], v[218:219], v[114:115]
v_exp_f32 v216, v216
v_exp_f32 v217, v217
v_exp_f32 v218, v218
v_exp_f32 v219, v219
v_pk_mul_f32 v[128:129], v[128:129], v[112:113]
v_pk_mul_f32 v[130:131], v[130:131], v[114:115]
v_pk_fma_f32 v[216:217], v[216:217], v[240:241], v[240:241] op_sel:[0,1,1] op_sel_hi:[1,1,1]
v_pk_fma_f32 v[218:219], v[218:219], v[240:241], v[240:241] op_sel:[0,1,1] op_sel_hi:[1,1,1]
v_rcp_f32 v216, v216
v_rcp_f32 v217, v217
v_rcp_f32 v218, v218
v_rcp_f32 v219, v219
v_pk_mul_f32 v[128:129], v[128:129], v[216:217]
v_pk_mul_f32 v[130:131], v[130:131], v[218:219]
v_cvt_pk_bf16_f32 v232, v128, v129
v_cvt_pk_bf16_f32 v233, v130, v131
v_pk_mul_f32 v[216:217], v[116:117], v[116:117]
v_pk_mul_f32 v[218:219], v[118:119], v[118:119]
v_pk_fma_f32 v[216:217], v[216:217], v[238:239], v[236:237] op_sel:[0,1,1] op_sel_hi:[1,1,1]
v_pk_fma_f32 v[218:219], v[218:219], v[238:239], v[236:237] op_sel:[0,1,1] op_sel_hi:[1,1,1]
v_pk_mul_f32 v[216:217], v[216:217], v[116:117]
v_pk_mul_f32 v[218:219], v[218:219], v[118:119]
v_exp_f32 v216, v216
v_exp_f32 v217, v217
v_exp_f32 v218, v218
v_exp_f32 v219, v219
v_pk_mul_f32 v[132:133], v[132:133], v[116:117]
v_pk_mul_f32 v[134:135], v[134:135], v[118:119]
v_pk_fma_f32 v[216:217], v[216:217], v[240:241], v[240:241] op_sel:[0,1,1] op_sel_hi:[1,1,1]
v_pk_fma_f32 v[218:219], v[218:219], v[240:241], v[240:241] op_sel:[0,1,1] op_sel_hi:[1,1,1]
v_rcp_f32 v216, v216
v_rcp_f32 v217, v217
v_rcp_f32 v218, v218
v_rcp_f32 v219, v219
v_pk_mul_f32 v[132:133], v[132:133], v[216:217]
v_pk_mul_f32 v[134:135], v[134:135], v[218:219]
v_cvt_pk_bf16_f32 v234, v132, v133
v_cvt_pk_bf16_f32 v235, v134, v135
buffer_store_dwordx4 v[232:235], v4, s[4:7], s78 offen offset:256 sc1
v_mov_b32 v15, 7
s_cmp_eq_u32 s18, 0
s_cbranch_scc1 Lo84
s_waitcnt vmcnt(0) lgkmcnt(0)
s_barrier
s_branch Lj85
Lr87_x:
s_add_u32 s57, s57, 1
s_cmp_lt_u32 s57, 1048576
s_cbranch_scc1 Lr87_0
s_mov_b64 vcc, 0
s_branch Lr87_d
Lo84:
s_cbranch_vccnz Lw86
s_mov_b32 s57, 0
s_mov_b64 exec, 1
s_waitcnt vmcnt(0) lgkmcnt(0)
s_barrier
buffer_store_dword v15, v12, s[4:7], s49 offen
s_mov_b64 exec, 0xffff
Lr87_0:
buffer_load_dword v15, v7, s[4:7], s23 offen sc1
Lr87_w:
s_waitcnt vmcnt(0)
v_cmp_gt_u32 vcc, 7, v15
s_nop 0
s_cbranch_vccnz Lr87_x
Lr87_d:
s_mov_b64 exec, -1
Lj85:
s_barrier
buffer_load_dwordx4 v[40:43], v4, s[4:7], s62 offen offset:0 sc1
s_add_u32 s66, s62, 6400
buffer_load_dwordx4 v[44:47], v4, s[4:7], s66 offen offset:0 sc1
s_add_u32 s66, s62, 12800
buffer_load_dwordx4 v[48:51], v4, s[4:7], s66 offen offset:0 sc1
s_add_u32 s66, s62, 19200
buffer_load_dwordx4 v[52:55], v4, s[4:7], s66 offen offset:0 sc1
buffer_load_dwordx4 v[56:59], v4, s[4:7], s62 offen offset:2048 sc1
s_add_u32 s66, s62, 8448
buffer_load_dwordx4 v[60:63], v4, s[4:7], s66 offen offset:0 sc1
s_add_u32 s66, s62, 14848
buffer_load_dwordx4 v[64:67], v4, s[4:7], s66 offen offset:0 sc1
s_add_u32 s66, s62, 21248
buffer_load_dwordx4 v[68:71], v4, s[4:7], s66 offen offset:0 sc1
s_add_u32 s66, s62, 4096
buffer_load_dwordx4 v[72:75], v4, s[4:7], s66 offen offset:0 sc1
s_add_u32 s66, s62, 10496
buffer_load_dwordx4 v[76:79], v4, s[4:7], s66 offen offset:0 sc1
s_waitcnt vmcnt(9)
v_mfma_f32_16x16x32_bf16 v[88:91], a[160:163], v[40:43], 0
s_add_u32 s66, s62, 16896
v_mfma_f32_16x16x32_bf16 v[92:95], a[164:167], v[40:43], 0
buffer_load_dwordx4 v[80:83], v4, s[4:7], s66 offen offset:0 sc1
v_mfma_f32_16x16x32_bf16 v[96:99], a[168:171], v[40:43], 0
s_add_u32 s66, s62, 23296
v_mfma_f32_16x16x32_bf16 v[100:103], a[172:175], v[40:43], 0
v_mfma_f32_16x16x32_bf16 v[104:107], a[176:179], v[40:43], 0
s_waitcnt vmcnt(9)
v_mfma_f32_16x16x32_bf16 v[88:91], a[180:183], v[44:47], v[88:91]
buffer_load_dwordx4 v[84:87], v4, s[4:7], s66 offen offset:0 sc1
v_mfma_f32_16x16x32_bf16 v[92:95], a[184:187], v[44:47], v[92:95]
v_mfma_f32_16x16x32_bf16 v[96:99], a[188:191], v[44:47], v[96:99]
v_mfma_f32_16x16x32_bf16 v[100:103], a[192:195], v[44:47], v[100:103]
v_mfma_f32_16x16x32_bf16 v[104:107], a[196:199], v[44:47], v[104:107]
s_waitcnt vmcnt(9)
v_mfma_f32_16x16x32_bf16 v[88:91], a[200:203], v[48:51], v[88:91]
buffer_load_dwordx4 v[40:43], v4, s[4:7], s63 offen offset:0 sc1
v_mfma_f32_16x16x32_bf16 v[92:95], a[204:207], v[48:51], v[92:95]
s_add_u32 s66, s63, 6400
v_mfma_f32_16x16x32_bf16 v[96:99], a[208:211], v[48:51], v[96:99]
v_mfma_f32_16x16x32_bf16 v[100:103], a[212:215], v[48:51], v[100:103]
v_mfma_f32_16x16x32_bf16 v[104:107], a[216:219], v[48:51], v[104:107]
s_waitcnt vmcnt(9)
v_mfma_f32_16x16x32_bf16 v[88:91], a[220:223], v[52:55], v[88:91]
buffer_load_dwordx4 v[44:47], v4, s[4:7], s66 offen offset:0 sc1
v_mfma_f32_16x16x32_bf16 v[92:95], a[224:227], v[52:55], v[92:95]
s_add_u32 s66, s63, 12800
v_mfma_f32_16x16x32_bf16 v[96:99], a[228:231], v[52:55], v[96:99]
v_mfma_f32_16x16x32_bf16 v[100:103], a[232:235], v[52:55], v[100:103]
v_mfma_f32_16x16x32_bf16 v[104:107], a[236:239], v[52:55], v[104:107]
s_waitcnt vmcnt(9)
v_mfma_f32_16x16x32_bf16 v[88:91], a[240:243], v[56:59], v[88:91]
buffer_load_dwordx4 v[48:51], v4, s[4:7], s66 offen offset:0 sc1
v_mfma_f32_16x16x32_bf16 v[92:95], a[244:247], v[56:59], v[92:95]
s_add_u32 s66, s63, 19200
v_mfma_f32_16x16x32_bf16 v[96:99], a[248:251], v[56:59], v[96:99]
v_mfma_f32_16x16x32_bf16 v[100:103], a[252:255], v[56:59], v[100:103]
v_mfma_f32_16x16x32_bf16 v[104:107], v[168:171], v[56:59], v[104:107]
s_waitcnt vmcnt(9)
v_mfma_f32_16x16x32_bf16 v[88:91], v[172:175], v[60:63], v[88:91]
buffer_load_dwordx4 v[52:55], v4, s[4:7], s66 offen offset:0 sc1
v_mfma_f32_16x16x32_bf16 v[92:95], v[176:179], v[60:63], v[92:95]
v_mfma_f32_16x16x32_bf16 v[96:99], v[180:183], v[60:63], v[96:99]
v_mfma_f32_16x16x32_bf16 v[100:103], v[184:187], v[60:63], v[100:103]
v_mfma_f32_16x16x32_bf16 v[104:107], v[188:191], v[60:63], v[104:107]
s_waitcnt vmcnt(9)
v_mfma_f32_16x16x32_bf16 v[88:91], v[192:195], v[64:67], v[88:91]
buffer_load_dwordx4 v[56:59], v4, s[4:7], s63 offen offset:2048 sc1
v_mfma_f32_16x16x32_bf16 v[92:95], v[196:199], v[64:67], v[92:95]
s_add_u32 s66, s63, 8448
v_mfma_f32_16x16x32_bf16 v[96:99], a[0:3], v[64:67], v[96:99]
v_mfma_f32_16x16x32_bf16 v[100:103], a[4:7], v[64:67], v[100:103]
v_mfma_f32_16x16x32_bf16 v[104:107], a[8:11], v[64:67], v[104:107]
s_waitcnt vmcnt(9)
v_mfma_f32_16x16x32_bf16 v[88:91], a[12:15], v[68:71], v[88:91]
buffer_load_dwordx4 v[60:63], v4, s[4:7], s66 offen offset:0 sc1
v_mfma_f32_16x16x32_bf16 v[92:95], a[16:19], v[68:71], v[92:95]
s_add_u32 s66, s63, 14848
v_mfma_f32_16x16x32_bf16 v[96:99], a[20:23], v[68:71], v[96:99]
v_mfma_f32_16x16x32_bf16 v[100:103], a[24:27], v[68:71], v[100:103]
v_mfma_f32_16x16x32_bf16 v[104:107], a[28:31], v[68:71], v[104:107]
s_waitcnt vmcnt(9)
v_mfma_f32_16x16x32_bf16 v[88:91], a[32:35], v[72:75], v[88:91]
buffer_load_dwordx4 v[64:67], v4, s[4:7], s66 offen offset:0 sc1
v_mfma_f32_16x16x32_bf16 v[92:95], a[36:39], v[72:75], v[92:95]
s_add_u32 s66, s63, 21248
v_mfma_f32_16x16x32_bf16 v[96:99], a[40:43], v[72:75], v[96:99]
v_mfma_f32_16x16x32_bf16 v[100:103], a[44:47], v[72:75], v[100:103]
v_mfma_f32_16x16x32_bf16 v[104:107], a[48:51], v[72:75], v[104:107]
s_waitcnt vmcnt(9)
v_mfma_f32_16x16x32_bf16 v[88:91], a[52:55], v[76:79], v[88:91]
buffer_load_dwordx4 v[68:71], v4, s[4:7], s66 offen offset:0 sc1
v_mfma_f32_16x16x32_bf16 v[92:95], a[56:59], v[76:79], v[92:95]
s_add_u32 s66, s63, 4096
v_mfma_f32_16x16x32_bf16 v[96:99], a[60:63], v[76:79], v[96:99]
v_mfma_f32_16x16x32_bf16 v[100:103], a[64:67], v[76:79], v[100:103]
v_mfma_f32_16x16x32_bf16 v[104:107], a[68:71], v[76:79], v[104:107]
s_waitcnt vmcnt(9)
v_mfma_f32_16x16x32_bf16 v[88:91], a[72:75], v[80:83], v[88:91]
buffer_load_dwordx4 v[72:75], v4, s[4:7], s66 offen offset:0 sc1
v_mfma_f32_16x16x32_bf16 v[92:95], a[76:79], v[80:83], v[92:95]
s_add_u32 s66, s63, 10496
v_mfma_f32_16x16x32_bf16 v[96:99], a[80:83], v[80:83], v[96:99]
v_mfma_f32_16x16x32_bf16 v[100:103], a[84:87], v[80:83], v[100:103]
v_mfma_f32_16x16x32_bf16 v[104:107], a[88:91], v[80:83], v[104:107]
s_waitcnt vmcnt(9)
v_mfma_f32_16x16x32_bf16 v[88:91], a[92:95], v[84:87], v[88:91]
buffer_load_dwordx4 v[76:79], v4, s[4:7], s66 offen offset:0 sc1
v_mfma_f32_16x16x32_bf16 v[92:95], a[96:99], v[84:87], v[92:95]
s_add_u32 s66, s63, 16896
v_mfma_f32_16x16x32_bf16 v[96:99], a[100:103], v[84:87], v[96:99]
v_mfma_f32_16x16x32_bf16 v[100:103], a[104:107], v[84:87], v[100:103]
v_mfma_f32_16x16x32_bf16 v[104:107], a[108:111], v[84:87], v[104:107]
s_waitcnt vmcnt(9)
v_mfma_f32_16x16x32_bf16 v[108:111], a[160:163], v[40:43], 0
buffer_load_dwordx4 v[80:83], v4, s[4:7], s66 offen offset:0 sc1
v_mfma_f32_16x16x32_bf16 v[112:115], a[164:167], v[40:43], 0
s_add_u32 s66, s63, 23296
v_mfma_f32_16x16x32_bf16 v[116:119], a[168:171], v[40:43], 0
v_mfma_f32_16x16x32_bf16 v[120:123], a[172:175], v[40:43], 0
ds_write_b128 v246, v[88:91] offset:0
v_mfma_f32_16x16x32_bf16 v[124:127], a[176:179], v[40:43], 0
s_waitcnt vmcnt(9)
v_mfma_f32_16x16x32_bf16 v[108:111], a[180:183], v[44:47], v[108:111]
buffer_load_dwordx4 v[84:87], v4, s[4:7], s66 offen offset:0 sc1
v_mfma_f32_16x16x32_bf16 v[112:115], a[184:187], v[44:47], v[112:115]
ds_write_b128 v246, v[92:95] offset:1024
v_mfma_f32_16x16x32_bf16 v[116:119], a[188:191], v[44:47], v[116:119]
v_mfma_f32_16x16x32_bf16 v[120:123], a[192:195], v[44:47], v[120:123]
v_mfma_f32_16x16x32_bf16 v[124:127], a[196:199], v[44:47], v[124:127]
s_waitcnt vmcnt(9)
ds_write_b128 v246, v[96:99] offset:2048
v_mfma_f32_16x16x32_bf16 v[108:111], a[200:203], v[48:51], v[108:111]
buffer_load_dwordx4 v[40:43], v4, s[4:7], s64 offen offset:0 sc1
v_mfma_f32_16x16x32_bf16 v[112:115], a[204:207], v[48:51], v[112:115]
s_add_u32 s66, s64, 6400
v_mfma_f32_16x16x32_bf16 v[116:119], a[208:211], v[48:51], v[116:119]
ds_write_b128 v246, v[100:103] offset:3072
v_mfma_f32_16x16x32_bf16 v[120:123], a[212:215], v[48:51], v[120:123]
v_mfma_f32_16x16x32_bf16 v[124:127], a[216:219], v[48:51], v[124:127]
s_waitcnt vmcnt(9)
v_mfma_f32_16x16x32_bf16 v[108:111], a[220:223], v[52:55], v[108:111]
buffer_load_dwordx4 v[44:47], v4, s[4:7], s66 offen offset:0 sc1
v_mfma_f32_16x16x32_bf16 v[112:115], a[224:227], v[52:55], v[112:115]
s_add_u32 s66, s64, 12800
ds_write_b128 v246, v[104:107] offset:4096
v_mfma_f32_16x16x32_bf16 v[116:119], a[228:231], v[52:55], v[116:119]
v_mfma_f32_16x16x32_bf16 v[120:123], a[232:235], v[52:55], v[120:123]
v_mfma_f32_16x16x32_bf16 v[124:127], a[236:239], v[52:55], v[124:127]
s_waitcnt vmcnt(9)
v_mfma_f32_16x16x32_bf16 v[108:111], a[240:243], v[56:59], v[108:111]
buffer_load_dwordx4 v[48:51], v4, s[4:7], s66 offen offset:0 sc1
v_mfma_f32_16x16x32_bf16 v[112:115], a[244:247], v[56:59], v[112:115]
s_add_u32 s66, s64, 19200
s_waitcnt lgkmcnt(0)
s_barrier
ds_read_b128 v[200:203], v249 offset:0
v_mfma_f32_16x16x32_bf16 v[116:119], a[248:251], v[56:59], v[116:119]
ds_read_b128 v[204:207], v249 offset:1024
v_mfma_f32_16x16x32_bf16 v[120:123], a[252:255], v[56:59], v[120:123]
ds_read_b128 v[208:211], v249 offset:2048
v_mfma_f32_16x16x32_bf16 v[124:127], v[168:171], v[56:59], v[124:127]
s_waitcnt vmcnt(9)
ds_read_b128 v[212:215], v249 offset:3072
v_mfma_f32_16x16x32_bf16 v[108:111], v[172:175], v[60:63], v[108:111]
buffer_load_dwordx4 v[52:55], v4, s[4:7], s66 offen offset:0 sc1
v_mfma_f32_16x16x32_bf16 v[112:115], v[176:179], v[60:63], v[112:115]
ds_read_b128 v[216:219], v249 offset:4096
v_mfma_f32_16x16x32_bf16 v[116:119], v[180:183], v[60:63], v[116:119]
v_mfma_f32_16x16x32_bf16 v[120:123], v[184:187], v[60:63], v[120:123]
v_mfma_f32_16x16x32_bf16 v[124:127], v[188:191], v[60:63], v[124:127]
s_waitcnt vmcnt(9)
v_mfma_f32_16x16x32_bf16 v[108:111], v[192:195], v[64:67], v[108:111]
buffer_load_dwordx4 v[56:59], v4, s[4:7], s64 offen offset:2048 sc1
v_mfma_f32_16x16x32_bf16 v[112:115], v[196:199], v[64:67], v[112:115]
s_add_u32 s66, s64, 8448
s_waitcnt lgkmcnt(0)
v_add_f32 v16, v16, v200
v_mfma_f32_16x16x32_bf16 v[116:119], a[0:3], v[64:67], v[116:119]
v_add_f32 v17, v17, v201
v_add_f32 v18, v18, v202
v_mfma_f32_16x16x32_bf16 v[120:123], a[4:7], v[64:67], v[120:123]
v_add_f32 v19, v19, v203
v_add_f32 v20, v20, v204
v_mfma_f32_16x16x32_bf16 v[124:127], a[8:11], v[64:67], v[124:127]
s_waitcnt vmcnt(9)
v_add_f32 v21, v21, v205
v_add_f32 v22, v22, v206
v_mfma_f32_16x16x32_bf16 v[108:111], a[12:15], v[68:71], v[108:111]
buffer_load_dwordx4 v[60:63], v4, s[4:7], s66 offen offset:0 sc1
v_mfma_f32_16x16x32_bf16 v[112:115], a[16:19], v[68:71], v[112:115]
s_add_u32 s66, s64, 14848
v_add_f32 v23, v23, v207
v_add_f32 v24, v24, v208
v_mfma_f32_16x16x32_bf16 v[116:119], a[20:23], v[68:71], v[116:119]
v_add_f32 v25, v25, v209
v_add_f32 v26, v26, v210
v_mfma_f32_16x16x32_bf16 v[120:123], a[24:27], v[68:71], v[120:123]
v_add_f32 v27, v27, v211
v_add_f32 v28, v28, v212
v_mfma_f32_16x16x32_bf16 v[124:127], a[28:31], v[68:71], v[124:127]
s_waitcnt vmcnt(9)
v_add_f32 v29, v29, v213
v_add_f32 v30, v30, v214
v_mfma_f32_16x16x32_bf16 v[108:111], a[32:35], v[72:75], v[108:111]
buffer_load_dwordx4 v[64:67], v4, s[4:7], s66 offen offset:0 sc1
v_mfma_f32_16x16x32_bf16 v[112:115], a[36:39], v[72:75], v[112:115]
s_add_u32 s66, s64, 21248
v_add_f32 v31, v31, v215
v_add_f32 v32, v32, v216
v_mfma_f32_16x16x32_bf16 v[116:119], a[40:43], v[72:75], v[116:119]
v_add_f32 v33, v33, v217
v_add_f32 v34, v34, v218
v_mfma_f32_16x16x32_bf16 v[120:123], a[44:47], v[72:75], v[120:123]
v_add_f32 v35, v35, v219
v_mfma_f32_16x16x32_bf16 v[124:127], a[48:51], v[72:75], v[124:127]
s_waitcnt vmcnt(9)
v_mfma_f32_16x16x32_bf16 v[108:111], a[52:55], v[76:79], v[108:111]
buffer_load_dwordx4 v[68:71], v4, s[4:7], s66 offen offset:0 sc1
v_mfma_f32_16x16x32_bf16 v[112:115], a[56:59], v[76:79], v[112:115]
s_add_u32 s66, s64, 4096
v_mfma_f32_16x16x32_bf16 v[116:119], a[60:63], v[76:79], v[116:119]
v_mfma_f32_16x16x32_bf16 v[120:123], a[64:67], v[76:79], v[120:123]
v_mfma_f32_16x16x32_bf16 v[124:127], a[68:71], v[76:79], v[124:127]
s_waitcnt vmcnt(9)
v_mfma_f32_16x16x32_bf16 v[108:111], a[72:75], v[80:83], v[108:111]
buffer_load_dwordx4 v[72:75], v4, s[4:7], s66 offen offset:0 sc1
v_mfma_f32_16x16x32_bf16 v[112:115], a[76:79], v[80:83], v[112:115]
s_add_u32 s66, s64, 10496
v_mfma_f32_16x16x32_bf16 v[116:119], a[80:83], v[80:83], v[116:119]
v_mfma_f32_16x16x32_bf16 v[120:123], a[84:87], v[80:83], v[120:123]
v_mfma_f32_16x16x32_bf16 v[124:127], a[88:91], v[80:83], v[124:127]
s_waitcnt vmcnt(9)
v_mfma_f32_16x16x32_bf16 v[108:111], a[92:95], v[84:87], v[108:111]
buffer_load_dwordx4 v[76:79], v4, s[4:7], s66 offen offset:0 sc1
v_mfma_f32_16x16x32_bf16 v[112:115], a[96:99], v[84:87], v[112:115]
s_add_u32 s66, s64, 16896
v_mfma_f32_16x16x32_bf16 v[116:119], a[100:103], v[84:87], v[116:119]
v_mfma_f32_16x16x32_bf16 v[120:123], a[104:107], v[84:87], v[120:123]
v_mfma_f32_16x16x32_bf16 v[124:127], a[108:111], v[84:87], v[124:127]
s_waitcnt vmcnt(9)
v_mfma_f32_16x16x32_bf16 v[128:131], a[160:163], v[40:43], 0
buffer_load_dwordx4 v[80:83], v4, s[4:7], s66 offen offset:0 sc1
v_mfma_f32_16x16x32_bf16 v[132:135], a[164:167], v[40:43], 0
s_add_u32 s66, s64, 23296
v_mfma_f32_16x16x32_bf16 v[136:139], a[168:171], v[40:43], 0
v_mfma_f32_16x16x32_bf16 v[140:143], a[172:175], v[40:43], 0
ds_write_b128 v247, v[108:111] offset:0
v_mfma_f32_16x16x32_bf16 v[144:147], a[176:179], v[40:43], 0
s_waitcnt vmcnt(9)
v_mfma_f32_16x16x32_bf16 v[128:131], a[180:183], v[44:47], v[128:131]
buffer_load_dwordx4 v[84:87], v4, s[4:7], s66 offen offset:0 sc1
v_mfma_f32_16x16x32_bf16 v[132:135], a[184:187], v[44:47], v[132:135]
ds_write_b128 v247, v[112:115] offset:1024
v_mfma_f32_16x16x32_bf16 v[136:139], a[188:191], v[44:47], v[136:139]
v_mfma_f32_16x16x32_bf16 v[140:143], a[192:195], v[44:47], v[140:143]
v_mfma_f32_16x16x32_bf16 v[144:147], a[196:199], v[44:47], v[144:147]
s_waitcnt vmcnt(9)
ds_write_b128 v247, v[116:119] offset:2048
v_mfma_f32_16x16x32_bf16 v[128:131], a[200:203], v[48:51], v[128:131]
buffer_load_dwordx4 v[40:43], v4, s[4:7], s65 offen offset:0 sc1
v_mfma_f32_16x16x32_bf16 v[132:135], a[204:207], v[48:51], v[132:135]
s_add_u32 s66, s65, 6400
v_mfma_f32_16x16x32_bf16 v[136:139], a[208:211], v[48:51], v[136:139]
ds_write_b128 v247, v[120:123] offset:3072
v_mfma_f32_16x16x32_bf16 v[140:143], a[212:215], v[48:51], v[140:143]
v_mfma_f32_16x16x32_bf16 v[144:147], a[216:219], v[48:51], v[144:147]
s_waitcnt vmcnt(9)
v_mfma_f32_16x16x32_bf16 v[128:131], a[220:223], v[52:55], v[128:131]
buffer_load_dwordx4 v[44:47], v4, s[4:7], s66 offen offset:0 sc1
v_mfma_f32_16x16x32_bf16 v[132:135], a[224:227], v[52:55], v[132:135]
s_add_u32 s66, s65, 12800
ds_write_b128 v247, v[124:127] offset:4096
v_mfma_f32_16x16x32_bf16 v[136:139], a[228:231], v[52:55], v[136:139]
v_mfma_f32_16x16x32_bf16 v[140:143], a[232:235], v[52:55], v[140:143]
v_mfma_f32_16x16x32_bf16 v[144:147], a[236:239], v[52:55], v[144:147]
s_waitcnt vmcnt(9)
v_mfma_f32_16x16x32_bf16 v[128:131], a[240:243], v[56:59], v[128:131]
buffer_load_dwordx4 v[48:51], v4, s[4:7], s66 offen offset:0 sc1
v_mfma_f32_16x16x32_bf16 v[132:135], a[244:247], v[56:59], v[132:135]
s_add_u32 s66, s65, 19200
s_waitcnt lgkmcnt(0)
s_barrier
ds_read_b128 v[220:223], v249 offset:20480
v_mfma_f32_16x16x32_bf16 v[136:139], a[248:251], v[56:59], v[136:139]
ds_read_b128 v[224:227], v249 offset:21504
v_mfma_f32_16x16x32_bf16 v[140:143], a[252:255], v[56:59], v[140:143]
ds_read_b128 v[228:231], v249 offset:22528
v_mfma_f32_16x16x32_bf16 v[144:147], v[168:171], v[56:59], v[144:147]
s_waitcnt vmcnt(9)
ds_read_b128 v[232:235], v249 offset:23552
v_mfma_f32_16x16x32_bf16 v[128:131], v[172:175], v[60:63], v[128:131]
buffer_load_dwordx4 v[52:55], v4, s[4:7], s66 offen offset:0 sc1
v_mfma_f32_16x16x32_bf16 v[132:135], v[176:179], v[60:63], v[132:135]
ds_read_b128 v[236:239], v249 offset:24576
v_mfma_f32_16x16x32_bf16 v[136:139], v[180:183], v[60:63], v[136:139]
v_mfma_f32_16x16x32_bf16 v[140:143], v[184:187], v[60:63], v[140:143]
v_mfma_f32_16x16x32_bf16 v[144:147], v[188:191], v[60:63], v[144:147]
s_waitcnt vmcnt(9)
v_mfma_f32_16x16x32_bf16 v[128:131], v[192:195], v[64:67], v[128:131]
buffer_load_dwordx4 v[56:59], v4, s[4:7], s65 offen offset:2048 sc1
v_mfma_f32_16x16x32_bf16 v[132:135], v[196:199], v[64:67], v[132:135]
s_add_u32 s66, s65, 8448
s_waitcnt lgkmcnt(0)
v_add_f32 v16, v16, v220
v_mfma_f32_16x16x32_bf16 v[136:139], a[0:3], v[64:67], v[136:139]
v_add_f32 v17, v17, v221
v_add_f32 v18, v18, v222
v_mfma_f32_16x16x32_bf16 v[140:143], a[4:7], v[64:67], v[140:143]
v_add_f32 v19, v19, v223
v_add_f32 v20, v20, v224
v_mfma_f32_16x16x32_bf16 v[144:147], a[8:11], v[64:67], v[144:147]
s_waitcnt vmcnt(9)
v_add_f32 v21, v21, v225
v_add_f32 v22, v22, v226
v_mfma_f32_16x16x32_bf16 v[128:131], a[12:15], v[68:71], v[128:131]
buffer_load_dwordx4 v[60:63], v4, s[4:7], s66 offen offset:0 sc1
v_mfma_f32_16x16x32_bf16 v[132:135], a[16:19], v[68:71], v[132:135]
s_add_u32 s66, s65, 14848
v_add_f32 v23, v23, v227
v_add_f32 v24, v24, v228
v_mfma_f32_16x16x32_bf16 v[136:139], a[20:23], v[68:71], v[136:139]
v_add_f32 v25, v25, v229
v_add_f32 v26, v26, v230
v_mfma_f32_16x16x32_bf16 v[140:143], a[24:27], v[68:71], v[140:143]
v_add_f32 v27, v27, v231
v_add_f32 v28, v28, v232
v_mfma_f32_16x16x32_bf16 v[144:147], a[28:31], v[68:71], v[144:147]
s_waitcnt vmcnt(9)
v_add_f32 v29, v29, v233
v_add_f32 v30, v30, v234
v_mfma_f32_16x16x32_bf16 v[128:131], a[32:35], v[72:75], v[128:131]
buffer_load_dwordx4 v[64:67], v4, s[4:7], s66 offen offset:0 sc1
v_mfma_f32_16x16x32_bf16 v[132:135], a[36:39], v[72:75], v[132:135]
s_add_u32 s66, s65, 21248
v_add_f32 v31, v31, v235
v_add_f32 v32, v32, v236
v_mfma_f32_16x16x32_bf16 v[136:139], a[40:43], v[72:75], v[136:139]
v_add_f32 v33, v33, v237
v_add_f32 v34, v34, v238
v_mfma_f32_16x16x32_bf16 v[140:143], a[44:47], v[72:75], v[140:143]
v_add_f32 v35, v35, v239
v_mfma_f32_16x16x32_bf16 v[144:147], a[48:51], v[72:75], v[144:147]
s_waitcnt vmcnt(9)
v_mfma_f32_16x16x32_bf16 v[128:131], a[52:55], v[76:79], v[128:131]
buffer_load_dwordx4 v[68:71], v4, s[4:7], s66 offen offset:0 sc1
v_mfma_f32_16x16x32_bf16 v[132:135], a[56:59], v[76:79], v[132:135]
s_add_u32 s66, s65, 4096
v_mfma_f32_16x16x32_bf16 v[136:139], a[60:63], v[76:79], v[136:139]
v_mfma_f32_16x16x32_bf16 v[140:143], a[64:67], v[76:79], v[140:143]
v_mfma_f32_16x16x32_bf16 v[144:147], a[68:71], v[76:79], v[144:147]
s_waitcnt vmcnt(9)
v_mfma_f32_16x16x32_bf16 v[128:131], a[72:75], v[80:83], v[128:131]
buffer_load_dwordx4 v[72:75], v4, s[4:7], s66 offen offset:0 sc1
v_mfma_f32_16x16x32_bf16 v[132:135], a[76:79], v[80:83], v[132:135]
s_add_u32 s66, s65, 10496
v_mfma_f32_16x16x32_bf16 v[136:139], a[80:83], v[80:83], v[136:139]
v_mfma_f32_16x16x32_bf16 v[140:143], a[84:87], v[80:83], v[140:143]
v_mfma_f32_16x16x32_bf16 v[144:147], a[88:91], v[80:83], v[144:147]
s_waitcnt vmcnt(9)
v_mfma_f32_16x16x32_bf16 v[128:131], a[92:95], v[84:87], v[128:131]
buffer_load_dwordx4 v[76:79], v4, s[4:7], s66 offen offset:0 sc1
v_mfma_f32_16x16x32_bf16 v[132:135], a[96:99], v[84:87], v[132:135]
s_add_u32 s66, s65, 16896
v_mfma_f32_16x16x32_bf16 v[136:139], a[100:103], v[84:87], v[136:139]
v_mfma_f32_16x16x32_bf16 v[140:143], a[104:107], v[84:87], v[140:143]
v_mfma_f32_16x16x32_bf16 v[144:147], a[108:111], v[84:87], v[144:147]
s_waitcnt vmcnt(9)
v_mfma_f32_16x16x32_bf16 v[148:151], a[160:163], v[40:43], 0
buffer_load_dwordx4 v[80:83], v4, s[4:7], s66 offen offset:0 sc1
v_mfma_f32_16x16x32_bf16 v[152:155], a[164:167], v[40:43], 0
s_add_u32 s66, s65, 23296
v_mfma_f32_16x16x32_bf16 v[156:159], a[168:171], v[40:43], 0
v_mfma_f32_16x16x32_bf16 v[160:163], a[172:175], v[40:43], 0
ds_write_b128 v248, v[128:131] offset:0
v_mfma_f32_16x16x32_bf16 v[164:167], a[176:179], v[40:43], 0
s_waitcnt vmcnt(9)
v_mfma_f32_16x16x32_bf16 v[148:151], a[180:183], v[44:47], v[148:151]
buffer_load_dwordx4 v[84:87], v4, s[4:7], s66 offen offset:0 sc1
v_mfma_f32_16x16x32_bf16 v[152:155], a[184:187], v[44:47], v[152:155]
ds_write_b128 v248, v[132:135] offset:1024
v_mfma_f32_16x16x32_bf16 v[156:159], a[188:191], v[44:47], v[156:159]
v_mfma_f32_16x16x32_bf16 v[160:163], a[192:195], v[44:47], v[160:163]
v_mfma_f32_16x16x32_bf16 v[164:167], a[196:199], v[44:47], v[164:167]
s_waitcnt vmcnt(9)
ds_write_b128 v248, v[136:139] offset:2048
v_mfma_f32_16x16x32_bf16 v[148:151], a[200:203], v[48:51], v[148:151]
v_mfma_f32_16x16x32_bf16 v[152:155], a[204:207], v[48:51], v[152:155]
v_mfma_f32_16x16x32_bf16 v[156:159], a[208:211], v[48:51], v[156:159]
ds_write_b128 v248, v[140:143] offset:3072
v_mfma_f32_16x16x32_bf16 v[160:163], a[212:215], v[48:51], v[160:163]
v_mfma_f32_16x16x32_bf16 v[164:167], a[216:219], v[48:51], v[164:167]
s_waitcnt vmcnt(8)
v_mfma_f32_16x16x32_bf16 v[148:151], a[220:223], v[52:55], v[148:151]
ds_write_b128 v248, v[144:147] offset:4096
v_mfma_f32_16x16x32_bf16 v[152:155], a[224:227], v[52:55], v[152:155]
v_mfma_f32_16x16x32_bf16 v[156:159], a[228:231], v[52:55], v[156:159]
v_mfma_f32_16x16x32_bf16 v[160:163], a[232:235], v[52:55], v[160:163]
v_mfma_f32_16x16x32_bf16 v[164:167], a[236:239], v[52:55], v[164:167]
s_waitcnt vmcnt(7)
v_mfma_f32_16x16x32_bf16 v[148:151], a[240:243], v[56:59], v[148:151]
s_waitcnt lgkmcnt(0)
s_barrier
ds_read_b128 v[200:203], v249 offset:0
v_mfma_f32_16x16x32_bf16 v[152:155], a[244:247], v[56:59], v[152:155]
ds_read_b128 v[204:207], v249 offset:1024
v_mfma_f32_16x16x32_bf16 v[156:159], a[248:251], v[56:59], v[156:159]
ds_read_b128 v[208:211], v249 offset:2048
v_mfma_f32_16x16x32_bf16 v[160:163], a[252:255], v[56:59], v[160:163]
ds_read_b128 v[212:215], v249 offset:3072
v_mfma_f32_16x16x32_bf16 v[164:167], v[168:171], v[56:59], v[164:167]
s_waitcnt vmcnt(6)
ds_read_b128 v[216:219], v249 offset:4096
v_mfma_f32_16x16x32_bf16 v[148:151], v[172:175], v[60:63], v[148:151]
v_mfma_f32_16x16x32_bf16 v[152:155], v[176:179], v[60:63], v[152:155]
v_mfma_f32_16x16x32_bf16 v[156:159], v[180:183], v[60:63], v[156:159]
v_mfma_f32_16x16x32_bf16 v[160:163], v[184:187], v[60:63], v[160:163]
v_mfma_f32_16x16x32_bf16 v[164:167], v[188:191], v[60:63], v[164:167]
s_waitcnt vmcnt(5)
v_mfma_f32_16x16x32_bf16 v[148:151], v[192:195], v[64:67], v[148:151]
s_waitcnt lgkmcnt(0)
v_add_f32 v16, v16, v200
v_mfma_f32_16x16x32_bf16 v[152:155], v[196:199], v[64:67], v[152:155]
v_add_f32 v17, v17, v201
v_add_f32 v18, v18, v202
v_mfma_f32_16x16x32_bf16 v[156:159], a[0:3], v[64:67], v[156:159]
v_add_f32 v19, v19, v203
v_add_f32 v20, v20, v204
v_mfma_f32_16x16x32_bf16 v[160:163], a[4:7], v[64:67], v[160:163]
v_add_f32 v21, v21, v205
v_add_f32 v22, v22, v206
v_mfma_f32_16x16x32_bf16 v[164:167], a[8:11], v[64:67], v[164:167]
s_waitcnt vmcnt(4)
v_add_f32 v23, v23, v207
v_add_f32 v24, v24, v208
v_mfma_f32_16x16x32_bf16 v[148:151], a[12:15], v[68:71], v[148:151]
v_add_f32 v25, v25, v209
v_add_f32 v26, v26, v210
v_mfma_f32_16x16x32_bf16 v[152:155], a[16:19], v[68:71], v[152:155]
v_add_f32 v27, v27, v211
v_add_f32 v28, v28, v212
v_mfma_f32_16x16x32_bf16 v[156:159], a[20:23], v[68:71], v[156:159]
v_add_f32 v29, v29, v213
v_add_f32 v30, v30, v214
v_mfma_f32_16x16x32_bf16 v[160:163], a[24:27], v[68:71], v[160:163]
v_add_f32 v31, v31, v215
v_add_f32 v32, v32, v216
v_mfma_f32_16x16x32_bf16 v[164:167], a[28:31], v[68:71], v[164:167]
s_waitcnt vmcnt(3)
v_add_f32 v33, v33, v217
v_add_f32 v34, v34, v218
v_mfma_f32_16x16x32_bf16 v[148:151], a[32:35], v[72:75], v[148:151]
v_add_f32 v35, v35, v219
v_mfma_f32_16x16x32_bf16 v[152:155], a[36:39], v[72:75], v[152:155]
v_mfma_f32_16x16x32_bf16 v[156:159], a[40:43], v[72:75], v[156:159]
v_mfma_f32_16x16x32_bf16 v[160:163], a[44:47], v[72:75], v[160:163]
v_mfma_f32_16x16x32_bf16 v[164:167], a[48:51], v[72:75], v[164:167]
s_waitcnt vmcnt(2)
v_mfma_f32_16x16x32_bf16 v[148:151], a[52:55], v[76:79], v[148:151]
v_mfma_f32_16x16x32_bf16 v[152:155], a[56:59], v[76:79], v[152:155]
v_mfma_f32_16x16x32_bf16 v[156:159], a[60:63], v[76:79], v[156:159]
v_mfma_f32_16x16x32_bf16 v[160:163], a[64:67], v[76:79], v[160:163]
v_mfma_f32_16x16x32_bf16 v[164:167], a[68:71], v[76:79], v[164:167]
s_waitcnt vmcnt(1)
v_mfma_f32_16x16x32_bf16 v[148:151], a[72:75], v[80:83], v[148:151]
v_mfma_f32_16x16x32_bf16 v[152:155], a[76:79], v[80:83], v[152:155]
v_mfma_f32_16x16x32_bf16 v[156:159], a[80:83], v[80:83], v[156:159]
v_mfma_f32_16x16x32_bf16 v[160:163], a[84:87], v[80:83], v[160:163]
v_mfma_f32_16x16x32_bf16 v[164:167], a[88:91], v[80:83], v[164:167]
s_waitcnt vmcnt(0)
v_mfma_f32_16x16x32_bf16 v[148:151], a[92:95], v[84:87], v[148:151]
v_mfma_f32_16x16x32_bf16 v[152:155], a[96:99], v[84:87], v[152:155]
v_mfma_f32_16x16x32_bf16 v[156:159], a[100:103], v[84:87], v[156:159]
v_mfma_f32_16x16x32_bf16 v[160:163], a[104:107], v[84:87], v[160:163]
v_mfma_f32_16x16x32_bf16 v[164:167], a[108:111], v[84:87], v[164:167]
s_nop 3
v_pk_add_f32 v[16:17], v[16:17], v[148:149]
v_pk_add_f32 v[18:19], v[18:19], v[150:151]
v_pk_add_f32 v[20:21], v[20:21], v[152:153]
v_pk_add_f32 v[22:23], v[22:23], v[154:155]
v_pk_add_f32 v[24:25], v[24:25], v[156:157]
v_pk_add_f32 v[26:27], v[26:27], v[158:159]
v_pk_add_f32 v[28:29], v[28:29], v[160:161]
v_pk_add_f32 v[30:31], v[30:31], v[162:163]
v_pk_add_f32 v[32:33], v[32:33], v[164:165]
v_pk_add_f32 v[34:35], v[34:35], v[166:167]
v_cvt_pk_bf16_f32 v40, v16, v17
v_cvt_pk_bf16_f32 v41, v18, v19
v_cvt_pk_bf16_f32 v42, v20, v21
v_cvt_pk_bf16_f32 v43, v22, v23
v_cvt_pk_bf16_f32 v44, v24, v25
v_cvt_pk_bf16_f32 v45, v26, v27
v_cvt_pk_bf16_f32 v46, v28, v29
v_cvt_pk_bf16_f32 v47, v30, v31
v_cvt_pk_bf16_f32 v48, v32, v33
v_cvt_pk_bf16_f32 v49, v34, v35
buffer_store_dwordx4 v[40:43], v254, s[12:15], s46 offen nt
buffer_store_dwordx4 v[44:47], v254, s[12:15], s46 offen offset:64 nt
buffer_store_dwordx2 v[48:49], v255, s[12:15], s46 offen offset:128 nt
s_endpgm
M_end:
s_endpgm
Lq3:
s_mov_b64 exec, 3
s_mov_b32 s57, 0
Lp5:
buffer_load_dword v15, v137, s[4:7], 0 offen offset:0 sc1
s_add_u32 s57, s57, 1
s_waitcnt vmcnt(0)
v_and_b32 v36, 0xff, v15
v_cmp_gt_u32 s[58:59], 16, v36
s_nop 0
s_cmp_eq_u64 s[58:59], 0
s_cbranch_scc1 Ld6
s_cmp_lt_u32 s57, 1048576
s_cbranch_scc1 Lp5
Ld6:
s_mov_b64 exec, -1
s_branch Lr4
Lq7:
s_mov_b64 exec, s[26:27]
s_mov_b32 s57, 0
Lp9:
buffer_load_dword v15, v37, s[4:7], 0 offen offset:0 sc1
s_add_u32 s57, s57, 1
s_waitcnt vmcnt(0)
v_cmp_gt_u32 s[58:59], 4, v15
s_nop 0
s_cmp_eq_u64 s[58:59], 0
s_cbranch_scc1 Ld10
s_cmp_lt_u32 s57, 1048576
s_cbranch_scc1 Lp9
Ld10:
s_mov_b64 exec, -1
s_branch Lr8
Lq12:
s_mov_b64 exec, s[26:27]
s_mov_b32 s57, 0
Lp14:
buffer_load_dword v15, v37, s[4:7], 0 offen offset:0 sc1
s_add_u32 s57, s57, 1
s_waitcnt vmcnt(0)
v_cmp_gt_u32 s[58:59], 8, v15
s_nop 0
s_cmp_eq_u64 s[58:59], 0
s_cbranch_scc1 Ld15
s_cmp_lt_u32 s57, 1048576
s_cbranch_scc1 Lp14
Ld15:
s_mov_b64 exec, -1
s_branch Lr13
Lq18:
s_mov_b64 exec, 7
s_mov_b32 s57, 0
Lp20:
buffer_load_dword v15, v37, s[4:7], 0 offen offset:0 sc1
s_add_u32 s57, s57, 1
s_waitcnt vmcnt(0)
v_and_b32 v36, 0xff, v15
v_cmp_gt_u32 s[58:59], 16, v36
s_nop 0
s_cmp_eq_u64 s[58:59], 0
s_cbranch_scc1 Ld21
s_cmp_lt_u32 s57, 1048576
s_cbranch_scc1 Lp20
Ld21:
s_mov_b64 exec, -1
v_readlane_b32 s56, v15, 2
s_lshl_b32 s57, s89, 4
s_branch Lr19a
Lq55:
s_mov_b64 exec, s[26:27]
s_mov_b32 s57, 0
Lp57:
buffer_load_dword v15, v37, s[4:7], 0 offen offset:0 sc1
s_add_u32 s57, s57, 1
s_waitcnt vmcnt(0)
v_cmp_gt_u32 s[58:59], 12, v15
s_nop 0
s_cmp_eq_u64 s[58:59], 0
s_cbranch_scc1 Ld58
s_cmp_lt_u32 s57, 1048576
s_cbranch_scc1 Lp57
Ld58:
s_mov_b64 exec, -1
s_branch Lr56
Lq60:
s_mov_b64 exec, s[26:27]
s_mov_b32 s57, 0
Lp62:
buffer_load_dword v15, v37, s[4:7], 0 offen offset:0 sc1
s_add_u32 s57, s57, 1
s_waitcnt vmcnt(0)
v_cmp_gt_u32 s[58:59], 16, v15
s_nop 0
s_cmp_eq_u64 s[58:59], 0
s_cbranch_scc1 Ld63
s_cmp_lt_u32 s57, 1048576
s_cbranch_scc1 Lp62
Ld63:
s_mov_b64 exec, -1
s_branch Lr61
M_hot_end:
A_spin:
s_mov_b32 s56, s80
s_and_b32 s57, s81, 0xffff
s_mov_b32 s58, 256
s_mov_b32 s59, 0x20000
s_mov_b64 exec, 1
s_mov_b32 s53, 0
Lp1:
buffer_load_dword v15, v12, s[56:59], 0 offen offset:0 sc1
s_add_u32 s53, s53, 1
s_waitcnt vmcnt(0)
v_cmp_gt_u32 s[54:55], 1, v15
s_nop 0
s_cmp_eq_u64 s[54:55], 0
s_cbranch_scc1 Ld2
s_cmp_lt_u32 s53, 1048576
s_cbranch_scc1 Lp1
Ld2:
s_mov_b64 exec, -1
s_branch A_spun
A_inv:
v_mov_b32 v160, 0
v_mov_b32 v161, 0
v_mov_b32 v162, 0
v_mov_b32 v163, 0
s_mul_i32 s53, s85, 6400
s_add_u32 s53, s53, 1310720
buffer_store_dwordx4 v[160:163], v1, s[4:7], s53 offen offset:0 sc1
buffer_store_dwordx4 v[160:163], v1, s[4:7], s53 offen offset:1024 sc1
s_nop 1
v_mov_b32 v162, 0x3f803f80
v_mov_b32 v163, 0x3f80
buffer_store_dwordx4 v[160:163], v1, s[4:7], s53 offen offset:2176 sc1
s_branch A_noinv
Lfb16:
s_nop 15
v_accvgpr_write_b32 a100, v168
v_accvgpr_write_b32 a101, v169
v_accvgpr_write_b32 a102, v170
v_accvgpr_write_b32 a103, v171
v_accvgpr_write_b32 a104, v172
v_accvgpr_write_b32 a105, v173
v_accvgpr_write_b32 a106, v174
v_accvgpr_write_b32 a107, v175
v_accvgpr_write_b32 a108, v176
v_accvgpr_write_b32 a109, v177
v_accvgpr_write_b32 a110, v178
v_accvgpr_write_b32 a111, v179
v_accvgpr_write_b32 a112, v180
v_accvgpr_write_b32 a113, v181
v_accvgpr_write_b32 a114, v182
v_accvgpr_write_b32 a115, v183
v_accvgpr_write_b32 a116, v184
v_accvgpr_write_b32 a117, v185
v_accvgpr_write_b32 a118, v186
v_accvgpr_write_b32 a119, v187
v_accvgpr_write_b32 a120, v188
v_accvgpr_write_b32 a121, v189
v_accvgpr_write_b32 a122, v190
v_accvgpr_write_b32 a123, v191
v_accvgpr_write_b32 a124, v192
v_accvgpr_write_b32 a125, v193
v_accvgpr_write_b32 a126, v194
v_accvgpr_write_b32 a127, v195
v_accvgpr_write_b32 a128, v196
v_accvgpr_write_b32 a129, v197
v_accvgpr_write_b32 a130, v198
v_accvgpr_write_b32 a131, v199
v_mov_b32 v246, 0
v_mov_b32 v208, 4284592614
ds_read_b128 v[168:171], v9 offset:0
ds_read_b128 v[172:175], v9 offset:2176
s_waitcnt lgkmcnt(1)
v_mfma_f32_32x32x16_bf16 v[176:191], v[168:171], v[240:243], v[136:151]
s_waitcnt lgkmcnt(0)
v_mfma_f32_32x32x16_bf16 v[176:191], v[172:175], v[244:247], v[176:191]
s_nop 11
v_max3_f32 v208, v176, v177, v208
v_max3_f32 v208, v178, v179, v208
v_max3_f32 v208, v180, v181, v208
v_max3_f32 v208, v182, v183, v208
v_max3_f32 v208, v184, v185, v208
v_max3_f32 v208, v186, v187, v208
v_max3_f32 v208, v188, v189, v208
v_max3_f32 v208, v190, v191, v208
ds_read_b128 v[168:171], v9 offset:3200
ds_read_b128 v[172:175], v9 offset:5376
s_waitcnt lgkmcnt(1)
v_mfma_f32_32x32x16_bf16 v[176:191], v[168:171], v[240:243], 0
s_waitcnt lgkmcnt(0)
v_mfma_f32_32x32x16_bf16 v[176:191], v[172:175], v[244:247], v[176:191]
s_nop 11
v_max3_f32 v208, v176, v177, v208
v_max3_f32 v208, v178, v179, v208
v_max3_f32 v208, v180, v181, v208
v_max3_f32 v208, v182, v183, v208
v_max3_f32 v208, v184, v185, v208
v_max3_f32 v208, v186, v187, v208
v_max3_f32 v208, v188, v189, v208
v_max3_f32 v208, v190, v191, v208
ds_read_b128 v[168:171], v9 offset:6400
ds_read_b128 v[172:175], v9 offset:8576
s_waitcnt lgkmcnt(1)
v_mfma_f32_32x32x16_bf16 v[176:191], v[168:171], v[240:243], 0
s_waitcnt lgkmcnt(0)
v_mfma_f32_32x32x16_bf16 v[176:191], v[172:175], v[244:247], v[176:191]
s_nop 11
v_max3_f32 v208, v176, v177, v208
v_max3_f32 v208, v178, v179, v208
v_max3_f32 v208, v180, v181, v208
v_max3_f32 v208, v182, v183, v208
v_max3_f32 v208, v184, v185, v208
v_max3_f32 v208, v186, v187, v208
v_max3_f32 v208, v188, v189, v208
v_max3_f32 v208, v190, v191, v208
ds_read_b128 v[168:171], v9 offset:9600
ds_read_b128 v[172:175], v9 offset:11776
s_waitcnt lgkmcnt(1)
v_mfma_f32_32x32x16_bf16 v[176:191], v[168:171], v[240:243], 0
s_waitcnt lgkmcnt(0)
v_mfma_f32_32x32x16_bf16 v[176:191], v[172:175], v[244:247], v[176:191]
s_nop 11
v_max3_f32 v208, v176, v177, v208
v_max3_f32 v208, v178, v179, v208
v_max3_f32 v208, v180, v181, v208
v_max3_f32 v208, v182, v183, v208
v_max3_f32 v208, v184, v185, v208
v_max3_f32 v208, v186, v187, v208
v_max3_f32 v208, v188, v189, v208
v_max3_f32 v208, v190, v191, v208
ds_read_b128 v[168:171], v9 offset:12800
ds_read_b128 v[172:175], v9 offset:14976
s_waitcnt lgkmcnt(1)
v_mfma_f32_32x32x16_bf16 v[176:191], v[168:171], v[240:243], 0
s_waitcnt lgkmcnt(0)
v_mfma_f32_32x32x16_bf16 v[176:191], v[172:175], v[244:247], v[176:191]
s_nop 11
v_max3_f32 v208, v176, v177, v208
v_max3_f32 v208, v178, v179, v208
v_max3_f32 v208, v180, v181, v208
v_max3_f32 v208, v182, v183, v208
v_max3_f32 v208, v184, v185, v208
v_max3_f32 v208, v186, v187, v208
v_max3_f32 v208, v188, v189, v208
v_max3_f32 v208, v190, v191, v208
ds_read_b128 v[168:171], v9 offset:16000
ds_read_b128 v[172:175], v9 offset:18176
s_waitcnt lgkmcnt(1)
v_mfma_f32_32x32x16_bf16 v[176:191], v[168:171], v[240:243], 0
s_waitcnt lgkmcnt(0)
v_mfma_f32_32x32x16_bf16 v[176:191], v[172:175], v[244:247], v[176:191]
s_nop 11
v_max3_f32 v208, v176, v177, v208
v_max3_f32 v208, v178, v179, v208
v_max3_f32 v208, v180, v181, v208
v_max3_f32 v208, v182, v183, v208
v_max3_f32 v208, v184, v185, v208
v_max3_f32 v208, v186, v187, v208
v_max3_f32 v208, v188, v189, v208
v_max3_f32 v208, v190, v191, v208
ds_read_b128 v[168:171], v9 offset:19200
ds_read_b128 v[172:175], v9 offset:21376
s_waitcnt lgkmcnt(1)
v_mfma_f32_32x32x16_bf16 v[176:191], v[168:171], v[240:243], 0
s_waitcnt lgkmcnt(0)
v_mfma_f32_32x32x16_bf16 v[176:191], v[172:175], v[244:247], v[176:191]
s_nop 11
v_max3_f32 v208, v176, v177, v208
v_max3_f32 v208, v178, v179, v208
v_max3_f32 v208, v180, v181, v208
v_max3_f32 v208, v182, v183, v208
v_max3_f32 v208, v184, v185, v208
v_max3_f32 v208, v186, v187, v208
v_max3_f32 v208, v188, v189, v208
v_max3_f32 v208, v190, v191, v208
ds_read_b128 v[168:171], v9 offset:22400
ds_read_b128 v[172:175], v9 offset:24576
s_waitcnt lgkmcnt(1)
v_mfma_f32_32x32x16_bf16 v[176:191], v[168:171], v[240:243], 0
s_waitcnt lgkmcnt(0)
v_mfma_f32_32x32x16_bf16 v[176:191], v[172:175], v[244:247], v[176:191]
s_nop 11
v_max3_f32 v208, v176, v177, v208
v_max3_f32 v208, v178, v179, v208
v_max3_f32 v208, v180, v181, v208
v_max3_f32 v208, v182, v183, v208
v_max3_f32 v208, v184, v185, v208
v_max3_f32 v208, v186, v187, v208
v_max3_f32 v208, v188, v189, v208
v_max3_f32 v208, v190, v191, v208
ds_read_b128 v[168:171], v9 offset:25600
ds_read_b128 v[172:175], v9 offset:27776
s_waitcnt lgkmcnt(1)
v_mfma_f32_32x32x16_bf16 v[176:191], v[168:171], v[240:243], v[152:167]
s_waitcnt lgkmcnt(0)
v_mfma_f32_32x32x16_bf16 v[176:191], v[172:175], v[244:247], v[176:191]
s_nop 11
v_max3_f32 v208, v176, v177, v208
v_max3_f32 v208, v178, v179, v208
v_max3_f32 v208, v180, v181, v208
v_max3_f32 v208, v182, v183, v208
v_max3_f32 v208, v184, v185, v208
v_max3_f32 v208, v186, v187, v208
v_max3_f32 v208, v188, v189, v208
v_max3_f32 v208, v190, v191, v208
v_mov_b32 v210, v208
s_nop 1
v_permlane32_swap_b32 v210, v208
v_max_f32 v210, v210, v208
v_cvt_pk_bf16_f32 v211, -v210, -v210
v_and_b32 v211, 0xffff0000, v211
v_fma_f32 v211, -1.0, v210, -v211
v_cvt_pk_bf16_f32 v211, -v210, v211
v_cndmask_b32 v246, v211, 0, s[44:45]
ds_read_b128 v[168:171], v9 offset:0
ds_read_b128 v[172:175], v9 offset:2176
s_waitcnt lgkmcnt(1)
v_mfma_f32_32x32x16_bf16 v[176:191], v[168:171], v[240:243], v[136:151]
s_waitcnt lgkmcnt(0)
v_mfma_f32_32x32x16_bf16 v[176:191], v[172:175], v[244:247], v[176:191]
ds_read_b64_tr_b16 v[168:169], v10 offset:0
ds_read_b64_tr_b16 v[170:171], v10 offset:128
ds_read_b64_tr_b16 v[172:173], v10 offset:256
ds_read_b64_tr_b16 v[174:175], v10 offset:384
s_nop 7
v_exp_f32 v176, v176
v_exp_f32 v177, v177
v_exp_f32 v178, v178
v_exp_f32 v179, v179
v_cvt_pk_bf16_f32 v192, v176, v177
v_cvt_pk_bf16_f32 v193, v178, v179
v_exp_f32 v180, v180
v_exp_f32 v181, v181
v_exp_f32 v182, v182
v_exp_f32 v183, v183
v_cvt_pk_bf16_f32 v194, v180, v181
v_cvt_pk_bf16_f32 v195, v182, v183
v_exp_f32 v184, v184
v_exp_f32 v185, v185
v_exp_f32 v186, v186
v_exp_f32 v187, v187
v_cvt_pk_bf16_f32 v196, v184, v185
v_cvt_pk_bf16_f32 v197, v186, v187
v_exp_f32 v188, v188
v_exp_f32 v189, v189
v_exp_f32 v190, v190
v_exp_f32 v191, v191
v_cvt_pk_bf16_f32 v198, v188, v189
v_cvt_pk_bf16_f32 v199, v190, v191
s_waitcnt lgkmcnt(2)
v_mfma_f32_32x32x16_bf16 v[96:111], v[168:171], v[192:195], 0
s_waitcnt lgkmcnt(0)
v_mfma_f32_32x32x16_bf16 v[96:111], v[172:175], v[196:199], v[96:111]
ds_read_b128 v[168:171], v9 offset:3200
ds_read_b128 v[172:175], v9 offset:5376
s_waitcnt lgkmcnt(1)
v_mfma_f32_32x32x16_bf16 v[176:191], v[168:171], v[240:243], 0
s_waitcnt lgkmcnt(0)
v_mfma_f32_32x32x16_bf16 v[176:191], v[172:175], v[244:247], v[176:191]
ds_read_b64_tr_b16 v[168:169], v10 offset:3200
ds_read_b64_tr_b16 v[170:171], v10 offset:3328
ds_read_b64_tr_b16 v[172:173], v10 offset:3456
ds_read_b64_tr_b16 v[174:175], v10 offset:3584
s_nop 7
v_exp_f32 v176, v176
v_exp_f32 v177, v177
v_exp_f32 v178, v178
v_exp_f32 v179, v179
v_cvt_pk_bf16_f32 v192, v176, v177
v_cvt_pk_bf16_f32 v193, v178, v179
v_exp_f32 v180, v180
v_exp_f32 v181, v181
v_exp_f32 v182, v182
v_exp_f32 v183, v183
v_cvt_pk_bf16_f32 v194, v180, v181
v_cvt_pk_bf16_f32 v195, v182, v183
v_exp_f32 v184, v184
v_exp_f32 v185, v185
v_exp_f32 v186, v186
v_exp_f32 v187, v187
v_cvt_pk_bf16_f32 v196, v184, v185
v_cvt_pk_bf16_f32 v197, v186, v187
v_exp_f32 v188, v188
v_exp_f32 v189, v189
v_exp_f32 v190, v190
v_exp_f32 v191, v191
v_cvt_pk_bf16_f32 v198, v188, v189
v_cvt_pk_bf16_f32 v199, v190, v191
s_waitcnt lgkmcnt(2)
v_mfma_f32_32x32x16_bf16 v[96:111], v[168:171], v[192:195], v[96:111]
s_waitcnt lgkmcnt(0)
v_mfma_f32_32x32x16_bf16 v[96:111], v[172:175], v[196:199], v[96:111]
ds_read_b128 v[168:171], v9 offset:6400
ds_read_b128 v[172:175], v9 offset:8576
s_waitcnt lgkmcnt(1)
v_mfma_f32_32x32x16_bf16 v[176:191], v[168:171], v[240:243], 0
s_waitcnt lgkmcnt(0)
v_mfma_f32_32x32x16_bf16 v[176:191], v[172:175], v[244:247], v[176:191]
ds_read_b64_tr_b16 v[168:169], v10 offset:6400
ds_read_b64_tr_b16 v[170:171], v10 offset:6528
ds_read_b64_tr_b16 v[172:173], v10 offset:6656
ds_read_b64_tr_b16 v[174:175], v10 offset:6784
s_nop 7
v_exp_f32 v176, v176
v_exp_f32 v177, v177
v_exp_f32 v178, v178
v_exp_f32 v179, v179
v_cvt_pk_bf16_f32 v192, v176, v177
v_cvt_pk_bf16_f32 v193, v178, v179
v_exp_f32 v180, v180
v_exp_f32 v181, v181
v_exp_f32 v182, v182
v_exp_f32 v183, v183
v_cvt_pk_bf16_f32 v194, v180, v181
v_cvt_pk_bf16_f32 v195, v182, v183
v_exp_f32 v184, v184
v_exp_f32 v185, v185
v_exp_f32 v186, v186
v_exp_f32 v187, v187
v_cvt_pk_bf16_f32 v196, v184, v185
v_cvt_pk_bf16_f32 v197, v186, v187
v_exp_f32 v188, v188
v_exp_f32 v189, v189
v_exp_f32 v190, v190
v_exp_f32 v191, v191
v_cvt_pk_bf16_f32 v198, v188, v189
v_cvt_pk_bf16_f32 v199, v190, v191
s_waitcnt lgkmcnt(2)
v_mfma_f32_32x32x16_bf16 v[96:111], v[168:171], v[192:195], v[96:111]
s_waitcnt lgkmcnt(0)
v_mfma_f32_32x32x16_bf16 v[96:111], v[172:175], v[196:199], v[96:111]
ds_read_b128 v[168:171], v9 offset:9600
ds_read_b128 v[172:175], v9 offset:11776
s_waitcnt lgkmcnt(1)
v_mfma_f32_32x32x16_bf16 v[176:191], v[168:171], v[240:243], 0
s_waitcnt lgkmcnt(0)
v_mfma_f32_32x32x16_bf16 v[176:191], v[172:175], v[244:247], v[176:191]
ds_read_b64_tr_b16 v[168:169], v10 offset:9600
ds_read_b64_tr_b16 v[170:171], v10 offset:9728
ds_read_b64_tr_b16 v[172:173], v10 offset:9856
ds_read_b64_tr_b16 v[174:175], v10 offset:9984
s_nop 7
v_exp_f32 v176, v176
v_exp_f32 v177, v177
v_exp_f32 v178, v178
v_exp_f32 v179, v179
v_cvt_pk_bf16_f32 v192, v176, v177
v_cvt_pk_bf16_f32 v193, v178, v179
v_exp_f32 v180, v180
v_exp_f32 v181, v181
v_exp_f32 v182, v182
v_exp_f32 v183, v183
v_cvt_pk_bf16_f32 v194, v180, v181
v_cvt_pk_bf16_f32 v195, v182, v183
v_exp_f32 v184, v184
v_exp_f32 v185, v185
v_exp_f32 v186, v186
v_exp_f32 v187, v187
v_cvt_pk_bf16_f32 v196, v184, v185
v_cvt_pk_bf16_f32 v197, v186, v187
v_exp_f32 v188, v188
v_exp_f32 v189, v189
v_exp_f32 v190, v190
v_exp_f32 v191, v191
v_cvt_pk_bf16_f32 v198, v188, v189
v_cvt_pk_bf16_f32 v199, v190, v191
s_waitcnt lgkmcnt(2)
v_mfma_f32_32x32x16_bf16 v[96:111], v[168:171], v[192:195], v[96:111]
s_waitcnt lgkmcnt(0)
v_mfma_f32_32x32x16_bf16 v[96:111], v[172:175], v[196:199], v[96:111]
ds_read_b128 v[168:171], v9 offset:12800
ds_read_b128 v[172:175], v9 offset:14976
s_waitcnt lgkmcnt(1)
v_mfma_f32_32x32x16_bf16 v[176:191], v[168:171], v[240:243], 0
s_waitcnt lgkmcnt(0)
v_mfma_f32_32x32x16_bf16 v[176:191], v[172:175], v[244:247], v[176:191]
ds_read_b64_tr_b16 v[168:169], v10 offset:12800
ds_read_b64_tr_b16 v[170:171], v10 offset:12928
ds_read_b64_tr_b16 v[172:173], v10 offset:13056
ds_read_b64_tr_b16 v[174:175], v10 offset:13184
s_nop 7
v_exp_f32 v176, v176
v_exp_f32 v177, v177
v_exp_f32 v178, v178
v_exp_f32 v179, v179
v_cvt_pk_bf16_f32 v192, v176, v177
v_cvt_pk_bf16_f32 v193, v178, v179
v_exp_f32 v180, v180
v_exp_f32 v181, v181
v_exp_f32 v182, v182
v_exp_f32 v183, v183
v_cvt_pk_bf16_f32 v194, v180, v181
v_cvt_pk_bf16_f32 v195, v182, v183
v_exp_f32 v184, v184
v_exp_f32 v185, v185
v_exp_f32 v186, v186
v_exp_f32 v187, v187
v_cvt_pk_bf16_f32 v196, v184, v185
v_cvt_pk_bf16_f32 v197, v186, v187
v_exp_f32 v188, v188
v_exp_f32 v189, v189
v_exp_f32 v190, v190
v_exp_f32 v191, v191
v_cvt_pk_bf16_f32 v198, v188, v189
v_cvt_pk_bf16_f32 v199, v190, v191
s_waitcnt lgkmcnt(2)
v_mfma_f32_32x32x16_bf16 v[96:111], v[168:171], v[192:195], v[96:111]
s_waitcnt lgkmcnt(0)
v_mfma_f32_32x32x16_bf16 v[96:111], v[172:175], v[196:199], v[96:111]
ds_read_b128 v[168:171], v9 offset:16000
ds_read_b128 v[172:175], v9 offset:18176
s_waitcnt lgkmcnt(1)
v_mfma_f32_32x32x16_bf16 v[176:191], v[168:171], v[240:243], 0
s_waitcnt lgkmcnt(0)
v_mfma_f32_32x32x16_bf16 v[176:191], v[172:175], v[244:247], v[176:191]
ds_read_b64_tr_b16 v[168:169], v10 offset:16000
ds_read_b64_tr_b16 v[170:171], v10 offset:16128
ds_read_b64_tr_b16 v[172:173], v10 offset:16256
ds_read_b64_tr_b16 v[174:175], v10 offset:16384
s_nop 7
v_exp_f32 v176, v176
v_exp_f32 v177, v177
v_exp_f32 v178, v178
v_exp_f32 v179, v179
v_cvt_pk_bf16_f32 v192, v176, v177
v_cvt_pk_bf16_f32 v193, v178, v179
v_exp_f32 v180, v180
v_exp_f32 v181, v181
v_exp_f32 v182, v182
v_exp_f32 v183, v183
v_cvt_pk_bf16_f32 v194, v180, v181
v_cvt_pk_bf16_f32 v195, v182, v183
v_exp_f32 v184, v184
v_exp_f32 v185, v185
v_exp_f32 v186, v186
v_exp_f32 v187, v187
v_cvt_pk_bf16_f32 v196, v184, v185
v_cvt_pk_bf16_f32 v197, v186, v187
v_exp_f32 v188, v188
v_exp_f32 v189, v189
v_exp_f32 v190, v190
v_exp_f32 v191, v191
v_cvt_pk_bf16_f32 v198, v188, v189
v_cvt_pk_bf16_f32 v199, v190, v191
s_waitcnt lgkmcnt(2)
v_mfma_f32_32x32x16_bf16 v[96:111], v[168:171], v[192:195], v[96:111]
s_waitcnt lgkmcnt(0)
v_mfma_f32_32x32x16_bf16 v[96:111], v[172:175], v[196:199], v[96:111]
ds_read_b128 v[168:171], v9 offset:19200
ds_read_b128 v[172:175], v9 offset:21376
s_waitcnt lgkmcnt(1)
v_mfma_f32_32x32x16_bf16 v[176:191], v[168:171], v[240:243], 0
s_waitcnt lgkmcnt(0)
v_mfma_f32_32x32x16_bf16 v[176:191], v[172:175], v[244:247], v[176:191]
ds_read_b64_tr_b16 v[168:169], v10 offset:19200
ds_read_b64_tr_b16 v[170:171], v10 offset:19328
ds_read_b64_tr_b16 v[172:173], v10 offset:19456
ds_read_b64_tr_b16 v[174:175], v10 offset:19584
s_nop 7
v_exp_f32 v176, v176
v_exp_f32 v177, v177
v_exp_f32 v178, v178
v_exp_f32 v179, v179
v_cvt_pk_bf16_f32 v192, v176, v177
v_cvt_pk_bf16_f32 v193, v178, v179
v_exp_f32 v180, v180
v_exp_f32 v181, v181
v_exp_f32 v182, v182
v_exp_f32 v183, v183
v_cvt_pk_bf16_f32 v194, v180, v181
v_cvt_pk_bf16_f32 v195, v182, v183
v_exp_f32 v184, v184
v_exp_f32 v185, v185
v_exp_f32 v186, v186
v_exp_f32 v187, v187
v_cvt_pk_bf16_f32 v196, v184, v185
v_cvt_pk_bf16_f32 v197, v186, v187
v_exp_f32 v188, v188
v_exp_f32 v189, v189
v_exp_f32 v190, v190
v_exp_f32 v191, v191
v_cvt_pk_bf16_f32 v198, v188, v189
v_cvt_pk_bf16_f32 v199, v190, v191
s_waitcnt lgkmcnt(2)
v_mfma_f32_32x32x16_bf16 v[96:111], v[168:171], v[192:195], v[96:111]
s_waitcnt lgkmcnt(0)
v_mfma_f32_32x32x16_bf16 v[96:111], v[172:175], v[196:199], v[96:111]
ds_read_b128 v[168:171], v9 offset:22400
ds_read_b128 v[172:175], v9 offset:24576
s_waitcnt lgkmcnt(1)
v_mfma_f32_32x32x16_bf16 v[176:191], v[168:171], v[240:243], 0
s_waitcnt lgkmcnt(0)
v_mfma_f32_32x32x16_bf16 v[176:191], v[172:175], v[244:247], v[176:191]
ds_read_b64_tr_b16 v[168:169], v10 offset:22400
ds_read_b64_tr_b16 v[170:171], v10 offset:22528
ds_read_b64_tr_b16 v[172:173], v10 offset:22656
ds_read_b64_tr_b16 v[174:175], v10 offset:22784
s_nop 7
v_exp_f32 v176, v176
v_exp_f32 v177, v177
v_exp_f32 v178, v178
v_exp_f32 v179, v179
v_cvt_pk_bf16_f32 v192, v176, v177
v_cvt_pk_bf16_f32 v193, v178, v179
v_exp_f32 v180, v180
v_exp_f32 v181, v181
v_exp_f32 v182, v182
v_exp_f32 v183, v183
v_cvt_pk_bf16_f32 v194, v180, v181
v_cvt_pk_bf16_f32 v195, v182, v183
v_exp_f32 v184, v184
v_exp_f32 v185, v185
v_exp_f32 v186, v186
v_exp_f32 v187, v187
v_cvt_pk_bf16_f32 v196, v184, v185
v_cvt_pk_bf16_f32 v197, v186, v187
v_exp_f32 v188, v188
v_exp_f32 v189, v189
v_exp_f32 v190, v190
v_exp_f32 v191, v191
v_cvt_pk_bf16_f32 v198, v188, v189
v_cvt_pk_bf16_f32 v199, v190, v191
s_waitcnt lgkmcnt(2)
v_mfma_f32_32x32x16_bf16 v[96:111], v[168:171], v[192:195], v[96:111]
s_waitcnt lgkmcnt(0)
v_mfma_f32_32x32x16_bf16 v[96:111], v[172:175], v[196:199], v[96:111]
ds_read_b128 v[168:171], v9 offset:25600
ds_read_b128 v[172:175], v9 offset:27776
s_waitcnt lgkmcnt(1)
v_mfma_f32_32x32x16_bf16 v[176:191], v[168:171], v[240:243], v[152:167]
s_waitcnt lgkmcnt(0)
v_mfma_f32_32x32x16_bf16 v[176:191], v[172:175], v[244:247], v[176:191]
ds_read_b64_tr_b16 v[168:169], v10 offset:25600
ds_read_b64_tr_b16 v[170:171], v10 offset:25728
ds_read_b64_tr_b16 v[172:173], v10 offset:25856
ds_read_b64_tr_b16 v[174:175], v10 offset:25984
s_nop 7
v_exp_f32 v176, v176
v_exp_f32 v177, v177
v_exp_f32 v178, v178
v_exp_f32 v179, v179
v_cvt_pk_bf16_f32 v192, v176, v177
v_cvt_pk_bf16_f32 v193, v178, v179
v_exp_f32 v180, v180
v_exp_f32 v181, v181
v_exp_f32 v182, v182
v_exp_f32 v183, v183
v_cvt_pk_bf16_f32 v194, v180, v181
v_cvt_pk_bf16_f32 v195, v182, v183
v_exp_f32 v184, v184
v_exp_f32 v185, v185
v_exp_f32 v186, v186
v_exp_f32 v187, v187
v_cvt_pk_bf16_f32 v196, v184, v185
v_cvt_pk_bf16_f32 v197, v186, v187
v_exp_f32 v188, v188
v_exp_f32 v189, v189
v_exp_f32 v190, v190
v_exp_f32 v191, v191
v_cvt_pk_bf16_f32 v198, v188, v189
v_cvt_pk_bf16_f32 v199, v190, v191
s_waitcnt lgkmcnt(2)
v_mfma_f32_32x32x16_bf16 v[96:111], v[168:171], v[192:195], v[96:111]
s_waitcnt lgkmcnt(0)
v_mfma_f32_32x32x16_bf16 v[96:111], v[172:175], v[196:199], v[96:111]
s_nop 7
v_accvgpr_read_b32 v168, a100
v_accvgpr_read_b32 v169, a101
v_accvgpr_read_b32 v170, a102
v_accvgpr_read_b32 v171, a103
v_accvgpr_read_b32 v172, a104
v_accvgpr_read_b32 v173, a105
v_accvgpr_read_b32 v174, a106
v_accvgpr_read_b32 v175, a107
v_accvgpr_read_b32 v176, a108
v_accvgpr_read_b32 v177, a109
v_accvgpr_read_b32 v178, a110
v_accvgpr_read_b32 v179, a111
v_accvgpr_read_b32 v180, a112
v_accvgpr_read_b32 v181, a113
v_accvgpr_read_b32 v182, a114
v_accvgpr_read_b32 v183, a115
v_accvgpr_read_b32 v184, a116
v_accvgpr_read_b32 v185, a117
v_accvgpr_read_b32 v186, a118
v_accvgpr_read_b32 v187, a119
v_accvgpr_read_b32 v188, a120
v_accvgpr_read_b32 v189, a121
v_accvgpr_read_b32 v190, a122
v_accvgpr_read_b32 v191, a123
v_accvgpr_read_b32 v192, a124
v_accvgpr_read_b32 v193, a125
v_accvgpr_read_b32 v194, a126
v_accvgpr_read_b32 v195, a127
v_accvgpr_read_b32 v196, a128
v_accvgpr_read_b32 v197, a129
v_accvgpr_read_b32 v198, a130
v_accvgpr_read_b32 v199, a131
v_rcp_f32 v210, v108
s_nop 0
v_mul_f32 v96, v96, v210
v_mul_f32 v97, v97, v210
v_mul_f32 v98, v98, v210
v_mul_f32 v99, v99, v210
v_mul_f32 v100, v100, v210
v_mul_f32 v101, v101, v210
v_mul_f32 v102, v102, v210
v_mul_f32 v103, v103, v210
v_mul_f32 v104, v104, v210
v_mul_f32 v105, v105, v210
v_mul_f32 v106, v106, v210
v_mul_f32 v107, v107, v210
v_cvt_pk_bf16_f32 v216, v96, v97
v_cvt_pk_bf16_f32 v217, v98, v99
v_cvt_pk_bf16_f32 v218, v100, v101
v_cvt_pk_bf16_f32 v219, v102, v103
v_cvt_pk_bf16_f32 v220, v104, v105
v_cvt_pk_bf16_f32 v221, v106, v107
s_branch Lfr17
Lfb22:
s_nop 15
v_accvgpr_write_b32 a100, v168
v_accvgpr_write_b32 a101, v169
v_accvgpr_write_b32 a102, v170
v_accvgpr_write_b32 a103, v171
v_accvgpr_write_b32 a104, v172
v_accvgpr_write_b32 a105, v173
v_accvgpr_write_b32 a106, v174
v_accvgpr_write_b32 a107, v175
v_accvgpr_write_b32 a108, v176
v_accvgpr_write_b32 a109, v177
v_accvgpr_write_b32 a110, v178
v_accvgpr_write_b32 a111, v179
v_accvgpr_write_b32 a112, v180
v_accvgpr_write_b32 a113, v181
v_accvgpr_write_b32 a114, v182
v_accvgpr_write_b32 a115, v183
v_accvgpr_write_b32 a116, v184
v_accvgpr_write_b32 a117, v185
v_accvgpr_write_b32 a118, v186
v_accvgpr_write_b32 a119, v187
v_accvgpr_write_b32 a120, v188
v_accvgpr_write_b32 a121, v189
v_accvgpr_write_b32 a122, v190
v_accvgpr_write_b32 a123, v191
v_accvgpr_write_b32 a124, v192
v_accvgpr_write_b32 a125, v193
v_accvgpr_write_b32 a126, v194
v_accvgpr_write_b32 a127, v195
v_accvgpr_write_b32 a128, v196
v_accvgpr_write_b32 a129, v197
v_accvgpr_write_b32 a130, v198
v_accvgpr_write_b32 a131, v199
v_mov_b32 v254, 0
v_mov_b32 v208, 4284592614
ds_read_b128 v[168:171], v239 offset:0
ds_read_b128 v[172:175], v239 offset:2176
s_waitcnt lgkmcnt(1)
v_mfma_f32_32x32x16_bf16 v[176:191], v[168:171], v[248:251], v[136:151]
s_waitcnt lgkmcnt(0)
v_mfma_f32_32x32x16_bf16 v[176:191], v[172:175], v[252:255], v[176:191]
s_nop 11
v_max3_f32 v208, v176, v177, v208
v_max3_f32 v208, v178, v179, v208
v_max3_f32 v208, v180, v181, v208
v_max3_f32 v208, v182, v183, v208
v_max3_f32 v208, v184, v185, v208
v_max3_f32 v208, v186, v187, v208
v_max3_f32 v208, v188, v189, v208
v_max3_f32 v208, v190, v191, v208
ds_read_b128 v[168:171], v239 offset:3200
ds_read_b128 v[172:175], v239 offset:5376
s_waitcnt lgkmcnt(1)
v_mfma_f32_32x32x16_bf16 v[176:191], v[168:171], v[248:251], 0
s_waitcnt lgkmcnt(0)
v_mfma_f32_32x32x16_bf16 v[176:191], v[172:175], v[252:255], v[176:191]
s_nop 11
v_max3_f32 v208, v176, v177, v208
v_max3_f32 v208, v178, v179, v208
v_max3_f32 v208, v180, v181, v208
v_max3_f32 v208, v182, v183, v208
v_max3_f32 v208, v184, v185, v208
v_max3_f32 v208, v186, v187, v208
v_max3_f32 v208, v188, v189, v208
v_max3_f32 v208, v190, v191, v208
ds_read_b128 v[168:171], v239 offset:6400
ds_read_b128 v[172:175], v239 offset:8576
s_waitcnt lgkmcnt(1)
v_mfma_f32_32x32x16_bf16 v[176:191], v[168:171], v[248:251], 0
s_waitcnt lgkmcnt(0)
v_mfma_f32_32x32x16_bf16 v[176:191], v[172:175], v[252:255], v[176:191]
s_nop 11
v_max3_f32 v208, v176, v177, v208
v_max3_f32 v208, v178, v179, v208
v_max3_f32 v208, v180, v181, v208
v_max3_f32 v208, v182, v183, v208
v_max3_f32 v208, v184, v185, v208
v_max3_f32 v208, v186, v187, v208
v_max3_f32 v208, v188, v189, v208
v_max3_f32 v208, v190, v191, v208
ds_read_b128 v[168:171], v239 offset:9600
ds_read_b128 v[172:175], v239 offset:11776
s_waitcnt lgkmcnt(1)
v_mfma_f32_32x32x16_bf16 v[176:191], v[168:171], v[248:251], 0
s_waitcnt lgkmcnt(0)
v_mfma_f32_32x32x16_bf16 v[176:191], v[172:175], v[252:255], v[176:191]
s_nop 11
v_max3_f32 v208, v176, v177, v208
v_max3_f32 v208, v178, v179, v208
v_max3_f32 v208, v180, v181, v208
v_max3_f32 v208, v182, v183, v208
v_max3_f32 v208, v184, v185, v208
v_max3_f32 v208, v186, v187, v208
v_max3_f32 v208, v188, v189, v208
v_max3_f32 v208, v190, v191, v208
ds_read_b128 v[168:171], v239 offset:12800
ds_read_b128 v[172:175], v239 offset:14976
s_waitcnt lgkmcnt(1)
v_mfma_f32_32x32x16_bf16 v[176:191], v[168:171], v[248:251], 0
s_waitcnt lgkmcnt(0)
v_mfma_f32_32x32x16_bf16 v[176:191], v[172:175], v[252:255], v[176:191]
s_nop 11
v_max3_f32 v208, v176, v177, v208
v_max3_f32 v208, v178, v179, v208
v_max3_f32 v208, v180, v181, v208
v_max3_f32 v208, v182, v183, v208
v_max3_f32 v208, v184, v185, v208
v_max3_f32 v208, v186, v187, v208
v_max3_f32 v208, v188, v189, v208
v_max3_f32 v208, v190, v191, v208
ds_read_b128 v[168:171], v239 offset:16000
ds_read_b128 v[172:175], v239 offset:18176
s_waitcnt lgkmcnt(1)
v_mfma_f32_32x32x16_bf16 v[176:191], v[168:171], v[248:251], 0
s_waitcnt lgkmcnt(0)
v_mfma_f32_32x32x16_bf16 v[176:191], v[172:175], v[252:255], v[176:191]
s_nop 11
v_max3_f32 v208, v176, v177, v208
v_max3_f32 v208, v178, v179, v208
v_max3_f32 v208, v180, v181, v208
v_max3_f32 v208, v182, v183, v208
v_max3_f32 v208, v184, v185, v208
v_max3_f32 v208, v186, v187, v208
v_max3_f32 v208, v188, v189, v208
v_max3_f32 v208, v190, v191, v208
ds_read_b128 v[168:171], v239 offset:19200
ds_read_b128 v[172:175], v239 offset:21376
s_waitcnt lgkmcnt(1)
v_mfma_f32_32x32x16_bf16 v[176:191], v[168:171], v[248:251], 0
s_waitcnt lgkmcnt(0)
v_mfma_f32_32x32x16_bf16 v[176:191], v[172:175], v[252:255], v[176:191]
s_nop 11
v_max3_f32 v208, v176, v177, v208
v_max3_f32 v208, v178, v179, v208
v_max3_f32 v208, v180, v181, v208
v_max3_f32 v208, v182, v183, v208
v_max3_f32 v208, v184, v185, v208
v_max3_f32 v208, v186, v187, v208
v_max3_f32 v208, v188, v189, v208
v_max3_f32 v208, v190, v191, v208
ds_read_b128 v[168:171], v239 offset:22400
ds_read_b128 v[172:175], v239 offset:24576
s_waitcnt lgkmcnt(1)
v_mfma_f32_32x32x16_bf16 v[176:191], v[168:171], v[248:251], 0
s_waitcnt lgkmcnt(0)
v_mfma_f32_32x32x16_bf16 v[176:191], v[172:175], v[252:255], v[176:191]
s_nop 11
v_max3_f32 v208, v176, v177, v208
v_max3_f32 v208, v178, v179, v208
v_max3_f32 v208, v180, v181, v208
v_max3_f32 v208, v182, v183, v208
v_max3_f32 v208, v184, v185, v208
v_max3_f32 v208, v186, v187, v208
v_max3_f32 v208, v188, v189, v208
v_max3_f32 v208, v190, v191, v208
ds_read_b128 v[168:171], v239 offset:25600
ds_read_b128 v[172:175], v239 offset:27776
s_waitcnt lgkmcnt(1)
v_mfma_f32_32x32x16_bf16 v[176:191], v[168:171], v[248:251], v[152:167]
s_waitcnt lgkmcnt(0)
v_mfma_f32_32x32x16_bf16 v[176:191], v[172:175], v[252:255], v[176:191]
s_nop 11
v_max3_f32 v208, v176, v177, v208
v_max3_f32 v208, v178, v179, v208
v_max3_f32 v208, v180, v181, v208
v_max3_f32 v208, v182, v183, v208
v_max3_f32 v208, v184, v185, v208
v_max3_f32 v208, v186, v187, v208
v_max3_f32 v208, v188, v189, v208
v_max3_f32 v208, v190, v191, v208
v_mov_b32 v210, v208
s_nop 1
v_permlane32_swap_b32 v210, v208
v_max_f32 v210, v210, v208
v_cvt_pk_bf16_f32 v211, -v210, -v210
v_and_b32 v211, 0xffff0000, v211
v_fma_f32 v211, -1.0, v210, -v211
v_cvt_pk_bf16_f32 v211, -v210, v211
v_cndmask_b32 v254, v211, 0, s[44:45]
ds_read_b128 v[168:171], v239 offset:0
ds_read_b128 v[172:175], v239 offset:2176
s_waitcnt lgkmcnt(1)
v_mfma_f32_32x32x16_bf16 v[176:191], v[168:171], v[248:251], v[136:151]
s_waitcnt lgkmcnt(0)
v_mfma_f32_32x32x16_bf16 v[176:191], v[172:175], v[252:255], v[176:191]
ds_read_b64_tr_b16 v[168:169], v38 offset:0
ds_read_b64_tr_b16 v[170:171], v38 offset:128
ds_read_b64_tr_b16 v[172:173], v38 offset:256
ds_read_b64_tr_b16 v[174:175], v38 offset:384
s_nop 7
v_exp_f32 v176, v176
v_exp_f32 v177, v177
v_exp_f32 v178, v178
v_exp_f32 v179, v179
v_cvt_pk_bf16_f32 v192, v176, v177
v_cvt_pk_bf16_f32 v193, v178, v179
v_exp_f32 v180, v180
v_exp_f32 v181, v181
v_exp_f32 v182, v182
v_exp_f32 v183, v183
v_cvt_pk_bf16_f32 v194, v180, v181
v_cvt_pk_bf16_f32 v195, v182, v183
v_exp_f32 v184, v184
v_exp_f32 v185, v185
v_exp_f32 v186, v186
v_exp_f32 v187, v187
v_cvt_pk_bf16_f32 v196, v184, v185
v_cvt_pk_bf16_f32 v197, v186, v187
v_exp_f32 v188, v188
v_exp_f32 v189, v189
v_exp_f32 v190, v190
v_exp_f32 v191, v191
v_cvt_pk_bf16_f32 v198, v188, v189
v_cvt_pk_bf16_f32 v199, v190, v191
s_waitcnt lgkmcnt(2)
v_mfma_f32_32x32x16_bf16 v[112:127], v[168:171], v[192:195], 0
s_waitcnt lgkmcnt(0)
v_mfma_f32_32x32x16_bf16 v[112:127], v[172:175], v[196:199], v[112:127]
ds_read_b128 v[168:171], v239 offset:3200
ds_read_b128 v[172:175], v239 offset:5376
s_waitcnt lgkmcnt(1)
v_mfma_f32_32x32x16_bf16 v[176:191], v[168:171], v[248:251], 0
s_waitcnt lgkmcnt(0)
v_mfma_f32_32x32x16_bf16 v[176:191], v[172:175], v[252:255], v[176:191]
ds_read_b64_tr_b16 v[168:169], v38 offset:3200
ds_read_b64_tr_b16 v[170:171], v38 offset:3328
ds_read_b64_tr_b16 v[172:173], v38 offset:3456
ds_read_b64_tr_b16 v[174:175], v38 offset:3584
s_nop 7
v_exp_f32 v176, v176
v_exp_f32 v177, v177
v_exp_f32 v178, v178
v_exp_f32 v179, v179
v_cvt_pk_bf16_f32 v192, v176, v177
v_cvt_pk_bf16_f32 v193, v178, v179
v_exp_f32 v180, v180
v_exp_f32 v181, v181
v_exp_f32 v182, v182
v_exp_f32 v183, v183
v_cvt_pk_bf16_f32 v194, v180, v181
v_cvt_pk_bf16_f32 v195, v182, v183
v_exp_f32 v184, v184
v_exp_f32 v185, v185
v_exp_f32 v186, v186
v_exp_f32 v187, v187
v_cvt_pk_bf16_f32 v196, v184, v185
v_cvt_pk_bf16_f32 v197, v186, v187
v_exp_f32 v188, v188
v_exp_f32 v189, v189
v_exp_f32 v190, v190
v_exp_f32 v191, v191
v_cvt_pk_bf16_f32 v198, v188, v189
v_cvt_pk_bf16_f32 v199, v190, v191
s_waitcnt lgkmcnt(2)
v_mfma_f32_32x32x16_bf16 v[112:127], v[168:171], v[192:195], v[112:127]
s_waitcnt lgkmcnt(0)
v_mfma_f32_32x32x16_bf16 v[112:127], v[172:175], v[196:199], v[112:127]
ds_read_b128 v[168:171], v239 offset:6400
ds_read_b128 v[172:175], v239 offset:8576
s_waitcnt lgkmcnt(1)
v_mfma_f32_32x32x16_bf16 v[176:191], v[168:171], v[248:251], 0
s_waitcnt lgkmcnt(0)
v_mfma_f32_32x32x16_bf16 v[176:191], v[172:175], v[252:255], v[176:191]
ds_read_b64_tr_b16 v[168:169], v38 offset:6400
ds_read_b64_tr_b16 v[170:171], v38 offset:6528
ds_read_b64_tr_b16 v[172:173], v38 offset:6656
ds_read_b64_tr_b16 v[174:175], v38 offset:6784
s_nop 7
v_exp_f32 v176, v176
v_exp_f32 v177, v177
v_exp_f32 v178, v178
v_exp_f32 v179, v179
v_cvt_pk_bf16_f32 v192, v176, v177
v_cvt_pk_bf16_f32 v193, v178, v179
v_exp_f32 v180, v180
v_exp_f32 v181, v181
v_exp_f32 v182, v182
v_exp_f32 v183, v183
v_cvt_pk_bf16_f32 v194, v180, v181
v_cvt_pk_bf16_f32 v195, v182, v183
v_exp_f32 v184, v184
v_exp_f32 v185, v185
v_exp_f32 v186, v186
v_exp_f32 v187, v187
v_cvt_pk_bf16_f32 v196, v184, v185
v_cvt_pk_bf16_f32 v197, v186, v187
v_exp_f32 v188, v188
v_exp_f32 v189, v189
v_exp_f32 v190, v190
v_exp_f32 v191, v191
v_cvt_pk_bf16_f32 v198, v188, v189
v_cvt_pk_bf16_f32 v199, v190, v191
s_waitcnt lgkmcnt(2)
v_mfma_f32_32x32x16_bf16 v[112:127], v[168:171], v[192:195], v[112:127]
s_waitcnt lgkmcnt(0)
v_mfma_f32_32x32x16_bf16 v[112:127], v[172:175], v[196:199], v[112:127]
ds_read_b128 v[168:171], v239 offset:9600
ds_read_b128 v[172:175], v239 offset:11776
s_waitcnt lgkmcnt(1)
v_mfma_f32_32x32x16_bf16 v[176:191], v[168:171], v[248:251], 0
s_waitcnt lgkmcnt(0)
v_mfma_f32_32x32x16_bf16 v[176:191], v[172:175], v[252:255], v[176:191]
ds_read_b64_tr_b16 v[168:169], v38 offset:9600
ds_read_b64_tr_b16 v[170:171], v38 offset:9728
ds_read_b64_tr_b16 v[172:173], v38 offset:9856
ds_read_b64_tr_b16 v[174:175], v38 offset:9984
s_nop 7
v_exp_f32 v176, v176
v_exp_f32 v177, v177
v_exp_f32 v178, v178
v_exp_f32 v179, v179
v_cvt_pk_bf16_f32 v192, v176, v177
v_cvt_pk_bf16_f32 v193, v178, v179
v_exp_f32 v180, v180
v_exp_f32 v181, v181
v_exp_f32 v182, v182
v_exp_f32 v183, v183
v_cvt_pk_bf16_f32 v194, v180, v181
v_cvt_pk_bf16_f32 v195, v182, v183
v_exp_f32 v184, v184
v_exp_f32 v185, v185
v_exp_f32 v186, v186
v_exp_f32 v187, v187
v_cvt_pk_bf16_f32 v196, v184, v185
v_cvt_pk_bf16_f32 v197, v186, v187
v_exp_f32 v188, v188
v_exp_f32 v189, v189
v_exp_f32 v190, v190
v_exp_f32 v191, v191
v_cvt_pk_bf16_f32 v198, v188, v189
v_cvt_pk_bf16_f32 v199, v190, v191
s_waitcnt lgkmcnt(2)
v_mfma_f32_32x32x16_bf16 v[112:127], v[168:171], v[192:195], v[112:127]
s_waitcnt lgkmcnt(0)
v_mfma_f32_32x32x16_bf16 v[112:127], v[172:175], v[196:199], v[112:127]
ds_read_b128 v[168:171], v239 offset:12800
ds_read_b128 v[172:175], v239 offset:14976
s_waitcnt lgkmcnt(1)
v_mfma_f32_32x32x16_bf16 v[176:191], v[168:171], v[248:251], 0
s_waitcnt lgkmcnt(0)
v_mfma_f32_32x32x16_bf16 v[176:191], v[172:175], v[252:255], v[176:191]
ds_read_b64_tr_b16 v[168:169], v38 offset:12800
ds_read_b64_tr_b16 v[170:171], v38 offset:12928
ds_read_b64_tr_b16 v[172:173], v38 offset:13056
ds_read_b64_tr_b16 v[174:175], v38 offset:13184
s_nop 7
v_exp_f32 v176, v176
v_exp_f32 v177, v177
v_exp_f32 v178, v178
v_exp_f32 v179, v179
v_cvt_pk_bf16_f32 v192, v176, v177
v_cvt_pk_bf16_f32 v193, v178, v179
v_exp_f32 v180, v180
v_exp_f32 v181, v181
v_exp_f32 v182, v182
v_exp_f32 v183, v183
v_cvt_pk_bf16_f32 v194, v180, v181
v_cvt_pk_bf16_f32 v195, v182, v183
v_exp_f32 v184, v184
v_exp_f32 v185, v185
v_exp_f32 v186, v186
v_exp_f32 v187, v187
v_cvt_pk_bf16_f32 v196, v184, v185
v_cvt_pk_bf16_f32 v197, v186, v187
v_exp_f32 v188, v188
v_exp_f32 v189, v189
v_exp_f32 v190, v190
v_exp_f32 v191, v191
v_cvt_pk_bf16_f32 v198, v188, v189
v_cvt_pk_bf16_f32 v199, v190, v191
s_waitcnt lgkmcnt(2)
v_mfma_f32_32x32x16_bf16 v[112:127], v[168:171], v[192:195], v[112:127]
s_waitcnt lgkmcnt(0)
v_mfma_f32_32x32x16_bf16 v[112:127], v[172:175], v[196:199], v[112:127]
ds_read_b128 v[168:171], v239 offset:16000
ds_read_b128 v[172:175], v239 offset:18176
s_waitcnt lgkmcnt(1)
v_mfma_f32_32x32x16_bf16 v[176:191], v[168:171], v[248:251], 0
s_waitcnt lgkmcnt(0)
v_mfma_f32_32x32x16_bf16 v[176:191], v[172:175], v[252:255], v[176:191]
ds_read_b64_tr_b16 v[168:169], v38 offset:16000
ds_read_b64_tr_b16 v[170:171], v38 offset:16128
ds_read_b64_tr_b16 v[172:173], v38 offset:16256
ds_read_b64_tr_b16 v[174:175], v38 offset:16384
s_nop 7
v_exp_f32 v176, v176
v_exp_f32 v177, v177
v_exp_f32 v178, v178
v_exp_f32 v179, v179
v_cvt_pk_bf16_f32 v192, v176, v177
v_cvt_pk_bf16_f32 v193, v178, v179
v_exp_f32 v180, v180
v_exp_f32 v181, v181
v_exp_f32 v182, v182
v_exp_f32 v183, v183
v_cvt_pk_bf16_f32 v194, v180, v181
v_cvt_pk_bf16_f32 v195, v182, v183
v_exp_f32 v184, v184
v_exp_f32 v185, v185
v_exp_f32 v186, v186
v_exp_f32 v187, v187
v_cvt_pk_bf16_f32 v196, v184, v185
v_cvt_pk_bf16_f32 v197, v186, v187
v_exp_f32 v188, v188
v_exp_f32 v189, v189
v_exp_f32 v190, v190
v_exp_f32 v191, v191
v_cvt_pk_bf16_f32 v198, v188, v189
v_cvt_pk_bf16_f32 v199, v190, v191
s_waitcnt lgkmcnt(2)
v_mfma_f32_32x32x16_bf16 v[112:127], v[168:171], v[192:195], v[112:127]
s_waitcnt lgkmcnt(0)
v_mfma_f32_32x32x16_bf16 v[112:127], v[172:175], v[196:199], v[112:127]
ds_read_b128 v[168:171], v239 offset:19200
ds_read_b128 v[172:175], v239 offset:21376
s_waitcnt lgkmcnt(1)
v_mfma_f32_32x32x16_bf16 v[176:191], v[168:171], v[248:251], 0
s_waitcnt lgkmcnt(0)
v_mfma_f32_32x32x16_bf16 v[176:191], v[172:175], v[252:255], v[176:191]
ds_read_b64_tr_b16 v[168:169], v38 offset:19200
ds_read_b64_tr_b16 v[170:171], v38 offset:19328
ds_read_b64_tr_b16 v[172:173], v38 offset:19456
ds_read_b64_tr_b16 v[174:175], v38 offset:19584
s_nop 7
v_exp_f32 v176, v176
v_exp_f32 v177, v177
v_exp_f32 v178, v178
v_exp_f32 v179, v179
v_cvt_pk_bf16_f32 v192, v176, v177
v_cvt_pk_bf16_f32 v193, v178, v179
v_exp_f32 v180, v180
v_exp_f32 v181, v181
v_exp_f32 v182, v182
v_exp_f32 v183, v183
v_cvt_pk_bf16_f32 v194, v180, v181
v_cvt_pk_bf16_f32 v195, v182, v183
v_exp_f32 v184, v184
v_exp_f32 v185, v185
v_exp_f32 v186, v186
v_exp_f32 v187, v187
v_cvt_pk_bf16_f32 v196, v184, v185
v_cvt_pk_bf16_f32 v197, v186, v187
v_exp_f32 v188, v188
v_exp_f32 v189, v189
v_exp_f32 v190, v190
v_exp_f32 v191, v191
v_cvt_pk_bf16_f32 v198, v188, v189
v_cvt_pk_bf16_f32 v199, v190, v191
s_waitcnt lgkmcnt(2)
v_mfma_f32_32x32x16_bf16 v[112:127], v[168:171], v[192:195], v[112:127]
s_waitcnt lgkmcnt(0)
v_mfma_f32_32x32x16_bf16 v[112:127], v[172:175], v[196:199], v[112:127]
ds_read_b128 v[168:171], v239 offset:22400
ds_read_b128 v[172:175], v239 offset:24576
s_waitcnt lgkmcnt(1)
v_mfma_f32_32x32x16_bf16 v[176:191], v[168:171], v[248:251], 0
s_waitcnt lgkmcnt(0)
v_mfma_f32_32x32x16_bf16 v[176:191], v[172:175], v[252:255], v[176:191]
ds_read_b64_tr_b16 v[168:169], v38 offset:22400
ds_read_b64_tr_b16 v[170:171], v38 offset:22528
ds_read_b64_tr_b16 v[172:173], v38 offset:22656
ds_read_b64_tr_b16 v[174:175], v38 offset:22784
s_nop 7
v_exp_f32 v176, v176
v_exp_f32 v177, v177
v_exp_f32 v178, v178
v_exp_f32 v179, v179
v_cvt_pk_bf16_f32 v192, v176, v177
v_cvt_pk_bf16_f32 v193, v178, v179
v_exp_f32 v180, v180
v_exp_f32 v181, v181
v_exp_f32 v182, v182
v_exp_f32 v183, v183
v_cvt_pk_bf16_f32 v194, v180, v181
v_cvt_pk_bf16_f32 v195, v182, v183
v_exp_f32 v184, v184
v_exp_f32 v185, v185
v_exp_f32 v186, v186
v_exp_f32 v187, v187
v_cvt_pk_bf16_f32 v196, v184, v185
v_cvt_pk_bf16_f32 v197, v186, v187
v_exp_f32 v188, v188
v_exp_f32 v189, v189
v_exp_f32 v190, v190
v_exp_f32 v191, v191
v_cvt_pk_bf16_f32 v198, v188, v189
v_cvt_pk_bf16_f32 v199, v190, v191
s_waitcnt lgkmcnt(2)
v_mfma_f32_32x32x16_bf16 v[112:127], v[168:171], v[192:195], v[112:127]
s_waitcnt lgkmcnt(0)
v_mfma_f32_32x32x16_bf16 v[112:127], v[172:175], v[196:199], v[112:127]
ds_read_b128 v[168:171], v239 offset:25600
ds_read_b128 v[172:175], v239 offset:27776
s_waitcnt lgkmcnt(1)
v_mfma_f32_32x32x16_bf16 v[176:191], v[168:171], v[248:251], v[152:167]
s_waitcnt lgkmcnt(0)
v_mfma_f32_32x32x16_bf16 v[176:191], v[172:175], v[252:255], v[176:191]
ds_read_b64_tr_b16 v[168:169], v38 offset:25600
ds_read_b64_tr_b16 v[170:171], v38 offset:25728
ds_read_b64_tr_b16 v[172:173], v38 offset:25856
ds_read_b64_tr_b16 v[174:175], v38 offset:25984
s_nop 7
v_exp_f32 v176, v176
v_exp_f32 v177, v177
v_exp_f32 v178, v178
v_exp_f32 v179, v179
v_cvt_pk_bf16_f32 v192, v176, v177
v_cvt_pk_bf16_f32 v193, v178, v179
v_exp_f32 v180, v180
v_exp_f32 v181, v181
v_exp_f32 v182, v182
v_exp_f32 v183, v183
v_cvt_pk_bf16_f32 v194, v180, v181
v_cvt_pk_bf16_f32 v195, v182, v183
v_exp_f32 v184, v184
v_exp_f32 v185, v185
v_exp_f32 v186, v186
v_exp_f32 v187, v187
v_cvt_pk_bf16_f32 v196, v184, v185
v_cvt_pk_bf16_f32 v197, v186, v187
v_exp_f32 v188, v188
v_exp_f32 v189, v189
v_exp_f32 v190, v190
v_exp_f32 v191, v191
v_cvt_pk_bf16_f32 v198, v188, v189
v_cvt_pk_bf16_f32 v199, v190, v191
s_waitcnt lgkmcnt(2)
v_mfma_f32_32x32x16_bf16 v[112:127], v[168:171], v[192:195], v[112:127]
s_waitcnt lgkmcnt(0)
v_mfma_f32_32x32x16_bf16 v[112:127], v[172:175], v[196:199], v[112:127]
s_nop 7
v_accvgpr_read_b32 v168, a100
v_accvgpr_read_b32 v169, a101
v_accvgpr_read_b32 v170, a102
v_accvgpr_read_b32 v171, a103
v_accvgpr_read_b32 v172, a104
v_accvgpr_read_b32 v173, a105
v_accvgpr_read_b32 v174, a106
v_accvgpr_read_b32 v175, a107
v_accvgpr_read_b32 v176, a108
v_accvgpr_read_b32 v177, a109
v_accvgpr_read_b32 v178, a110
v_accvgpr_read_b32 v179, a111
v_accvgpr_read_b32 v180, a112
v_accvgpr_read_b32 v181, a113
v_accvgpr_read_b32 v182, a114
v_accvgpr_read_b32 v183, a115
v_accvgpr_read_b32 v184, a116
v_accvgpr_read_b32 v185, a117
v_accvgpr_read_b32 v186, a118
v_accvgpr_read_b32 v187, a119
v_accvgpr_read_b32 v188, a120
v_accvgpr_read_b32 v189, a121
v_accvgpr_read_b32 v190, a122
v_accvgpr_read_b32 v191, a123
v_accvgpr_read_b32 v192, a124
v_accvgpr_read_b32 v193, a125
v_accvgpr_read_b32 v194, a126
v_accvgpr_read_b32 v195, a127
v_accvgpr_read_b32 v196, a128
v_accvgpr_read_b32 v197, a129
v_accvgpr_read_b32 v198, a130
v_accvgpr_read_b32 v199, a131
v_rcp_f32 v210, v124
s_nop 0
v_pk_mul_f32 v[112:113], v[112:113], v[210:211] op_sel_hi:[1,0]
v_pk_mul_f32 v[114:115], v[114:115], v[210:211] op_sel_hi:[1,0]
v_pk_mul_f32 v[116:117], v[116:117], v[210:211] op_sel_hi:[1,0]
v_pk_mul_f32 v[118:119], v[118:119], v[210:211] op_sel_hi:[1,0]
v_pk_mul_f32 v[120:121], v[120:121], v[210:211] op_sel_hi:[1,0]
v_pk_mul_f32 v[122:123], v[122:123], v[210:211] op_sel_hi:[1,0]
v_cvt_pk_bf16_f32 v224, v112, v113
v_cvt_pk_bf16_f32 v225, v114, v115
v_cvt_pk_bf16_f32 v226, v116, v117
v_cvt_pk_bf16_f32 v227, v118, v119
v_cvt_pk_bf16_f32 v222, v120, v121
v_cvt_pk_bf16_f32 v223, v122, v123
s_branch Lfr23
Lw26:
s_mov_b64 exec, 1
s_waitcnt vmcnt(0) lgkmcnt(0)
s_barrier
buffer_store_dword v15, v12, s[4:7], s49 offen sc1
s_mov_b64 exec, 0xffff
s_mov_b32 s57, 0
Lp28:
buffer_load_dword v15, v7, s[4:7], s23 offen offset:0 sc1
s_add_u32 s57, s57, 1
s_waitcnt vmcnt(0)
v_cmp_gt_u32 s[58:59], 1, v15
s_nop 0
s_cmp_eq_u64 s[58:59], 0
s_cbranch_scc1 Ld29
s_cmp_lt_u32 s57, 1048576
s_cbranch_scc1 Lp28
Ld29:
s_branch Lr27_d
Ls31:
s_waitcnt lgkmcnt(0)
s_nop 15
v_pk_add_f32 v[16:17], v[16:17], v[148:149]
v_pk_add_f32 v[18:19], v[18:19], v[150:151]
v_pk_add_f32 v[20:21], v[20:21], v[152:153]
v_pk_add_f32 v[22:23], v[22:23], v[154:155]
v_pk_add_f32 v[24:25], v[24:25], v[156:157]
v_pk_add_f32 v[26:27], v[26:27], v[158:159]
v_pk_add_f32 v[28:29], v[28:29], v[160:161]
v_pk_add_f32 v[30:31], v[30:31], v[162:163]
v_pk_add_f32 v[32:33], v[32:33], v[164:165]
v_pk_add_f32 v[34:35], v[34:35], v[166:167]
v_pk_add_f32 v[16:17], v[16:17], v[200:201]
v_pk_add_f32 v[18:19], v[18:19], v[202:203]
v_pk_add_f32 v[20:21], v[20:21], v[204:205]
v_pk_add_f32 v[22:23], v[22:23], v[206:207]
v_pk_add_f32 v[24:25], v[24:25], v[208:209]
v_pk_add_f32 v[26:27], v[26:27], v[210:211]
v_pk_add_f32 v[28:29], v[28:29], v[212:213]
v_pk_add_f32 v[30:31], v[30:31], v[214:215]
v_pk_add_f32 v[32:33], v[32:33], v[216:217]
v_pk_add_f32 v[34:35], v[34:35], v[218:219]
v_cvt_pk_bf16_f32 v40, v16, v17
v_cvt_pk_bf16_f32 v41, v18, v19
v_cvt_pk_bf16_f32 v42, v20, v21
v_cvt_pk_bf16_f32 v43, v22, v23
v_cvt_pk_bf16_f32 v44, v24, v25
v_cvt_pk_bf16_f32 v45, v26, v27
v_cvt_pk_bf16_f32 v46, v28, v29
v_cvt_pk_bf16_f32 v47, v30, v31
v_cvt_pk_bf16_f32 v48, v32, v33
v_cvt_pk_bf16_f32 v49, v34, v35
v_cvt_pk_bf16_f32 v50, v32, v33
v_cvt_pk_bf16_f32 v51, v34, v35
buffer_store_dwordx4 v[40:43], v4, s[12:15], s34 offen sc1
buffer_store_dwordx4 v[44:47], v4, s[12:15], s34 offen offset:2048 sc1
v_permlane16_swap_b32 v48, v50
v_permlane16_swap_b32 v49, v51
v_pk_add_f32 v[52:53], v[16:17], v[18:19]
v_pk_mul_f32 v[54:55], v[16:17], v[16:17]
v_pk_fma_f32 v[54:55], v[18:19], v[18:19], v[54:55]
v_pk_add_f32 v[52:53], v[52:53], v[20:21]
v_pk_fma_f32 v[54:55], v[20:21], v[20:21], v[54:55]
v_pk_add_f32 v[52:53], v[52:53], v[22:23]
v_pk_fma_f32 v[54:55], v[22:23], v[22:23], v[54:55]
v_pk_add_f32 v[52:53], v[52:53], v[24:25]
v_pk_fma_f32 v[54:55], v[24:25], v[24:25], v[54:55]
v_pk_add_f32 v[52:53], v[52:53], v[26:27]
v_pk_fma_f32 v[54:55], v[26:27], v[26:27], v[54:55]
v_pk_add_f32 v[52:53], v[52:53], v[28:29]
v_pk_fma_f32 v[54:55], v[28:29], v[28:29], v[54:55]
v_pk_add_f32 v[52:53], v[52:53], v[30:31]
v_pk_fma_f32 v[54:55], v[30:31], v[30:31], v[54:55]
v_pk_add_f32 v[52:53], v[52:53], v[32:33]
v_pk_fma_f32 v[54:55], v[32:33], v[32:33], v[54:55]
v_pk_add_f32 v[52:53], v[52:53], v[34:35]
v_pk_fma_f32 v[54:55], v[34:35], v[34:35], v[54:55]
v_add_f32 v52, v52, v53
v_add_f32 v54, v54, v55
s_mov_b64 exec, s[64:65]
buffer_store_dwordx4 v[48:51], v5, s[12:15], s34 offen sc1
s_mov_b64 exec, -1
v_permlane32_swap_b32 v52, v54
v_add_f32 v53, v52, v54
v_add_f32 v52, v52, v54
s_nop 1
v_permlane16_swap_b32 v52, v53
v_add_f32 v52, v52, v53
s_mov_b64 exec, s[64:65]
buffer_store_dword v52, v7, s[4:7], s35 offen sc1
s_mov_b64 exec, -1
s_branch Lt32
Lw35:
s_mov_b64 exec, 1
s_waitcnt vmcnt(0) lgkmcnt(0)
s_barrier
buffer_store_dword v15, v12, s[4:7], s49 offen sc1
s_mov_b64 exec, 0xffff
s_mov_b32 s57, 0
Lp37:
buffer_load_dword v15, v7, s[4:7], s23 offen offset:0 sc1
s_add_u32 s57, s57, 1
s_waitcnt vmcnt(0)
v_cmp_gt_u32 s[58:59], 2, v15
s_nop 0
s_cmp_eq_u64 s[58:59], 0
s_cbranch_scc1 Ld38
s_cmp_lt_u32 s57, 1048576
s_cbranch_scc1 Lp37
Ld38:
s_branch Lr36_d
Lw42:
s_mov_b64 exec, 1
s_waitcnt vmcnt(0) lgkmcnt(0)
s_barrier
buffer_store_dword v15, v12, s[4:7], s49 offen sc1
s_mov_b64 exec, 0xffff
s_mov_b32 s57, 0
Lp44:
buffer_load_dword v15, v7, s[4:7], s23 offen offset:0 sc1
s_add_u32 s57, s57, 1
s_waitcnt vmcnt(0)
v_cmp_gt_u32 s[58:59], 3, v15
s_nop 0
s_cmp_eq_u64 s[58:59], 0
s_cbranch_scc1 Ld45
s_cmp_lt_u32 s57, 1048576
s_cbranch_scc1 Lp44
Ld45:
s_branch Lr43_d
Ls47:
s_waitcnt lgkmcnt(0)
s_nop 15
v_pk_add_f32 v[16:17], v[16:17], v[148:149]
v_pk_add_f32 v[18:19], v[18:19], v[150:151]
v_pk_add_f32 v[20:21], v[20:21], v[152:153]
v_pk_add_f32 v[22:23], v[22:23], v[154:155]
v_pk_add_f32 v[24:25], v[24:25], v[156:157]
v_pk_add_f32 v[26:27], v[26:27], v[158:159]
v_pk_add_f32 v[28:29], v[28:29], v[160:161]
v_pk_add_f32 v[30:31], v[30:31], v[162:163]
v_pk_add_f32 v[32:33], v[32:33], v[164:165]
v_pk_add_f32 v[34:35], v[34:35], v[166:167]
v_cvt_pk_bf16_f32 v40, v16, v17
v_cvt_pk_bf16_f32 v41, v18, v19
v_cvt_pk_bf16_f32 v42, v20, v21
v_cvt_pk_bf16_f32 v43, v22, v23
v_cvt_pk_bf16_f32 v44, v24, v25
v_cvt_pk_bf16_f32 v45, v26, v27
v_cvt_pk_bf16_f32 v46, v28, v29
v_cvt_pk_bf16_f32 v47, v30, v31
v_cvt_pk_bf16_f32 v48, v32, v33
v_cvt_pk_bf16_f32 v49, v34, v35
v_cvt_pk_bf16_f32 v50, v32, v33
v_cvt_pk_bf16_f32 v51, v34, v35
buffer_store_dwordx4 v[40:43], v4, s[12:15], s34 offen sc1
buffer_store_dwordx4 v[44:47], v4, s[12:15], s34 offen offset:2048 sc1
v_permlane16_swap_b32 v48, v50
v_permlane16_swap_b32 v49, v51
v_pk_add_f32 v[52:53], v[16:17], v[18:19]
v_pk_mul_f32 v[54:55], v[16:17], v[16:17]
v_pk_fma_f32 v[54:55], v[18:19], v[18:19], v[54:55]
v_pk_add_f32 v[52:53], v[52:53], v[20:21]
v_pk_fma_f32 v[54:55], v[20:21], v[20:21], v[54:55]
v_pk_add_f32 v[52:53], v[52:53], v[22:23]
v_pk_fma_f32 v[54:55], v[22:23], v[22:23], v[54:55]
v_pk_add_f32 v[52:53], v[52:53], v[24:25]
v_pk_fma_f32 v[54:55], v[24:25], v[24:25], v[54:55]
v_pk_add_f32 v[52:53], v[52:53], v[26:27]
v_pk_fma_f32 v[54:55], v[26:27], v[26:27], v[54:55]
v_pk_add_f32 v[52:53], v[52:53], v[28:29]
v_pk_fma_f32 v[54:55], v[28:29], v[28:29], v[54:55]
v_pk_add_f32 v[52:53], v[52:53], v[30:31]
v_pk_fma_f32 v[54:55], v[30:31], v[30:31], v[54:55]
v_pk_add_f32 v[52:53], v[52:53], v[32:33]
v_pk_fma_f32 v[54:55], v[32:33], v[32:33], v[54:55]
v_pk_add_f32 v[52:53], v[52:53], v[34:35]
v_pk_fma_f32 v[54:55], v[34:35], v[34:35], v[54:55]
v_add_f32 v52, v52, v53
v_add_f32 v54, v54, v55
s_mov_b64 exec, s[64:65]
buffer_store_dwordx4 v[48:51], v5, s[12:15], s34 offen sc1
s_mov_b64 exec, -1
v_permlane32_swap_b32 v52, v54
v_add_f32 v53, v52, v54
v_add_f32 v52, v52, v54
s_nop 1
v_permlane16_swap_b32 v52, v53
v_add_f32 v52, v52, v53
s_mov_b64 exec, s[64:65]
buffer_store_dword v52, v7, s[4:7], s35 offen sc1
s_mov_b64 exec, -1
s_branch Lt48
Lw51:
s_mov_b64 exec, 1
s_waitcnt vmcnt(0) lgkmcnt(0)
s_barrier
buffer_store_dword v15, v12, s[4:7], s49 offen sc1
s_mov_b64 exec, 0xffff
s_mov_b32 s57, 0
Lp53:
buffer_load_dword v15, v7, s[4:7], s23 offen offset:0 sc1
s_add_u32 s57, s57, 1
s_waitcnt vmcnt(0)
v_cmp_gt_u32 s[58:59], 4, v15
s_nop 0
s_cmp_eq_u64 s[58:59], 0
s_cbranch_scc1 Ld54
s_cmp_lt_u32 s57, 1048576
s_cbranch_scc1 Lp53
Ld54:
s_branch Lr52_d
Lfb64:
s_nop 15
v_accvgpr_write_b32 a100, v168
v_accvgpr_write_b32 a101, v169
v_accvgpr_write_b32 a102, v170
v_accvgpr_write_b32 a103, v171
v_accvgpr_write_b32 a104, v172
v_accvgpr_write_b32 a105, v173
v_accvgpr_write_b32 a106, v174
v_accvgpr_write_b32 a107, v175
v_accvgpr_write_b32 a108, v176
v_accvgpr_write_b32 a109, v177
v_accvgpr_write_b32 a110, v178
v_accvgpr_write_b32 a111, v179
v_accvgpr_write_b32 a112, v180
v_accvgpr_write_b32 a113, v181
v_accvgpr_write_b32 a114, v182
v_accvgpr_write_b32 a115, v183
v_accvgpr_write_b32 a116, v184
v_accvgpr_write_b32 a117, v185
v_accvgpr_write_b32 a118, v186
v_accvgpr_write_b32 a119, v187
v_accvgpr_write_b32 a120, v188
v_accvgpr_write_b32 a121, v189
v_accvgpr_write_b32 a122, v190
v_accvgpr_write_b32 a123, v191
v_accvgpr_write_b32 a124, v192
v_accvgpr_write_b32 a125, v193
v_accvgpr_write_b32 a126, v194
v_accvgpr_write_b32 a127, v195
v_accvgpr_write_b32 a128, v196
v_accvgpr_write_b32 a129, v197
v_accvgpr_write_b32 a130, v198
v_accvgpr_write_b32 a131, v199
v_mov_b32 v246, 0
v_mov_b32 v208, 4284592614
ds_read_b128 v[168:171], v9 offset:0
ds_read_b128 v[172:175], v9 offset:2176
s_waitcnt lgkmcnt(1)
v_mfma_f32_32x32x16_bf16 v[176:191], v[168:171], v[240:243], v[136:151]
s_waitcnt lgkmcnt(0)
v_mfma_f32_32x32x16_bf16 v[176:191], v[172:175], v[244:247], v[176:191]
s_nop 11
v_max3_f32 v208, v176, v177, v208
v_max3_f32 v208, v178, v179, v208
v_max3_f32 v208, v180, v181, v208
v_max3_f32 v208, v182, v183, v208
v_max3_f32 v208, v184, v185, v208
v_max3_f32 v208, v186, v187, v208
v_max3_f32 v208, v188, v189, v208
v_max3_f32 v208, v190, v191, v208
ds_read_b128 v[168:171], v9 offset:3200
ds_read_b128 v[172:175], v9 offset:5376
s_waitcnt lgkmcnt(1)
v_mfma_f32_32x32x16_bf16 v[176:191], v[168:171], v[240:243], 0
s_waitcnt lgkmcnt(0)
v_mfma_f32_32x32x16_bf16 v[176:191], v[172:175], v[244:247], v[176:191]
s_nop 11
v_max3_f32 v208, v176, v177, v208
v_max3_f32 v208, v178, v179, v208
v_max3_f32 v208, v180, v181, v208
v_max3_f32 v208, v182, v183, v208
v_max3_f32 v208, v184, v185, v208
v_max3_f32 v208, v186, v187, v208
v_max3_f32 v208, v188, v189, v208
v_max3_f32 v208, v190, v191, v208
ds_read_b128 v[168:171], v9 offset:6400
ds_read_b128 v[172:175], v9 offset:8576
s_waitcnt lgkmcnt(1)
v_mfma_f32_32x32x16_bf16 v[176:191], v[168:171], v[240:243], 0
s_waitcnt lgkmcnt(0)
v_mfma_f32_32x32x16_bf16 v[176:191], v[172:175], v[244:247], v[176:191]
s_nop 11
v_max3_f32 v208, v176, v177, v208
v_max3_f32 v208, v178, v179, v208
v_max3_f32 v208, v180, v181, v208
v_max3_f32 v208, v182, v183, v208
v_max3_f32 v208, v184, v185, v208
v_max3_f32 v208, v186, v187, v208
v_max3_f32 v208, v188, v189, v208
v_max3_f32 v208, v190, v191, v208
ds_read_b128 v[168:171], v9 offset:9600
ds_read_b128 v[172:175], v9 offset:11776
s_waitcnt lgkmcnt(1)
v_mfma_f32_32x32x16_bf16 v[176:191], v[168:171], v[240:243], 0
s_waitcnt lgkmcnt(0)
v_mfma_f32_32x32x16_bf16 v[176:191], v[172:175], v[244:247], v[176:191]
s_nop 11
v_max3_f32 v208, v176, v177, v208
v_max3_f32 v208, v178, v179, v208
v_max3_f32 v208, v180, v181, v208
v_max3_f32 v208, v182, v183, v208
v_max3_f32 v208, v184, v185, v208
v_max3_f32 v208, v186, v187, v208
v_max3_f32 v208, v188, v189, v208
v_max3_f32 v208, v190, v191, v208
ds_read_b128 v[168:171], v9 offset:12800
ds_read_b128 v[172:175], v9 offset:14976
s_waitcnt lgkmcnt(1)
v_mfma_f32_32x32x16_bf16 v[176:191], v[168:171], v[240:243], 0
s_waitcnt lgkmcnt(0)
v_mfma_f32_32x32x16_bf16 v[176:191], v[172:175], v[244:247], v[176:191]
s_nop 11
v_max3_f32 v208, v176, v177, v208
v_max3_f32 v208, v178, v179, v208
v_max3_f32 v208, v180, v181, v208
v_max3_f32 v208, v182, v183, v208
v_max3_f32 v208, v184, v185, v208
v_max3_f32 v208, v186, v187, v208
v_max3_f32 v208, v188, v189, v208
v_max3_f32 v208, v190, v191, v208
ds_read_b128 v[168:171], v9 offset:16000
ds_read_b128 v[172:175], v9 offset:18176
s_waitcnt lgkmcnt(1)
v_mfma_f32_32x32x16_bf16 v[176:191], v[168:171], v[240:243], 0
s_waitcnt lgkmcnt(0)
v_mfma_f32_32x32x16_bf16 v[176:191], v[172:175], v[244:247], v[176:191]
s_nop 11
v_max3_f32 v208, v176, v177, v208
v_max3_f32 v208, v178, v179, v208
v_max3_f32 v208, v180, v181, v208
v_max3_f32 v208, v182, v183, v208
v_max3_f32 v208, v184, v185, v208
v_max3_f32 v208, v186, v187, v208
v_max3_f32 v208, v188, v189, v208
v_max3_f32 v208, v190, v191, v208
ds_read_b128 v[168:171], v9 offset:19200
ds_read_b128 v[172:175], v9 offset:21376
s_waitcnt lgkmcnt(1)
v_mfma_f32_32x32x16_bf16 v[176:191], v[168:171], v[240:243], 0
s_waitcnt lgkmcnt(0)
v_mfma_f32_32x32x16_bf16 v[176:191], v[172:175], v[244:247], v[176:191]
s_nop 11
v_max3_f32 v208, v176, v177, v208
v_max3_f32 v208, v178, v179, v208
v_max3_f32 v208, v180, v181, v208
v_max3_f32 v208, v182, v183, v208
v_max3_f32 v208, v184, v185, v208
v_max3_f32 v208, v186, v187, v208
v_max3_f32 v208, v188, v189, v208
v_max3_f32 v208, v190, v191, v208
ds_read_b128 v[168:171], v9 offset:22400
ds_read_b128 v[172:175], v9 offset:24576
s_waitcnt lgkmcnt(1)
v_mfma_f32_32x32x16_bf16 v[176:191], v[168:171], v[240:243], 0
s_waitcnt lgkmcnt(0)
v_mfma_f32_32x32x16_bf16 v[176:191], v[172:175], v[244:247], v[176:191]
s_nop 11
v_max3_f32 v208, v176, v177, v208
v_max3_f32 v208, v178, v179, v208
v_max3_f32 v208, v180, v181, v208
v_max3_f32 v208, v182, v183, v208
v_max3_f32 v208, v184, v185, v208
v_max3_f32 v208, v186, v187, v208
v_max3_f32 v208, v188, v189, v208
v_max3_f32 v208, v190, v191, v208
ds_read_b128 v[168:171], v9 offset:25600
ds_read_b128 v[172:175], v9 offset:27776
s_waitcnt lgkmcnt(1)
v_mfma_f32_32x32x16_bf16 v[176:191], v[168:171], v[240:243], v[152:167]
s_waitcnt lgkmcnt(0)
v_mfma_f32_32x32x16_bf16 v[176:191], v[172:175], v[244:247], v[176:191]
s_nop 11
v_max3_f32 v208, v176, v177, v208
v_max3_f32 v208, v178, v179, v208
v_max3_f32 v208, v180, v181, v208
v_max3_f32 v208, v182, v183, v208
v_max3_f32 v208, v184, v185, v208
v_max3_f32 v208, v186, v187, v208
v_max3_f32 v208, v188, v189, v208
v_max3_f32 v208, v190, v191, v208
v_mov_b32 v210, v208
s_nop 1
v_permlane32_swap_b32 v210, v208
v_max_f32 v210, v210, v208
v_cvt_pk_bf16_f32 v211, -v210, -v210
v_and_b32 v211, 0xffff0000, v211
v_fma_f32 v211, -1.0, v210, -v211
v_cvt_pk_bf16_f32 v211, -v210, v211
v_cndmask_b32 v246, v211, 0, s[44:45]
ds_read_b128 v[168:171], v9 offset:0
ds_read_b128 v[172:175], v9 offset:2176
s_waitcnt lgkmcnt(1)
v_mfma_f32_32x32x16_bf16 v[176:191], v[168:171], v[240:243], v[136:151]
s_waitcnt lgkmcnt(0)
v_mfma_f32_32x32x16_bf16 v[176:191], v[172:175], v[244:247], v[176:191]
ds_read_b64_tr_b16 v[168:169], v10 offset:0
ds_read_b64_tr_b16 v[170:171], v10 offset:128
ds_read_b64_tr_b16 v[172:173], v10 offset:256
ds_read_b64_tr_b16 v[174:175], v10 offset:384
s_nop 7
v_exp_f32 v176, v176
v_exp_f32 v177, v177
v_exp_f32 v178, v178
v_exp_f32 v179, v179
v_cvt_pk_bf16_f32 v192, v176, v177
v_cvt_pk_bf16_f32 v193, v178, v179
v_exp_f32 v180, v180
v_exp_f32 v181, v181
v_exp_f32 v182, v182
v_exp_f32 v183, v183
v_cvt_pk_bf16_f32 v194, v180, v181
v_cvt_pk_bf16_f32 v195, v182, v183
v_exp_f32 v184, v184
v_exp_f32 v185, v185
v_exp_f32 v186, v186
v_exp_f32 v187, v187
v_cvt_pk_bf16_f32 v196, v184, v185
v_cvt_pk_bf16_f32 v197, v186, v187
v_exp_f32 v188, v188
v_exp_f32 v189, v189
v_exp_f32 v190, v190
v_exp_f32 v191, v191
v_cvt_pk_bf16_f32 v198, v188, v189
v_cvt_pk_bf16_f32 v199, v190, v191
s_waitcnt lgkmcnt(2)
v_mfma_f32_32x32x16_bf16 v[96:111], v[168:171], v[192:195], 0
s_waitcnt lgkmcnt(0)
v_mfma_f32_32x32x16_bf16 v[96:111], v[172:175], v[196:199], v[96:111]
ds_read_b128 v[168:171], v9 offset:3200
ds_read_b128 v[172:175], v9 offset:5376
s_waitcnt lgkmcnt(1)
v_mfma_f32_32x32x16_bf16 v[176:191], v[168:171], v[240:243], 0
s_waitcnt lgkmcnt(0)
v_mfma_f32_32x32x16_bf16 v[176:191], v[172:175], v[244:247], v[176:191]
ds_read_b64_tr_b16 v[168:169], v10 offset:3200
ds_read_b64_tr_b16 v[170:171], v10 offset:3328
ds_read_b64_tr_b16 v[172:173], v10 offset:3456
ds_read_b64_tr_b16 v[174:175], v10 offset:3584
s_nop 7
v_exp_f32 v176, v176
v_exp_f32 v177, v177
v_exp_f32 v178, v178
v_exp_f32 v179, v179
v_cvt_pk_bf16_f32 v192, v176, v177
v_cvt_pk_bf16_f32 v193, v178, v179
v_exp_f32 v180, v180
v_exp_f32 v181, v181
v_exp_f32 v182, v182
v_exp_f32 v183, v183
v_cvt_pk_bf16_f32 v194, v180, v181
v_cvt_pk_bf16_f32 v195, v182, v183
v_exp_f32 v184, v184
v_exp_f32 v185, v185
v_exp_f32 v186, v186
v_exp_f32 v187, v187
v_cvt_pk_bf16_f32 v196, v184, v185
v_cvt_pk_bf16_f32 v197, v186, v187
v_exp_f32 v188, v188
v_exp_f32 v189, v189
v_exp_f32 v190, v190
v_exp_f32 v191, v191
v_cvt_pk_bf16_f32 v198, v188, v189
v_cvt_pk_bf16_f32 v199, v190, v191
s_waitcnt lgkmcnt(2)
v_mfma_f32_32x32x16_bf16 v[96:111], v[168:171], v[192:195], v[96:111]
s_waitcnt lgkmcnt(0)
v_mfma_f32_32x32x16_bf16 v[96:111], v[172:175], v[196:199], v[96:111]
ds_read_b128 v[168:171], v9 offset:6400
ds_read_b128 v[172:175], v9 offset:8576
s_waitcnt lgkmcnt(1)
v_mfma_f32_32x32x16_bf16 v[176:191], v[168:171], v[240:243], 0
s_waitcnt lgkmcnt(0)
v_mfma_f32_32x32x16_bf16 v[176:191], v[172:175], v[244:247], v[176:191]
ds_read_b64_tr_b16 v[168:169], v10 offset:6400
ds_read_b64_tr_b16 v[170:171], v10 offset:6528
ds_read_b64_tr_b16 v[172:173], v10 offset:6656
ds_read_b64_tr_b16 v[174:175], v10 offset:6784
s_nop 7
v_exp_f32 v176, v176
v_exp_f32 v177, v177
v_exp_f32 v178, v178
v_exp_f32 v179, v179
v_cvt_pk_bf16_f32 v192, v176, v177
v_cvt_pk_bf16_f32 v193, v178, v179
v_exp_f32 v180, v180
v_exp_f32 v181, v181
v_exp_f32 v182, v182
v_exp_f32 v183, v183
v_cvt_pk_bf16_f32 v194, v180, v181
v_cvt_pk_bf16_f32 v195, v182, v183
v_exp_f32 v184, v184
v_exp_f32 v185, v185
v_exp_f32 v186, v186
v_exp_f32 v187, v187
v_cvt_pk_bf16_f32 v196, v184, v185
v_cvt_pk_bf16_f32 v197, v186, v187
v_exp_f32 v188, v188
v_exp_f32 v189, v189
v_exp_f32 v190, v190
v_exp_f32 v191, v191
v_cvt_pk_bf16_f32 v198, v188, v189
v_cvt_pk_bf16_f32 v199, v190, v191
s_waitcnt lgkmcnt(2)
v_mfma_f32_32x32x16_bf16 v[96:111], v[168:171], v[192:195], v[96:111]
s_waitcnt lgkmcnt(0)
v_mfma_f32_32x32x16_bf16 v[96:111], v[172:175], v[196:199], v[96:111]
ds_read_b128 v[168:171], v9 offset:9600
ds_read_b128 v[172:175], v9 offset:11776
s_waitcnt lgkmcnt(1)
v_mfma_f32_32x32x16_bf16 v[176:191], v[168:171], v[240:243], 0
s_waitcnt lgkmcnt(0)
v_mfma_f32_32x32x16_bf16 v[176:191], v[172:175], v[244:247], v[176:191]
ds_read_b64_tr_b16 v[168:169], v10 offset:9600
ds_read_b64_tr_b16 v[170:171], v10 offset:9728
ds_read_b64_tr_b16 v[172:173], v10 offset:9856
ds_read_b64_tr_b16 v[174:175], v10 offset:9984
s_nop 7
v_exp_f32 v176, v176
v_exp_f32 v177, v177
v_exp_f32 v178, v178
v_exp_f32 v179, v179
v_cvt_pk_bf16_f32 v192, v176, v177
v_cvt_pk_bf16_f32 v193, v178, v179
v_exp_f32 v180, v180
v_exp_f32 v181, v181
v_exp_f32 v182, v182
v_exp_f32 v183, v183
v_cvt_pk_bf16_f32 v194, v180, v181
v_cvt_pk_bf16_f32 v195, v182, v183
v_exp_f32 v184, v184
v_exp_f32 v185, v185
v_exp_f32 v186, v186
v_exp_f32 v187, v187
v_cvt_pk_bf16_f32 v196, v184, v185
v_cvt_pk_bf16_f32 v197, v186, v187
v_exp_f32 v188, v188
v_exp_f32 v189, v189
v_exp_f32 v190, v190
v_exp_f32 v191, v191
v_cvt_pk_bf16_f32 v198, v188, v189
v_cvt_pk_bf16_f32 v199, v190, v191
s_waitcnt lgkmcnt(2)
v_mfma_f32_32x32x16_bf16 v[96:111], v[168:171], v[192:195], v[96:111]
s_waitcnt lgkmcnt(0)
v_mfma_f32_32x32x16_bf16 v[96:111], v[172:175], v[196:199], v[96:111]
ds_read_b128 v[168:171], v9 offset:12800
ds_read_b128 v[172:175], v9 offset:14976
s_waitcnt lgkmcnt(1)
v_mfma_f32_32x32x16_bf16 v[176:191], v[168:171], v[240:243], 0
s_waitcnt lgkmcnt(0)
v_mfma_f32_32x32x16_bf16 v[176:191], v[172:175], v[244:247], v[176:191]
ds_read_b64_tr_b16 v[168:169], v10 offset:12800
ds_read_b64_tr_b16 v[170:171], v10 offset:12928
ds_read_b64_tr_b16 v[172:173], v10 offset:13056
ds_read_b64_tr_b16 v[174:175], v10 offset:13184
s_nop 7
v_exp_f32 v176, v176
v_exp_f32 v177, v177
v_exp_f32 v178, v178
v_exp_f32 v179, v179
v_cvt_pk_bf16_f32 v192, v176, v177
v_cvt_pk_bf16_f32 v193, v178, v179
v_exp_f32 v180, v180
v_exp_f32 v181, v181
v_exp_f32 v182, v182
v_exp_f32 v183, v183
v_cvt_pk_bf16_f32 v194, v180, v181
v_cvt_pk_bf16_f32 v195, v182, v183
v_exp_f32 v184, v184
v_exp_f32 v185, v185
v_exp_f32 v186, v186
v_exp_f32 v187, v187
v_cvt_pk_bf16_f32 v196, v184, v185
v_cvt_pk_bf16_f32 v197, v186, v187
v_exp_f32 v188, v188
v_exp_f32 v189, v189
v_exp_f32 v190, v190
v_exp_f32 v191, v191
v_cvt_pk_bf16_f32 v198, v188, v189
v_cvt_pk_bf16_f32 v199, v190, v191
s_waitcnt lgkmcnt(2)
v_mfma_f32_32x32x16_bf16 v[96:111], v[168:171], v[192:195], v[96:111]
s_waitcnt lgkmcnt(0)
v_mfma_f32_32x32x16_bf16 v[96:111], v[172:175], v[196:199], v[96:111]
ds_read_b128 v[168:171], v9 offset:16000
ds_read_b128 v[172:175], v9 offset:18176
s_waitcnt lgkmcnt(1)
v_mfma_f32_32x32x16_bf16 v[176:191], v[168:171], v[240:243], 0
s_waitcnt lgkmcnt(0)
v_mfma_f32_32x32x16_bf16 v[176:191], v[172:175], v[244:247], v[176:191]
ds_read_b64_tr_b16 v[168:169], v10 offset:16000
ds_read_b64_tr_b16 v[170:171], v10 offset:16128
ds_read_b64_tr_b16 v[172:173], v10 offset:16256
ds_read_b64_tr_b16 v[174:175], v10 offset:16384
s_nop 7
v_exp_f32 v176, v176
v_exp_f32 v177, v177
v_exp_f32 v178, v178
v_exp_f32 v179, v179
v_cvt_pk_bf16_f32 v192, v176, v177
v_cvt_pk_bf16_f32 v193, v178, v179
v_exp_f32 v180, v180
v_exp_f32 v181, v181
v_exp_f32 v182, v182
v_exp_f32 v183, v183
v_cvt_pk_bf16_f32 v194, v180, v181
v_cvt_pk_bf16_f32 v195, v182, v183
v_exp_f32 v184, v184
v_exp_f32 v185, v185
v_exp_f32 v186, v186
v_exp_f32 v187, v187
v_cvt_pk_bf16_f32 v196, v184, v185
v_cvt_pk_bf16_f32 v197, v186, v187
v_exp_f32 v188, v188
v_exp_f32 v189, v189
v_exp_f32 v190, v190
v_exp_f32 v191, v191
v_cvt_pk_bf16_f32 v198, v188, v189
v_cvt_pk_bf16_f32 v199, v190, v191
s_waitcnt lgkmcnt(2)
v_mfma_f32_32x32x16_bf16 v[96:111], v[168:171], v[192:195], v[96:111]
s_waitcnt lgkmcnt(0)
v_mfma_f32_32x32x16_bf16 v[96:111], v[172:175], v[196:199], v[96:111]
ds_read_b128 v[168:171], v9 offset:19200
ds_read_b128 v[172:175], v9 offset:21376
s_waitcnt lgkmcnt(1)
v_mfma_f32_32x32x16_bf16 v[176:191], v[168:171], v[240:243], 0
s_waitcnt lgkmcnt(0)
v_mfma_f32_32x32x16_bf16 v[176:191], v[172:175], v[244:247], v[176:191]
ds_read_b64_tr_b16 v[168:169], v10 offset:19200
ds_read_b64_tr_b16 v[170:171], v10 offset:19328
ds_read_b64_tr_b16 v[172:173], v10 offset:19456
ds_read_b64_tr_b16 v[174:175], v10 offset:19584
s_nop 7
v_exp_f32 v176, v176
v_exp_f32 v177, v177
v_exp_f32 v178, v178
v_exp_f32 v179, v179
v_cvt_pk_bf16_f32 v192, v176, v177
v_cvt_pk_bf16_f32 v193, v178, v179
v_exp_f32 v180, v180
v_exp_f32 v181, v181
v_exp_f32 v182, v182
v_exp_f32 v183, v183
v_cvt_pk_bf16_f32 v194, v180, v181
v_cvt_pk_bf16_f32 v195, v182, v183
v_exp_f32 v184, v184
v_exp_f32 v185, v185
v_exp_f32 v186, v186
v_exp_f32 v187, v187
v_cvt_pk_bf16_f32 v196, v184, v185
v_cvt_pk_bf16_f32 v197, v186, v187
v_exp_f32 v188, v188
v_exp_f32 v189, v189
v_exp_f32 v190, v190
v_exp_f32 v191, v191
v_cvt_pk_bf16_f32 v198, v188, v189
v_cvt_pk_bf16_f32 v199, v190, v191
s_waitcnt lgkmcnt(2)
v_mfma_f32_32x32x16_bf16 v[96:111], v[168:171], v[192:195], v[96:111]
s_waitcnt lgkmcnt(0)
v_mfma_f32_32x32x16_bf16 v[96:111], v[172:175], v[196:199], v[96:111]
ds_read_b128 v[168:171], v9 offset:22400
ds_read_b128 v[172:175], v9 offset:24576
s_waitcnt lgkmcnt(1)
v_mfma_f32_32x32x16_bf16 v[176:191], v[168:171], v[240:243], 0
s_waitcnt lgkmcnt(0)
v_mfma_f32_32x32x16_bf16 v[176:191], v[172:175], v[244:247], v[176:191]
ds_read_b64_tr_b16 v[168:169], v10 offset:22400
ds_read_b64_tr_b16 v[170:171], v10 offset:22528
ds_read_b64_tr_b16 v[172:173], v10 offset:22656
ds_read_b64_tr_b16 v[174:175], v10 offset:22784
s_nop 7
v_exp_f32 v176, v176
v_exp_f32 v177, v177
v_exp_f32 v178, v178
v_exp_f32 v179, v179
v_cvt_pk_bf16_f32 v192, v176, v177
v_cvt_pk_bf16_f32 v193, v178, v179
v_exp_f32 v180, v180
v_exp_f32 v181, v181
v_exp_f32 v182, v182
v_exp_f32 v183, v183
v_cvt_pk_bf16_f32 v194, v180, v181
v_cvt_pk_bf16_f32 v195, v182, v183
v_exp_f32 v184, v184
v_exp_f32 v185, v185
v_exp_f32 v186, v186
v_exp_f32 v187, v187
v_cvt_pk_bf16_f32 v196, v184, v185
v_cvt_pk_bf16_f32 v197, v186, v187
v_exp_f32 v188, v188
v_exp_f32 v189, v189
v_exp_f32 v190, v190
v_exp_f32 v191, v191
v_cvt_pk_bf16_f32 v198, v188, v189
v_cvt_pk_bf16_f32 v199, v190, v191
s_waitcnt lgkmcnt(2)
v_mfma_f32_32x32x16_bf16 v[96:111], v[168:171], v[192:195], v[96:111]
s_waitcnt lgkmcnt(0)
v_mfma_f32_32x32x16_bf16 v[96:111], v[172:175], v[196:199], v[96:111]
ds_read_b128 v[168:171], v9 offset:25600
ds_read_b128 v[172:175], v9 offset:27776
s_waitcnt lgkmcnt(1)
v_mfma_f32_32x32x16_bf16 v[176:191], v[168:171], v[240:243], v[152:167]
s_waitcnt lgkmcnt(0)
v_mfma_f32_32x32x16_bf16 v[176:191], v[172:175], v[244:247], v[176:191]
ds_read_b64_tr_b16 v[168:169], v10 offset:25600
ds_read_b64_tr_b16 v[170:171], v10 offset:25728
ds_read_b64_tr_b16 v[172:173], v10 offset:25856
ds_read_b64_tr_b16 v[174:175], v10 offset:25984
s_nop 7
v_exp_f32 v176, v176
v_exp_f32 v177, v177
v_exp_f32 v178, v178
v_exp_f32 v179, v179
v_cvt_pk_bf16_f32 v192, v176, v177
v_cvt_pk_bf16_f32 v193, v178, v179
v_exp_f32 v180, v180
v_exp_f32 v181, v181
v_exp_f32 v182, v182
v_exp_f32 v183, v183
v_cvt_pk_bf16_f32 v194, v180, v181
v_cvt_pk_bf16_f32 v195, v182, v183
v_exp_f32 v184, v184
v_exp_f32 v185, v185
v_exp_f32 v186, v186
v_exp_f32 v187, v187
v_cvt_pk_bf16_f32 v196, v184, v185
v_cvt_pk_bf16_f32 v197, v186, v187
v_exp_f32 v188, v188
v_exp_f32 v189, v189
v_exp_f32 v190, v190
v_exp_f32 v191, v191
v_cvt_pk_bf16_f32 v198, v188, v189
v_cvt_pk_bf16_f32 v199, v190, v191
s_waitcnt lgkmcnt(2)
v_mfma_f32_32x32x16_bf16 v[96:111], v[168:171], v[192:195], v[96:111]
s_waitcnt lgkmcnt(0)
v_mfma_f32_32x32x16_bf16 v[96:111], v[172:175], v[196:199], v[96:111]
s_nop 7
v_accvgpr_read_b32 v168, a100
v_accvgpr_read_b32 v169, a101
v_accvgpr_read_b32 v170, a102
v_accvgpr_read_b32 v171, a103
v_accvgpr_read_b32 v172, a104
v_accvgpr_read_b32 v173, a105
v_accvgpr_read_b32 v174, a106
v_accvgpr_read_b32 v175, a107
v_accvgpr_read_b32 v176, a108
v_accvgpr_read_b32 v177, a109
v_accvgpr_read_b32 v178, a110
v_accvgpr_read_b32 v179, a111
v_accvgpr_read_b32 v180, a112
v_accvgpr_read_b32 v181, a113
v_accvgpr_read_b32 v182, a114
v_accvgpr_read_b32 v183, a115
v_accvgpr_read_b32 v184, a116
v_accvgpr_read_b32 v185, a117
v_accvgpr_read_b32 v186, a118
v_accvgpr_read_b32 v187, a119
v_accvgpr_read_b32 v188, a120
v_accvgpr_read_b32 v189, a121
v_accvgpr_read_b32 v190, a122
v_accvgpr_read_b32 v191, a123
v_accvgpr_read_b32 v192, a124
v_accvgpr_read_b32 v193, a125
v_accvgpr_read_b32 v194, a126
v_accvgpr_read_b32 v195, a127
v_accvgpr_read_b32 v196, a128
v_accvgpr_read_b32 v197, a129
v_accvgpr_read_b32 v198, a130
v_accvgpr_read_b32 v199, a131
v_rcp_f32 v210, v108
s_nop 0
v_mul_f32 v96, v96, v210
v_mul_f32 v97, v97, v210
v_mul_f32 v98, v98, v210
v_mul_f32 v99, v99, v210
v_mul_f32 v100, v100, v210
v_mul_f32 v101, v101, v210
v_mul_f32 v102, v102, v210
v_mul_f32 v103, v103, v210
v_mul_f32 v104, v104, v210
v_mul_f32 v105, v105, v210
v_mul_f32 v106, v106, v210
v_mul_f32 v107, v107, v210
v_cvt_pk_bf16_f32 v216, v96, v97
v_cvt_pk_bf16_f32 v217, v98, v99
v_cvt_pk_bf16_f32 v218, v100, v101
v_cvt_pk_bf16_f32 v219, v102, v103
v_cvt_pk_bf16_f32 v220, v104, v105
v_cvt_pk_bf16_f32 v221, v106, v107
s_branch Lfr65
Lfb66:
s_cmp_eq_u64 s[58:59], 0
s_cbranch_scc1 Lfb66s
s_nop 15
v_accvgpr_write_b32 a100, v168
v_accvgpr_write_b32 a101, v169
v_accvgpr_write_b32 a102, v170
v_accvgpr_write_b32 a103, v171
v_accvgpr_write_b32 a104, v172
v_accvgpr_write_b32 a105, v173
v_accvgpr_write_b32 a106, v174
v_accvgpr_write_b32 a107, v175
v_accvgpr_write_b32 a108, v176
v_accvgpr_write_b32 a109, v177
v_accvgpr_write_b32 a110, v178
v_accvgpr_write_b32 a111, v179
v_accvgpr_write_b32 a112, v180
v_accvgpr_write_b32 a113, v181
v_accvgpr_write_b32 a114, v182
v_accvgpr_write_b32 a115, v183
v_accvgpr_write_b32 a116, v184
v_accvgpr_write_b32 a117, v185
v_accvgpr_write_b32 a118, v186
v_accvgpr_write_b32 a119, v187
v_accvgpr_write_b32 a120, v188
v_accvgpr_write_b32 a121, v189
v_accvgpr_write_b32 a122, v190
v_accvgpr_write_b32 a123, v191
v_accvgpr_write_b32 a124, v192
v_accvgpr_write_b32 a125, v193
v_accvgpr_write_b32 a126, v194
v_accvgpr_write_b32 a127, v195
v_accvgpr_write_b32 a128, v196
v_accvgpr_write_b32 a129, v197
v_accvgpr_write_b32 a130, v198
v_accvgpr_write_b32 a131, v199
v_mov_b32 v254, 0
v_mov_b32 v208, 4284592614
ds_read_b128 v[168:171], v239 offset:0
ds_read_b128 v[172:175], v239 offset:2176
s_waitcnt lgkmcnt(1)
v_mfma_f32_32x32x16_bf16 v[176:191], v[168:171], v[248:251], v[136:151]
s_waitcnt lgkmcnt(0)
v_mfma_f32_32x32x16_bf16 v[176:191], v[172:175], v[252:255], v[176:191]
s_nop 11
v_max3_f32 v208, v176, v177, v208
v_max3_f32 v208, v178, v179, v208
v_max3_f32 v208, v180, v181, v208
v_max3_f32 v208, v182, v183, v208
v_max3_f32 v208, v184, v185, v208
v_max3_f32 v208, v186, v187, v208
v_max3_f32 v208, v188, v189, v208
v_max3_f32 v208, v190, v191, v208
ds_read_b128 v[168:171], v239 offset:3200
ds_read_b128 v[172:175], v239 offset:5376
s_waitcnt lgkmcnt(1)
v_mfma_f32_32x32x16_bf16 v[176:191], v[168:171], v[248:251], 0
s_waitcnt lgkmcnt(0)
v_mfma_f32_32x32x16_bf16 v[176:191], v[172:175], v[252:255], v[176:191]
s_nop 11
v_max3_f32 v208, v176, v177, v208
v_max3_f32 v208, v178, v179, v208
v_max3_f32 v208, v180, v181, v208
v_max3_f32 v208, v182, v183, v208
v_max3_f32 v208, v184, v185, v208
v_max3_f32 v208, v186, v187, v208
v_max3_f32 v208, v188, v189, v208
v_max3_f32 v208, v190, v191, v208
ds_read_b128 v[168:171], v239 offset:6400
ds_read_b128 v[172:175], v239 offset:8576
s_waitcnt lgkmcnt(1)
v_mfma_f32_32x32x16_bf16 v[176:191], v[168:171], v[248:251], 0
s_waitcnt lgkmcnt(0)
v_mfma_f32_32x32x16_bf16 v[176:191], v[172:175], v[252:255], v[176:191]
s_nop 11
v_max3_f32 v208, v176, v177, v208
v_max3_f32 v208, v178, v179, v208
v_max3_f32 v208, v180, v181, v208
v_max3_f32 v208, v182, v183, v208
v_max3_f32 v208, v184, v185, v208
v_max3_f32 v208, v186, v187, v208
v_max3_f32 v208, v188, v189, v208
v_max3_f32 v208, v190, v191, v208
ds_read_b128 v[168:171], v239 offset:9600
ds_read_b128 v[172:175], v239 offset:11776
s_waitcnt lgkmcnt(1)
v_mfma_f32_32x32x16_bf16 v[176:191], v[168:171], v[248:251], 0
s_waitcnt lgkmcnt(0)
v_mfma_f32_32x32x16_bf16 v[176:191], v[172:175], v[252:255], v[176:191]
s_nop 11
v_max3_f32 v208, v176, v177, v208
v_max3_f32 v208, v178, v179, v208
v_max3_f32 v208, v180, v181, v208
v_max3_f32 v208, v182, v183, v208
v_max3_f32 v208, v184, v185, v208
v_max3_f32 v208, v186, v187, v208
v_max3_f32 v208, v188, v189, v208
v_max3_f32 v208, v190, v191, v208
ds_read_b128 v[168:171], v239 offset:12800
ds_read_b128 v[172:175], v239 offset:14976
s_waitcnt lgkmcnt(1)
v_mfma_f32_32x32x16_bf16 v[176:191], v[168:171], v[248:251], 0
s_waitcnt lgkmcnt(0)
v_mfma_f32_32x32x16_bf16 v[176:191], v[172:175], v[252:255], v[176:191]
s_nop 11
v_max3_f32 v208, v176, v177, v208
v_max3_f32 v208, v178, v179, v208
v_max3_f32 v208, v180, v181, v208
v_max3_f32 v208, v182, v183, v208
v_max3_f32 v208, v184, v185, v208
v_max3_f32 v208, v186, v187, v208
v_max3_f32 v208, v188, v189, v208
v_max3_f32 v208, v190, v191, v208
ds_read_b128 v[168:171], v239 offset:16000
ds_read_b128 v[172:175], v239 offset:18176
s_waitcnt lgkmcnt(1)
v_mfma_f32_32x32x16_bf16 v[176:191], v[168:171], v[248:251], 0
s_waitcnt lgkmcnt(0)
v_mfma_f32_32x32x16_bf16 v[176:191], v[172:175], v[252:255], v[176:191]
s_nop 11
v_max3_f32 v208, v176, v177, v208
v_max3_f32 v208, v178, v179, v208
v_max3_f32 v208, v180, v181, v208
v_max3_f32 v208, v182, v183, v208
v_max3_f32 v208, v184, v185, v208
v_max3_f32 v208, v186, v187, v208
v_max3_f32 v208, v188, v189, v208
v_max3_f32 v208, v190, v191, v208
ds_read_b128 v[168:171], v239 offset:19200
ds_read_b128 v[172:175], v239 offset:21376
s_waitcnt lgkmcnt(1)
v_mfma_f32_32x32x16_bf16 v[176:191], v[168:171], v[248:251], 0
s_waitcnt lgkmcnt(0)
v_mfma_f32_32x32x16_bf16 v[176:191], v[172:175], v[252:255], v[176:191]
s_nop 11
v_max3_f32 v208, v176, v177, v208
v_max3_f32 v208, v178, v179, v208
v_max3_f32 v208, v180, v181, v208
v_max3_f32 v208, v182, v183, v208
v_max3_f32 v208, v184, v185, v208
v_max3_f32 v208, v186, v187, v208
v_max3_f32 v208, v188, v189, v208
v_max3_f32 v208, v190, v191, v208
ds_read_b128 v[168:171], v239 offset:22400
ds_read_b128 v[172:175], v239 offset:24576
s_waitcnt lgkmcnt(1)
v_mfma_f32_32x32x16_bf16 v[176:191], v[168:171], v[248:251], 0
s_waitcnt lgkmcnt(0)
v_mfma_f32_32x32x16_bf16 v[176:191], v[172:175], v[252:255], v[176:191]
s_nop 11
v_max3_f32 v208, v176, v177, v208
v_max3_f32 v208, v178, v179, v208
v_max3_f32 v208, v180, v181, v208
v_max3_f32 v208, v182, v183, v208
v_max3_f32 v208, v184, v185, v208
v_max3_f32 v208, v186, v187, v208
v_max3_f32 v208, v188, v189, v208
v_max3_f32 v208, v190, v191, v208
ds_read_b128 v[168:171], v239 offset:25600
ds_read_b128 v[172:175], v239 offset:27776
s_waitcnt lgkmcnt(1)
v_mfma_f32_32x32x16_bf16 v[176:191], v[168:171], v[248:251], v[152:167]
s_waitcnt lgkmcnt(0)
v_mfma_f32_32x32x16_bf16 v[176:191], v[172:175], v[252:255], v[176:191]
s_nop 11
v_max3_f32 v208, v176, v177, v208
v_max3_f32 v208, v178, v179, v208
v_max3_f32 v208, v180, v181, v208
v_max3_f32 v208, v182, v183, v208
v_max3_f32 v208, v184, v185, v208
v_max3_f32 v208, v186, v187, v208
v_max3_f32 v208, v188, v189, v208
v_max3_f32 v208, v190, v191, v208
v_mov_b32 v210, v208
s_nop 1
v_permlane32_swap_b32 v210, v208
v_max_f32 v210, v210, v208
v_cvt_pk_bf16_f32 v211, -v210, -v210
v_and_b32 v211, 0xffff0000, v211
v_fma_f32 v211, -1.0, v210, -v211
v_cvt_pk_bf16_f32 v211, -v210, v211
v_cndmask_b32 v254, v211, 0, s[44:45]
ds_read_b128 v[168:171], v239 offset:0
ds_read_b128 v[172:175], v239 offset:2176
s_waitcnt lgkmcnt(1)
v_mfma_f32_32x32x16_bf16 v[176:191], v[168:171], v[248:251], v[136:151]
s_waitcnt lgkmcnt(0)
v_mfma_f32_32x32x16_bf16 v[176:191], v[172:175], v[252:255], v[176:191]
ds_read_b64_tr_b16 v[168:169], v38 offset:0
ds_read_b64_tr_b16 v[170:171], v38 offset:128
ds_read_b64_tr_b16 v[172:173], v38 offset:256
ds_read_b64_tr_b16 v[174:175], v38 offset:384
s_nop 7
v_exp_f32 v176, v176
v_exp_f32 v177, v177
v_exp_f32 v178, v178
v_exp_f32 v179, v179
v_cvt_pk_bf16_f32 v192, v176, v177
v_cvt_pk_bf16_f32 v193, v178, v179
v_exp_f32 v180, v180
v_exp_f32 v181, v181
v_exp_f32 v182, v182
v_exp_f32 v183, v183
v_cvt_pk_bf16_f32 v194, v180, v181
v_cvt_pk_bf16_f32 v195, v182, v183
v_exp_f32 v184, v184
v_exp_f32 v185, v185
v_exp_f32 v186, v186
v_exp_f32 v187, v187
v_cvt_pk_bf16_f32 v196, v184, v185
v_cvt_pk_bf16_f32 v197, v186, v187
v_exp_f32 v188, v188
v_exp_f32 v189, v189
v_exp_f32 v190, v190
v_exp_f32 v191, v191
v_cvt_pk_bf16_f32 v198, v188, v189
v_cvt_pk_bf16_f32 v199, v190, v191
s_waitcnt lgkmcnt(2)
v_mfma_f32_32x32x16_bf16 v[112:127], v[168:171], v[192:195], 0
s_waitcnt lgkmcnt(0)
v_mfma_f32_32x32x16_bf16 v[112:127], v[172:175], v[196:199], v[112:127]
ds_read_b128 v[168:171], v239 offset:3200
ds_read_b128 v[172:175], v239 offset:5376
s_waitcnt lgkmcnt(1)
v_mfma_f32_32x32x16_bf16 v[176:191], v[168:171], v[248:251], 0
s_waitcnt lgkmcnt(0)
v_mfma_f32_32x32x16_bf16 v[176:191], v[172:175], v[252:255], v[176:191]
ds_read_b64_tr_b16 v[168:169], v38 offset:3200
ds_read_b64_tr_b16 v[170:171], v38 offset:3328
ds_read_b64_tr_b16 v[172:173], v38 offset:3456
ds_read_b64_tr_b16 v[174:175], v38 offset:3584
s_nop 7
v_exp_f32 v176, v176
v_exp_f32 v177, v177
v_exp_f32 v178, v178
v_exp_f32 v179, v179
v_cvt_pk_bf16_f32 v192, v176, v177
v_cvt_pk_bf16_f32 v193, v178, v179
v_exp_f32 v180, v180
v_exp_f32 v181, v181
v_exp_f32 v182, v182
v_exp_f32 v183, v183
v_cvt_pk_bf16_f32 v194, v180, v181
v_cvt_pk_bf16_f32 v195, v182, v183
v_exp_f32 v184, v184
v_exp_f32 v185, v185
v_exp_f32 v186, v186
v_exp_f32 v187, v187
v_cvt_pk_bf16_f32 v196, v184, v185
v_cvt_pk_bf16_f32 v197, v186, v187
v_exp_f32 v188, v188
v_exp_f32 v189, v189
v_exp_f32 v190, v190
v_exp_f32 v191, v191
v_cvt_pk_bf16_f32 v198, v188, v189
v_cvt_pk_bf16_f32 v199, v190, v191
s_waitcnt lgkmcnt(2)
v_mfma_f32_32x32x16_bf16 v[112:127], v[168:171], v[192:195], v[112:127]
s_waitcnt lgkmcnt(0)
v_mfma_f32_32x32x16_bf16 v[112:127], v[172:175], v[196:199], v[112:127]
ds_read_b128 v[168:171], v239 offset:6400
ds_read_b128 v[172:175], v239 offset:8576
s_waitcnt lgkmcnt(1)
v_mfma_f32_32x32x16_bf16 v[176:191], v[168:171], v[248:251], 0
s_waitcnt lgkmcnt(0)
v_mfma_f32_32x32x16_bf16 v[176:191], v[172:175], v[252:255], v[176:191]
ds_read_b64_tr_b16 v[168:169], v38 offset:6400
ds_read_b64_tr_b16 v[170:171], v38 offset:6528
ds_read_b64_tr_b16 v[172:173], v38 offset:6656
ds_read_b64_tr_b16 v[174:175], v38 offset:6784
s_nop 7
v_exp_f32 v176, v176
v_exp_f32 v177, v177
v_exp_f32 v178, v178
v_exp_f32 v179, v179
v_cvt_pk_bf16_f32 v192, v176, v177
v_cvt_pk_bf16_f32 v193, v178, v179
v_exp_f32 v180, v180
v_exp_f32 v181, v181
v_exp_f32 v182, v182
v_exp_f32 v183, v183
v_cvt_pk_bf16_f32 v194, v180, v181
v_cvt_pk_bf16_f32 v195, v182, v183
v_exp_f32 v184, v184
v_exp_f32 v185, v185
v_exp_f32 v186, v186
v_exp_f32 v187, v187
v_cvt_pk_bf16_f32 v196, v184, v185
v_cvt_pk_bf16_f32 v197, v186, v187
v_exp_f32 v188, v188
v_exp_f32 v189, v189
v_exp_f32 v190, v190
v_exp_f32 v191, v191
v_cvt_pk_bf16_f32 v198, v188, v189
v_cvt_pk_bf16_f32 v199, v190, v191
s_waitcnt lgkmcnt(2)
v_mfma_f32_32x32x16_bf16 v[112:127], v[168:171], v[192:195], v[112:127]
s_waitcnt lgkmcnt(0)
v_mfma_f32_32x32x16_bf16 v[112:127], v[172:175], v[196:199], v[112:127]
ds_read_b128 v[168:171], v239 offset:9600
ds_read_b128 v[172:175], v239 offset:11776
s_waitcnt lgkmcnt(1)
v_mfma_f32_32x32x16_bf16 v[176:191], v[168:171], v[248:251], 0
s_waitcnt lgkmcnt(0)
v_mfma_f32_32x32x16_bf16 v[176:191], v[172:175], v[252:255], v[176:191]
ds_read_b64_tr_b16 v[168:169], v38 offset:9600
ds_read_b64_tr_b16 v[170:171], v38 offset:9728
ds_read_b64_tr_b16 v[172:173], v38 offset:9856
ds_read_b64_tr_b16 v[174:175], v38 offset:9984
s_nop 7
v_exp_f32 v176, v176
v_exp_f32 v177, v177
v_exp_f32 v178, v178
v_exp_f32 v179, v179
v_cvt_pk_bf16_f32 v192, v176, v177
v_cvt_pk_bf16_f32 v193, v178, v179
v_exp_f32 v180, v180
v_exp_f32 v181, v181
v_exp_f32 v182, v182
v_exp_f32 v183, v183
v_cvt_pk_bf16_f32 v194, v180, v181
v_cvt_pk_bf16_f32 v195, v182, v183
v_exp_f32 v184, v184
v_exp_f32 v185, v185
v_exp_f32 v186, v186
v_exp_f32 v187, v187
v_cvt_pk_bf16_f32 v196, v184, v185
v_cvt_pk_bf16_f32 v197, v186, v187
v_exp_f32 v188, v188
v_exp_f32 v189, v189
v_exp_f32 v190, v190
v_exp_f32 v191, v191
v_cvt_pk_bf16_f32 v198, v188, v189
v_cvt_pk_bf16_f32 v199, v190, v191
s_waitcnt lgkmcnt(2)
v_mfma_f32_32x32x16_bf16 v[112:127], v[168:171], v[192:195], v[112:127]
s_waitcnt lgkmcnt(0)
v_mfma_f32_32x32x16_bf16 v[112:127], v[172:175], v[196:199], v[112:127]
ds_read_b128 v[168:171], v239 offset:12800
ds_read_b128 v[172:175], v239 offset:14976
s_waitcnt lgkmcnt(1)
v_mfma_f32_32x32x16_bf16 v[176:191], v[168:171], v[248:251], 0
s_waitcnt lgkmcnt(0)
v_mfma_f32_32x32x16_bf16 v[176:191], v[172:175], v[252:255], v[176:191]
ds_read_b64_tr_b16 v[168:169], v38 offset:12800
ds_read_b64_tr_b16 v[170:171], v38 offset:12928
ds_read_b64_tr_b16 v[172:173], v38 offset:13056
ds_read_b64_tr_b16 v[174:175], v38 offset:13184
s_nop 7
v_exp_f32 v176, v176
v_exp_f32 v177, v177
v_exp_f32 v178, v178
v_exp_f32 v179, v179
v_cvt_pk_bf16_f32 v192, v176, v177
v_cvt_pk_bf16_f32 v193, v178, v179
v_exp_f32 v180, v180
v_exp_f32 v181, v181
v_exp_f32 v182, v182
v_exp_f32 v183, v183
v_cvt_pk_bf16_f32 v194, v180, v181
v_cvt_pk_bf16_f32 v195, v182, v183
v_exp_f32 v184, v184
v_exp_f32 v185, v185
v_exp_f32 v186, v186
v_exp_f32 v187, v187
v_cvt_pk_bf16_f32 v196, v184, v185
v_cvt_pk_bf16_f32 v197, v186, v187
v_exp_f32 v188, v188
v_exp_f32 v189, v189
v_exp_f32 v190, v190
v_exp_f32 v191, v191
v_cvt_pk_bf16_f32 v198, v188, v189
v_cvt_pk_bf16_f32 v199, v190, v191
s_waitcnt lgkmcnt(2)
v_mfma_f32_32x32x16_bf16 v[112:127], v[168:171], v[192:195], v[112:127]
s_waitcnt lgkmcnt(0)
v_mfma_f32_32x32x16_bf16 v[112:127], v[172:175], v[196:199], v[112:127]
ds_read_b128 v[168:171], v239 offset:16000
ds_read_b128 v[172:175], v239 offset:18176
s_waitcnt lgkmcnt(1)
v_mfma_f32_32x32x16_bf16 v[176:191], v[168:171], v[248:251], 0
s_waitcnt lgkmcnt(0)
v_mfma_f32_32x32x16_bf16 v[176:191], v[172:175], v[252:255], v[176:191]
ds_read_b64_tr_b16 v[168:169], v38 offset:16000
ds_read_b64_tr_b16 v[170:171], v38 offset:16128
ds_read_b64_tr_b16 v[172:173], v38 offset:16256
ds_read_b64_tr_b16 v[174:175], v38 offset:16384
s_nop 7
v_exp_f32 v176, v176
v_exp_f32 v177, v177
v_exp_f32 v178, v178
v_exp_f32 v179, v179
v_cvt_pk_bf16_f32 v192, v176, v177
v_cvt_pk_bf16_f32 v193, v178, v179
v_exp_f32 v180, v180
v_exp_f32 v181, v181
v_exp_f32 v182, v182
v_exp_f32 v183, v183
v_cvt_pk_bf16_f32 v194, v180, v181
v_cvt_pk_bf16_f32 v195, v182, v183
v_exp_f32 v184, v184
v_exp_f32 v185, v185
v_exp_f32 v186, v186
v_exp_f32 v187, v187
v_cvt_pk_bf16_f32 v196, v184, v185
v_cvt_pk_bf16_f32 v197, v186, v187
v_exp_f32 v188, v188
v_exp_f32 v189, v189
v_exp_f32 v190, v190
v_exp_f32 v191, v191
v_cvt_pk_bf16_f32 v198, v188, v189
v_cvt_pk_bf16_f32 v199, v190, v191
s_waitcnt lgkmcnt(2)
v_mfma_f32_32x32x16_bf16 v[112:127], v[168:171], v[192:195], v[112:127]
s_waitcnt lgkmcnt(0)
v_mfma_f32_32x32x16_bf16 v[112:127], v[172:175], v[196:199], v[112:127]
ds_read_b128 v[168:171], v239 offset:19200
ds_read_b128 v[172:175], v239 offset:21376
s_waitcnt lgkmcnt(1)
v_mfma_f32_32x32x16_bf16 v[176:191], v[168:171], v[248:251], 0
s_waitcnt lgkmcnt(0)
v_mfma_f32_32x32x16_bf16 v[176:191], v[172:175], v[252:255], v[176:191]
ds_read_b64_tr_b16 v[168:169], v38 offset:19200
ds_read_b64_tr_b16 v[170:171], v38 offset:19328
ds_read_b64_tr_b16 v[172:173], v38 offset:19456
ds_read_b64_tr_b16 v[174:175], v38 offset:19584
s_nop 7
v_exp_f32 v176, v176
v_exp_f32 v177, v177
v_exp_f32 v178, v178
v_exp_f32 v179, v179
v_cvt_pk_bf16_f32 v192, v176, v177
v_cvt_pk_bf16_f32 v193, v178, v179
v_exp_f32 v180, v180
v_exp_f32 v181, v181
v_exp_f32 v182, v182
v_exp_f32 v183, v183
v_cvt_pk_bf16_f32 v194, v180, v181
v_cvt_pk_bf16_f32 v195, v182, v183
v_exp_f32 v184, v184
v_exp_f32 v185, v185
v_exp_f32 v186, v186
v_exp_f32 v187, v187
v_cvt_pk_bf16_f32 v196, v184, v185
v_cvt_pk_bf16_f32 v197, v186, v187
v_exp_f32 v188, v188
v_exp_f32 v189, v189
v_exp_f32 v190, v190
v_exp_f32 v191, v191
v_cvt_pk_bf16_f32 v198, v188, v189
v_cvt_pk_bf16_f32 v199, v190, v191
s_waitcnt lgkmcnt(2)
v_mfma_f32_32x32x16_bf16 v[112:127], v[168:171], v[192:195], v[112:127]
s_waitcnt lgkmcnt(0)
v_mfma_f32_32x32x16_bf16 v[112:127], v[172:175], v[196:199], v[112:127]
ds_read_b128 v[168:171], v239 offset:22400
ds_read_b128 v[172:175], v239 offset:24576
s_waitcnt lgkmcnt(1)
v_mfma_f32_32x32x16_bf16 v[176:191], v[168:171], v[248:251], 0
s_waitcnt lgkmcnt(0)
v_mfma_f32_32x32x16_bf16 v[176:191], v[172:175], v[252:255], v[176:191]
ds_read_b64_tr_b16 v[168:169], v38 offset:22400
ds_read_b64_tr_b16 v[170:171], v38 offset:22528
ds_read_b64_tr_b16 v[172:173], v38 offset:22656
ds_read_b64_tr_b16 v[174:175], v38 offset:22784
s_nop 7
v_exp_f32 v176, v176
v_exp_f32 v177, v177
v_exp_f32 v178, v178
v_exp_f32 v179, v179
v_cvt_pk_bf16_f32 v192, v176, v177
v_cvt_pk_bf16_f32 v193, v178, v179
v_exp_f32 v180, v180
v_exp_f32 v181, v181
v_exp_f32 v182, v182
v_exp_f32 v183, v183
v_cvt_pk_bf16_f32 v194, v180, v181
v_cvt_pk_bf16_f32 v195, v182, v183
v_exp_f32 v184, v184
v_exp_f32 v185, v185
v_exp_f32 v186, v186
v_exp_f32 v187, v187
v_cvt_pk_bf16_f32 v196, v184, v185
v_cvt_pk_bf16_f32 v197, v186, v187
v_exp_f32 v188, v188
v_exp_f32 v189, v189
v_exp_f32 v190, v190
v_exp_f32 v191, v191
v_cvt_pk_bf16_f32 v198, v188, v189
v_cvt_pk_bf16_f32 v199, v190, v191
s_waitcnt lgkmcnt(2)
v_mfma_f32_32x32x16_bf16 v[112:127], v[168:171], v[192:195], v[112:127]
s_waitcnt lgkmcnt(0)
v_mfma_f32_32x32x16_bf16 v[112:127], v[172:175], v[196:199], v[112:127]
ds_read_b128 v[168:171], v239 offset:25600
ds_read_b128 v[172:175], v239 offset:27776
s_waitcnt lgkmcnt(1)
v_mfma_f32_32x32x16_bf16 v[176:191], v[168:171], v[248:251], v[152:167]
s_waitcnt lgkmcnt(0)
v_mfma_f32_32x32x16_bf16 v[176:191], v[172:175], v[252:255], v[176:191]
ds_read_b64_tr_b16 v[168:169], v38 offset:25600
ds_read_b64_tr_b16 v[170:171], v38 offset:25728
ds_read_b64_tr_b16 v[172:173], v38 offset:25856
ds_read_b64_tr_b16 v[174:175], v38 offset:25984
s_nop 7
v_exp_f32 v176, v176
v_exp_f32 v177, v177
v_exp_f32 v178, v178
v_exp_f32 v179, v179
v_cvt_pk_bf16_f32 v192, v176, v177
v_cvt_pk_bf16_f32 v193, v178, v179
v_exp_f32 v180, v180
v_exp_f32 v181, v181
v_exp_f32 v182, v182
v_exp_f32 v183, v183
v_cvt_pk_bf16_f32 v194, v180, v181
v_cvt_pk_bf16_f32 v195, v182, v183
v_exp_f32 v184, v184
v_exp_f32 v185, v185
v_exp_f32 v186, v186
v_exp_f32 v187, v187
v_cvt_pk_bf16_f32 v196, v184, v185
v_cvt_pk_bf16_f32 v197, v186, v187
v_exp_f32 v188, v188
v_exp_f32 v189, v189
v_exp_f32 v190, v190
v_exp_f32 v191, v191
v_cvt_pk_bf16_f32 v198, v188, v189
v_cvt_pk_bf16_f32 v199, v190, v191
s_waitcnt lgkmcnt(2)
v_mfma_f32_32x32x16_bf16 v[112:127], v[168:171], v[192:195], v[112:127]
s_waitcnt lgkmcnt(0)
v_mfma_f32_32x32x16_bf16 v[112:127], v[172:175], v[196:199], v[112:127]
s_nop 7
v_accvgpr_read_b32 v168, a100
v_accvgpr_read_b32 v169, a101
v_accvgpr_read_b32 v170, a102
v_accvgpr_read_b32 v171, a103
v_accvgpr_read_b32 v172, a104
v_accvgpr_read_b32 v173, a105
v_accvgpr_read_b32 v174, a106
v_accvgpr_read_b32 v175, a107
v_accvgpr_read_b32 v176, a108
v_accvgpr_read_b32 v177, a109
v_accvgpr_read_b32 v178, a110
v_accvgpr_read_b32 v179, a111
v_accvgpr_read_b32 v180, a112
v_accvgpr_read_b32 v181, a113
v_accvgpr_read_b32 v182, a114
v_accvgpr_read_b32 v183, a115
v_accvgpr_read_b32 v184, a116
v_accvgpr_read_b32 v185, a117
v_accvgpr_read_b32 v186, a118
v_accvgpr_read_b32 v187, a119
v_accvgpr_read_b32 v188, a120
v_accvgpr_read_b32 v189, a121
v_accvgpr_read_b32 v190, a122
v_accvgpr_read_b32 v191, a123
v_accvgpr_read_b32 v192, a124
v_accvgpr_read_b32 v193, a125
v_accvgpr_read_b32 v194, a126
v_accvgpr_read_b32 v195, a127
v_accvgpr_read_b32 v196, a128
v_accvgpr_read_b32 v197, a129
v_accvgpr_read_b32 v198, a130
v_accvgpr_read_b32 v199, a131
v_rcp_f32 v210, v124
s_nop 0
v_pk_mul_f32 v[112:113], v[112:113], v[210:211] op_sel_hi:[1,0]
v_pk_mul_f32 v[114:115], v[114:115], v[210:211] op_sel_hi:[1,0]
v_pk_mul_f32 v[116:117], v[116:117], v[210:211] op_sel_hi:[1,0]
v_pk_mul_f32 v[118:119], v[118:119], v[210:211] op_sel_hi:[1,0]
v_pk_mul_f32 v[120:121], v[120:121], v[210:211] op_sel_hi:[1,0]
v_pk_mul_f32 v[122:123], v[122:123], v[210:211] op_sel_hi:[1,0]
v_cvt_pk_bf16_f32 v224, v112, v113
v_cvt_pk_bf16_f32 v225, v114, v115
v_cvt_pk_bf16_f32 v226, v116, v117
v_cvt_pk_bf16_f32 v227, v118, v119
v_cvt_pk_bf16_f32 v222, v120, v121
v_cvt_pk_bf16_f32 v223, v122, v123
Lfb66s:
buffer_store_dwordx4 v[224:227], v1, s[4:7], s38 offen offset:1024 sc1
s_mov_b32 exec_hi, 0
buffer_store_dwordx4 v[220:223], v1, s[4:7], s38 offen offset:2048 sc1
s_mov_b64 exec, -1
s_branch Lfr67
Lw70:
s_mov_b64 exec, 1
s_waitcnt vmcnt(0) lgkmcnt(0)
s_barrier
buffer_store_dword v15, v12, s[4:7], s49 offen sc1
s_mov_b64 exec, 0xffff
s_mov_b32 s57, 0
Lp72:
buffer_load_dword v15, v7, s[4:7], s23 offen offset:0 sc1
s_add_u32 s57, s57, 1
s_waitcnt vmcnt(0)
v_cmp_gt_u32 s[58:59], 5, v15
s_nop 0
s_cmp_eq_u64 s[58:59], 0
s_cbranch_scc1 Ld73
s_cmp_lt_u32 s57, 1048576
s_cbranch_scc1 Lp72
Ld73:
s_branch Lr71_d
Ls75:
s_waitcnt lgkmcnt(0)
s_nop 15
v_pk_add_f32 v[16:17], v[16:17], v[148:149]
v_pk_add_f32 v[18:19], v[18:19], v[150:151]
v_pk_add_f32 v[20:21], v[20:21], v[152:153]
v_pk_add_f32 v[22:23], v[22:23], v[154:155]
v_pk_add_f32 v[24:25], v[24:25], v[156:157]
v_pk_add_f32 v[26:27], v[26:27], v[158:159]
v_pk_add_f32 v[28:29], v[28:29], v[160:161]
v_pk_add_f32 v[30:31], v[30:31], v[162:163]
v_pk_add_f32 v[32:33], v[32:33], v[164:165]
v_pk_add_f32 v[34:35], v[34:35], v[166:167]
v_pk_add_f32 v[16:17], v[16:17], v[200:201]
v_pk_add_f32 v[18:19], v[18:19], v[202:203]
v_pk_add_f32 v[20:21], v[20:21], v[204:205]
v_pk_add_f32 v[22:23], v[22:23], v[206:207]
v_pk_add_f32 v[24:25], v[24:25], v[208:209]
v_pk_add_f32 v[26:27], v[26:27], v[210:211]
v_pk_add_f32 v[28:29], v[28:29], v[212:213]
v_pk_add_f32 v[30:31], v[30:31], v[214:215]
v_pk_add_f32 v[32:33], v[32:33], v[216:217]
v_pk_add_f32 v[34:35], v[34:35], v[218:219]
v_cvt_pk_bf16_f32 v40, v16, v17
v_cvt_pk_bf16_f32 v41, v18, v19
v_cvt_pk_bf16_f32 v42, v20, v21
v_cvt_pk_bf16_f32 v43, v22, v23
v_cvt_pk_bf16_f32 v44, v24, v25
v_cvt_pk_bf16_f32 v45, v26, v27
v_cvt_pk_bf16_f32 v46, v28, v29
v_cvt_pk_bf16_f32 v47, v30, v31
v_cvt_pk_bf16_f32 v48, v32, v33
v_cvt_pk_bf16_f32 v49, v34, v35
v_cvt_pk_bf16_f32 v50, v32, v33
v_cvt_pk_bf16_f32 v51, v34, v35
buffer_store_dwordx4 v[40:43], v4, s[12:15], s34 offen sc1
buffer_store_dwordx4 v[44:47], v4, s[12:15], s34 offen offset:2048 sc1
v_permlane16_swap_b32 v48, v50
v_permlane16_swap_b32 v49, v51
v_pk_add_f32 v[52:53], v[16:17], v[18:19]
v_pk_mul_f32 v[54:55], v[16:17], v[16:17]
v_pk_fma_f32 v[54:55], v[18:19], v[18:19], v[54:55]
v_pk_add_f32 v[52:53], v[52:53], v[20:21]
v_pk_fma_f32 v[54:55], v[20:21], v[20:21], v[54:55]
v_pk_add_f32 v[52:53], v[52:53], v[22:23]
v_pk_fma_f32 v[54:55], v[22:23], v[22:23], v[54:55]
v_pk_add_f32 v[52:53], v[52:53], v[24:25]
v_pk_fma_f32 v[54:55], v[24:25], v[24:25], v[54:55]
v_pk_add_f32 v[52:53], v[52:53], v[26:27]
v_pk_fma_f32 v[54:55], v[26:27], v[26:27], v[54:55]
v_pk_add_f32 v[52:53], v[52:53], v[28:29]
v_pk_fma_f32 v[54:55], v[28:29], v[28:29], v[54:55]
v_pk_add_f32 v[52:53], v[52:53], v[30:31]
v_pk_fma_f32 v[54:55], v[30:31], v[30:31], v[54:55]
v_pk_add_f32 v[52:53], v[52:53], v[32:33]
v_pk_fma_f32 v[54:55], v[32:33], v[32:33], v[54:55]
v_pk_add_f32 v[52:53], v[52:53], v[34:35]
v_pk_fma_f32 v[54:55], v[34:35], v[34:35], v[54:55]
v_add_f32 v52, v52, v53
v_add_f32 v54, v54, v55
s_mov_b64 exec, s[64:65]
buffer_store_dwordx4 v[48:51], v5, s[12:15], s34 offen sc1
s_mov_b64 exec, -1
v_permlane32_swap_b32 v52, v54
v_add_f32 v53, v52, v54
v_add_f32 v52, v52, v54
s_nop 1
v_permlane16_swap_b32 v52, v53
v_add_f32 v52, v52, v53
s_mov_b64 exec, s[64:65]
buffer_store_dword v52, v7, s[4:7], s35 offen sc1
s_mov_b64 exec, -1
s_branch Lt76
Lw79:
s_mov_b64 exec, 1
s_waitcnt vmcnt(0) lgkmcnt(0)
s_barrier
buffer_store_dword v15, v12, s[4:7], s49 offen sc1
s_mov_b64 exec, 0xffff
s_mov_b32 s57, 0
Lp81:
buffer_load_dword v15, v7, s[4:7], s23 offen offset:0 sc1
s_add_u32 s57, s57, 1
s_waitcnt vmcnt(0)
v_cmp_gt_u32 s[58:59], 6, v15
s_nop 0
s_cmp_eq_u64 s[58:59], 0
s_cbranch_scc1 Ld82
s_cmp_lt_u32 s57, 1048576
s_cbranch_scc1 Lp81
Ld82:
s_branch Lr80_d
Lw86:
s_mov_b64 exec, 1
s_waitcnt vmcnt(0) lgkmcnt(0)
s_barrier
buffer_store_dword v15, v12, s[4:7], s49 offen sc1
s_mov_b64 exec, 0xffff
s_mov_b32 s57, 0
Lp88:
buffer_load_dword v15, v7, s[4:7], s23 offen offset:0 sc1
s_add_u32 s57, s57, 1
s_waitcnt vmcnt(0)
v_cmp_gt_u32 s[58:59], 7, v15
s_nop 0
s_cmp_eq_u64 s[58:59], 0
s_cbranch_scc1 Ld89
s_cmp_lt_u32 s57, 1048576
s_cbranch_scc1 Lp88
Ld89:
s_branch Lr87_d
M_text_end:
s_endpgm
.section .rodata,"a"
.p2align 6
.amdhsa_kernel interleave_layers__sliding_block__glu_gated_geglu__prompt_kernel
  .amdhsa_next_free_vgpr 512
  .amdhsa_next_free_sgpr 102
  .amdhsa_accum_offset 256
  .amdhsa_group_segment_fixed_size 0
  .amdhsa_kernarg_size 80
  .amdhsa_user_sgpr_count 2
  .amdhsa_user_sgpr_kernarg_segment_ptr 1
  .amdhsa_system_sgpr_workgroup_id_x 1
  .amdhsa_float_denorm_mode_32 3
.end_amdhsa_kernel
```
